```python
import torch

def _softmax(x, axis=-1):
    return torch.softmax(x, dim=axis)
def _gelu(x):
    return torch.nn.functional.gelu(x, approximate="tanh")
def _silu(x):
    return torch.nn.functional.silu(x)
def _sigmoid(x):
    return torch.sigmoid(x)
def _layernorm(x, axis=-1, eps=1e-5):
    m = x.mean(dim=axis, keepdim=True)
    v = x.var(dim=axis, keepdim=True, unbiased=False)
    return (x - m) / torch.sqrt(v + eps)
def _scatter_add(tgt, idx, src, axis=0):
    return tgt.clone().index_add_(axis, idx, src)
def _segment_sum(src, seg, n):
    out = torch.zeros((n,) + src.shape[1:], dtype=src.dtype)
    return out.index_add_(0, seg, src)
def _pad(x, pw):
    flat = tuple(v for pair in reversed(pw) for v in pair)
    return torch.nn.functional.pad(x, flat)

kernel_name = 'recurrent_scan__gqa_block_cached__glu_gated_bilinear__prompt'

def setup_inputs():

    _w = (lambda a: (lambda t: t.to(torch.bfloat16) if t.is_floating_point() else t)(torch.as_tensor(a)))
    def _A_setup():
        B, Sq, D = 1, 2048, 512
        Hq, Hkv, Sk, Dh = 32, 8, 2048, 128
        assert Hq % Hkv == 0, (Hq, Hkv)
        return {
            "x": _w((lambda *s: torch.randn(*s, dtype=torch.bfloat16) * 0.05)(B, Sq, D)),
            "k_cache": _w((lambda *s: torch.randn(*s, dtype=torch.bfloat16) * 1.6)(B, Hkv, Sk, Dh)),
            "v_cache": _w((lambda *s: torch.randn(*s, dtype=torch.bfloat16) * 1.6)(B, Hkv, Sk, Dh)),
            "wq": _w((lambda *s: torch.randn(*s, dtype=torch.bfloat16) * 1.6)(D, Hq * Dh) * (D ** -0.5)),
            "wo": _w((lambda *s: torch.randn(*s, dtype=torch.bfloat16) * 1.6)(Hq * Dh, D) * ((Hq * Dh) ** -0.5)),
        }
    _A_in = _A_setup()

    def _B_setup():
        B, S, D, F = 1, 2048, 512, 1792
        return {
            "x": _w((lambda *s: torch.randn(*s, dtype=torch.bfloat16) * 0.05)(B, S, D)),
            "w_gate": _w((lambda *s: torch.randn(*s, dtype=torch.bfloat16) * 0.2)(D, F) * (D ** -0.5)),
            "w_up": _w((lambda *s: torch.randn(*s, dtype=torch.bfloat16) * 0.2)(D, F) * (D ** -0.5)),
            "w_down": _w((lambda *s: torch.randn(*s, dtype=torch.bfloat16) * 0.2)(F, D) * (F ** -0.5)),
        }
    _B_in = _B_setup()

    return {
        "A_x": _A_in["x"],
        "A_k_cache": _A_in["k_cache"],
        "A_v_cache": _A_in["v_cache"],
        "A_wq": _A_in["wq"],
        "A_wo": _A_in["wo"],
        "B_x": _B_in["x"],
        "B_w_gate": _B_in["w_gate"],
        "B_w_up": _B_in["w_up"],
        "B_w_down": _B_in["w_down"],
    }

def reference(A_x, A_k_cache, A_v_cache, A_wq, A_wo, B_x, B_w_gate, B_w_up, B_w_down):
    def _A_ref(x, k_cache, v_cache, wq, wo):
        B, Sq, D = x.shape
        Hq, Dh = 32, 128
        Hkv = k_cache.shape[1]
        rep = Hq // Hkv
        q = (lambda x, *d: x.permute(*d))((x @ wq).reshape(B, Sq, Hq, Dh), 0, 2, 1, 3)
        k = (lambda x, n, axis: torch.repeat_interleave(x, n, dim=axis))(k_cache, rep, axis=1)
        v = (lambda x, n, axis: torch.repeat_interleave(x, n, dim=axis))(v_cache, rep, axis=1)
        scores = torch.einsum("bhqd,bhkd->bhqk", q, k) * (Dh ** -0.5)
        p = _softmax(scores, axis=-1)
        o = torch.einsum("bhqk,bhkd->bhqd", p, v)
        return (lambda x, *d: x.permute(*d))(o, 0, 2, 1, 3).reshape(B, Sq, Hq * Dh) @ wo

    def _B_ref(x, w_gate, w_up, w_down):
        g = torch.einsum("bsd,df->bsf", x, w_gate)
        u = torch.einsum("bsd,df->bsf", x, w_up)
        h = g * u
        return torch.einsum("bsf,fd->bsd", h, w_down)

    x = A_x
    xn = _layernorm(x, axis=-1)
    s = _A_ref(xn, A_k_cache, A_v_cache, A_wq, A_wo)
    g = _silu(_B_ref(xn, B_w_gate, B_w_up, B_w_down))
    return x + s * g
```

```asm
; @launch grid=(256,1,1) block=(256,1,1) lds=163840
.amdgcn_target "amdgcn-amd-amdhsa--gfx950"
.text
.globl recurrent_scan__gqa_block_cached__glu_gated_bilinear__prompt_kernel
.p2align 8
.type recurrent_scan__gqa_block_cached__glu_gated_bilinear__prompt_kernel,@function
recurrent_scan__gqa_block_cached__glu_gated_bilinear__prompt_kernel:
    s_cmp_ge_u32 s2, 256
    s_cbranch_scc1 L_end
    v_lshrrev_b32 v228, 6, v0
    v_and_b32 v236, 63, v0
    s_mov_b32 s81, 0
    s_getpc_b64 s[84:85]
    v_lshlrev_b32 v229, 4, v0
    global_load_dwordx4 v[64:67], v229, s[84:85]
    v_readfirstlane_b32 s72, v228
L_restart:
    s_load_dwordx8 s[64:71], s[0:1], 64
    s_load_dwordx16 s[48:63], s[0:1], 0
    s_lshl_b32 s75, s72, 12
    v_and_b32 v228, 15, v236
    v_lshlrev_b32 v228, 10, v228
    v_lshrrev_b32 v229, 4, v236
    v_lshl_add_u32 v189, v229, 4, v228
    v_lshl_add_u32 v239, v229, 3, v228
    s_mov_b32 s95, s2
    s_and_b32 s73, s95, 3
    s_lshl_b32 s73, s73, 1
    s_bfe_u32 s76, s95, 65539
    s_or_b32 s73, s73, s76
    s_lshl_b32 s80, s76, 3
    s_bfe_u32 s74, s95, 65538
    s_lshl_b32 s74, s74, 4
    s_lshr_b32 s76, s95, 4
    s_or_b32 s74, s74, s76
    s_and_b32 s92, s74, 1
    s_add_u32 s80, s80, s74
    s_and_b32 s80, s80, 14
    s_lshl_b32 s82, s74, 16
    s_lshl_b32 s76, s72, 14
    s_add_u32 s82, s82, s76
    s_lshl_b32 s94, s80, 6
    s_waitcnt lgkmcnt(0)
    s_mov_b32 s4, s48
    s_mov_b32 s5, s49
    s_mov_b32 s6, 2097152
    s_mov_b32 s7, 0x20000
    s_or_b32 s76, s82, s94
    buffer_load_dwordx4 v[0:3], v189, s[4:7], s76 offen
    s_add_u32 s94, s94, 64
    s_and_b32 s94, s94, 1023
    s_or_b32 s76, s82, s94
    buffer_load_dwordx4 v[4:7], v189, s[4:7], s76 offen
    s_add_u32 s94, s94, 64
    s_and_b32 s94, s94, 1023
    s_or_b32 s76, s82, s94
    buffer_load_dwordx4 v[8:11], v189, s[4:7], s76 offen
    s_add_u32 s94, s94, 64
    s_and_b32 s94, s94, 1023
    s_or_b32 s76, s82, s94
    buffer_load_dwordx4 v[12:15], v189, s[4:7], s76 offen
    s_add_u32 s94, s94, 64
    s_and_b32 s94, s94, 1023
    s_barrier
    s_or_b32 s76, s82, s94
    buffer_load_dwordx4 v[16:19], v189, s[4:7], s76 offen
    s_add_u32 s94, s94, 64
    s_and_b32 s94, s94, 1023
    s_or_b32 s76, s82, s94
    buffer_load_dwordx4 v[20:23], v189, s[4:7], s76 offen
    s_add_u32 s94, s94, 64
    s_and_b32 s94, s94, 1023
    s_or_b32 s76, s82, s94
    buffer_load_dwordx4 v[24:27], v189, s[4:7], s76 offen
    s_add_u32 s94, s94, 64
    s_and_b32 s94, s94, 1023
    s_or_b32 s76, s82, s94
    buffer_load_dwordx4 v[28:31], v189, s[4:7], s76 offen
    s_add_u32 s94, s94, 64
    s_and_b32 s94, s94, 1023
    s_barrier
    v_lshrrev_b32 v229, 3, v236
    v_mul_u32_u24 v228, 3584, v229
    v_and_b32 v229, 2, v229
    v_and_b32 v230, 7, v236
    v_xor_b32 v229, v229, v230
    v_lshl_add_u32 v168, v229, 4, v228
    v_xor_b32 v230, 4, v229
    v_lshl_add_u32 v169, v230, 4, v228
    v_add_u32 v169, 27648, v169
    v_lshl_add_u32 v170, v229, 4, v228
    v_add_u32 v170, 55296, v170
    v_xor_b32 v230, 4, v229
    v_lshl_add_u32 v171, v230, 4, v228
    v_add_u32 v171, 82944, v171
    v_lshrrev_b32 v229, 3, v236
    v_mul_u32_u24 v228, 8192, v229
    v_and_b32 v229, 2, v229
    v_and_b32 v230, 7, v236
    v_xor_b32 v229, v229, v230
    v_lshl_add_u32 v172, v229, 4, v228
    v_xor_b32 v230, 4, v229
    v_lshl_add_u32 v173, v230, 4, v228
    v_add_u32 v173, 64512, v173
    v_lshl_add_u32 v174, v229, 4, v228
    v_add_u32 v174, 129024, v174
    v_xor_b32 v230, 4, v229
    v_lshl_add_u32 v175, v230, 4, v228
    v_add_u32 v175, 193536, v175
    v_bfe_u32 v228, v236, 3, 2
    v_lshrrev_b32 v229, 4, v236
    v_bfe_u32 v230, v236, 2, 2
    v_lshl_add_u32 v229, v229, 3, v230
    v_and_b32 v230, 3, v236
    v_lshl_add_u32 v229, v229, 4, v230
    v_lshl_add_u32 v229, v229, 3, s75
    v_add_u32 v229, 65536, v229
    v_xor_b32 v230, 0, v228
    v_lshl_add_u32 v160, v230, 5, v229
    v_add_u32 v164, 65536, v160
    v_xor_b32 v230, 1, v228
    v_lshl_add_u32 v161, v230, 5, v229
    v_add_u32 v165, 65536, v161
    v_xor_b32 v230, 2, v228
    v_lshl_add_u32 v162, v230, 5, v229
    v_add_u32 v166, 65536, v162
    v_xor_b32 v230, 3, v228
    v_lshl_add_u32 v163, v230, 5, v229
    v_add_u32 v167, 65536, v163
    v_and_b32 v228, 15, v236
    v_lshrrev_b32 v229, 4, v236
    v_xor_b32 v229, v229, v228
    v_and_b32 v230, 12, v228
    v_add_u32 v230, v230, v228
    v_lshlrev_b32 v230, 8, v230
    v_add_u32 v230, 98304, v230
    v_xor_b32 v231, 0, v229
    v_lshl_add_u32 v212, v231, 4, v230
    v_xor_b32 v231, 4, v229
    v_lshl_add_u32 v213, v231, 4, v230
    v_xor_b32 v231, 8, v229
    v_lshl_add_u32 v214, v231, 4, v230
    v_xor_b32 v231, 12, v229
    v_lshl_add_u32 v215, v231, 4, v230
    v_lshrrev_b32 v228, 2, v236
    v_and_b32 v228, 7, v228
    v_lshrrev_b32 v229, 4, v236
    v_and_b32 v230, 3, v228
    v_lshl_add_u32 v229, v229, 3, v230
    v_lshlrev_b32 v229, 8, v229
    v_and_b32 v230, 3, v236
    v_lshl_add_u32 v229, v230, 3, v229
    v_add_u32 v229, 32768, v229
    v_xor_b32 v230, 0, v228
    v_lshl_add_u32 v216, v230, 5, v229
    v_xor_b32 v230, 1, v228
    v_lshl_add_u32 v217, v230, 5, v229
    v_xor_b32 v230, 2, v228
    v_lshl_add_u32 v218, v230, 5, v229
    v_xor_b32 v230, 3, v228
    v_lshl_add_u32 v219, v230, 5, v229
    v_xor_b32 v230, 4, v228
    v_lshl_add_u32 v220, v230, 5, v229
    v_xor_b32 v230, 5, v228
    v_lshl_add_u32 v221, v230, 5, v229
    v_xor_b32 v230, 6, v228
    v_lshl_add_u32 v222, v230, 5, v229
    v_xor_b32 v230, 7, v228
    v_lshl_add_u32 v223, v230, 5, v229
    v_lshrrev_b32 v228, 4, v236
    s_lshl_b32 s76, s72, 12
    v_lshl_add_u32 v229, v228, 8, s76
    v_and_b32 v230, 15, v236
    v_xor_b32 v231, v230, v228
    s_lshl_b32 s76, s72, 3
    s_and_b32 s76, s76, 8
    v_xor_b32 v231, s76, v231
    v_lshl_add_u32 v224, v231, 4, v229
    v_xor_b32 v231, 4, v231
    v_lshl_add_u32 v225, v231, 4, v229
    v_lshlrev_b32 v231, 1, v228
    v_xor_b32 v231, v231, v230
    v_lshl_add_u32 v226, v231, 4, v229
    v_xor_b32 v231, 8, v231
    v_lshl_add_u32 v227, v231, 4, v229
    v_bfe_u32 v228, v236, 3, 2
    v_lshrrev_b32 v229, 4, v236
    v_bfe_u32 v230, v236, 2, 2
    v_lshl_add_u32 v229, v229, 2, v230
    v_and_b32 v230, 3, v236
    v_lshl_add_u32 v229, v229, 4, v230
    v_lshl_add_u32 v229, v229, 3, s75
    v_add_u32 v229, 65536, v229
    v_xor_b32 v230, 0, v228
    v_lshl_add_u32 v244, v230, 5, v229
    v_add_u32 v248, 65536, v244
    v_xor_b32 v230, 1, v228
    v_lshl_add_u32 v245, v230, 5, v229
    v_add_u32 v249, 65536, v245
    v_xor_b32 v230, 2, v228
    v_lshl_add_u32 v246, v230, 5, v229
    v_add_u32 v250, 65536, v246
    v_xor_b32 v230, 3, v228
    v_lshl_add_u32 v247, v230, 5, v229
    v_add_u32 v251, 65536, v247
    v_lshrrev_b32 v229, 3, v236
    v_mul_u32_u24 v228, 1024, v229
    v_and_b32 v229, 6, v229
    v_and_b32 v230, 7, v236
    v_xor_b32 v229, v229, v230
    v_lshl_add_u32 v240, v229, 4, v228
    v_lshl_add_u32 v241, v229, 4, v228
    v_add_u32 v241, 7168, v241
    v_lshl_add_u32 v242, v229, 4, v228
    v_add_u32 v242, 14336, v242
    v_lshl_add_u32 v243, v229, 4, v228
    v_add_u32 v243, 21504, v243
    v_lshlrev_b32 v237, 4, v236
    v_mov_b32 v176, 0x3f803f80
    v_mov_b32 v177, 0x3f803f80
    v_mov_b32 v178, 0x3f803f80
    v_mov_b32 v179, 0x3f803f80
    s_lshl_b32 s76, s72, 10
    v_add_u32 v188, s76, v237
    v_mov_b32 v252, 0
    s_lshl_b32 s76, s92, 7
    v_xor_b32 v212, s76, v212
    v_xor_b32 v213, s76, v213
    v_xor_b32 v214, s76, v214
    v_xor_b32 v215, s76, v215
    s_cmp_eq_u32 s73, 7
    s_cselect_b32 s93, 1, s81
    s_cmp_eq_u32 s92, 0
    s_cselect_b64 s[24:25], s[60:61], s[62:63]
    s_cselect_b64 s[28:29], s[62:63], s[60:61]
    s_mov_b32 s26, 1835008
    s_mov_b32 s27, 0x20000
    s_mov_b32 s30, 1835008
    s_mov_b32 s31, 0x20000
    s_lshl_b32 s76, s73, 19
    s_mov_b32 s16, s54
    s_mov_b32 s17, s55
    s_mov_b32 s18, 4194304
    s_mov_b32 s19, 0x20000
    s_add_u32 s8, s50, s76
    s_addc_u32 s9, s51, 0
    s_mov_b32 s10, 524288
    s_mov_b32 s11, 0x20000
    s_add_u32 s12, s52, s76
    s_addc_u32 s13, s53, 0
    s_mov_b32 s14, 524288
    s_mov_b32 s15, 0x20000
    s_add_u32 s20, s56, s76
    s_addc_u32 s21, s57, 0
    s_mov_b32 s22, 524288
    s_mov_b32 s23, 0x20000
    s_mov_b32 s32, s64
    s_mov_b32 s33, s65
    s_mov_b32 s34, 1835008
    s_mov_b32 s35, 0x20000
    s_mov_b64 s[88:89], s[66:67]
    s_mov_b32 s44, s68
    s_mov_b32 s45, s69
    s_mov_b32 s46, 256
    s_mov_b32 s47, 0x20000
    s_mov_b32 s40, s70
    s_mov_b32 s41, s71
    s_mov_b32 s42, 268435456
    s_mov_b32 s43, 0x20000
    s_lshl_b32 s49, s73, 9
    s_lshl_b32 s76, s72, 7
    s_add_u32 s49, s49, s76
    s_add_u32 s50, s49, 1835008
    s_mul_i32 s48, s80, 114688
    s_add_u32 s48, s48, s49
    s_lshl_b32 s51, s73, 2
    s_add_u32 s51, s51, s72
    s_lshl_b32 s51, s51, 1
    s_add_u32 s51, s51, s92
    s_lshl_b32 s51, s51, 7
    s_lshl_b32 s76, s80, 18
    s_add_u32 s51, s51, s76
    s_mul_i32 s56, s74, 229376
    s_lshl_b32 s76, s73, 15
    s_add_u32 s56, s56, s76
    s_cmp_eq_u32 s93, 0
    s_cselect_b32 s56, s56, 7340032
    s_lshl_b32 s76, s72, 13
    s_add_u32 s56, s56, s76
    s_lshl_b32 s83, s74, 2
    s_add_u32 s83, s83, s72
    s_lshl_b32 s83, s83, 3
    s_add_u32 s83, s83, s73
    s_lshl_b32 s83, s83, 2
    s_add_u32 s83, s83, 33554432
    s_lshr_b32 s96, s74, 2
    s_lshl_b32 s96, s96, 3
    s_and_b32 s76, s74, 3
    s_add_u32 s96, s96, s76
    s_lshl_b32 s96, s96, 2
    v_and_b32 v228, 3, v236
    v_cmp_eq_u32 s[62:63], 1, v228
    v_cmp_eq_u32 s[64:65], 2, v228
    v_cmp_eq_u32 s[66:67], 3, v228
    v_bfe_u32 v228, v236, 2, 2
    v_lshrrev_b32 v229, 4, v236
    v_cmp_eq_u32 s[60:61], v228, v229
    s_cmp_eq_u32 s93, 0
    s_cselect_b64 s[36:37], s[24:25], s[16:17]
    s_cselect_b32 s38, s26, s18
    s_mov_b32 s39, 0x20000
    s_cselect_b32 s52, s48, s51
    s_mov_b32 s55, 114688
    s_cselect_b32 s55, s55, 262144
    s_cselect_b32 s57, 0, 32768
    s_cselect_b64 vcc, -1, 0
    s_and_b32 s76, s51, 8191
    s_cmp_eq_u32 s93, 0
    s_cselect_b32 s53, s49, s76
    s_lshl_b32 s54, s55, 4
    s_add_u32 s54, s54, s53
    s_add_u32 s57, s57, s75
    v_cndmask_b32 v232, v172, v168, vcc
    v_cndmask_b32 v233, v173, v169, vcc
    v_cndmask_b32 v234, v174, v170, vcc
    v_cndmask_b32 v235, v175, v171, vcc
    s_or_b32 s76, s82, s94
    buffer_load_dwordx4 v[32:35], v189, s[4:7], s76 offen
    s_add_u32 s94, s94, 64
    s_and_b32 s94, s94, 1023
    s_or_b32 s76, s82, s94
    buffer_load_dwordx4 v[36:39], v189, s[4:7], s76 offen
    s_add_u32 s94, s94, 64
    s_and_b32 s94, s94, 1023
    s_barrier
    s_or_b32 s76, s82, s94
    buffer_load_dwordx4 v[40:43], v189, s[4:7], s76 offen
    s_add_u32 s94, s94, 64
    s_and_b32 s94, s94, 1023
    s_or_b32 s76, s82, s94
    buffer_load_dwordx4 v[44:47], v189, s[4:7], s76 offen
    s_add_u32 s94, s94, 64
    s_and_b32 s94, s94, 1023
    s_barrier
    s_or_b32 s76, s82, s94
    buffer_load_dwordx4 v[48:51], v189, s[4:7], s76 offen
    s_add_u32 s94, s94, 64
    s_and_b32 s94, s94, 1023
    s_or_b32 s76, s82, s94
    buffer_load_dwordx4 v[52:55], v189, s[4:7], s76 offen
    s_add_u32 s94, s94, 64
    s_and_b32 s94, s94, 1023
    s_barrier
    s_or_b32 s76, s82, s94
    buffer_load_dwordx4 v[56:59], v189, s[4:7], s76 offen
    s_add_u32 s94, s94, 64
    s_and_b32 s94, s94, 1023
    s_or_b32 s76, s82, s94
    buffer_load_dwordx4 v[60:63], v189, s[4:7], s76 offen
    s_mov_b64 exec, 1
    buffer_store_dword v252, off, s[40:43], s83 sc1
    s_mov_b64 exec, -1
    s_getpc_b64 s[84:85]
L_pc:
    s_and_b32 s76, s74, 7
    s_lshl_b32 s76, s76, 2
    s_add_u32 s76, s76, s72
    s_lshl_b32 s76, s76, 12
    v_lshl_add_u32 v228, v236, 6, s76
    v_min_u32 v228, L_end-L_pc, v228
    global_load_dword v253, v228, s[84:85]
    s_waitcnt vmcnt(17)
    v_mfma_f32_16x16x32_bf16 v[180:183], v[176:179], v[0:3], 0
    v_mfma_f32_16x16x32_bf16 v[184:187], v[0:3], v[0:3], 0
    v_lshlrev_b32 v64, 16, v0
    v_and_b32 v65, 0xffff0000, v0
    v_lshlrev_b32 v66, 16, v1
    v_and_b32 v67, 0xffff0000, v1
    v_lshlrev_b32 v68, 16, v2
    v_and_b32 v69, 0xffff0000, v2
    v_lshlrev_b32 v70, 16, v3
    v_and_b32 v71, 0xffff0000, v3
    s_waitcnt vmcnt(16)
    v_mfma_f32_16x16x32_bf16 v[180:183], v[176:179], v[4:7], v[180:183]
    v_mfma_f32_16x16x32_bf16 v[184:187], v[4:7], v[4:7], v[184:187]
    v_lshlrev_b32 v72, 16, v4
    v_and_b32 v73, 0xffff0000, v4
    v_lshlrev_b32 v74, 16, v5
    v_and_b32 v75, 0xffff0000, v5
    v_lshlrev_b32 v76, 16, v6
    v_and_b32 v77, 0xffff0000, v6
    v_lshlrev_b32 v78, 16, v7
    v_and_b32 v79, 0xffff0000, v7
    s_add_u32 m0, s57, 65536
    s_nop 0
    buffer_load_dwordx4 v232, s[36:39], s52 offen lds
    s_waitcnt vmcnt(16)
    v_mfma_f32_16x16x32_bf16 v[180:183], v[176:179], v[8:11], v[180:183]
    v_mfma_f32_16x16x32_bf16 v[184:187], v[8:11], v[8:11], v[184:187]
    v_lshlrev_b32 v80, 16, v8
    v_and_b32 v81, 0xffff0000, v8
    v_lshlrev_b32 v82, 16, v9
    v_and_b32 v83, 0xffff0000, v9
    v_lshlrev_b32 v84, 16, v10
    v_and_b32 v85, 0xffff0000, v10
    v_lshlrev_b32 v86, 16, v11
    v_and_b32 v87, 0xffff0000, v11
    s_waitcnt vmcnt(15)
    v_mfma_f32_16x16x32_bf16 v[180:183], v[176:179], v[12:15], v[180:183]
    v_mfma_f32_16x16x32_bf16 v[184:187], v[12:15], v[12:15], v[184:187]
    v_lshlrev_b32 v88, 16, v12
    v_and_b32 v89, 0xffff0000, v12
    v_lshlrev_b32 v90, 16, v13
    v_and_b32 v91, 0xffff0000, v13
    v_lshlrev_b32 v92, 16, v14
    v_and_b32 v93, 0xffff0000, v14
    v_lshlrev_b32 v94, 16, v15
    v_and_b32 v95, 0xffff0000, v15
    buffer_load_dwordx4 v233, s[36:39], s52 offen offset:1024 lds
    s_waitcnt vmcnt(15)
    v_mfma_f32_16x16x32_bf16 v[180:183], v[176:179], v[16:19], v[180:183]
    v_mfma_f32_16x16x32_bf16 v[184:187], v[16:19], v[16:19], v[184:187]
    v_lshlrev_b32 v96, 16, v16
    v_and_b32 v97, 0xffff0000, v16
    v_lshlrev_b32 v98, 16, v17
    v_and_b32 v99, 0xffff0000, v17
    v_lshlrev_b32 v100, 16, v18
    v_and_b32 v101, 0xffff0000, v18
    v_lshlrev_b32 v102, 16, v19
    v_and_b32 v103, 0xffff0000, v19
    s_waitcnt vmcnt(14)
    v_mfma_f32_16x16x32_bf16 v[180:183], v[176:179], v[20:23], v[180:183]
    v_mfma_f32_16x16x32_bf16 v[184:187], v[20:23], v[20:23], v[184:187]
    v_lshlrev_b32 v104, 16, v20
    v_and_b32 v105, 0xffff0000, v20
    v_lshlrev_b32 v106, 16, v21
    v_and_b32 v107, 0xffff0000, v21
    v_lshlrev_b32 v108, 16, v22
    v_and_b32 v109, 0xffff0000, v22
    v_lshlrev_b32 v110, 16, v23
    v_and_b32 v111, 0xffff0000, v23
    buffer_load_dwordx4 v234, s[36:39], s52 offen offset:2048 lds
    s_waitcnt vmcnt(14)
    v_mfma_f32_16x16x32_bf16 v[180:183], v[176:179], v[24:27], v[180:183]
    v_mfma_f32_16x16x32_bf16 v[184:187], v[24:27], v[24:27], v[184:187]
    v_lshlrev_b32 v112, 16, v24
    v_and_b32 v113, 0xffff0000, v24
    v_lshlrev_b32 v114, 16, v25
    v_and_b32 v115, 0xffff0000, v25
    v_lshlrev_b32 v116, 16, v26
    v_and_b32 v117, 0xffff0000, v26
    v_lshlrev_b32 v118, 16, v27
    v_and_b32 v119, 0xffff0000, v27
    s_waitcnt vmcnt(13)
    v_mfma_f32_16x16x32_bf16 v[180:183], v[176:179], v[28:31], v[180:183]
    v_mfma_f32_16x16x32_bf16 v[184:187], v[28:31], v[28:31], v[184:187]
    v_lshlrev_b32 v120, 16, v28
    v_and_b32 v121, 0xffff0000, v28
    v_lshlrev_b32 v122, 16, v29
    v_and_b32 v123, 0xffff0000, v29
    v_lshlrev_b32 v124, 16, v30
    v_and_b32 v125, 0xffff0000, v30
    v_lshlrev_b32 v126, 16, v31
    v_and_b32 v127, 0xffff0000, v31
    buffer_load_dwordx4 v235, s[36:39], s52 offen offset:3072 lds
    s_waitcnt vmcnt(13)
    v_mfma_f32_16x16x32_bf16 v[180:183], v[176:179], v[32:35], v[180:183]
    v_mfma_f32_16x16x32_bf16 v[184:187], v[32:35], v[32:35], v[184:187]
    v_lshlrev_b32 v128, 16, v32
    v_and_b32 v129, 0xffff0000, v32
    v_lshlrev_b32 v130, 16, v33
    v_and_b32 v131, 0xffff0000, v33
    v_lshlrev_b32 v132, 16, v34
    v_and_b32 v133, 0xffff0000, v34
    v_lshlrev_b32 v134, 16, v35
    v_and_b32 v135, 0xffff0000, v35
    s_waitcnt vmcnt(12)
    v_mfma_f32_16x16x32_bf16 v[180:183], v[176:179], v[36:39], v[180:183]
    v_mfma_f32_16x16x32_bf16 v[184:187], v[36:39], v[36:39], v[184:187]
    v_lshlrev_b32 v136, 16, v36
    v_and_b32 v137, 0xffff0000, v36
    v_lshlrev_b32 v138, 16, v37
    v_and_b32 v139, 0xffff0000, v37
    v_lshlrev_b32 v140, 16, v38
    v_and_b32 v141, 0xffff0000, v38
    v_lshlrev_b32 v142, 16, v39
    v_and_b32 v143, 0xffff0000, v39
    s_add_u32 s52, s52, s55
    s_cmp_lt_u32 s52, s54
    s_cselect_b32 s52, s52, s53
    s_add_u32 m0, s57, 81920
    s_nop 0
    buffer_load_dwordx4 v232, s[36:39], s52 offen lds
    s_waitcnt vmcnt(12)
    v_mfma_f32_16x16x32_bf16 v[180:183], v[176:179], v[40:43], v[180:183]
    v_mfma_f32_16x16x32_bf16 v[184:187], v[40:43], v[40:43], v[184:187]
    v_lshlrev_b32 v144, 16, v40
    v_and_b32 v145, 0xffff0000, v40
    v_lshlrev_b32 v146, 16, v41
    v_and_b32 v147, 0xffff0000, v41
    v_lshlrev_b32 v148, 16, v42
    v_and_b32 v149, 0xffff0000, v42
    v_lshlrev_b32 v150, 16, v43
    v_and_b32 v151, 0xffff0000, v43
    s_waitcnt vmcnt(11)
    v_mfma_f32_16x16x32_bf16 v[180:183], v[176:179], v[44:47], v[180:183]
    v_mfma_f32_16x16x32_bf16 v[184:187], v[44:47], v[44:47], v[184:187]
    v_lshlrev_b32 v152, 16, v44
    v_and_b32 v153, 0xffff0000, v44
    v_lshlrev_b32 v154, 16, v45
    v_and_b32 v155, 0xffff0000, v45
    v_lshlrev_b32 v156, 16, v46
    v_and_b32 v157, 0xffff0000, v46
    v_lshlrev_b32 v158, 16, v47
    v_and_b32 v159, 0xffff0000, v47
    buffer_load_dwordx4 v233, s[36:39], s52 offen offset:1024 lds
    s_waitcnt vmcnt(11)
    v_mfma_f32_16x16x32_bf16 v[180:183], v[176:179], v[48:51], v[180:183]
    v_mfma_f32_16x16x32_bf16 v[184:187], v[48:51], v[48:51], v[184:187]
    v_lshlrev_b32 v192, 16, v48
    v_and_b32 v193, 0xffff0000, v48
    v_lshlrev_b32 v194, 16, v49
    v_and_b32 v195, 0xffff0000, v49
    v_lshlrev_b32 v196, 16, v50
    v_and_b32 v197, 0xffff0000, v50
    v_lshlrev_b32 v198, 16, v51
    v_and_b32 v199, 0xffff0000, v51
    s_waitcnt vmcnt(10)
    v_mfma_f32_16x16x32_bf16 v[180:183], v[176:179], v[52:55], v[180:183]
    v_mfma_f32_16x16x32_bf16 v[184:187], v[52:55], v[52:55], v[184:187]
    v_lshlrev_b32 v200, 16, v52
    v_and_b32 v201, 0xffff0000, v52
    v_lshlrev_b32 v202, 16, v53
    v_and_b32 v203, 0xffff0000, v53
    v_lshlrev_b32 v204, 16, v54
    v_and_b32 v205, 0xffff0000, v54
    v_lshlrev_b32 v206, 16, v55
    v_and_b32 v207, 0xffff0000, v55
    buffer_load_dwordx4 v234, s[36:39], s52 offen offset:2048 lds
    s_waitcnt vmcnt(10)
    v_mfma_f32_16x16x32_bf16 v[180:183], v[176:179], v[56:59], v[180:183]
    v_mfma_f32_16x16x32_bf16 v[184:187], v[56:59], v[56:59], v[184:187]
    s_waitcnt vmcnt(9)
    v_mfma_f32_16x16x32_bf16 v[180:183], v[176:179], v[60:63], v[180:183]
    v_mfma_f32_16x16x32_bf16 v[184:187], v[60:63], v[60:63], v[184:187]
    buffer_load_dwordx4 v235, s[36:39], s52 offen offset:3072 lds
    s_nop 7
    v_cndmask_b32 v230, v184, v185, s[62:63]
    v_cndmask_b32 v230, v230, v186, s[64:65]
    v_cndmask_b32 v230, v230, v187, s[66:67]
    v_cndmask_b32 v230, 0, v230, s[60:61]
    v_mul_f32 v229, 0x3b000000, v180
    v_mov_b32 v231, v230
    s_nop 1
    v_permlane32_swap_b32 v231, v230
    v_add_f32 v230, v231, v230
    v_mov_b32 v231, v230
    s_nop 1
    v_permlane16_swap_b32 v231, v230
    v_add_f32 v230, v231, v230
    v_mul_f32 v231, v229, v229
    s_mov_b32 s76, 0x3b000000
    v_fma_f32 v230, v230, s76, -v231
    v_max_f32 v230, 0, v230
    v_add_f32 v230, 0x3727c5ac, v230
    v_rsq_f32 v230, v230
    s_nop 0
    v_mul_f32 v176, 0x3e0293ee, v230
    v_mul_f32 v177, 0x3e0293ee, v230
    v_mul_f32 v178, v176, -v229
    v_mul_f32 v179, v176, -v229
    v_pk_fma_f32 v[64:65], v[64:65], v[176:177], v[178:179]
    v_pk_fma_f32 v[66:67], v[66:67], v[176:177], v[178:179]
    v_pk_fma_f32 v[68:69], v[68:69], v[176:177], v[178:179]
    v_pk_fma_f32 v[70:71], v[70:71], v[176:177], v[178:179]
    v_cvt_pk_bf16_f32 v0, v64, v65
    v_cvt_pk_bf16_f32 v1, v66, v67
    v_cvt_pk_bf16_f32 v2, v68, v69
    v_cvt_pk_bf16_f32 v3, v70, v71
    ds_write_b128 v188, v[0:3] offset:0
    v_pk_fma_f32 v[72:73], v[72:73], v[176:177], v[178:179]
    v_pk_fma_f32 v[74:75], v[74:75], v[176:177], v[178:179]
    v_pk_fma_f32 v[76:77], v[76:77], v[176:177], v[178:179]
    v_pk_fma_f32 v[78:79], v[78:79], v[176:177], v[178:179]
    v_cvt_pk_bf16_f32 v4, v72, v73
    v_cvt_pk_bf16_f32 v5, v74, v75
    v_cvt_pk_bf16_f32 v6, v76, v77
    v_cvt_pk_bf16_f32 v7, v78, v79
    ds_write_b128 v188, v[4:7] offset:4096
    v_pk_fma_f32 v[80:81], v[80:81], v[176:177], v[178:179]
    v_pk_fma_f32 v[82:83], v[82:83], v[176:177], v[178:179]
    v_pk_fma_f32 v[84:85], v[84:85], v[176:177], v[178:179]
    v_pk_fma_f32 v[86:87], v[86:87], v[176:177], v[178:179]
    v_cvt_pk_bf16_f32 v8, v80, v81
    v_cvt_pk_bf16_f32 v9, v82, v83
    v_cvt_pk_bf16_f32 v10, v84, v85
    v_cvt_pk_bf16_f32 v11, v86, v87
    ds_write_b128 v188, v[8:11] offset:8192
    v_pk_fma_f32 v[88:89], v[88:89], v[176:177], v[178:179]
    v_pk_fma_f32 v[90:91], v[90:91], v[176:177], v[178:179]
    v_pk_fma_f32 v[92:93], v[92:93], v[176:177], v[178:179]
    v_pk_fma_f32 v[94:95], v[94:95], v[176:177], v[178:179]
    v_cvt_pk_bf16_f32 v12, v88, v89
    v_cvt_pk_bf16_f32 v13, v90, v91
    v_cvt_pk_bf16_f32 v14, v92, v93
    v_cvt_pk_bf16_f32 v15, v94, v95
    ds_write_b128 v188, v[12:15] offset:12288
    v_pk_fma_f32 v[96:97], v[96:97], v[176:177], v[178:179]
    v_pk_fma_f32 v[98:99], v[98:99], v[176:177], v[178:179]
    v_pk_fma_f32 v[100:101], v[100:101], v[176:177], v[178:179]
    v_pk_fma_f32 v[102:103], v[102:103], v[176:177], v[178:179]
    v_cvt_pk_bf16_f32 v16, v96, v97
    v_cvt_pk_bf16_f32 v17, v98, v99
    v_cvt_pk_bf16_f32 v18, v100, v101
    v_cvt_pk_bf16_f32 v19, v102, v103
    ds_write_b128 v188, v[16:19] offset:16384
    v_pk_fma_f32 v[104:105], v[104:105], v[176:177], v[178:179]
    v_pk_fma_f32 v[106:107], v[106:107], v[176:177], v[178:179]
    v_pk_fma_f32 v[108:109], v[108:109], v[176:177], v[178:179]
    v_pk_fma_f32 v[110:111], v[110:111], v[176:177], v[178:179]
    v_cvt_pk_bf16_f32 v20, v104, v105
    v_cvt_pk_bf16_f32 v21, v106, v107
    v_cvt_pk_bf16_f32 v22, v108, v109
    v_cvt_pk_bf16_f32 v23, v110, v111
    ds_write_b128 v188, v[20:23] offset:20480
    v_pk_fma_f32 v[112:113], v[112:113], v[176:177], v[178:179]
    v_pk_fma_f32 v[114:115], v[114:115], v[176:177], v[178:179]
    v_pk_fma_f32 v[116:117], v[116:117], v[176:177], v[178:179]
    v_pk_fma_f32 v[118:119], v[118:119], v[176:177], v[178:179]
    v_cvt_pk_bf16_f32 v24, v112, v113
    v_cvt_pk_bf16_f32 v25, v114, v115
    v_cvt_pk_bf16_f32 v26, v116, v117
    v_cvt_pk_bf16_f32 v27, v118, v119
    ds_write_b128 v188, v[24:27] offset:24576
    v_pk_fma_f32 v[120:121], v[120:121], v[176:177], v[178:179]
    v_pk_fma_f32 v[122:123], v[122:123], v[176:177], v[178:179]
    v_pk_fma_f32 v[124:125], v[124:125], v[176:177], v[178:179]
    v_pk_fma_f32 v[126:127], v[126:127], v[176:177], v[178:179]
    v_cvt_pk_bf16_f32 v28, v120, v121
    v_cvt_pk_bf16_f32 v29, v122, v123
    v_cvt_pk_bf16_f32 v30, v124, v125
    v_cvt_pk_bf16_f32 v31, v126, v127
    ds_write_b128 v188, v[28:31] offset:28672
    v_pk_fma_f32 v[128:129], v[128:129], v[176:177], v[178:179]
    v_pk_fma_f32 v[130:131], v[130:131], v[176:177], v[178:179]
    v_pk_fma_f32 v[132:133], v[132:133], v[176:177], v[178:179]
    v_pk_fma_f32 v[134:135], v[134:135], v[176:177], v[178:179]
    v_cvt_pk_bf16_f32 v32, v128, v129
    v_cvt_pk_bf16_f32 v33, v130, v131
    v_cvt_pk_bf16_f32 v34, v132, v133
    v_cvt_pk_bf16_f32 v35, v134, v135
    s_add_u32 s52, s52, s55
    s_cmp_lt_u32 s52, s54
    s_cselect_b32 s52, s52, s53
    s_add_u32 m0, s57, 98304
    s_nop 0
    buffer_load_dwordx4 v232, s[36:39], s52 offen lds
    ds_write_b128 v188, v[32:35] offset:32768
    v_pk_fma_f32 v[136:137], v[136:137], v[176:177], v[178:179]
    v_pk_fma_f32 v[138:139], v[138:139], v[176:177], v[178:179]
    v_pk_fma_f32 v[140:141], v[140:141], v[176:177], v[178:179]
    v_pk_fma_f32 v[142:143], v[142:143], v[176:177], v[178:179]
    v_cvt_pk_bf16_f32 v36, v136, v137
    v_cvt_pk_bf16_f32 v37, v138, v139
    v_cvt_pk_bf16_f32 v38, v140, v141
    v_cvt_pk_bf16_f32 v39, v142, v143
    ds_write_b128 v188, v[36:39] offset:36864
    v_pk_fma_f32 v[144:145], v[144:145], v[176:177], v[178:179]
    v_pk_fma_f32 v[146:147], v[146:147], v[176:177], v[178:179]
    v_pk_fma_f32 v[148:149], v[148:149], v[176:177], v[178:179]
    v_pk_fma_f32 v[150:151], v[150:151], v[176:177], v[178:179]
    v_cvt_pk_bf16_f32 v40, v144, v145
    v_cvt_pk_bf16_f32 v41, v146, v147
    v_cvt_pk_bf16_f32 v42, v148, v149
    v_cvt_pk_bf16_f32 v43, v150, v151
    buffer_load_dwordx4 v233, s[36:39], s52 offen offset:1024 lds
    ds_write_b128 v188, v[40:43] offset:40960
    v_pk_fma_f32 v[152:153], v[152:153], v[176:177], v[178:179]
    v_pk_fma_f32 v[154:155], v[154:155], v[176:177], v[178:179]
    v_pk_fma_f32 v[156:157], v[156:157], v[176:177], v[178:179]
    v_pk_fma_f32 v[158:159], v[158:159], v[176:177], v[178:179]
    v_cvt_pk_bf16_f32 v44, v152, v153
    v_cvt_pk_bf16_f32 v45, v154, v155
    v_cvt_pk_bf16_f32 v46, v156, v157
    v_cvt_pk_bf16_f32 v47, v158, v159
    ds_write_b128 v188, v[44:47] offset:45056
    v_pk_fma_f32 v[192:193], v[192:193], v[176:177], v[178:179]
    v_pk_fma_f32 v[194:195], v[194:195], v[176:177], v[178:179]
    v_pk_fma_f32 v[196:197], v[196:197], v[176:177], v[178:179]
    v_pk_fma_f32 v[198:199], v[198:199], v[176:177], v[178:179]
    v_cvt_pk_bf16_f32 v48, v192, v193
    v_cvt_pk_bf16_f32 v49, v194, v195
    v_cvt_pk_bf16_f32 v50, v196, v197
    v_cvt_pk_bf16_f32 v51, v198, v199
    buffer_load_dwordx4 v234, s[36:39], s52 offen offset:2048 lds
    ds_write_b128 v188, v[48:51] offset:49152
    v_pk_fma_f32 v[200:201], v[200:201], v[176:177], v[178:179]
    v_pk_fma_f32 v[202:203], v[202:203], v[176:177], v[178:179]
    v_pk_fma_f32 v[204:205], v[204:205], v[176:177], v[178:179]
    v_pk_fma_f32 v[206:207], v[206:207], v[176:177], v[178:179]
    v_cvt_pk_bf16_f32 v52, v200, v201
    v_cvt_pk_bf16_f32 v53, v202, v203
    v_cvt_pk_bf16_f32 v54, v204, v205
    v_cvt_pk_bf16_f32 v55, v206, v207
    v_lshlrev_b32 v64, 16, v56
    v_and_b32 v65, 0xffff0000, v56
    v_lshlrev_b32 v66, 16, v57
    v_and_b32 v67, 0xffff0000, v57
    v_lshlrev_b32 v68, 16, v58
    v_and_b32 v69, 0xffff0000, v58
    v_lshlrev_b32 v70, 16, v59
    v_and_b32 v71, 0xffff0000, v59
    ds_write_b128 v188, v[52:55] offset:53248
    v_pk_fma_f32 v[64:65], v[64:65], v[176:177], v[178:179]
    v_pk_fma_f32 v[66:67], v[66:67], v[176:177], v[178:179]
    v_pk_fma_f32 v[68:69], v[68:69], v[176:177], v[178:179]
    v_pk_fma_f32 v[70:71], v[70:71], v[176:177], v[178:179]
    v_cvt_pk_bf16_f32 v56, v64, v65
    v_cvt_pk_bf16_f32 v57, v66, v67
    v_cvt_pk_bf16_f32 v58, v68, v69
    v_cvt_pk_bf16_f32 v59, v70, v71
    s_waitcnt lgkmcnt(8)
    buffer_load_dwordx4 v235, s[36:39], s52 offen offset:3072 lds
    v_lshlrev_b32 v72, 16, v60
    v_and_b32 v73, 0xffff0000, v60
    v_lshlrev_b32 v74, 16, v61
    v_and_b32 v75, 0xffff0000, v61
    v_lshlrev_b32 v76, 16, v62
    v_and_b32 v77, 0xffff0000, v62
    v_lshlrev_b32 v78, 16, v63
    v_and_b32 v79, 0xffff0000, v63
    ds_write_b128 v188, v[56:59] offset:57344
    v_pk_fma_f32 v[72:73], v[72:73], v[176:177], v[178:179]
    v_pk_fma_f32 v[74:75], v[74:75], v[176:177], v[178:179]
    v_pk_fma_f32 v[76:77], v[76:77], v[176:177], v[178:179]
    v_pk_fma_f32 v[78:79], v[78:79], v[176:177], v[178:179]
    v_cvt_pk_bf16_f32 v60, v72, v73
    v_cvt_pk_bf16_f32 v61, v74, v75
    v_cvt_pk_bf16_f32 v62, v76, v77
    v_cvt_pk_bf16_f32 v63, v78, v79
    ds_write_b128 v188, v[60:63] offset:61440
    s_cmp_eq_u32 s93, 0
    s_cselect_b32 s48, s52, s48
    s_cselect_b32 s51, s51, s52
    s_mov_b32 s36, s88
    s_mov_b32 s37, s89
    s_mov_b32 s38, 2097152
    s_mov_b32 s39, 0x20000
    s_cmp_lg_u32 s93, 0
    s_cbranch_scc1 L_skipG
    s_waitcnt vmcnt(8)
    ds_read_b64_tr_b16 v[128:129], v160 offset:0
    ds_read_b64_tr_b16 v[130:131], v160 offset:512
    ds_read_b64_tr_b16 v[132:133], v161 offset:0
    ds_read_b64_tr_b16 v[134:135], v161 offset:512
    s_waitcnt lgkmcnt(4)
    s_barrier
    ds_read_b128 a[0:3], v237 offset:0
    ds_read_b128 a[4:7], v237 offset:1024
    ds_read_b128 a[8:11], v237 offset:2048
    ds_read_b128 a[12:15], v237 offset:3072
    s_waitcnt lgkmcnt(3)
    v_mfma_f32_16x16x32_bf16 v[0:3], v[128:131], a[0:3], 0
    ds_read_b64_tr_b16 v[136:137], v162 offset:0
    ds_read_b64_tr_b16 v[138:139], v162 offset:512
    s_waitcnt lgkmcnt(4)
    v_mfma_f32_16x16x32_bf16 v[4:7], v[128:131], a[4:7], 0
    ds_read_b128 a[16:19], v237 offset:4096
    ds_read_b128 a[20:23], v237 offset:5120
    s_add_u32 s48, s48, 114688
    s_cmp_lt_u32 s48, s50
    s_cselect_b32 s48, s48, s49
    s_add_u32 m0, s75, 114688
    s_waitcnt lgkmcnt(5)
    v_mfma_f32_16x16x32_bf16 v[8:11], v[128:131], a[8:11], 0
    buffer_load_dwordx4 v168, s[24:27], s48 offen lds
    s_waitcnt lgkmcnt(4)
    v_mfma_f32_16x16x32_bf16 v[12:15], v[128:131], a[12:15], 0
    v_mfma_f32_16x16x32_bf16 v[16:19], v[132:135], a[0:3], 0
    ds_read_b64_tr_b16 v[140:141], v163 offset:0
    ds_read_b64_tr_b16 v[142:143], v163 offset:512
    v_mfma_f32_16x16x32_bf16 v[20:23], v[132:135], a[4:7], 0
    v_mfma_f32_16x16x32_bf16 v[24:27], v[132:135], a[8:11], 0
    buffer_load_dwordx4 v169, s[24:27], s48 offen offset:1024 lds
    v_mfma_f32_16x16x32_bf16 v[28:31], v[132:135], a[12:15], 0
    s_waitcnt vmcnt(6) lgkmcnt(4)
    v_mfma_f32_16x16x32_bf16 v[32:35], v[136:139], a[0:3], 0
    ds_read_b64_tr_b16 v[144:145], v160 offset:16384
    ds_read_b64_tr_b16 v[146:147], v160 offset:16896
    v_mfma_f32_16x16x32_bf16 v[36:39], v[136:139], a[4:7], 0
    ds_read_b128 a[24:27], v237 offset:6144
    ds_read_b128 a[28:31], v237 offset:7168
    v_mfma_f32_16x16x32_bf16 v[40:43], v[136:139], a[8:11], 0
    buffer_load_dwordx4 v170, s[24:27], s48 offen offset:2048 lds
    v_mfma_f32_16x16x32_bf16 v[44:47], v[136:139], a[12:15], 0
    s_waitcnt lgkmcnt(4)
    v_mfma_f32_16x16x32_bf16 v[48:51], v[140:143], a[0:3], 0
    ds_read_b64_tr_b16 v[148:149], v161 offset:16384
    ds_read_b64_tr_b16 v[150:151], v161 offset:16896
    v_mfma_f32_16x16x32_bf16 v[52:55], v[140:143], a[4:7], 0
    v_mfma_f32_16x16x32_bf16 v[56:59], v[140:143], a[8:11], 0
    buffer_load_dwordx4 v171, s[24:27], s48 offen offset:3072 lds
    v_mfma_f32_16x16x32_bf16 v[60:63], v[140:143], a[12:15], 0
    s_waitcnt lgkmcnt(2)
    s_add_u32 s48, s48, 114688
    s_cmp_lt_u32 s48, s50
    v_mfma_f32_16x16x32_bf16 v[0:3], v[144:147], a[16:19], v[0:3]
    ds_read_b64_tr_b16 v[152:153], v162 offset:16384
    ds_read_b64_tr_b16 v[154:155], v162 offset:16896
    v_mfma_f32_16x16x32_bf16 v[4:7], v[144:147], a[20:23], v[4:7]
    ds_read_b128 a[32:35], v237 offset:8192
    ds_read_b128 a[36:39], v237 offset:9216
    s_cselect_b32 s48, s48, s49
    s_add_u32 m0, s75, 131072
    v_mfma_f32_16x16x32_bf16 v[8:11], v[144:147], a[24:27], v[8:11]
    buffer_load_dwordx4 v168, s[24:27], s48 offen lds
    v_mfma_f32_16x16x32_bf16 v[12:15], v[144:147], a[28:31], v[12:15]
    s_waitcnt lgkmcnt(4)
    v_mfma_f32_16x16x32_bf16 v[16:19], v[148:151], a[16:19], v[16:19]
    ds_read_b64_tr_b16 v[156:157], v163 offset:16384
    ds_read_b64_tr_b16 v[158:159], v163 offset:16896
    v_mfma_f32_16x16x32_bf16 v[20:23], v[148:151], a[20:23], v[20:23]
    buffer_load_dwordx4 v169, s[24:27], s48 offen offset:1024 lds
    v_mfma_f32_16x16x32_bf16 v[24:27], v[148:151], a[24:27], v[24:27]
    buffer_load_dwordx4 v170, s[24:27], s48 offen offset:2048 lds
    v_mfma_f32_16x16x32_bf16 v[28:31], v[148:151], a[28:31], v[28:31]
    s_waitcnt vmcnt(7) lgkmcnt(4)
    v_mfma_f32_16x16x32_bf16 v[32:35], v[152:155], a[16:19], v[32:35]
    ds_read_b64_tr_b16 v[128:129], v160 offset:32768
    ds_read_b64_tr_b16 v[130:131], v160 offset:33280
    v_mfma_f32_16x16x32_bf16 v[36:39], v[152:155], a[20:23], v[36:39]
    ds_read_b128 a[40:43], v237 offset:10240
    ds_read_b128 a[44:47], v237 offset:11264
    v_mfma_f32_16x16x32_bf16 v[40:43], v[152:155], a[24:27], v[40:43]
    buffer_load_dwordx4 v171, s[24:27], s48 offen offset:3072 lds
    v_mfma_f32_16x16x32_bf16 v[44:47], v[152:155], a[28:31], v[44:47]
    s_waitcnt lgkmcnt(4)
    s_add_u32 s48, s48, 114688
    s_cmp_lt_u32 s48, s50
    v_mfma_f32_16x16x32_bf16 v[48:51], v[156:159], a[16:19], v[48:51]
    ds_read_b64_tr_b16 v[132:133], v161 offset:32768
    ds_read_b64_tr_b16 v[134:135], v161 offset:33280
    v_mfma_f32_16x16x32_bf16 v[52:55], v[156:159], a[20:23], v[52:55]
    s_cselect_b32 s48, s48, s49
    s_add_u32 m0, s75, 147456
    v_mfma_f32_16x16x32_bf16 v[56:59], v[156:159], a[24:27], v[56:59]
    buffer_load_dwordx4 v168, s[24:27], s48 offen lds
    v_mfma_f32_16x16x32_bf16 v[60:63], v[156:159], a[28:31], v[60:63]
    s_waitcnt lgkmcnt(2)
    v_mfma_f32_16x16x32_bf16 v[0:3], v[128:131], a[32:35], v[0:3]
    ds_read_b64_tr_b16 v[136:137], v162 offset:32768
    ds_read_b64_tr_b16 v[138:139], v162 offset:33280
    v_mfma_f32_16x16x32_bf16 v[4:7], v[128:131], a[36:39], v[4:7]
    ds_read_b128 a[48:51], v237 offset:12288
    ds_read_b128 a[52:55], v237 offset:13312
    v_mfma_f32_16x16x32_bf16 v[8:11], v[128:131], a[40:43], v[8:11]
    buffer_load_dwordx4 v169, s[24:27], s48 offen offset:1024 lds
    v_mfma_f32_16x16x32_bf16 v[12:15], v[128:131], a[44:47], v[12:15]
    s_waitcnt lgkmcnt(4)
    v_mfma_f32_16x16x32_bf16 v[16:19], v[132:135], a[32:35], v[16:19]
    ds_read_b64_tr_b16 v[140:141], v163 offset:32768
    ds_read_b64_tr_b16 v[142:143], v163 offset:33280
    v_mfma_f32_16x16x32_bf16 v[20:23], v[132:135], a[36:39], v[20:23]
    v_mfma_f32_16x16x32_bf16 v[24:27], v[132:135], a[40:43], v[24:27]
    buffer_load_dwordx4 v170, s[24:27], s48 offen offset:2048 lds
    v_mfma_f32_16x16x32_bf16 v[28:31], v[132:135], a[44:47], v[28:31]
    s_waitcnt vmcnt(7) lgkmcnt(4)
    v_mfma_f32_16x16x32_bf16 v[32:35], v[136:139], a[32:35], v[32:35]
    ds_read_b64_tr_b16 v[144:145], v160 offset:49152
    ds_read_b64_tr_b16 v[146:147], v160 offset:49664
    v_mfma_f32_16x16x32_bf16 v[36:39], v[136:139], a[36:39], v[36:39]
    ds_read_b128 a[56:59], v237 offset:14336
    ds_read_b128 a[60:63], v237 offset:15360
    v_mfma_f32_16x16x32_bf16 v[40:43], v[136:139], a[40:43], v[40:43]
    buffer_load_dwordx4 v171, s[24:27], s48 offen offset:3072 lds
    v_mfma_f32_16x16x32_bf16 v[44:47], v[136:139], a[44:47], v[44:47]
    s_waitcnt lgkmcnt(4)
    s_add_u32 s48, s48, 114688
    s_cmp_lt_u32 s48, s50
    s_cselect_b32 s48, s48, s49
    s_add_u32 m0, s75, 65536
    v_mfma_f32_16x16x32_bf16 v[48:51], v[140:143], a[32:35], v[48:51]
    ds_read_b64_tr_b16 v[148:149], v161 offset:49152
    ds_read_b64_tr_b16 v[150:151], v161 offset:49664
    v_mfma_f32_16x16x32_bf16 v[52:55], v[140:143], a[36:39], v[52:55]
    buffer_load_dwordx4 v168, s[24:27], s48 offen lds
    v_mfma_f32_16x16x32_bf16 v[56:59], v[140:143], a[40:43], v[56:59]
    buffer_load_dwordx4 v169, s[24:27], s48 offen offset:1024 lds
    v_mfma_f32_16x16x32_bf16 v[60:63], v[140:143], a[44:47], v[60:63]
    s_waitcnt lgkmcnt(2)
    v_mfma_f32_16x16x32_bf16 v[0:3], v[144:147], a[48:51], v[0:3]
    ds_read_b64_tr_b16 v[152:153], v162 offset:49152
    ds_read_b64_tr_b16 v[154:155], v162 offset:49664
    v_mfma_f32_16x16x32_bf16 v[4:7], v[144:147], a[52:55], v[4:7]
    ds_read_b128 a[64:67], v237 offset:16384
    ds_read_b128 a[68:71], v237 offset:17408
    v_mfma_f32_16x16x32_bf16 v[8:11], v[144:147], a[56:59], v[8:11]
    buffer_load_dwordx4 v170, s[24:27], s48 offen offset:2048 lds
    v_mfma_f32_16x16x32_bf16 v[12:15], v[144:147], a[60:63], v[12:15]
    s_waitcnt lgkmcnt(4)
    v_mfma_f32_16x16x32_bf16 v[16:19], v[148:151], a[48:51], v[16:19]
    ds_read_b64_tr_b16 v[156:157], v163 offset:49152
    ds_read_b64_tr_b16 v[158:159], v163 offset:49664
    v_mfma_f32_16x16x32_bf16 v[20:23], v[148:151], a[52:55], v[20:23]
    v_mfma_f32_16x16x32_bf16 v[24:27], v[148:151], a[56:59], v[24:27]
    buffer_load_dwordx4 v171, s[24:27], s48 offen offset:3072 lds
    v_mfma_f32_16x16x32_bf16 v[28:31], v[148:151], a[60:63], v[28:31]
    s_waitcnt vmcnt(8) lgkmcnt(4)
    s_add_u32 s48, s48, 114688
    s_cmp_lt_u32 s48, s50
    v_mfma_f32_16x16x32_bf16 v[32:35], v[152:155], a[48:51], v[32:35]
    ds_read_b64_tr_b16 v[128:129], v164 offset:0
    ds_read_b64_tr_b16 v[130:131], v164 offset:512
    v_mfma_f32_16x16x32_bf16 v[36:39], v[152:155], a[52:55], v[36:39]
    ds_read_b128 a[72:75], v237 offset:18432
    ds_read_b128 a[76:79], v237 offset:19456
    s_cselect_b32 s48, s48, s49
    s_add_u32 m0, s75, 81920
    v_mfma_f32_16x16x32_bf16 v[40:43], v[152:155], a[56:59], v[40:43]
    buffer_load_dwordx4 v168, s[24:27], s48 offen lds
    v_mfma_f32_16x16x32_bf16 v[44:47], v[152:155], a[60:63], v[44:47]
    s_waitcnt lgkmcnt(4)
    v_mfma_f32_16x16x32_bf16 v[48:51], v[156:159], a[48:51], v[48:51]
    ds_read_b64_tr_b16 v[132:133], v165 offset:0
    ds_read_b64_tr_b16 v[134:135], v165 offset:512
    v_mfma_f32_16x16x32_bf16 v[52:55], v[156:159], a[52:55], v[52:55]
    v_mfma_f32_16x16x32_bf16 v[56:59], v[156:159], a[56:59], v[56:59]
    buffer_load_dwordx4 v169, s[24:27], s48 offen offset:1024 lds
    v_mfma_f32_16x16x32_bf16 v[60:63], v[156:159], a[60:63], v[60:63]
    s_waitcnt lgkmcnt(2)
    v_mfma_f32_16x16x32_bf16 v[0:3], v[128:131], a[64:67], v[0:3]
    ds_read_b64_tr_b16 v[136:137], v166 offset:0
    ds_read_b64_tr_b16 v[138:139], v166 offset:512
    v_mfma_f32_16x16x32_bf16 v[4:7], v[128:131], a[68:71], v[4:7]
    ds_read_b128 a[80:83], v237 offset:20480
    ds_read_b128 a[84:87], v237 offset:21504
    v_mfma_f32_16x16x32_bf16 v[8:11], v[128:131], a[72:75], v[8:11]
    buffer_load_dwordx4 v170, s[24:27], s48 offen offset:2048 lds
    v_mfma_f32_16x16x32_bf16 v[12:15], v[128:131], a[76:79], v[12:15]
    s_waitcnt lgkmcnt(4)
    v_mfma_f32_16x16x32_bf16 v[16:19], v[132:135], a[64:67], v[16:19]
    ds_read_b64_tr_b16 v[140:141], v167 offset:0
    ds_read_b64_tr_b16 v[142:143], v167 offset:512
    v_mfma_f32_16x16x32_bf16 v[20:23], v[132:135], a[68:71], v[20:23]
    v_mfma_f32_16x16x32_bf16 v[24:27], v[132:135], a[72:75], v[24:27]
    buffer_load_dwordx4 v171, s[24:27], s48 offen offset:3072 lds
    v_mfma_f32_16x16x32_bf16 v[28:31], v[132:135], a[76:79], v[28:31]
    s_waitcnt vmcnt(8) lgkmcnt(4)
    s_add_u32 s48, s48, 114688
    s_cmp_lt_u32 s48, s50
    v_mfma_f32_16x16x32_bf16 v[32:35], v[136:139], a[64:67], v[32:35]
    ds_read_b64_tr_b16 v[144:145], v164 offset:16384
    ds_read_b64_tr_b16 v[146:147], v164 offset:16896
    v_mfma_f32_16x16x32_bf16 v[36:39], v[136:139], a[68:71], v[36:39]
    ds_read_b128 a[88:91], v237 offset:22528
    ds_read_b128 a[92:95], v237 offset:23552
    s_cselect_b32 s48, s48, s49
    s_add_u32 m0, s75, 98304
    v_mfma_f32_16x16x32_bf16 v[40:43], v[136:139], a[72:75], v[40:43]
    buffer_load_dwordx4 v168, s[24:27], s48 offen lds
    v_mfma_f32_16x16x32_bf16 v[44:47], v[136:139], a[76:79], v[44:47]
    s_waitcnt lgkmcnt(4)
    v_mfma_f32_16x16x32_bf16 v[48:51], v[140:143], a[64:67], v[48:51]
    ds_read_b64_tr_b16 v[148:149], v165 offset:16384
    ds_read_b64_tr_b16 v[150:151], v165 offset:16896
    v_mfma_f32_16x16x32_bf16 v[52:55], v[140:143], a[68:71], v[52:55]
    buffer_load_dwordx4 v169, s[24:27], s48 offen offset:1024 lds
    v_mfma_f32_16x16x32_bf16 v[56:59], v[140:143], a[72:75], v[56:59]
    buffer_load_dwordx4 v170, s[24:27], s48 offen offset:2048 lds
    v_mfma_f32_16x16x32_bf16 v[60:63], v[140:143], a[76:79], v[60:63]
    s_waitcnt lgkmcnt(2)
    v_mfma_f32_16x16x32_bf16 v[0:3], v[144:147], a[80:83], v[0:3]
    ds_read_b64_tr_b16 v[152:153], v166 offset:16384
    ds_read_b64_tr_b16 v[154:155], v166 offset:16896
    v_mfma_f32_16x16x32_bf16 v[4:7], v[144:147], a[84:87], v[4:7]
    ds_read_b128 a[96:99], v237 offset:24576
    ds_read_b128 a[100:103], v237 offset:25600
    v_mfma_f32_16x16x32_bf16 v[8:11], v[144:147], a[88:91], v[8:11]
    buffer_load_dwordx4 v171, s[24:27], s48 offen offset:3072 lds
    v_mfma_f32_16x16x32_bf16 v[12:15], v[144:147], a[92:95], v[12:15]
    s_waitcnt lgkmcnt(4)
    s_add_u32 s48, s48, 114688
    s_cmp_lt_u32 s48, s50
    v_mfma_f32_16x16x32_bf16 v[16:19], v[148:151], a[80:83], v[16:19]
    ds_read_b64_tr_b16 v[156:157], v167 offset:16384
    ds_read_b64_tr_b16 v[158:159], v167 offset:16896
    v_mfma_f32_16x16x32_bf16 v[20:23], v[148:151], a[84:87], v[20:23]
    s_cselect_b32 s48, s48, s49
    s_add_u32 m0, s75, 114688
    v_mfma_f32_16x16x32_bf16 v[24:27], v[148:151], a[88:91], v[24:27]
    buffer_load_dwordx4 v168, s[24:27], s48 offen lds
    v_mfma_f32_16x16x32_bf16 v[28:31], v[148:151], a[92:95], v[28:31]
    s_waitcnt vmcnt(9) lgkmcnt(4)
    v_mfma_f32_16x16x32_bf16 v[32:35], v[152:155], a[80:83], v[32:35]
    ds_read_b64_tr_b16 v[128:129], v160 offset:0
    ds_read_b64_tr_b16 v[130:131], v160 offset:512
    v_mfma_f32_16x16x32_bf16 v[36:39], v[152:155], a[84:87], v[36:39]
    ds_read_b128 a[104:107], v237 offset:26624
    ds_read_b128 a[108:111], v237 offset:27648
    v_mfma_f32_16x16x32_bf16 v[40:43], v[152:155], a[88:91], v[40:43]
    buffer_load_dwordx4 v169, s[24:27], s48 offen offset:1024 lds
    v_mfma_f32_16x16x32_bf16 v[44:47], v[152:155], a[92:95], v[44:47]
    s_waitcnt lgkmcnt(4)
    v_mfma_f32_16x16x32_bf16 v[48:51], v[156:159], a[80:83], v[48:51]
    ds_read_b64_tr_b16 v[132:133], v161 offset:0
    ds_read_b64_tr_b16 v[134:135], v161 offset:512
    v_mfma_f32_16x16x32_bf16 v[52:55], v[156:159], a[84:87], v[52:55]
    buffer_load_dwordx4 v170, s[24:27], s48 offen offset:2048 lds
    v_mfma_f32_16x16x32_bf16 v[56:59], v[156:159], a[88:91], v[56:59]
    buffer_load_dwordx4 v171, s[24:27], s48 offen offset:3072 lds
    v_mfma_f32_16x16x32_bf16 v[60:63], v[156:159], a[92:95], v[60:63]
    s_waitcnt lgkmcnt(2)
    s_add_u32 s48, s48, 114688
    s_cmp_lt_u32 s48, s50
    v_mfma_f32_16x16x32_bf16 v[0:3], v[128:131], a[96:99], v[0:3]
    ds_read_b64_tr_b16 v[136:137], v162 offset:0
    ds_read_b64_tr_b16 v[138:139], v162 offset:512
    v_mfma_f32_16x16x32_bf16 v[4:7], v[128:131], a[100:103], v[4:7]
    ds_read_b128 a[112:115], v237 offset:28672
    ds_read_b128 a[116:119], v237 offset:29696
    s_cselect_b32 s48, s48, s49
    s_add_u32 m0, s75, 131072
    v_mfma_f32_16x16x32_bf16 v[8:11], v[128:131], a[104:107], v[8:11]
    buffer_load_dwordx4 v168, s[24:27], s48 offen lds
    v_mfma_f32_16x16x32_bf16 v[12:15], v[128:131], a[108:111], v[12:15]
    s_waitcnt lgkmcnt(4)
    v_mfma_f32_16x16x32_bf16 v[16:19], v[132:135], a[96:99], v[16:19]
    ds_read_b64_tr_b16 v[140:141], v163 offset:0
    ds_read_b64_tr_b16 v[142:143], v163 offset:512
    v_mfma_f32_16x16x32_bf16 v[20:23], v[132:135], a[100:103], v[20:23]
    v_mfma_f32_16x16x32_bf16 v[24:27], v[132:135], a[104:107], v[24:27]
    buffer_load_dwordx4 v169, s[24:27], s48 offen offset:1024 lds
    v_mfma_f32_16x16x32_bf16 v[28:31], v[132:135], a[108:111], v[28:31]
    s_waitcnt vmcnt(10) lgkmcnt(4)
    v_mfma_f32_16x16x32_bf16 v[32:35], v[136:139], a[96:99], v[32:35]
    ds_read_b64_tr_b16 v[144:145], v160 offset:16384
    ds_read_b64_tr_b16 v[146:147], v160 offset:16896
    v_mfma_f32_16x16x32_bf16 v[36:39], v[136:139], a[100:103], v[36:39]
    ds_read_b128 a[120:123], v237 offset:30720
    ds_read_b128 a[124:127], v237 offset:31744
    v_mfma_f32_16x16x32_bf16 v[40:43], v[136:139], a[104:107], v[40:43]
    buffer_load_dwordx4 v170, s[24:27], s48 offen offset:2048 lds
    v_mfma_f32_16x16x32_bf16 v[44:47], v[136:139], a[108:111], v[44:47]
    s_waitcnt lgkmcnt(4)
    v_mfma_f32_16x16x32_bf16 v[48:51], v[140:143], a[96:99], v[48:51]
    ds_read_b64_tr_b16 v[148:149], v161 offset:16384
    ds_read_b64_tr_b16 v[150:151], v161 offset:16896
    v_mfma_f32_16x16x32_bf16 v[52:55], v[140:143], a[100:103], v[52:55]
    v_mfma_f32_16x16x32_bf16 v[56:59], v[140:143], a[104:107], v[56:59]
    buffer_load_dwordx4 v171, s[24:27], s48 offen offset:3072 lds
    v_mfma_f32_16x16x32_bf16 v[60:63], v[140:143], a[108:111], v[60:63]
    s_waitcnt lgkmcnt(2)
    s_add_u32 s48, s48, 114688
    s_cmp_lt_u32 s48, s50
    v_mfma_f32_16x16x32_bf16 v[0:3], v[144:147], a[112:115], v[0:3]
    ds_read_b64_tr_b16 v[152:153], v162 offset:16384
    ds_read_b64_tr_b16 v[154:155], v162 offset:16896
    v_mfma_f32_16x16x32_bf16 v[4:7], v[144:147], a[116:119], v[4:7]
    ds_read_b128 a[128:131], v237 offset:32768
    ds_read_b128 a[132:135], v237 offset:33792
    s_cselect_b32 s48, s48, s49
    s_add_u32 m0, s75, 147456
    v_mfma_f32_16x16x32_bf16 v[8:11], v[144:147], a[120:123], v[8:11]
    buffer_load_dwordx4 v168, s[24:27], s48 offen lds
    v_mfma_f32_16x16x32_bf16 v[12:15], v[144:147], a[124:127], v[12:15]
    s_waitcnt lgkmcnt(4)
    v_mfma_f32_16x16x32_bf16 v[16:19], v[148:151], a[112:115], v[16:19]
    ds_read_b64_tr_b16 v[156:157], v163 offset:16384
    ds_read_b64_tr_b16 v[158:159], v163 offset:16896
    v_mfma_f32_16x16x32_bf16 v[20:23], v[148:151], a[116:119], v[20:23]
    buffer_load_dwordx4 v169, s[24:27], s48 offen offset:1024 lds
    v_mfma_f32_16x16x32_bf16 v[24:27], v[148:151], a[120:123], v[24:27]
    buffer_load_dwordx4 v170, s[24:27], s48 offen offset:2048 lds
    v_mfma_f32_16x16x32_bf16 v[28:31], v[148:151], a[124:127], v[28:31]
    s_waitcnt vmcnt(11) lgkmcnt(4)
    v_mfma_f32_16x16x32_bf16 v[32:35], v[152:155], a[112:115], v[32:35]
    ds_read_b64_tr_b16 v[128:129], v160 offset:32768
    ds_read_b64_tr_b16 v[130:131], v160 offset:33280
    v_mfma_f32_16x16x32_bf16 v[36:39], v[152:155], a[116:119], v[36:39]
    ds_read_b128 a[136:139], v237 offset:34816
    ds_read_b128 a[140:143], v237 offset:35840
    v_mfma_f32_16x16x32_bf16 v[40:43], v[152:155], a[120:123], v[40:43]
    buffer_load_dwordx4 v171, s[24:27], s48 offen offset:3072 lds
    v_mfma_f32_16x16x32_bf16 v[44:47], v[152:155], a[124:127], v[44:47]
    s_waitcnt lgkmcnt(4)
    s_add_u32 s48, s48, 114688
    s_cmp_lt_u32 s48, s50
    v_mfma_f32_16x16x32_bf16 v[48:51], v[156:159], a[112:115], v[48:51]
    ds_read_b64_tr_b16 v[132:133], v161 offset:32768
    ds_read_b64_tr_b16 v[134:135], v161 offset:33280
    v_mfma_f32_16x16x32_bf16 v[52:55], v[156:159], a[116:119], v[52:55]
    s_cselect_b32 s48, s48, s49
    s_add_u32 m0, s75, 65536
    v_mfma_f32_16x16x32_bf16 v[56:59], v[156:159], a[120:123], v[56:59]
    buffer_load_dwordx4 v168, s[24:27], s48 offen lds
    v_mfma_f32_16x16x32_bf16 v[60:63], v[156:159], a[124:127], v[60:63]
    s_waitcnt lgkmcnt(2)
    v_mfma_f32_16x16x32_bf16 v[0:3], v[128:131], a[128:131], v[0:3]
    ds_read_b64_tr_b16 v[136:137], v162 offset:32768
    ds_read_b64_tr_b16 v[138:139], v162 offset:33280
    v_mfma_f32_16x16x32_bf16 v[4:7], v[128:131], a[132:135], v[4:7]
    ds_read_b128 a[144:147], v237 offset:36864
    ds_read_b128 a[148:151], v237 offset:37888
    v_mfma_f32_16x16x32_bf16 v[8:11], v[128:131], a[136:139], v[8:11]
    buffer_load_dwordx4 v169, s[24:27], s48 offen offset:1024 lds
    v_mfma_f32_16x16x32_bf16 v[12:15], v[128:131], a[140:143], v[12:15]
    s_waitcnt lgkmcnt(4)
    v_mfma_f32_16x16x32_bf16 v[16:19], v[132:135], a[128:131], v[16:19]
    ds_read_b64_tr_b16 v[140:141], v163 offset:32768
    ds_read_b64_tr_b16 v[142:143], v163 offset:33280
    v_mfma_f32_16x16x32_bf16 v[20:23], v[132:135], a[132:135], v[20:23]
    v_mfma_f32_16x16x32_bf16 v[24:27], v[132:135], a[136:139], v[24:27]
    buffer_load_dwordx4 v170, s[24:27], s48 offen offset:2048 lds
    v_mfma_f32_16x16x32_bf16 v[28:31], v[132:135], a[140:143], v[28:31]
    s_waitcnt vmcnt(11) lgkmcnt(4)
    v_mfma_f32_16x16x32_bf16 v[32:35], v[136:139], a[128:131], v[32:35]
    ds_read_b64_tr_b16 v[144:145], v160 offset:49152
    ds_read_b64_tr_b16 v[146:147], v160 offset:49664
    v_mfma_f32_16x16x32_bf16 v[36:39], v[136:139], a[132:135], v[36:39]
    ds_read_b128 a[152:155], v237 offset:38912
    ds_read_b128 a[156:159], v237 offset:39936
    v_mfma_f32_16x16x32_bf16 v[40:43], v[136:139], a[136:139], v[40:43]
    buffer_load_dwordx4 v171, s[24:27], s48 offen offset:3072 lds
    v_mfma_f32_16x16x32_bf16 v[44:47], v[136:139], a[140:143], v[44:47]
    s_waitcnt lgkmcnt(4)
    s_add_u32 s48, s48, 114688
    s_cmp_lt_u32 s48, s50
    s_cselect_b32 s48, s48, s49
    s_add_u32 m0, s75, 81920
    v_mfma_f32_16x16x32_bf16 v[48:51], v[140:143], a[128:131], v[48:51]
    ds_read_b64_tr_b16 v[148:149], v161 offset:49152
    ds_read_b64_tr_b16 v[150:151], v161 offset:49664
    v_mfma_f32_16x16x32_bf16 v[52:55], v[140:143], a[132:135], v[52:55]
    buffer_load_dwordx4 v168, s[24:27], s48 offen lds
    v_mfma_f32_16x16x32_bf16 v[56:59], v[140:143], a[136:139], v[56:59]
    buffer_load_dwordx4 v169, s[24:27], s48 offen offset:1024 lds
    v_mfma_f32_16x16x32_bf16 v[60:63], v[140:143], a[140:143], v[60:63]
    s_waitcnt lgkmcnt(2)
    v_mfma_f32_16x16x32_bf16 v[0:3], v[144:147], a[144:147], v[0:3]
    ds_read_b64_tr_b16 v[152:153], v162 offset:49152
    ds_read_b64_tr_b16 v[154:155], v162 offset:49664
    v_mfma_f32_16x16x32_bf16 v[4:7], v[144:147], a[148:151], v[4:7]
    ds_read_b128 a[160:163], v237 offset:40960
    ds_read_b128 a[164:167], v237 offset:41984
    v_mfma_f32_16x16x32_bf16 v[8:11], v[144:147], a[152:155], v[8:11]
    buffer_load_dwordx4 v170, s[24:27], s48 offen offset:2048 lds
    v_mfma_f32_16x16x32_bf16 v[12:15], v[144:147], a[156:159], v[12:15]
    s_waitcnt lgkmcnt(4)
    v_mfma_f32_16x16x32_bf16 v[16:19], v[148:151], a[144:147], v[16:19]
    ds_read_b64_tr_b16 v[156:157], v163 offset:49152
    ds_read_b64_tr_b16 v[158:159], v163 offset:49664
    v_mfma_f32_16x16x32_bf16 v[20:23], v[148:151], a[148:151], v[20:23]
    v_mfma_f32_16x16x32_bf16 v[24:27], v[148:151], a[152:155], v[24:27]
    buffer_load_dwordx4 v171, s[24:27], s48 offen offset:3072 lds
    v_mfma_f32_16x16x32_bf16 v[28:31], v[148:151], a[156:159], v[28:31]
    s_waitcnt vmcnt(12) lgkmcnt(4)
    s_add_u32 s48, s48, 114688
    s_cmp_lt_u32 s48, s50
    v_mfma_f32_16x16x32_bf16 v[32:35], v[152:155], a[144:147], v[32:35]
    ds_read_b64_tr_b16 v[128:129], v164 offset:0
    ds_read_b64_tr_b16 v[130:131], v164 offset:512
    v_mfma_f32_16x16x32_bf16 v[36:39], v[152:155], a[148:151], v[36:39]
    ds_read_b128 a[168:171], v237 offset:43008
    ds_read_b128 a[172:175], v237 offset:44032
    s_cselect_b32 s48, s48, s49
    s_add_u32 m0, s75, 98304
    v_mfma_f32_16x16x32_bf16 v[40:43], v[152:155], a[152:155], v[40:43]
    buffer_load_dwordx4 v168, s[24:27], s48 offen lds
    v_mfma_f32_16x16x32_bf16 v[44:47], v[152:155], a[156:159], v[44:47]
    s_waitcnt lgkmcnt(4)
    v_mfma_f32_16x16x32_bf16 v[48:51], v[156:159], a[144:147], v[48:51]
    ds_read_b64_tr_b16 v[132:133], v165 offset:0
    ds_read_b64_tr_b16 v[134:135], v165 offset:512
    v_mfma_f32_16x16x32_bf16 v[52:55], v[156:159], a[148:151], v[52:55]
    v_mfma_f32_16x16x32_bf16 v[56:59], v[156:159], a[152:155], v[56:59]
    buffer_load_dwordx4 v169, s[24:27], s48 offen offset:1024 lds
    v_mfma_f32_16x16x32_bf16 v[60:63], v[156:159], a[156:159], v[60:63]
    s_waitcnt lgkmcnt(2)
    v_mfma_f32_16x16x32_bf16 v[0:3], v[128:131], a[160:163], v[0:3]
    ds_read_b64_tr_b16 v[136:137], v166 offset:0
    ds_read_b64_tr_b16 v[138:139], v166 offset:512
    v_mfma_f32_16x16x32_bf16 v[4:7], v[128:131], a[164:167], v[4:7]
    ds_read_b128 a[176:179], v237 offset:45056
    ds_read_b128 a[180:183], v237 offset:46080
    v_mfma_f32_16x16x32_bf16 v[8:11], v[128:131], a[168:171], v[8:11]
    buffer_load_dwordx4 v170, s[24:27], s48 offen offset:2048 lds
    v_mfma_f32_16x16x32_bf16 v[12:15], v[128:131], a[172:175], v[12:15]
    s_waitcnt lgkmcnt(4)
    v_mfma_f32_16x16x32_bf16 v[16:19], v[132:135], a[160:163], v[16:19]
    ds_read_b64_tr_b16 v[140:141], v167 offset:0
    ds_read_b64_tr_b16 v[142:143], v167 offset:512
    v_mfma_f32_16x16x32_bf16 v[20:23], v[132:135], a[164:167], v[20:23]
    v_mfma_f32_16x16x32_bf16 v[24:27], v[132:135], a[168:171], v[24:27]
    buffer_load_dwordx4 v171, s[24:27], s48 offen offset:3072 lds
    v_mfma_f32_16x16x32_bf16 v[28:31], v[132:135], a[172:175], v[28:31]
    s_waitcnt vmcnt(12) lgkmcnt(4)
    s_add_u32 s48, s48, 114688
    s_cmp_lt_u32 s48, s50
    v_mfma_f32_16x16x32_bf16 v[32:35], v[136:139], a[160:163], v[32:35]
    ds_read_b64_tr_b16 v[144:145], v164 offset:16384
    ds_read_b64_tr_b16 v[146:147], v164 offset:16896
    v_mfma_f32_16x16x32_bf16 v[36:39], v[136:139], a[164:167], v[36:39]
    ds_read_b128 a[184:187], v237 offset:47104
    ds_read_b128 a[188:191], v237 offset:48128
    s_cselect_b32 s48, s48, s49
    s_add_u32 m0, s75, 114688
    v_mfma_f32_16x16x32_bf16 v[40:43], v[136:139], a[168:171], v[40:43]
    buffer_load_dwordx4 v168, s[24:27], s48 offen lds
    v_mfma_f32_16x16x32_bf16 v[44:47], v[136:139], a[172:175], v[44:47]
    s_waitcnt lgkmcnt(4)
    v_mfma_f32_16x16x32_bf16 v[48:51], v[140:143], a[160:163], v[48:51]
    ds_read_b64_tr_b16 v[148:149], v165 offset:16384
    ds_read_b64_tr_b16 v[150:151], v165 offset:16896
    v_mfma_f32_16x16x32_bf16 v[52:55], v[140:143], a[164:167], v[52:55]
    buffer_load_dwordx4 v169, s[24:27], s48 offen offset:1024 lds
    v_mfma_f32_16x16x32_bf16 v[56:59], v[140:143], a[168:171], v[56:59]
    buffer_load_dwordx4 v170, s[24:27], s48 offen offset:2048 lds
    v_mfma_f32_16x16x32_bf16 v[60:63], v[140:143], a[172:175], v[60:63]
    s_waitcnt lgkmcnt(2)
    v_mfma_f32_16x16x32_bf16 v[0:3], v[144:147], a[176:179], v[0:3]
    ds_read_b64_tr_b16 v[152:153], v166 offset:16384
    ds_read_b64_tr_b16 v[154:155], v166 offset:16896
    v_mfma_f32_16x16x32_bf16 v[4:7], v[144:147], a[180:183], v[4:7]
    ds_read_b128 a[192:195], v237 offset:49152
    ds_read_b128 a[196:199], v237 offset:50176
    v_mfma_f32_16x16x32_bf16 v[8:11], v[144:147], a[184:187], v[8:11]
    buffer_load_dwordx4 v171, s[24:27], s48 offen offset:3072 lds
    v_mfma_f32_16x16x32_bf16 v[12:15], v[144:147], a[188:191], v[12:15]
    s_waitcnt lgkmcnt(4)
    s_add_u32 s48, s48, 114688
    s_cmp_lt_u32 s48, s50
    v_mfma_f32_16x16x32_bf16 v[16:19], v[148:151], a[176:179], v[16:19]
    ds_read_b64_tr_b16 v[156:157], v167 offset:16384
    ds_read_b64_tr_b16 v[158:159], v167 offset:16896
    v_mfma_f32_16x16x32_bf16 v[20:23], v[148:151], a[180:183], v[20:23]
    s_cselect_b32 s48, s48, s49
    s_add_u32 m0, s75, 131072
    v_mfma_f32_16x16x32_bf16 v[24:27], v[148:151], a[184:187], v[24:27]
    buffer_load_dwordx4 v168, s[28:31], s48 offen lds
    v_mfma_f32_16x16x32_bf16 v[28:31], v[148:151], a[188:191], v[28:31]
    s_waitcnt vmcnt(13) lgkmcnt(4)
    v_mfma_f32_16x16x32_bf16 v[32:35], v[152:155], a[176:179], v[32:35]
    ds_read_b64_tr_b16 v[128:129], v160 offset:0
    ds_read_b64_tr_b16 v[130:131], v160 offset:512
    v_mfma_f32_16x16x32_bf16 v[36:39], v[152:155], a[180:183], v[36:39]
    ds_read_b128 a[200:203], v237 offset:51200
    ds_read_b128 a[204:207], v237 offset:52224
    v_mfma_f32_16x16x32_bf16 v[40:43], v[152:155], a[184:187], v[40:43]
    buffer_load_dwordx4 v169, s[28:31], s48 offen offset:1024 lds
    v_mfma_f32_16x16x32_bf16 v[44:47], v[152:155], a[188:191], v[44:47]
    s_waitcnt lgkmcnt(4)
    v_mfma_f32_16x16x32_bf16 v[48:51], v[156:159], a[176:179], v[48:51]
    ds_read_b64_tr_b16 v[132:133], v161 offset:0
    ds_read_b64_tr_b16 v[134:135], v161 offset:512
    v_mfma_f32_16x16x32_bf16 v[52:55], v[156:159], a[180:183], v[52:55]
    buffer_load_dwordx4 v170, s[28:31], s48 offen offset:2048 lds
    v_mfma_f32_16x16x32_bf16 v[56:59], v[156:159], a[184:187], v[56:59]
    buffer_load_dwordx4 v171, s[28:31], s48 offen offset:3072 lds
    v_mfma_f32_16x16x32_bf16 v[60:63], v[156:159], a[188:191], v[60:63]
    s_waitcnt lgkmcnt(2)
    s_add_u32 s48, s48, 114688
    s_cmp_lt_u32 s48, s50
    v_mfma_f32_16x16x32_bf16 v[0:3], v[128:131], a[192:195], v[0:3]
    ds_read_b64_tr_b16 v[136:137], v162 offset:0
    ds_read_b64_tr_b16 v[138:139], v162 offset:512
    v_mfma_f32_16x16x32_bf16 v[4:7], v[128:131], a[196:199], v[4:7]
    ds_read_b128 a[208:211], v237 offset:53248
    ds_read_b128 a[212:215], v237 offset:54272
    s_cselect_b32 s48, s48, s49
    s_add_u32 m0, s75, 147456
    v_mfma_f32_16x16x32_bf16 v[8:11], v[128:131], a[200:203], v[8:11]
    buffer_load_dwordx4 v168, s[28:31], s48 offen lds
    v_mfma_f32_16x16x32_bf16 v[12:15], v[128:131], a[204:207], v[12:15]
    s_waitcnt lgkmcnt(4)
    v_mfma_f32_16x16x32_bf16 v[16:19], v[132:135], a[192:195], v[16:19]
    ds_read_b64_tr_b16 v[140:141], v163 offset:0
    ds_read_b64_tr_b16 v[142:143], v163 offset:512
    v_mfma_f32_16x16x32_bf16 v[20:23], v[132:135], a[196:199], v[20:23]
    v_mfma_f32_16x16x32_bf16 v[24:27], v[132:135], a[200:203], v[24:27]
    buffer_load_dwordx4 v169, s[28:31], s48 offen offset:1024 lds
    v_mfma_f32_16x16x32_bf16 v[28:31], v[132:135], a[204:207], v[28:31]
    s_waitcnt vmcnt(14) lgkmcnt(4)
    v_mfma_f32_16x16x32_bf16 v[32:35], v[136:139], a[192:195], v[32:35]
    ds_read_b64_tr_b16 v[144:145], v160 offset:16384
    ds_read_b64_tr_b16 v[146:147], v160 offset:16896
    v_mfma_f32_16x16x32_bf16 v[36:39], v[136:139], a[196:199], v[36:39]
    ds_read_b128 a[216:219], v237 offset:55296
    ds_read_b128 a[220:223], v237 offset:56320
    v_mfma_f32_16x16x32_bf16 v[40:43], v[136:139], a[200:203], v[40:43]
    buffer_load_dwordx4 v170, s[28:31], s48 offen offset:2048 lds
    v_mfma_f32_16x16x32_bf16 v[44:47], v[136:139], a[204:207], v[44:47]
    s_waitcnt lgkmcnt(4)
    v_mfma_f32_16x16x32_bf16 v[48:51], v[140:143], a[192:195], v[48:51]
    ds_read_b64_tr_b16 v[148:149], v161 offset:16384
    ds_read_b64_tr_b16 v[150:151], v161 offset:16896
    v_mfma_f32_16x16x32_bf16 v[52:55], v[140:143], a[196:199], v[52:55]
    v_mfma_f32_16x16x32_bf16 v[56:59], v[140:143], a[200:203], v[56:59]
    buffer_load_dwordx4 v171, s[28:31], s48 offen offset:3072 lds
    v_mfma_f32_16x16x32_bf16 v[60:63], v[140:143], a[204:207], v[60:63]
    s_waitcnt lgkmcnt(2)
    s_add_u32 s48, s48, 114688
    s_cmp_lt_u32 s48, s50
    v_mfma_f32_16x16x32_bf16 v[0:3], v[144:147], a[208:211], v[0:3]
    ds_read_b64_tr_b16 v[152:153], v162 offset:16384
    ds_read_b64_tr_b16 v[154:155], v162 offset:16896
    v_mfma_f32_16x16x32_bf16 v[4:7], v[144:147], a[212:215], v[4:7]
    ds_read_b128 a[224:227], v237 offset:57344
    ds_read_b128 a[228:231], v237 offset:58368
    s_cselect_b32 s48, s48, s49
    s_add_u32 m0, s75, 65536
    v_mfma_f32_16x16x32_bf16 v[8:11], v[144:147], a[216:219], v[8:11]
    buffer_load_dwordx4 v168, s[28:31], s48 offen lds
    v_mfma_f32_16x16x32_bf16 v[12:15], v[144:147], a[220:223], v[12:15]
    s_waitcnt lgkmcnt(4)
    v_mfma_f32_16x16x32_bf16 v[16:19], v[148:151], a[208:211], v[16:19]
    ds_read_b64_tr_b16 v[156:157], v163 offset:16384
    ds_read_b64_tr_b16 v[158:159], v163 offset:16896
    v_mfma_f32_16x16x32_bf16 v[20:23], v[148:151], a[212:215], v[20:23]
    v_mfma_f32_16x16x32_bf16 v[24:27], v[148:151], a[216:219], v[24:27]
    buffer_load_dwordx4 v169, s[28:31], s48 offen offset:1024 lds
    v_mfma_f32_16x16x32_bf16 v[28:31], v[148:151], a[220:223], v[28:31]
    s_waitcnt vmcnt(14) lgkmcnt(4)
    v_mfma_f32_16x16x32_bf16 v[32:35], v[152:155], a[208:211], v[32:35]
    ds_read_b64_tr_b16 v[128:129], v160 offset:32768
    ds_read_b64_tr_b16 v[130:131], v160 offset:33280
    v_mfma_f32_16x16x32_bf16 v[36:39], v[152:155], a[212:215], v[36:39]
    ds_read_b128 a[232:235], v237 offset:59392
    ds_read_b128 a[236:239], v237 offset:60416
    v_mfma_f32_16x16x32_bf16 v[40:43], v[152:155], a[216:219], v[40:43]
    buffer_load_dwordx4 v170, s[28:31], s48 offen offset:2048 lds
    v_mfma_f32_16x16x32_bf16 v[44:47], v[152:155], a[220:223], v[44:47]
    s_waitcnt lgkmcnt(4)
    v_mfma_f32_16x16x32_bf16 v[48:51], v[156:159], a[208:211], v[48:51]
    ds_read_b64_tr_b16 v[132:133], v161 offset:32768
    ds_read_b64_tr_b16 v[134:135], v161 offset:33280
    v_mfma_f32_16x16x32_bf16 v[52:55], v[156:159], a[212:215], v[52:55]
    v_mfma_f32_16x16x32_bf16 v[56:59], v[156:159], a[216:219], v[56:59]
    buffer_load_dwordx4 v171, s[28:31], s48 offen offset:3072 lds
    v_mfma_f32_16x16x32_bf16 v[60:63], v[156:159], a[220:223], v[60:63]
    s_waitcnt lgkmcnt(2)
    s_add_u32 s48, s48, 114688
    s_cmp_lt_u32 s48, s50
    v_mfma_f32_16x16x32_bf16 v[0:3], v[128:131], a[224:227], v[0:3]
    ds_read_b64_tr_b16 v[136:137], v162 offset:32768
    ds_read_b64_tr_b16 v[138:139], v162 offset:33280
    v_mfma_f32_16x16x32_bf16 v[4:7], v[128:131], a[228:231], v[4:7]
    ds_read_b128 a[240:243], v237 offset:61440
    ds_read_b128 a[244:247], v237 offset:62464
    s_cselect_b32 s48, s48, s49
    s_add_u32 m0, s75, 81920
    v_mfma_f32_16x16x32_bf16 v[8:11], v[128:131], a[232:235], v[8:11]
    buffer_load_dwordx4 v168, s[28:31], s48 offen lds
    v_mfma_f32_16x16x32_bf16 v[12:15], v[128:131], a[236:239], v[12:15]
    s_waitcnt lgkmcnt(4)
    v_mfma_f32_16x16x32_bf16 v[16:19], v[132:135], a[224:227], v[16:19]
    ds_read_b64_tr_b16 v[140:141], v163 offset:32768
    ds_read_b64_tr_b16 v[142:143], v163 offset:33280
    v_mfma_f32_16x16x32_bf16 v[20:23], v[132:135], a[228:231], v[20:23]
    v_mfma_f32_16x16x32_bf16 v[24:27], v[132:135], a[232:235], v[24:27]
    buffer_load_dwordx4 v169, s[28:31], s48 offen offset:1024 lds
    v_mfma_f32_16x16x32_bf16 v[28:31], v[132:135], a[236:239], v[28:31]
    s_waitcnt vmcnt(14) lgkmcnt(4)
    v_mfma_f32_16x16x32_bf16 v[32:35], v[136:139], a[224:227], v[32:35]
    ds_read_b64_tr_b16 v[144:145], v160 offset:49152
    ds_read_b64_tr_b16 v[146:147], v160 offset:49664
    v_mfma_f32_16x16x32_bf16 v[36:39], v[136:139], a[228:231], v[36:39]
    ds_read_b128 a[248:251], v237 offset:63488
    ds_read_b128 a[252:255], v237 offset:64512
    v_mfma_f32_16x16x32_bf16 v[40:43], v[136:139], a[232:235], v[40:43]
    buffer_load_dwordx4 v170, s[28:31], s48 offen offset:2048 lds
    v_mfma_f32_16x16x32_bf16 v[44:47], v[136:139], a[236:239], v[44:47]
    s_waitcnt lgkmcnt(4)
    v_mfma_f32_16x16x32_bf16 v[48:51], v[140:143], a[224:227], v[48:51]
    ds_read_b64_tr_b16 v[148:149], v161 offset:49152
    ds_read_b64_tr_b16 v[150:151], v161 offset:49664
    v_mfma_f32_16x16x32_bf16 v[52:55], v[140:143], a[228:231], v[52:55]
    v_mfma_f32_16x16x32_bf16 v[56:59], v[140:143], a[232:235], v[56:59]
    buffer_load_dwordx4 v171, s[28:31], s48 offen offset:3072 lds
    v_mfma_f32_16x16x32_bf16 v[60:63], v[140:143], a[236:239], v[60:63]
    s_waitcnt lgkmcnt(2)
    s_add_u32 s48, s48, 114688
    s_cmp_lt_u32 s48, s50
    v_mfma_f32_16x16x32_bf16 v[0:3], v[144:147], a[240:243], v[0:3]
    ds_read_b64_tr_b16 v[152:153], v162 offset:49152
    ds_read_b64_tr_b16 v[154:155], v162 offset:49664
    v_mfma_f32_16x16x32_bf16 v[4:7], v[144:147], a[244:247], v[4:7]
    s_cselect_b32 s48, s48, s49
    s_add_u32 m0, s75, 98304
    v_mfma_f32_16x16x32_bf16 v[8:11], v[144:147], a[248:251], v[8:11]
    buffer_load_dwordx4 v168, s[28:31], s48 offen lds
    v_mfma_f32_16x16x32_bf16 v[12:15], v[144:147], a[252:255], v[12:15]
    s_waitcnt lgkmcnt(2)
    v_mfma_f32_16x16x32_bf16 v[16:19], v[148:151], a[240:243], v[16:19]
    ds_read_b64_tr_b16 v[156:157], v163 offset:49152
    ds_read_b64_tr_b16 v[158:159], v163 offset:49664
    v_mfma_f32_16x16x32_bf16 v[20:23], v[148:151], a[244:247], v[20:23]
    v_mfma_f32_16x16x32_bf16 v[24:27], v[148:151], a[248:251], v[24:27]
    buffer_load_dwordx4 v169, s[28:31], s48 offen offset:1024 lds
    v_mfma_f32_16x16x32_bf16 v[28:31], v[148:151], a[252:255], v[28:31]
    s_waitcnt vmcnt(14) lgkmcnt(2)
    v_mfma_f32_16x16x32_bf16 v[32:35], v[152:155], a[240:243], v[32:35]
    ds_read_b64_tr_b16 v[128:129], v164 offset:0
    ds_read_b64_tr_b16 v[130:131], v164 offset:512
    v_mfma_f32_16x16x32_bf16 v[36:39], v[152:155], a[244:247], v[36:39]
    v_mfma_f32_16x16x32_bf16 v[40:43], v[152:155], a[248:251], v[40:43]
    buffer_load_dwordx4 v170, s[28:31], s48 offen offset:2048 lds
    v_mfma_f32_16x16x32_bf16 v[44:47], v[152:155], a[252:255], v[44:47]
    s_waitcnt lgkmcnt(2)
    v_mfma_f32_16x16x32_bf16 v[48:51], v[156:159], a[240:243], v[48:51]
    ds_read_b64_tr_b16 v[132:133], v165 offset:0
    ds_read_b64_tr_b16 v[134:135], v165 offset:512
    v_mfma_f32_16x16x32_bf16 v[52:55], v[156:159], a[244:247], v[52:55]
    v_mfma_f32_16x16x32_bf16 v[56:59], v[156:159], a[248:251], v[56:59]
    buffer_load_dwordx4 v171, s[28:31], s48 offen offset:3072 lds
    v_mfma_f32_16x16x32_bf16 v[60:63], v[156:159], a[252:255], v[60:63]
    s_waitcnt lgkmcnt(2)
    s_add_u32 s48, s48, 114688
    s_cmp_lt_u32 s48, s50
    v_mfma_f32_16x16x32_bf16 v[64:67], v[128:131], a[0:3], 0
    ds_read_b64_tr_b16 v[136:137], v166 offset:0
    ds_read_b64_tr_b16 v[138:139], v166 offset:512
    v_mfma_f32_16x16x32_bf16 v[68:71], v[128:131], a[4:7], 0
    s_cselect_b32 s48, s48, s49
    s_add_u32 m0, s75, 114688
    v_mfma_f32_16x16x32_bf16 v[72:75], v[128:131], a[8:11], 0
    buffer_load_dwordx4 v168, s[28:31], s48 offen lds
    v_mfma_f32_16x16x32_bf16 v[76:79], v[128:131], a[12:15], 0
    s_waitcnt lgkmcnt(2)
    v_mfma_f32_16x16x32_bf16 v[80:83], v[132:135], a[0:3], 0
    ds_read_b64_tr_b16 v[140:141], v167 offset:0
    ds_read_b64_tr_b16 v[142:143], v167 offset:512
    v_mfma_f32_16x16x32_bf16 v[84:87], v[132:135], a[4:7], 0
    v_mfma_f32_16x16x32_bf16 v[88:91], v[132:135], a[8:11], 0
    buffer_load_dwordx4 v169, s[28:31], s48 offen offset:1024 lds
    v_mfma_f32_16x16x32_bf16 v[92:95], v[132:135], a[12:15], 0
    s_waitcnt vmcnt(14) lgkmcnt(2)
    v_mfma_f32_16x16x32_bf16 v[96:99], v[136:139], a[0:3], 0
    ds_read_b64_tr_b16 v[144:145], v164 offset:16384
    ds_read_b64_tr_b16 v[146:147], v164 offset:16896
    v_mfma_f32_16x16x32_bf16 v[100:103], v[136:139], a[4:7], 0
    v_mfma_f32_16x16x32_bf16 v[104:107], v[136:139], a[8:11], 0
    buffer_load_dwordx4 v170, s[28:31], s48 offen offset:2048 lds
    v_mfma_f32_16x16x32_bf16 v[108:111], v[136:139], a[12:15], 0
    s_waitcnt lgkmcnt(2)
    v_mfma_f32_16x16x32_bf16 v[112:115], v[140:143], a[0:3], 0
    ds_read_b64_tr_b16 v[148:149], v165 offset:16384
    ds_read_b64_tr_b16 v[150:151], v165 offset:16896
    v_mfma_f32_16x16x32_bf16 v[116:119], v[140:143], a[4:7], 0
    v_mfma_f32_16x16x32_bf16 v[120:123], v[140:143], a[8:11], 0
    buffer_load_dwordx4 v171, s[28:31], s48 offen offset:3072 lds
    v_mfma_f32_16x16x32_bf16 v[124:127], v[140:143], a[12:15], 0
    s_waitcnt lgkmcnt(2)
    s_add_u32 s48, s48, 114688
    s_cmp_lt_u32 s48, s50
    v_mfma_f32_16x16x32_bf16 v[64:67], v[144:147], a[16:19], v[64:67]
    ds_read_b64_tr_b16 v[152:153], v166 offset:16384
    ds_read_b64_tr_b16 v[154:155], v166 offset:16896
    v_mfma_f32_16x16x32_bf16 v[68:71], v[144:147], a[20:23], v[68:71]
    s_cselect_b32 s48, s48, s49
    s_add_u32 m0, s75, 131072
    v_mfma_f32_16x16x32_bf16 v[72:75], v[144:147], a[24:27], v[72:75]
    buffer_load_dwordx4 v168, s[28:31], s48 offen lds
    v_mfma_f32_16x16x32_bf16 v[76:79], v[144:147], a[28:31], v[76:79]
    s_waitcnt lgkmcnt(2)
    v_mfma_f32_16x16x32_bf16 v[80:83], v[148:151], a[16:19], v[80:83]
    ds_read_b64_tr_b16 v[156:157], v167 offset:16384
    ds_read_b64_tr_b16 v[158:159], v167 offset:16896
    v_mfma_f32_16x16x32_bf16 v[84:87], v[148:151], a[20:23], v[84:87]
    v_mfma_f32_16x16x32_bf16 v[88:91], v[148:151], a[24:27], v[88:91]
    buffer_load_dwordx4 v169, s[28:31], s48 offen offset:1024 lds
    v_mfma_f32_16x16x32_bf16 v[92:95], v[148:151], a[28:31], v[92:95]
    s_waitcnt vmcnt(14) lgkmcnt(2)
    v_mfma_f32_16x16x32_bf16 v[96:99], v[152:155], a[16:19], v[96:99]
    ds_read_b64_tr_b16 v[128:129], v160 offset:0
    ds_read_b64_tr_b16 v[130:131], v160 offset:512
    v_mfma_f32_16x16x32_bf16 v[100:103], v[152:155], a[20:23], v[100:103]
    v_mfma_f32_16x16x32_bf16 v[104:107], v[152:155], a[24:27], v[104:107]
    buffer_load_dwordx4 v170, s[28:31], s48 offen offset:2048 lds
    v_mfma_f32_16x16x32_bf16 v[108:111], v[152:155], a[28:31], v[108:111]
    s_waitcnt lgkmcnt(2)
    v_mfma_f32_16x16x32_bf16 v[112:115], v[156:159], a[16:19], v[112:115]
    ds_read_b64_tr_b16 v[132:133], v161 offset:0
    ds_read_b64_tr_b16 v[134:135], v161 offset:512
    v_mfma_f32_16x16x32_bf16 v[116:119], v[156:159], a[20:23], v[116:119]
    v_mfma_f32_16x16x32_bf16 v[120:123], v[156:159], a[24:27], v[120:123]
    buffer_load_dwordx4 v171, s[28:31], s48 offen offset:3072 lds
    v_mfma_f32_16x16x32_bf16 v[124:127], v[156:159], a[28:31], v[124:127]
    s_waitcnt lgkmcnt(2)
    s_add_u32 s48, s48, 114688
    s_cmp_lt_u32 s48, s50
    v_mfma_f32_16x16x32_bf16 v[64:67], v[128:131], a[32:35], v[64:67]
    ds_read_b64_tr_b16 v[136:137], v162 offset:0
    ds_read_b64_tr_b16 v[138:139], v162 offset:512
    v_mfma_f32_16x16x32_bf16 v[68:71], v[128:131], a[36:39], v[68:71]
    s_cselect_b32 s48, s48, s49
    s_add_u32 m0, s75, 147456
    v_mfma_f32_16x16x32_bf16 v[72:75], v[128:131], a[40:43], v[72:75]
    buffer_load_dwordx4 v168, s[28:31], s48 offen lds
    v_mfma_f32_16x16x32_bf16 v[76:79], v[128:131], a[44:47], v[76:79]
    s_waitcnt lgkmcnt(2)
    v_mfma_f32_16x16x32_bf16 v[80:83], v[132:135], a[32:35], v[80:83]
    ds_read_b64_tr_b16 v[140:141], v163 offset:0
    ds_read_b64_tr_b16 v[142:143], v163 offset:512
    v_mfma_f32_16x16x32_bf16 v[84:87], v[132:135], a[36:39], v[84:87]
    v_mfma_f32_16x16x32_bf16 v[88:91], v[132:135], a[40:43], v[88:91]
    buffer_load_dwordx4 v169, s[28:31], s48 offen offset:1024 lds
    v_mfma_f32_16x16x32_bf16 v[92:95], v[132:135], a[44:47], v[92:95]
    s_waitcnt vmcnt(14) lgkmcnt(2)
    v_mfma_f32_16x16x32_bf16 v[96:99], v[136:139], a[32:35], v[96:99]
    ds_read_b64_tr_b16 v[144:145], v160 offset:16384
    ds_read_b64_tr_b16 v[146:147], v160 offset:16896
    v_mfma_f32_16x16x32_bf16 v[100:103], v[136:139], a[36:39], v[100:103]
    v_mfma_f32_16x16x32_bf16 v[104:107], v[136:139], a[40:43], v[104:107]
    buffer_load_dwordx4 v170, s[28:31], s48 offen offset:2048 lds
    v_mfma_f32_16x16x32_bf16 v[108:111], v[136:139], a[44:47], v[108:111]
    s_waitcnt lgkmcnt(2)
    v_mfma_f32_16x16x32_bf16 v[112:115], v[140:143], a[32:35], v[112:115]
    ds_read_b64_tr_b16 v[148:149], v161 offset:16384
    ds_read_b64_tr_b16 v[150:151], v161 offset:16896
    v_mfma_f32_16x16x32_bf16 v[116:119], v[140:143], a[36:39], v[116:119]
    v_mfma_f32_16x16x32_bf16 v[120:123], v[140:143], a[40:43], v[120:123]
    buffer_load_dwordx4 v171, s[28:31], s48 offen offset:3072 lds
    v_mfma_f32_16x16x32_bf16 v[124:127], v[140:143], a[44:47], v[124:127]
    s_waitcnt lgkmcnt(2)
    s_add_u32 s48, s48, 114688
    s_cmp_lt_u32 s48, s50
    v_mfma_f32_16x16x32_bf16 v[64:67], v[144:147], a[48:51], v[64:67]
    ds_read_b64_tr_b16 v[152:153], v162 offset:16384
    ds_read_b64_tr_b16 v[154:155], v162 offset:16896
    v_mfma_f32_16x16x32_bf16 v[68:71], v[144:147], a[52:55], v[68:71]
    s_cselect_b32 s48, s48, s49
    s_add_u32 m0, s75, 65536
    v_mfma_f32_16x16x32_bf16 v[72:75], v[144:147], a[56:59], v[72:75]
    buffer_load_dwordx4 v168, s[28:31], s48 offen lds
    v_mfma_f32_16x16x32_bf16 v[76:79], v[144:147], a[60:63], v[76:79]
    s_waitcnt lgkmcnt(2)
    v_mfma_f32_16x16x32_bf16 v[80:83], v[148:151], a[48:51], v[80:83]
    ds_read_b64_tr_b16 v[156:157], v163 offset:16384
    ds_read_b64_tr_b16 v[158:159], v163 offset:16896
    v_mfma_f32_16x16x32_bf16 v[84:87], v[148:151], a[52:55], v[84:87]
    v_mfma_f32_16x16x32_bf16 v[88:91], v[148:151], a[56:59], v[88:91]
    buffer_load_dwordx4 v169, s[28:31], s48 offen offset:1024 lds
    v_mfma_f32_16x16x32_bf16 v[92:95], v[148:151], a[60:63], v[92:95]
    s_waitcnt vmcnt(14) lgkmcnt(2)
    v_mfma_f32_16x16x32_bf16 v[96:99], v[152:155], a[48:51], v[96:99]
    ds_read_b64_tr_b16 v[128:129], v160 offset:32768
    ds_read_b64_tr_b16 v[130:131], v160 offset:33280
    v_mfma_f32_16x16x32_bf16 v[100:103], v[152:155], a[52:55], v[100:103]
    v_mfma_f32_16x16x32_bf16 v[104:107], v[152:155], a[56:59], v[104:107]
    buffer_load_dwordx4 v170, s[28:31], s48 offen offset:2048 lds
    v_mfma_f32_16x16x32_bf16 v[108:111], v[152:155], a[60:63], v[108:111]
    s_waitcnt lgkmcnt(2)
    v_mfma_f32_16x16x32_bf16 v[112:115], v[156:159], a[48:51], v[112:115]
    ds_read_b64_tr_b16 v[132:133], v161 offset:32768
    ds_read_b64_tr_b16 v[134:135], v161 offset:33280
    v_mfma_f32_16x16x32_bf16 v[116:119], v[156:159], a[52:55], v[116:119]
    v_mfma_f32_16x16x32_bf16 v[120:123], v[156:159], a[56:59], v[120:123]
    buffer_load_dwordx4 v171, s[28:31], s48 offen offset:3072 lds
    v_mfma_f32_16x16x32_bf16 v[124:127], v[156:159], a[60:63], v[124:127]
    s_waitcnt lgkmcnt(2)
    s_add_u32 s48, s48, 114688
    s_cmp_lt_u32 s48, s50
    v_mfma_f32_16x16x32_bf16 v[64:67], v[128:131], a[64:67], v[64:67]
    ds_read_b64_tr_b16 v[136:137], v162 offset:32768
    ds_read_b64_tr_b16 v[138:139], v162 offset:33280
    v_mfma_f32_16x16x32_bf16 v[68:71], v[128:131], a[68:71], v[68:71]
    s_cselect_b32 s48, s48, s49
    s_add_u32 m0, s75, 81920
    v_mfma_f32_16x16x32_bf16 v[72:75], v[128:131], a[72:75], v[72:75]
    buffer_load_dwordx4 v168, s[28:31], s48 offen lds
    v_mfma_f32_16x16x32_bf16 v[76:79], v[128:131], a[76:79], v[76:79]
    s_waitcnt lgkmcnt(2)
    v_mfma_f32_16x16x32_bf16 v[80:83], v[132:135], a[64:67], v[80:83]
    ds_read_b64_tr_b16 v[140:141], v163 offset:32768
    ds_read_b64_tr_b16 v[142:143], v163 offset:33280
    v_mfma_f32_16x16x32_bf16 v[84:87], v[132:135], a[68:71], v[84:87]
    v_mfma_f32_16x16x32_bf16 v[88:91], v[132:135], a[72:75], v[88:91]
    buffer_load_dwordx4 v169, s[28:31], s48 offen offset:1024 lds
    v_mfma_f32_16x16x32_bf16 v[92:95], v[132:135], a[76:79], v[92:95]
    s_waitcnt vmcnt(14) lgkmcnt(2)
    v_mfma_f32_16x16x32_bf16 v[96:99], v[136:139], a[64:67], v[96:99]
    ds_read_b64_tr_b16 v[144:145], v160 offset:49152
    ds_read_b64_tr_b16 v[146:147], v160 offset:49664
    v_mfma_f32_16x16x32_bf16 v[100:103], v[136:139], a[68:71], v[100:103]
    v_mfma_f32_16x16x32_bf16 v[104:107], v[136:139], a[72:75], v[104:107]
    buffer_load_dwordx4 v170, s[28:31], s48 offen offset:2048 lds
    v_mfma_f32_16x16x32_bf16 v[108:111], v[136:139], a[76:79], v[108:111]
    s_waitcnt lgkmcnt(2)
    v_mfma_f32_16x16x32_bf16 v[112:115], v[140:143], a[64:67], v[112:115]
    ds_read_b64_tr_b16 v[148:149], v161 offset:49152
    ds_read_b64_tr_b16 v[150:151], v161 offset:49664
    v_mfma_f32_16x16x32_bf16 v[116:119], v[140:143], a[68:71], v[116:119]
    v_mfma_f32_16x16x32_bf16 v[120:123], v[140:143], a[72:75], v[120:123]
    buffer_load_dwordx4 v171, s[28:31], s48 offen offset:3072 lds
    v_mfma_f32_16x16x32_bf16 v[124:127], v[140:143], a[76:79], v[124:127]
    s_waitcnt lgkmcnt(2)
    s_add_u32 s48, s48, 114688
    s_cmp_lt_u32 s48, s50
    v_mfma_f32_16x16x32_bf16 v[64:67], v[144:147], a[80:83], v[64:67]
    ds_read_b64_tr_b16 v[152:153], v162 offset:49152
    ds_read_b64_tr_b16 v[154:155], v162 offset:49664
    v_mfma_f32_16x16x32_bf16 v[68:71], v[144:147], a[84:87], v[68:71]
    s_cselect_b32 s48, s48, s49
    s_add_u32 m0, s75, 98304
    v_mfma_f32_16x16x32_bf16 v[72:75], v[144:147], a[88:91], v[72:75]
    buffer_load_dwordx4 v168, s[28:31], s48 offen lds
    v_mfma_f32_16x16x32_bf16 v[76:79], v[144:147], a[92:95], v[76:79]
    s_waitcnt lgkmcnt(2)
    v_mfma_f32_16x16x32_bf16 v[80:83], v[148:151], a[80:83], v[80:83]
    ds_read_b64_tr_b16 v[156:157], v163 offset:49152
    ds_read_b64_tr_b16 v[158:159], v163 offset:49664
    v_mfma_f32_16x16x32_bf16 v[84:87], v[148:151], a[84:87], v[84:87]
    v_mfma_f32_16x16x32_bf16 v[88:91], v[148:151], a[88:91], v[88:91]
    buffer_load_dwordx4 v169, s[28:31], s48 offen offset:1024 lds
    v_mfma_f32_16x16x32_bf16 v[92:95], v[148:151], a[92:95], v[92:95]
    s_waitcnt vmcnt(14) lgkmcnt(2)
    v_mfma_f32_16x16x32_bf16 v[96:99], v[152:155], a[80:83], v[96:99]
    ds_read_b64_tr_b16 v[128:129], v164 offset:0
    ds_read_b64_tr_b16 v[130:131], v164 offset:512
    v_mfma_f32_16x16x32_bf16 v[100:103], v[152:155], a[84:87], v[100:103]
    v_mfma_f32_16x16x32_bf16 v[104:107], v[152:155], a[88:91], v[104:107]
    buffer_load_dwordx4 v170, s[28:31], s48 offen offset:2048 lds
    v_mfma_f32_16x16x32_bf16 v[108:111], v[152:155], a[92:95], v[108:111]
    s_waitcnt lgkmcnt(2)
    v_mfma_f32_16x16x32_bf16 v[112:115], v[156:159], a[80:83], v[112:115]
    ds_read_b64_tr_b16 v[132:133], v165 offset:0
    ds_read_b64_tr_b16 v[134:135], v165 offset:512
    v_mfma_f32_16x16x32_bf16 v[116:119], v[156:159], a[84:87], v[116:119]
    v_mfma_f32_16x16x32_bf16 v[120:123], v[156:159], a[88:91], v[120:123]
    buffer_load_dwordx4 v171, s[28:31], s48 offen offset:3072 lds
    v_mfma_f32_16x16x32_bf16 v[124:127], v[156:159], a[92:95], v[124:127]
    s_waitcnt lgkmcnt(2)
    s_add_u32 s48, s48, 114688
    s_cmp_lt_u32 s48, s50
    v_mfma_f32_16x16x32_bf16 v[64:67], v[128:131], a[96:99], v[64:67]
    ds_read_b64_tr_b16 v[136:137], v166 offset:0
    ds_read_b64_tr_b16 v[138:139], v166 offset:512
    v_mfma_f32_16x16x32_bf16 v[68:71], v[128:131], a[100:103], v[68:71]
    s_cselect_b32 s48, s48, s49
    s_add_u32 m0, s75, 114688
    v_mfma_f32_16x16x32_bf16 v[72:75], v[128:131], a[104:107], v[72:75]
    buffer_load_dwordx4 v168, s[28:31], s48 offen lds
    v_mfma_f32_16x16x32_bf16 v[76:79], v[128:131], a[108:111], v[76:79]
    s_waitcnt lgkmcnt(2)
    v_mfma_f32_16x16x32_bf16 v[80:83], v[132:135], a[96:99], v[80:83]
    ds_read_b64_tr_b16 v[140:141], v167 offset:0
    ds_read_b64_tr_b16 v[142:143], v167 offset:512
    v_mfma_f32_16x16x32_bf16 v[84:87], v[132:135], a[100:103], v[84:87]
    v_mfma_f32_16x16x32_bf16 v[88:91], v[132:135], a[104:107], v[88:91]
    buffer_load_dwordx4 v169, s[28:31], s48 offen offset:1024 lds
    v_mfma_f32_16x16x32_bf16 v[92:95], v[132:135], a[108:111], v[92:95]
    s_waitcnt vmcnt(14) lgkmcnt(2)
    v_mfma_f32_16x16x32_bf16 v[96:99], v[136:139], a[96:99], v[96:99]
    ds_read_b64_tr_b16 v[144:145], v164 offset:16384
    ds_read_b64_tr_b16 v[146:147], v164 offset:16896
    v_mfma_f32_16x16x32_bf16 v[100:103], v[136:139], a[100:103], v[100:103]
    v_mfma_f32_16x16x32_bf16 v[104:107], v[136:139], a[104:107], v[104:107]
    buffer_load_dwordx4 v170, s[28:31], s48 offen offset:2048 lds
    v_mfma_f32_16x16x32_bf16 v[108:111], v[136:139], a[108:111], v[108:111]
    s_waitcnt lgkmcnt(2)
    v_mfma_f32_16x16x32_bf16 v[112:115], v[140:143], a[96:99], v[112:115]
    ds_read_b64_tr_b16 v[148:149], v165 offset:16384
    ds_read_b64_tr_b16 v[150:151], v165 offset:16896
    v_mfma_f32_16x16x32_bf16 v[116:119], v[140:143], a[100:103], v[116:119]
    v_mfma_f32_16x16x32_bf16 v[120:123], v[140:143], a[104:107], v[120:123]
    buffer_load_dwordx4 v171, s[28:31], s48 offen offset:3072 lds
    v_mfma_f32_16x16x32_bf16 v[124:127], v[140:143], a[108:111], v[124:127]
    s_waitcnt lgkmcnt(2)
    s_add_u32 s48, s48, 114688
    s_cmp_lt_u32 s48, s50
    v_mfma_f32_16x16x32_bf16 v[64:67], v[144:147], a[112:115], v[64:67]
    ds_read_b64_tr_b16 v[152:153], v166 offset:16384
    ds_read_b64_tr_b16 v[154:155], v166 offset:16896
    v_mfma_f32_16x16x32_bf16 v[68:71], v[144:147], a[116:119], v[68:71]
    s_cselect_b32 s48, s48, s49
    s_add_u32 m0, s75, 131072
    v_mfma_f32_16x16x32_bf16 v[72:75], v[144:147], a[120:123], v[72:75]
    buffer_load_dwordx4 v168, s[28:31], s48 offen lds
    v_mfma_f32_16x16x32_bf16 v[76:79], v[144:147], a[124:127], v[76:79]
    s_waitcnt lgkmcnt(2)
    v_mfma_f32_16x16x32_bf16 v[80:83], v[148:151], a[112:115], v[80:83]
    ds_read_b64_tr_b16 v[156:157], v167 offset:16384
    ds_read_b64_tr_b16 v[158:159], v167 offset:16896
    v_mfma_f32_16x16x32_bf16 v[84:87], v[148:151], a[116:119], v[84:87]
    v_mfma_f32_16x16x32_bf16 v[88:91], v[148:151], a[120:123], v[88:91]
    buffer_load_dwordx4 v169, s[28:31], s48 offen offset:1024 lds
    v_mfma_f32_16x16x32_bf16 v[92:95], v[148:151], a[124:127], v[92:95]
    s_waitcnt vmcnt(14) lgkmcnt(2)
    v_mfma_f32_16x16x32_bf16 v[96:99], v[152:155], a[112:115], v[96:99]
    ds_read_b64_tr_b16 v[128:129], v160 offset:0
    ds_read_b64_tr_b16 v[130:131], v160 offset:512
    v_mfma_f32_16x16x32_bf16 v[100:103], v[152:155], a[116:119], v[100:103]
    v_mfma_f32_16x16x32_bf16 v[104:107], v[152:155], a[120:123], v[104:107]
    buffer_load_dwordx4 v170, s[28:31], s48 offen offset:2048 lds
    v_mfma_f32_16x16x32_bf16 v[108:111], v[152:155], a[124:127], v[108:111]
    s_waitcnt lgkmcnt(2)
    v_mfma_f32_16x16x32_bf16 v[112:115], v[156:159], a[112:115], v[112:115]
    ds_read_b64_tr_b16 v[132:133], v161 offset:0
    ds_read_b64_tr_b16 v[134:135], v161 offset:512
    v_mfma_f32_16x16x32_bf16 v[116:119], v[156:159], a[116:119], v[116:119]
    v_mfma_f32_16x16x32_bf16 v[120:123], v[156:159], a[120:123], v[120:123]
    buffer_load_dwordx4 v171, s[28:31], s48 offen offset:3072 lds
    v_mfma_f32_16x16x32_bf16 v[124:127], v[156:159], a[124:127], v[124:127]
    s_waitcnt lgkmcnt(2)
    s_add_u32 s48, s48, 114688
    s_cmp_lt_u32 s48, s50
    v_mfma_f32_16x16x32_bf16 v[64:67], v[128:131], a[128:131], v[64:67]
    ds_read_b64_tr_b16 v[136:137], v162 offset:0
    ds_read_b64_tr_b16 v[138:139], v162 offset:512
    v_mfma_f32_16x16x32_bf16 v[68:71], v[128:131], a[132:135], v[68:71]
    s_cselect_b32 s48, s48, s49
    s_add_u32 m0, s75, 147456
    v_mfma_f32_16x16x32_bf16 v[72:75], v[128:131], a[136:139], v[72:75]
    buffer_load_dwordx4 v168, s[28:31], s48 offen lds
    v_mfma_f32_16x16x32_bf16 v[76:79], v[128:131], a[140:143], v[76:79]
    s_waitcnt lgkmcnt(2)
    v_mfma_f32_16x16x32_bf16 v[80:83], v[132:135], a[128:131], v[80:83]
    ds_read_b64_tr_b16 v[140:141], v163 offset:0
    ds_read_b64_tr_b16 v[142:143], v163 offset:512
    v_mfma_f32_16x16x32_bf16 v[84:87], v[132:135], a[132:135], v[84:87]
    v_mfma_f32_16x16x32_bf16 v[88:91], v[132:135], a[136:139], v[88:91]
    buffer_load_dwordx4 v169, s[28:31], s48 offen offset:1024 lds
    v_mfma_f32_16x16x32_bf16 v[92:95], v[132:135], a[140:143], v[92:95]
    s_waitcnt vmcnt(14) lgkmcnt(2)
    v_mfma_f32_16x16x32_bf16 v[96:99], v[136:139], a[128:131], v[96:99]
    ds_read_b64_tr_b16 v[144:145], v160 offset:16384
    ds_read_b64_tr_b16 v[146:147], v160 offset:16896
    v_mfma_f32_16x16x32_bf16 v[100:103], v[136:139], a[132:135], v[100:103]
    v_mfma_f32_16x16x32_bf16 v[104:107], v[136:139], a[136:139], v[104:107]
    buffer_load_dwordx4 v170, s[28:31], s48 offen offset:2048 lds
    v_mfma_f32_16x16x32_bf16 v[108:111], v[136:139], a[140:143], v[108:111]
    s_waitcnt lgkmcnt(2)
    v_mfma_f32_16x16x32_bf16 v[112:115], v[140:143], a[128:131], v[112:115]
    ds_read_b64_tr_b16 v[148:149], v161 offset:16384
    ds_read_b64_tr_b16 v[150:151], v161 offset:16896
    v_mfma_f32_16x16x32_bf16 v[116:119], v[140:143], a[132:135], v[116:119]
    v_mfma_f32_16x16x32_bf16 v[120:123], v[140:143], a[136:139], v[120:123]
    buffer_load_dwordx4 v171, s[28:31], s48 offen offset:3072 lds
    v_mfma_f32_16x16x32_bf16 v[124:127], v[140:143], a[140:143], v[124:127]
    s_waitcnt lgkmcnt(2)
    s_add_u32 s48, s48, 114688
    s_cmp_lt_u32 s48, s50
    v_mfma_f32_16x16x32_bf16 v[64:67], v[144:147], a[144:147], v[64:67]
    ds_read_b64_tr_b16 v[152:153], v162 offset:16384
    ds_read_b64_tr_b16 v[154:155], v162 offset:16896
    v_mfma_f32_16x16x32_bf16 v[68:71], v[144:147], a[148:151], v[68:71]
    s_cselect_b32 s48, s48, s49
    s_add_u32 m0, s75, 65536
    v_mfma_f32_16x16x32_bf16 v[72:75], v[144:147], a[152:155], v[72:75]
    buffer_load_dwordx4 v168, s[28:31], s48 offen lds
    v_mfma_f32_16x16x32_bf16 v[76:79], v[144:147], a[156:159], v[76:79]
    s_waitcnt lgkmcnt(2)
    v_mfma_f32_16x16x32_bf16 v[80:83], v[148:151], a[144:147], v[80:83]
    ds_read_b64_tr_b16 v[156:157], v163 offset:16384
    ds_read_b64_tr_b16 v[158:159], v163 offset:16896
    v_mfma_f32_16x16x32_bf16 v[84:87], v[148:151], a[148:151], v[84:87]
    v_mfma_f32_16x16x32_bf16 v[88:91], v[148:151], a[152:155], v[88:91]
    buffer_load_dwordx4 v169, s[28:31], s48 offen offset:1024 lds
    v_mfma_f32_16x16x32_bf16 v[92:95], v[148:151], a[156:159], v[92:95]
    s_waitcnt vmcnt(14) lgkmcnt(2)
    v_mfma_f32_16x16x32_bf16 v[96:99], v[152:155], a[144:147], v[96:99]
    ds_read_b64_tr_b16 v[128:129], v160 offset:32768
    ds_read_b64_tr_b16 v[130:131], v160 offset:33280
    v_mfma_f32_16x16x32_bf16 v[100:103], v[152:155], a[148:151], v[100:103]
    v_mfma_f32_16x16x32_bf16 v[104:107], v[152:155], a[152:155], v[104:107]
    buffer_load_dwordx4 v170, s[28:31], s48 offen offset:2048 lds
    v_mfma_f32_16x16x32_bf16 v[108:111], v[152:155], a[156:159], v[108:111]
    s_waitcnt lgkmcnt(2)
    v_mfma_f32_16x16x32_bf16 v[112:115], v[156:159], a[144:147], v[112:115]
    ds_read_b64_tr_b16 v[132:133], v161 offset:32768
    ds_read_b64_tr_b16 v[134:135], v161 offset:33280
    v_mfma_f32_16x16x32_bf16 v[116:119], v[156:159], a[148:151], v[116:119]
    v_mfma_f32_16x16x32_bf16 v[120:123], v[156:159], a[152:155], v[120:123]
    buffer_load_dwordx4 v171, s[28:31], s48 offen offset:3072 lds
    v_mfma_f32_16x16x32_bf16 v[124:127], v[156:159], a[156:159], v[124:127]
    s_waitcnt lgkmcnt(2)
    s_add_u32 s48, s48, 114688
    s_cmp_lt_u32 s48, s50
    v_mfma_f32_16x16x32_bf16 v[64:67], v[128:131], a[160:163], v[64:67]
    ds_read_b64_tr_b16 v[136:137], v162 offset:32768
    ds_read_b64_tr_b16 v[138:139], v162 offset:33280
    v_mfma_f32_16x16x32_bf16 v[68:71], v[128:131], a[164:167], v[68:71]
    s_cselect_b32 s48, s48, s49
    s_add_u32 m0, s75, 81920
    v_mfma_f32_16x16x32_bf16 v[72:75], v[128:131], a[168:171], v[72:75]
    buffer_load_dwordx4 v168, s[28:31], s48 offen lds
    v_mfma_f32_16x16x32_bf16 v[76:79], v[128:131], a[172:175], v[76:79]
    s_waitcnt lgkmcnt(2)
    v_mfma_f32_16x16x32_bf16 v[80:83], v[132:135], a[160:163], v[80:83]
    ds_read_b64_tr_b16 v[140:141], v163 offset:32768
    ds_read_b64_tr_b16 v[142:143], v163 offset:33280
    v_mfma_f32_16x16x32_bf16 v[84:87], v[132:135], a[164:167], v[84:87]
    v_mfma_f32_16x16x32_bf16 v[88:91], v[132:135], a[168:171], v[88:91]
    buffer_load_dwordx4 v169, s[28:31], s48 offen offset:1024 lds
    v_mfma_f32_16x16x32_bf16 v[92:95], v[132:135], a[172:175], v[92:95]
    s_waitcnt vmcnt(14) lgkmcnt(2)
    v_mfma_f32_16x16x32_bf16 v[96:99], v[136:139], a[160:163], v[96:99]
    ds_read_b64_tr_b16 v[144:145], v160 offset:49152
    ds_read_b64_tr_b16 v[146:147], v160 offset:49664
    v_mfma_f32_16x16x32_bf16 v[100:103], v[136:139], a[164:167], v[100:103]
    v_mfma_f32_16x16x32_bf16 v[104:107], v[136:139], a[168:171], v[104:107]
    buffer_load_dwordx4 v170, s[28:31], s48 offen offset:2048 lds
    v_mfma_f32_16x16x32_bf16 v[108:111], v[136:139], a[172:175], v[108:111]
    s_waitcnt lgkmcnt(2)
    v_mfma_f32_16x16x32_bf16 v[112:115], v[140:143], a[160:163], v[112:115]
    ds_read_b64_tr_b16 v[148:149], v161 offset:49152
    ds_read_b64_tr_b16 v[150:151], v161 offset:49664
    v_mfma_f32_16x16x32_bf16 v[116:119], v[140:143], a[164:167], v[116:119]
    v_mfma_f32_16x16x32_bf16 v[120:123], v[140:143], a[168:171], v[120:123]
    buffer_load_dwordx4 v171, s[28:31], s48 offen offset:3072 lds
    v_mfma_f32_16x16x32_bf16 v[124:127], v[140:143], a[172:175], v[124:127]
    s_waitcnt lgkmcnt(2)
    s_add_u32 m0, s75, 98304
    v_mfma_f32_16x16x32_bf16 v[64:67], v[144:147], a[176:179], v[64:67]
    ds_read_b64_tr_b16 v[152:153], v162 offset:49152
    ds_read_b64_tr_b16 v[154:155], v162 offset:49664
    v_mfma_f32_16x16x32_bf16 v[68:71], v[144:147], a[180:183], v[68:71]
    v_mfma_f32_16x16x32_bf16 v[72:75], v[144:147], a[184:187], v[72:75]
    buffer_load_dwordx4 v172, s[16:19], s51 offen lds
    v_mfma_f32_16x16x32_bf16 v[76:79], v[144:147], a[188:191], v[76:79]
    s_waitcnt lgkmcnt(2)
    v_mfma_f32_16x16x32_bf16 v[80:83], v[148:151], a[176:179], v[80:83]
    ds_read_b64_tr_b16 v[156:157], v163 offset:49152
    ds_read_b64_tr_b16 v[158:159], v163 offset:49664
    v_mfma_f32_16x16x32_bf16 v[84:87], v[148:151], a[180:183], v[84:87]
    v_mfma_f32_16x16x32_bf16 v[88:91], v[148:151], a[184:187], v[88:91]
    buffer_load_dwordx4 v173, s[16:19], s51 offen offset:1024 lds
    v_mfma_f32_16x16x32_bf16 v[92:95], v[148:151], a[188:191], v[92:95]
    s_waitcnt vmcnt(14) lgkmcnt(2)
    v_mfma_f32_16x16x32_bf16 v[96:99], v[152:155], a[176:179], v[96:99]
    ds_read_b64_tr_b16 v[128:129], v164 offset:0
    ds_read_b64_tr_b16 v[130:131], v164 offset:512
    v_mfma_f32_16x16x32_bf16 v[100:103], v[152:155], a[180:183], v[100:103]
    v_mfma_f32_16x16x32_bf16 v[104:107], v[152:155], a[184:187], v[104:107]
    buffer_load_dwordx4 v174, s[16:19], s51 offen offset:2048 lds
    v_mfma_f32_16x16x32_bf16 v[108:111], v[152:155], a[188:191], v[108:111]
    s_waitcnt lgkmcnt(2)
    v_mfma_f32_16x16x32_bf16 v[112:115], v[156:159], a[176:179], v[112:115]
    ds_read_b64_tr_b16 v[132:133], v165 offset:0
    ds_read_b64_tr_b16 v[134:135], v165 offset:512
    v_mfma_f32_16x16x32_bf16 v[116:119], v[156:159], a[180:183], v[116:119]
    v_mfma_f32_16x16x32_bf16 v[120:123], v[156:159], a[184:187], v[120:123]
    buffer_load_dwordx4 v175, s[16:19], s51 offen offset:3072 lds
    v_mfma_f32_16x16x32_bf16 v[124:127], v[156:159], a[188:191], v[124:127]
    s_waitcnt lgkmcnt(2)
    s_add_u32 s51, s51, 262144
    s_and_b32 s51, s51, 4194303
    v_mfma_f32_16x16x32_bf16 v[64:67], v[128:131], a[192:195], v[64:67]
    ds_read_b64_tr_b16 v[136:137], v166 offset:0
    ds_read_b64_tr_b16 v[138:139], v166 offset:512
    v_mfma_f32_16x16x32_bf16 v[68:71], v[128:131], a[196:199], v[68:71]
    s_add_u32 m0, s75, 114688
    v_mfma_f32_16x16x32_bf16 v[72:75], v[128:131], a[200:203], v[72:75]
    buffer_load_dwordx4 v172, s[16:19], s51 offen lds
    v_mfma_f32_16x16x32_bf16 v[76:79], v[128:131], a[204:207], v[76:79]
    s_waitcnt lgkmcnt(2)
    v_mfma_f32_16x16x32_bf16 v[80:83], v[132:135], a[192:195], v[80:83]
    ds_read_b64_tr_b16 v[140:141], v167 offset:0
    ds_read_b64_tr_b16 v[142:143], v167 offset:512
    v_mfma_f32_16x16x32_bf16 v[84:87], v[132:135], a[196:199], v[84:87]
    v_mfma_f32_16x16x32_bf16 v[88:91], v[132:135], a[200:203], v[88:91]
    buffer_load_dwordx4 v173, s[16:19], s51 offen offset:1024 lds
    v_mfma_f32_16x16x32_bf16 v[92:95], v[132:135], a[204:207], v[92:95]
    s_waitcnt vmcnt(14) lgkmcnt(2)
    v_mfma_f32_16x16x32_bf16 v[96:99], v[136:139], a[192:195], v[96:99]
    ds_read_b64_tr_b16 v[144:145], v164 offset:16384
    ds_read_b64_tr_b16 v[146:147], v164 offset:16896
    v_mfma_f32_16x16x32_bf16 v[100:103], v[136:139], a[196:199], v[100:103]
    v_mfma_f32_16x16x32_bf16 v[104:107], v[136:139], a[200:203], v[104:107]
    buffer_load_dwordx4 v174, s[16:19], s51 offen offset:2048 lds
    v_mfma_f32_16x16x32_bf16 v[108:111], v[136:139], a[204:207], v[108:111]
    s_waitcnt lgkmcnt(2)
    v_mfma_f32_16x16x32_bf16 v[112:115], v[140:143], a[192:195], v[112:115]
    ds_read_b64_tr_b16 v[148:149], v165 offset:16384
    ds_read_b64_tr_b16 v[150:151], v165 offset:16896
    v_mfma_f32_16x16x32_bf16 v[116:119], v[140:143], a[196:199], v[116:119]
    v_mfma_f32_16x16x32_bf16 v[120:123], v[140:143], a[200:203], v[120:123]
    buffer_load_dwordx4 v175, s[16:19], s51 offen offset:3072 lds
    v_mfma_f32_16x16x32_bf16 v[124:127], v[140:143], a[204:207], v[124:127]
    s_waitcnt lgkmcnt(2)
    s_add_u32 s51, s51, 262144
    s_and_b32 s51, s51, 4194303
    v_mfma_f32_16x16x32_bf16 v[64:67], v[144:147], a[208:211], v[64:67]
    ds_read_b64_tr_b16 v[152:153], v166 offset:16384
    ds_read_b64_tr_b16 v[154:155], v166 offset:16896
    v_mfma_f32_16x16x32_bf16 v[68:71], v[144:147], a[212:215], v[68:71]
    s_add_u32 m0, s75, 131072
    v_mfma_f32_16x16x32_bf16 v[72:75], v[144:147], a[216:219], v[72:75]
    buffer_load_dwordx4 v172, s[16:19], s51 offen lds
    v_mfma_f32_16x16x32_bf16 v[76:79], v[144:147], a[220:223], v[76:79]
    s_waitcnt lgkmcnt(2)
    v_mfma_f32_16x16x32_bf16 v[80:83], v[148:151], a[208:211], v[80:83]
    ds_read_b64_tr_b16 v[156:157], v167 offset:16384
    ds_read_b64_tr_b16 v[158:159], v167 offset:16896
    v_mfma_f32_16x16x32_bf16 v[84:87], v[148:151], a[212:215], v[84:87]
    v_mfma_f32_16x16x32_bf16 v[88:91], v[148:151], a[216:219], v[88:91]
    buffer_load_dwordx4 v173, s[16:19], s51 offen offset:1024 lds
    v_mfma_f32_16x16x32_bf16 v[92:95], v[148:151], a[220:223], v[92:95]
    s_waitcnt vmcnt(14) lgkmcnt(2)
    v_mfma_f32_16x16x32_bf16 v[96:99], v[152:155], a[208:211], v[96:99]
    ds_read_b64_tr_b16 v[128:129], v160 offset:0
    ds_read_b64_tr_b16 v[130:131], v160 offset:512
    v_mfma_f32_16x16x32_bf16 v[100:103], v[152:155], a[212:215], v[100:103]
    v_mfma_f32_16x16x32_bf16 v[104:107], v[152:155], a[216:219], v[104:107]
    buffer_load_dwordx4 v174, s[16:19], s51 offen offset:2048 lds
    v_mfma_f32_16x16x32_bf16 v[108:111], v[152:155], a[220:223], v[108:111]
    s_waitcnt lgkmcnt(2)
    v_mfma_f32_16x16x32_bf16 v[112:115], v[156:159], a[208:211], v[112:115]
    ds_read_b64_tr_b16 v[132:133], v161 offset:0
    ds_read_b64_tr_b16 v[134:135], v161 offset:512
    v_mfma_f32_16x16x32_bf16 v[116:119], v[156:159], a[212:215], v[116:119]
    v_mfma_f32_16x16x32_bf16 v[120:123], v[156:159], a[216:219], v[120:123]
    buffer_load_dwordx4 v175, s[16:19], s51 offen offset:3072 lds
    v_mfma_f32_16x16x32_bf16 v[124:127], v[156:159], a[220:223], v[124:127]
    s_waitcnt lgkmcnt(2)
    s_add_u32 s51, s51, 262144
    s_and_b32 s51, s51, 4194303
    v_mfma_f32_16x16x32_bf16 v[64:67], v[128:131], a[224:227], v[64:67]
    ds_read_b64_tr_b16 v[136:137], v162 offset:0
    ds_read_b64_tr_b16 v[138:139], v162 offset:512
    v_mfma_f32_16x16x32_bf16 v[68:71], v[128:131], a[228:231], v[68:71]
    s_add_u32 m0, s75, 147456
    v_mfma_f32_16x16x32_bf16 v[72:75], v[128:131], a[232:235], v[72:75]
    buffer_load_dwordx4 v172, s[16:19], s51 offen lds
    v_mfma_f32_16x16x32_bf16 v[76:79], v[128:131], a[236:239], v[76:79]
    s_waitcnt lgkmcnt(2)
    v_mfma_f32_16x16x32_bf16 v[80:83], v[132:135], a[224:227], v[80:83]
    ds_read_b64_tr_b16 v[140:141], v163 offset:0
    ds_read_b64_tr_b16 v[142:143], v163 offset:512
    v_mfma_f32_16x16x32_bf16 v[84:87], v[132:135], a[228:231], v[84:87]
    v_mfma_f32_16x16x32_bf16 v[88:91], v[132:135], a[232:235], v[88:91]
    buffer_load_dwordx4 v173, s[16:19], s51 offen offset:1024 lds
    v_mfma_f32_16x16x32_bf16 v[92:95], v[132:135], a[236:239], v[92:95]
    s_waitcnt vmcnt(14) lgkmcnt(2)
    v_mfma_f32_16x16x32_bf16 v[96:99], v[136:139], a[224:227], v[96:99]
    ds_read_b64_tr_b16 v[144:145], v160 offset:16384
    ds_read_b64_tr_b16 v[146:147], v160 offset:16896
    v_mfma_f32_16x16x32_bf16 v[100:103], v[136:139], a[228:231], v[100:103]
    v_mfma_f32_16x16x32_bf16 v[104:107], v[136:139], a[232:235], v[104:107]
    buffer_load_dwordx4 v174, s[16:19], s51 offen offset:2048 lds
    v_mfma_f32_16x16x32_bf16 v[108:111], v[136:139], a[236:239], v[108:111]
    s_waitcnt lgkmcnt(2)
    v_mfma_f32_16x16x32_bf16 v[112:115], v[140:143], a[224:227], v[112:115]
    ds_read_b64_tr_b16 v[148:149], v161 offset:16384
    ds_read_b64_tr_b16 v[150:151], v161 offset:16896
    v_mfma_f32_16x16x32_bf16 v[116:119], v[140:143], a[228:231], v[116:119]
    v_mfma_f32_16x16x32_bf16 v[120:123], v[140:143], a[232:235], v[120:123]
    buffer_load_dwordx4 v175, s[16:19], s51 offen offset:3072 lds
    v_mfma_f32_16x16x32_bf16 v[124:127], v[140:143], a[236:239], v[124:127]
    s_waitcnt lgkmcnt(2)
    s_add_u32 s51, s51, 262144
    s_and_b32 s51, s51, 4194303
    v_mfma_f32_16x16x32_bf16 v[64:67], v[144:147], a[240:243], v[64:67]
    ds_read_b64_tr_b16 v[152:153], v162 offset:16384
    ds_read_b64_tr_b16 v[154:155], v162 offset:16896
    v_mfma_f32_16x16x32_bf16 v[68:71], v[144:147], a[244:247], v[68:71]
    s_add_u32 m0, s75, 65536
    v_mfma_f32_16x16x32_bf16 v[72:75], v[144:147], a[248:251], v[72:75]
    buffer_load_dwordx4 v172, s[16:19], s51 offen lds
    v_mfma_f32_16x16x32_bf16 v[76:79], v[144:147], a[252:255], v[76:79]
    s_waitcnt lgkmcnt(2)
    v_mfma_f32_16x16x32_bf16 v[80:83], v[148:151], a[240:243], v[80:83]
    ds_read_b64_tr_b16 v[156:157], v163 offset:16384
    ds_read_b64_tr_b16 v[158:159], v163 offset:16896
    v_mfma_f32_16x16x32_bf16 v[84:87], v[148:151], a[244:247], v[84:87]
    v_mul_f32 v64, v0, v64
    v_mul_f32 v65, v1, v65
    v_mfma_f32_16x16x32_bf16 v[88:91], v[148:151], a[248:251], v[88:91]
    buffer_load_dwordx4 v173, s[16:19], s51 offen offset:1024 lds
    v_mfma_f32_16x16x32_bf16 v[92:95], v[148:151], a[252:255], v[92:95]
    s_waitcnt vmcnt(14) lgkmcnt(2)
    v_mul_f32 v66, v2, v66
    v_mul_f32 v67, v3, v67
    v_mfma_f32_16x16x32_bf16 v[96:99], v[152:155], a[240:243], v[96:99]
    ds_read_b64_tr_b16 v[128:129], v160 offset:32768
    ds_read_b64_tr_b16 v[130:131], v160 offset:33280
    v_mfma_f32_16x16x32_bf16 v[100:103], v[152:155], a[244:247], v[100:103]
    v_mul_f32 v68, v4, v68
    v_mul_f32 v69, v5, v69
    v_mfma_f32_16x16x32_bf16 v[104:107], v[152:155], a[248:251], v[104:107]
    buffer_load_dwordx4 v174, s[16:19], s51 offen offset:2048 lds
    v_mfma_f32_16x16x32_bf16 v[108:111], v[152:155], a[252:255], v[108:111]
    s_waitcnt lgkmcnt(2)
    v_mul_f32 v70, v6, v70
    v_mul_f32 v71, v7, v71
    v_mfma_f32_16x16x32_bf16 v[112:115], v[156:159], a[240:243], v[112:115]
    ds_read_b64_tr_b16 v[132:133], v161 offset:32768
    ds_read_b64_tr_b16 v[134:135], v161 offset:33280
    v_mfma_f32_16x16x32_bf16 v[116:119], v[156:159], a[244:247], v[116:119]
    v_mul_f32 v72, v8, v72
    v_mul_f32 v73, v9, v73
    v_mfma_f32_16x16x32_bf16 v[120:123], v[156:159], a[248:251], v[120:123]
    buffer_load_dwordx4 v175, s[16:19], s51 offen offset:3072 lds
    v_mfma_f32_16x16x32_bf16 v[124:127], v[156:159], a[252:255], v[124:127]
    s_waitcnt lgkmcnt(2)
    v_mul_f32 v74, v10, v74
    v_mul_f32 v75, v11, v75
L_Q:
    v_mfma_f32_16x16x32_bf16 v[0:3], v[128:131], a[0:3], 0
    ds_read_b64_tr_b16 v[136:137], v162 offset:32768
    ds_read_b64_tr_b16 v[138:139], v162 offset:33280
    v_mfma_f32_16x16x32_bf16 v[4:7], v[128:131], a[4:7], 0
    s_add_u32 s51, s51, 262144
    s_and_b32 s51, s51, 4194303
    s_add_u32 m0, s75, 81920
    v_mul_f32 v76, v12, v76
    v_mul_f32 v77, v13, v77
    v_mul_f32 v78, v14, v78
    v_mul_f32 v79, v15, v79
    v_mfma_f32_16x16x32_bf16 v[8:11], v[128:131], a[8:11], 0
    buffer_load_dwordx4 v172, s[16:19], s51 offen lds
    v_mfma_f32_16x16x32_bf16 v[12:15], v[128:131], a[12:15], 0
    s_waitcnt lgkmcnt(2)
    v_mul_f32 v80, v16, v80
    v_mul_f32 v81, v17, v81
    v_mul_f32 v82, v18, v82
    v_mul_f32 v83, v19, v83
    v_mul_f32 v84, v20, v84
    v_mul_f32 v85, v21, v85
    v_mul_f32 v86, v22, v86
    v_mul_f32 v87, v23, v87
    v_mfma_f32_16x16x32_bf16 v[16:19], v[132:135], a[0:3], 0
    ds_read_b64_tr_b16 v[140:141], v163 offset:32768
    ds_read_b64_tr_b16 v[142:143], v163 offset:33280
    v_mfma_f32_16x16x32_bf16 v[20:23], v[132:135], a[4:7], 0
    v_mul_f32 v88, v24, v88
    v_mul_f32 v89, v25, v89
    v_mul_f32 v90, v26, v90
    v_mul_f32 v91, v27, v91
    v_mul_f32 v92, v28, v92
    v_mul_f32 v93, v29, v93
    v_mul_f32 v94, v30, v94
    v_mul_f32 v95, v31, v95
    v_mfma_f32_16x16x32_bf16 v[24:27], v[132:135], a[8:11], 0
    buffer_load_dwordx4 v173, s[16:19], s51 offen offset:1024 lds
    v_mfma_f32_16x16x32_bf16 v[28:31], v[132:135], a[12:15], 0
    s_waitcnt vmcnt(14) lgkmcnt(2)
    v_mul_f32 v96, v32, v96
    v_mul_f32 v97, v33, v97
    v_mul_f32 v98, v34, v98
    v_mul_f32 v99, v35, v99
    v_mul_f32 v100, v36, v100
    v_mul_f32 v101, v37, v101
    v_mul_f32 v102, v38, v102
    v_mul_f32 v103, v39, v103
    v_mfma_f32_16x16x32_bf16 v[32:35], v[136:139], a[0:3], 0
    ds_read_b64_tr_b16 v[144:145], v160 offset:49152
    ds_read_b64_tr_b16 v[146:147], v160 offset:49664
    v_mfma_f32_16x16x32_bf16 v[36:39], v[136:139], a[4:7], 0
    v_mul_f32 v104, v40, v104
    v_mul_f32 v105, v41, v105
    v_mul_f32 v106, v42, v106
    v_mul_f32 v107, v43, v107
    v_mul_f32 v108, v44, v108
    v_mul_f32 v109, v45, v109
    v_mul_f32 v110, v46, v110
    v_mul_f32 v111, v47, v111
    v_mfma_f32_16x16x32_bf16 v[40:43], v[136:139], a[8:11], 0
    buffer_load_dwordx4 v174, s[16:19], s51 offen offset:2048 lds
    v_mfma_f32_16x16x32_bf16 v[44:47], v[136:139], a[12:15], 0
    s_waitcnt lgkmcnt(2)
    v_mul_f32 v112, v48, v112
    v_mul_f32 v113, v49, v113
    v_mul_f32 v114, v50, v114
    v_mul_f32 v115, v51, v115
    v_mul_f32 v116, v52, v116
    v_mul_f32 v117, v53, v117
    v_mul_f32 v118, v54, v118
    v_mul_f32 v119, v55, v119
    v_mfma_f32_16x16x32_bf16 v[48:51], v[140:143], a[0:3], 0
    ds_read_b64_tr_b16 v[148:149], v161 offset:49152
    ds_read_b64_tr_b16 v[150:151], v161 offset:49664
    v_mfma_f32_16x16x32_bf16 v[52:55], v[140:143], a[4:7], 0
    v_mul_f32 v120, v56, v120
    v_mul_f32 v121, v57, v121
    v_mul_f32 v122, v58, v122
    v_mul_f32 v123, v59, v123
    v_mul_f32 v124, v60, v124
    v_mul_f32 v125, v61, v125
    v_mul_f32 v126, v62, v126
    v_mul_f32 v127, v63, v127
    v_mfma_f32_16x16x32_bf16 v[56:59], v[140:143], a[8:11], 0
    buffer_load_dwordx4 v175, s[16:19], s51 offen offset:3072 lds
    v_mfma_f32_16x16x32_bf16 v[60:63], v[140:143], a[12:15], 0
    s_waitcnt lgkmcnt(2)
    s_add_u32 s51, s51, 262144
    s_and_b32 s51, s51, 4194303
    v_mfma_f32_16x16x32_bf16 v[0:3], v[144:147], a[16:19], v[0:3]
    ds_read_b64_tr_b16 v[152:153], v162 offset:49152
    ds_read_b64_tr_b16 v[154:155], v162 offset:49664
    v_mfma_f32_16x16x32_bf16 v[4:7], v[144:147], a[20:23], v[4:7]
    s_add_u32 m0, s75, 98304
    v_cvt_pk_bf16_f32 v192, v64, v65
    v_cvt_pk_bf16_f32 v193, v66, v67
    v_mfma_f32_16x16x32_bf16 v[8:11], v[144:147], a[24:27], v[8:11]
    buffer_load_dwordx4 v172, s[16:19], s51 offen lds
    v_mfma_f32_16x16x32_bf16 v[12:15], v[144:147], a[28:31], v[12:15]
    s_waitcnt lgkmcnt(2)
    v_cvt_pk_bf16_f32 v194, v80, v81
    v_cvt_pk_bf16_f32 v195, v82, v83
    v_mfma_f32_16x16x32_bf16 v[16:19], v[148:151], a[16:19], v[16:19]
    ds_read_b64_tr_b16 v[156:157], v163 offset:49152
    ds_read_b64_tr_b16 v[158:159], v163 offset:49664
    v_mfma_f32_16x16x32_bf16 v[20:23], v[148:151], a[20:23], v[20:23]
    v_cvt_pk_bf16_f32 v196, v68, v69
    v_cvt_pk_bf16_f32 v197, v70, v71
    v_mfma_f32_16x16x32_bf16 v[24:27], v[148:151], a[24:27], v[24:27]
    buffer_load_dwordx4 v173, s[16:19], s51 offen offset:1024 lds
    v_mfma_f32_16x16x32_bf16 v[28:31], v[148:151], a[28:31], v[28:31]
    s_waitcnt vmcnt(14) lgkmcnt(2)
    v_cvt_pk_bf16_f32 v198, v84, v85
    v_cvt_pk_bf16_f32 v199, v86, v87
    v_mfma_f32_16x16x32_bf16 v[32:35], v[152:155], a[16:19], v[32:35]
    ds_read_b64_tr_b16 v[128:129], v164 offset:0
    ds_read_b64_tr_b16 v[130:131], v164 offset:512
    v_mfma_f32_16x16x32_bf16 v[36:39], v[152:155], a[20:23], v[36:39]
    v_cvt_pk_bf16_f32 v200, v72, v73
    v_cvt_pk_bf16_f32 v201, v74, v75
    v_mfma_f32_16x16x32_bf16 v[40:43], v[152:155], a[24:27], v[40:43]
    buffer_load_dwordx4 v174, s[16:19], s51 offen offset:2048 lds
    v_mfma_f32_16x16x32_bf16 v[44:47], v[152:155], a[28:31], v[44:47]
    s_waitcnt lgkmcnt(2)
    v_cvt_pk_bf16_f32 v202, v88, v89
    v_cvt_pk_bf16_f32 v203, v90, v91
    v_mfma_f32_16x16x32_bf16 v[48:51], v[156:159], a[16:19], v[48:51]
    ds_read_b64_tr_b16 v[132:133], v165 offset:0
    ds_read_b64_tr_b16 v[134:135], v165 offset:512
    v_mfma_f32_16x16x32_bf16 v[52:55], v[156:159], a[20:23], v[52:55]
    v_cvt_pk_bf16_f32 v204, v76, v77
    v_cvt_pk_bf16_f32 v205, v78, v79
    v_mfma_f32_16x16x32_bf16 v[56:59], v[156:159], a[24:27], v[56:59]
    buffer_load_dwordx4 v175, s[16:19], s51 offen offset:3072 lds
    v_mfma_f32_16x16x32_bf16 v[60:63], v[156:159], a[28:31], v[60:63]
    s_waitcnt lgkmcnt(2)
    s_add_u32 s51, s51, 262144
    s_and_b32 s51, s51, 4194303
    v_mfma_f32_16x16x32_bf16 v[0:3], v[128:131], a[32:35], v[0:3]
    ds_read_b64_tr_b16 v[136:137], v166 offset:0
    ds_read_b64_tr_b16 v[138:139], v166 offset:512
    v_mfma_f32_16x16x32_bf16 v[4:7], v[128:131], a[36:39], v[4:7]
    s_add_u32 m0, s75, 114688
    v_cvt_pk_bf16_f32 v206, v92, v93
    v_cvt_pk_bf16_f32 v207, v94, v95
    v_mfma_f32_16x16x32_bf16 v[8:11], v[128:131], a[40:43], v[8:11]
    buffer_load_dwordx4 v172, s[16:19], s51 offen lds
    v_mfma_f32_16x16x32_bf16 v[12:15], v[128:131], a[44:47], v[12:15]
    s_waitcnt lgkmcnt(2)
    v_cvt_pk_bf16_f32 v176, v96, v97
    v_cvt_pk_bf16_f32 v177, v98, v99
    v_mfma_f32_16x16x32_bf16 v[16:19], v[132:135], a[32:35], v[16:19]
    ds_read_b64_tr_b16 v[140:141], v167 offset:0
    ds_read_b64_tr_b16 v[142:143], v167 offset:512
    v_mfma_f32_16x16x32_bf16 v[20:23], v[132:135], a[36:39], v[20:23]
    v_cvt_pk_bf16_f32 v178, v112, v113
    v_cvt_pk_bf16_f32 v179, v114, v115
    v_mfma_f32_16x16x32_bf16 v[24:27], v[132:135], a[40:43], v[24:27]
    buffer_load_dwordx4 v173, s[16:19], s51 offen offset:1024 lds
    v_mfma_f32_16x16x32_bf16 v[28:31], v[132:135], a[44:47], v[28:31]
    s_waitcnt vmcnt(14) lgkmcnt(2)
    v_cvt_pk_bf16_f32 v180, v100, v101
    v_cvt_pk_bf16_f32 v181, v102, v103
    v_mfma_f32_16x16x32_bf16 v[32:35], v[136:139], a[32:35], v[32:35]
    ds_read_b64_tr_b16 v[144:145], v164 offset:16384
    ds_read_b64_tr_b16 v[146:147], v164 offset:16896
    v_mfma_f32_16x16x32_bf16 v[36:39], v[136:139], a[36:39], v[36:39]
    v_cvt_pk_bf16_f32 v182, v116, v117
    v_cvt_pk_bf16_f32 v183, v118, v119
    v_mfma_f32_16x16x32_bf16 v[40:43], v[136:139], a[40:43], v[40:43]
    buffer_load_dwordx4 v174, s[16:19], s51 offen offset:2048 lds
    v_mfma_f32_16x16x32_bf16 v[44:47], v[136:139], a[44:47], v[44:47]
    s_waitcnt lgkmcnt(2)
    v_cvt_pk_bf16_f32 v184, v104, v105
    v_cvt_pk_bf16_f32 v185, v106, v107
    v_mfma_f32_16x16x32_bf16 v[48:51], v[140:143], a[32:35], v[48:51]
    ds_read_b64_tr_b16 v[148:149], v165 offset:16384
    ds_read_b64_tr_b16 v[150:151], v165 offset:16896
    v_mfma_f32_16x16x32_bf16 v[52:55], v[140:143], a[36:39], v[52:55]
    v_cvt_pk_bf16_f32 v186, v120, v121
    v_cvt_pk_bf16_f32 v187, v122, v123
    v_mfma_f32_16x16x32_bf16 v[56:59], v[140:143], a[40:43], v[56:59]
    buffer_load_dwordx4 v175, s[16:19], s51 offen offset:3072 lds
    v_mfma_f32_16x16x32_bf16 v[60:63], v[140:143], a[44:47], v[60:63]
    s_waitcnt lgkmcnt(2)
    s_add_u32 s51, s51, 262144
    s_and_b32 s51, s51, 4194303
    v_mfma_f32_16x16x32_bf16 v[0:3], v[144:147], a[48:51], v[0:3]
    ds_read_b64_tr_b16 v[152:153], v166 offset:16384
    ds_read_b64_tr_b16 v[154:155], v166 offset:16896
    v_mfma_f32_16x16x32_bf16 v[4:7], v[144:147], a[52:55], v[4:7]
    s_add_u32 m0, s75, 131072
    v_cvt_pk_bf16_f32 v208, v108, v109
    v_cvt_pk_bf16_f32 v209, v110, v111
    v_mfma_f32_16x16x32_bf16 v[8:11], v[144:147], a[56:59], v[8:11]
    buffer_load_dwordx4 v172, s[16:19], s51 offen lds
    v_mfma_f32_16x16x32_bf16 v[12:15], v[144:147], a[60:63], v[12:15]
    s_waitcnt lgkmcnt(2)
    v_cvt_pk_bf16_f32 v210, v124, v125
    v_cvt_pk_bf16_f32 v211, v126, v127
    v_mfma_f32_16x16x32_bf16 v[16:19], v[148:151], a[48:51], v[16:19]
    ds_read_b64_tr_b16 v[156:157], v167 offset:16384
    ds_read_b64_tr_b16 v[158:159], v167 offset:16896
    v_mfma_f32_16x16x32_bf16 v[20:23], v[148:151], a[52:55], v[20:23]
    v_mfma_f32_16x16x32_bf16 v[24:27], v[148:151], a[56:59], v[24:27]
    buffer_load_dwordx4 v173, s[16:19], s51 offen offset:1024 lds
    v_mfma_f32_16x16x32_bf16 v[28:31], v[148:151], a[60:63], v[28:31]
    s_waitcnt vmcnt(14) lgkmcnt(2)
    v_mfma_f32_16x16x32_bf16 v[32:35], v[152:155], a[48:51], v[32:35]
    ds_read_b64_tr_b16 v[128:129], v160 offset:0
    ds_read_b64_tr_b16 v[130:131], v160 offset:512
    v_mfma_f32_16x16x32_bf16 v[36:39], v[152:155], a[52:55], v[36:39]
    v_mfma_f32_16x16x32_bf16 v[40:43], v[152:155], a[56:59], v[40:43]
    buffer_load_dwordx4 v174, s[16:19], s51 offen offset:2048 lds
    v_mfma_f32_16x16x32_bf16 v[44:47], v[152:155], a[60:63], v[44:47]
    s_waitcnt lgkmcnt(2)
    v_mfma_f32_16x16x32_bf16 v[48:51], v[156:159], a[48:51], v[48:51]
    ds_read_b64_tr_b16 v[132:133], v161 offset:0
    ds_read_b64_tr_b16 v[134:135], v161 offset:512
    v_mfma_f32_16x16x32_bf16 v[52:55], v[156:159], a[52:55], v[52:55]
    v_mfma_f32_16x16x32_bf16 v[56:59], v[156:159], a[56:59], v[56:59]
    buffer_load_dwordx4 v175, s[16:19], s51 offen offset:3072 lds
    v_mfma_f32_16x16x32_bf16 v[60:63], v[156:159], a[60:63], v[60:63]
    s_waitcnt lgkmcnt(2)
    s_add_u32 s51, s51, 262144
    s_and_b32 s51, s51, 4194303
    v_mfma_f32_16x16x32_bf16 v[0:3], v[128:131], a[64:67], v[0:3]
    ds_read_b64_tr_b16 v[136:137], v162 offset:0
    ds_read_b64_tr_b16 v[138:139], v162 offset:512
    v_mfma_f32_16x16x32_bf16 v[4:7], v[128:131], a[68:71], v[4:7]
    s_add_u32 m0, s75, 147456
    v_mfma_f32_16x16x32_bf16 v[8:11], v[128:131], a[72:75], v[8:11]
    buffer_load_dwordx4 v172, s[16:19], s51 offen lds
    v_mfma_f32_16x16x32_bf16 v[12:15], v[128:131], a[76:79], v[12:15]
    s_waitcnt lgkmcnt(2)
    v_mfma_f32_16x16x32_bf16 v[16:19], v[132:135], a[64:67], v[16:19]
    ds_read_b64_tr_b16 v[140:141], v163 offset:0
    ds_read_b64_tr_b16 v[142:143], v163 offset:512
    v_mfma_f32_16x16x32_bf16 v[20:23], v[132:135], a[68:71], v[20:23]
    v_mfma_f32_16x16x32_bf16 v[24:27], v[132:135], a[72:75], v[24:27]
    buffer_load_dwordx4 v173, s[16:19], s51 offen offset:1024 lds
    v_mfma_f32_16x16x32_bf16 v[28:31], v[132:135], a[76:79], v[28:31]
    s_waitcnt vmcnt(14) lgkmcnt(2)
    v_mfma_f32_16x16x32_bf16 v[32:35], v[136:139], a[64:67], v[32:35]
    ds_read_b64_tr_b16 v[144:145], v160 offset:16384
    ds_read_b64_tr_b16 v[146:147], v160 offset:16896
    v_mfma_f32_16x16x32_bf16 v[36:39], v[136:139], a[68:71], v[36:39]
    v_mfma_f32_16x16x32_bf16 v[40:43], v[136:139], a[72:75], v[40:43]
    buffer_load_dwordx4 v174, s[16:19], s51 offen offset:2048 lds
    v_mfma_f32_16x16x32_bf16 v[44:47], v[136:139], a[76:79], v[44:47]
    s_waitcnt lgkmcnt(2)
    v_mfma_f32_16x16x32_bf16 v[48:51], v[140:143], a[64:67], v[48:51]
    ds_read_b64_tr_b16 v[148:149], v161 offset:16384
    ds_read_b64_tr_b16 v[150:151], v161 offset:16896
    v_mfma_f32_16x16x32_bf16 v[52:55], v[140:143], a[68:71], v[52:55]
    v_mfma_f32_16x16x32_bf16 v[56:59], v[140:143], a[72:75], v[56:59]
    buffer_load_dwordx4 v175, s[16:19], s51 offen offset:3072 lds
    v_mfma_f32_16x16x32_bf16 v[60:63], v[140:143], a[76:79], v[60:63]
    s_waitcnt lgkmcnt(2)
    s_add_u32 s51, s51, 262144
    s_and_b32 s51, s51, 4194303
    v_mfma_f32_16x16x32_bf16 v[0:3], v[144:147], a[80:83], v[0:3]
    ds_read_b64_tr_b16 v[152:153], v162 offset:16384
    ds_read_b64_tr_b16 v[154:155], v162 offset:16896
    v_mfma_f32_16x16x32_bf16 v[4:7], v[144:147], a[84:87], v[4:7]
    s_add_u32 m0, s75, 65536
    v_mfma_f32_16x16x32_bf16 v[8:11], v[144:147], a[88:91], v[8:11]
    buffer_load_dwordx4 v172, s[16:19], s51 offen lds
    v_mfma_f32_16x16x32_bf16 v[12:15], v[144:147], a[92:95], v[12:15]
    s_waitcnt lgkmcnt(2)
    v_mfma_f32_16x16x32_bf16 v[16:19], v[148:151], a[80:83], v[16:19]
    ds_read_b64_tr_b16 v[156:157], v163 offset:16384
    ds_read_b64_tr_b16 v[158:159], v163 offset:16896
    v_mfma_f32_16x16x32_bf16 v[20:23], v[148:151], a[84:87], v[20:23]
    v_mfma_f32_16x16x32_bf16 v[24:27], v[148:151], a[88:91], v[24:27]
    buffer_load_dwordx4 v173, s[16:19], s51 offen offset:1024 lds
    v_mfma_f32_16x16x32_bf16 v[28:31], v[148:151], a[92:95], v[28:31]
    s_waitcnt vmcnt(14) lgkmcnt(2)
    v_mfma_f32_16x16x32_bf16 v[32:35], v[152:155], a[80:83], v[32:35]
    ds_read_b64_tr_b16 v[128:129], v160 offset:32768
    ds_read_b64_tr_b16 v[130:131], v160 offset:33280
    v_mfma_f32_16x16x32_bf16 v[36:39], v[152:155], a[84:87], v[36:39]
    v_mfma_f32_16x16x32_bf16 v[40:43], v[152:155], a[88:91], v[40:43]
    buffer_load_dwordx4 v174, s[16:19], s51 offen offset:2048 lds
    v_mfma_f32_16x16x32_bf16 v[44:47], v[152:155], a[92:95], v[44:47]
    s_waitcnt lgkmcnt(2)
    v_mfma_f32_16x16x32_bf16 v[48:51], v[156:159], a[80:83], v[48:51]
    ds_read_b64_tr_b16 v[132:133], v161 offset:32768
    ds_read_b64_tr_b16 v[134:135], v161 offset:33280
    v_mfma_f32_16x16x32_bf16 v[52:55], v[156:159], a[84:87], v[52:55]
    v_mfma_f32_16x16x32_bf16 v[56:59], v[156:159], a[88:91], v[56:59]
    buffer_load_dwordx4 v175, s[16:19], s51 offen offset:3072 lds
    v_mfma_f32_16x16x32_bf16 v[60:63], v[156:159], a[92:95], v[60:63]
    s_waitcnt lgkmcnt(2)
    s_add_u32 s51, s51, 262144
    s_and_b32 s51, s51, 4194303
    v_mfma_f32_16x16x32_bf16 v[0:3], v[128:131], a[96:99], v[0:3]
    ds_read_b64_tr_b16 v[136:137], v162 offset:32768
    ds_read_b64_tr_b16 v[138:139], v162 offset:33280
    v_mfma_f32_16x16x32_bf16 v[4:7], v[128:131], a[100:103], v[4:7]
    s_add_u32 m0, s75, 81920
    v_mfma_f32_16x16x32_bf16 v[8:11], v[128:131], a[104:107], v[8:11]
    buffer_load_dwordx4 v172, s[16:19], s51 offen lds
    v_mfma_f32_16x16x32_bf16 v[12:15], v[128:131], a[108:111], v[12:15]
    s_waitcnt lgkmcnt(2)
    v_mfma_f32_16x16x32_bf16 v[16:19], v[132:135], a[96:99], v[16:19]
    ds_read_b64_tr_b16 v[140:141], v163 offset:32768
    ds_read_b64_tr_b16 v[142:143], v163 offset:33280
    v_mfma_f32_16x16x32_bf16 v[20:23], v[132:135], a[100:103], v[20:23]
    v_mfma_f32_16x16x32_bf16 v[24:27], v[132:135], a[104:107], v[24:27]
    buffer_load_dwordx4 v173, s[16:19], s51 offen offset:1024 lds
    v_mfma_f32_16x16x32_bf16 v[28:31], v[132:135], a[108:111], v[28:31]
    s_waitcnt vmcnt(14) lgkmcnt(2)
    v_mfma_f32_16x16x32_bf16 v[32:35], v[136:139], a[96:99], v[32:35]
    ds_read_b64_tr_b16 v[144:145], v160 offset:49152
    ds_read_b64_tr_b16 v[146:147], v160 offset:49664
    v_mfma_f32_16x16x32_bf16 v[36:39], v[136:139], a[100:103], v[36:39]
    v_mfma_f32_16x16x32_bf16 v[40:43], v[136:139], a[104:107], v[40:43]
    buffer_load_dwordx4 v174, s[16:19], s51 offen offset:2048 lds
    v_mfma_f32_16x16x32_bf16 v[44:47], v[136:139], a[108:111], v[44:47]
    s_waitcnt lgkmcnt(2)
    v_mfma_f32_16x16x32_bf16 v[48:51], v[140:143], a[96:99], v[48:51]
    ds_read_b64_tr_b16 v[148:149], v161 offset:49152
    ds_read_b64_tr_b16 v[150:151], v161 offset:49664
    v_mfma_f32_16x16x32_bf16 v[52:55], v[140:143], a[100:103], v[52:55]
    v_mfma_f32_16x16x32_bf16 v[56:59], v[140:143], a[104:107], v[56:59]
    buffer_load_dwordx4 v175, s[16:19], s51 offen offset:3072 lds
    v_mfma_f32_16x16x32_bf16 v[60:63], v[140:143], a[108:111], v[60:63]
    s_waitcnt lgkmcnt(2)
    s_add_u32 s51, s51, 262144
    s_and_b32 s51, s51, 4194303
    v_mfma_f32_16x16x32_bf16 v[0:3], v[144:147], a[112:115], v[0:3]
    ds_read_b64_tr_b16 v[152:153], v162 offset:49152
    ds_read_b64_tr_b16 v[154:155], v162 offset:49664
    v_mfma_f32_16x16x32_bf16 v[4:7], v[144:147], a[116:119], v[4:7]
    s_add_u32 m0, s75, 98304
    v_mfma_f32_16x16x32_bf16 v[8:11], v[144:147], a[120:123], v[8:11]
    buffer_load_dwordx4 v172, s[16:19], s51 offen lds
    v_mfma_f32_16x16x32_bf16 v[12:15], v[144:147], a[124:127], v[12:15]
    s_waitcnt lgkmcnt(2)
    v_mfma_f32_16x16x32_bf16 v[16:19], v[148:151], a[112:115], v[16:19]
    ds_read_b64_tr_b16 v[156:157], v163 offset:49152
    ds_read_b64_tr_b16 v[158:159], v163 offset:49664
    v_mfma_f32_16x16x32_bf16 v[20:23], v[148:151], a[116:119], v[20:23]
    v_mfma_f32_16x16x32_bf16 v[24:27], v[148:151], a[120:123], v[24:27]
    buffer_load_dwordx4 v173, s[16:19], s51 offen offset:1024 lds
    v_mfma_f32_16x16x32_bf16 v[28:31], v[148:151], a[124:127], v[28:31]
    s_waitcnt vmcnt(14) lgkmcnt(2)
    v_mfma_f32_16x16x32_bf16 v[32:35], v[152:155], a[112:115], v[32:35]
    ds_read_b64_tr_b16 v[128:129], v164 offset:0
    ds_read_b64_tr_b16 v[130:131], v164 offset:512
    v_mfma_f32_16x16x32_bf16 v[36:39], v[152:155], a[116:119], v[36:39]
    v_mfma_f32_16x16x32_bf16 v[40:43], v[152:155], a[120:123], v[40:43]
    buffer_load_dwordx4 v174, s[16:19], s51 offen offset:2048 lds
    v_mfma_f32_16x16x32_bf16 v[44:47], v[152:155], a[124:127], v[44:47]
    s_waitcnt lgkmcnt(2)
    v_mfma_f32_16x16x32_bf16 v[48:51], v[156:159], a[112:115], v[48:51]
    ds_read_b64_tr_b16 v[132:133], v165 offset:0
    ds_read_b64_tr_b16 v[134:135], v165 offset:512
    v_mfma_f32_16x16x32_bf16 v[52:55], v[156:159], a[116:119], v[52:55]
    v_mfma_f32_16x16x32_bf16 v[56:59], v[156:159], a[120:123], v[56:59]
    buffer_load_dwordx4 v175, s[16:19], s51 offen offset:3072 lds
    v_mfma_f32_16x16x32_bf16 v[60:63], v[156:159], a[124:127], v[60:63]
    s_waitcnt lgkmcnt(2)
    s_add_u32 s51, s51, 262144
    s_and_b32 s51, s51, 4194303
    v_mfma_f32_16x16x32_bf16 v[0:3], v[128:131], a[128:131], v[0:3]
    ds_read_b64_tr_b16 v[136:137], v166 offset:0
    ds_read_b64_tr_b16 v[138:139], v166 offset:512
    v_mfma_f32_16x16x32_bf16 v[4:7], v[128:131], a[132:135], v[4:7]
    s_add_u32 m0, s75, 114688
    v_mfma_f32_16x16x32_bf16 v[8:11], v[128:131], a[136:139], v[8:11]
    buffer_load_dwordx4 v172, s[16:19], s51 offen lds
    v_mfma_f32_16x16x32_bf16 v[12:15], v[128:131], a[140:143], v[12:15]
    s_waitcnt lgkmcnt(2)
    v_mfma_f32_16x16x32_bf16 v[16:19], v[132:135], a[128:131], v[16:19]
    ds_read_b64_tr_b16 v[140:141], v167 offset:0
    ds_read_b64_tr_b16 v[142:143], v167 offset:512
    v_mfma_f32_16x16x32_bf16 v[20:23], v[132:135], a[132:135], v[20:23]
    v_mfma_f32_16x16x32_bf16 v[24:27], v[132:135], a[136:139], v[24:27]
    buffer_load_dwordx4 v173, s[16:19], s51 offen offset:1024 lds
    v_mfma_f32_16x16x32_bf16 v[28:31], v[132:135], a[140:143], v[28:31]
    s_waitcnt vmcnt(14) lgkmcnt(2)
    v_mfma_f32_16x16x32_bf16 v[32:35], v[136:139], a[128:131], v[32:35]
    ds_read_b64_tr_b16 v[144:145], v164 offset:16384
    ds_read_b64_tr_b16 v[146:147], v164 offset:16896
    v_mfma_f32_16x16x32_bf16 v[36:39], v[136:139], a[132:135], v[36:39]
    v_mfma_f32_16x16x32_bf16 v[40:43], v[136:139], a[136:139], v[40:43]
    buffer_load_dwordx4 v174, s[16:19], s51 offen offset:2048 lds
    v_mfma_f32_16x16x32_bf16 v[44:47], v[136:139], a[140:143], v[44:47]
    s_waitcnt lgkmcnt(2)
    v_mfma_f32_16x16x32_bf16 v[48:51], v[140:143], a[128:131], v[48:51]
    ds_read_b64_tr_b16 v[148:149], v165 offset:16384
    ds_read_b64_tr_b16 v[150:151], v165 offset:16896
    v_mfma_f32_16x16x32_bf16 v[52:55], v[140:143], a[132:135], v[52:55]
    v_mfma_f32_16x16x32_bf16 v[56:59], v[140:143], a[136:139], v[56:59]
    buffer_load_dwordx4 v175, s[16:19], s51 offen offset:3072 lds
    v_mfma_f32_16x16x32_bf16 v[60:63], v[140:143], a[140:143], v[60:63]
    s_waitcnt lgkmcnt(2)
    s_add_u32 s51, s51, 262144
    s_and_b32 s51, s51, 4194303
    v_mfma_f32_16x16x32_bf16 v[0:3], v[144:147], a[144:147], v[0:3]
    ds_read_b64_tr_b16 v[152:153], v166 offset:16384
    ds_read_b64_tr_b16 v[154:155], v166 offset:16896
    v_mfma_f32_16x16x32_bf16 v[4:7], v[144:147], a[148:151], v[4:7]
    s_add_u32 m0, s75, 131072
    v_mfma_f32_16x16x32_bf16 v[8:11], v[144:147], a[152:155], v[8:11]
    buffer_load_dwordx4 v172, s[16:19], s51 offen lds
    v_mfma_f32_16x16x32_bf16 v[12:15], v[144:147], a[156:159], v[12:15]
    s_waitcnt lgkmcnt(2)
    v_mfma_f32_16x16x32_bf16 v[16:19], v[148:151], a[144:147], v[16:19]
    ds_read_b64_tr_b16 v[156:157], v167 offset:16384
    ds_read_b64_tr_b16 v[158:159], v167 offset:16896
    v_mfma_f32_16x16x32_bf16 v[20:23], v[148:151], a[148:151], v[20:23]
    v_mfma_f32_16x16x32_bf16 v[24:27], v[148:151], a[152:155], v[24:27]
    buffer_load_dwordx4 v173, s[16:19], s51 offen offset:1024 lds
    v_mfma_f32_16x16x32_bf16 v[28:31], v[148:151], a[156:159], v[28:31]
    s_waitcnt vmcnt(14) lgkmcnt(2)
    v_mfma_f32_16x16x32_bf16 v[32:35], v[152:155], a[144:147], v[32:35]
    ds_read_b64_tr_b16 v[128:129], v160 offset:0
    ds_read_b64_tr_b16 v[130:131], v160 offset:512
    v_mfma_f32_16x16x32_bf16 v[36:39], v[152:155], a[148:151], v[36:39]
    v_mfma_f32_16x16x32_bf16 v[40:43], v[152:155], a[152:155], v[40:43]
    buffer_load_dwordx4 v174, s[16:19], s51 offen offset:2048 lds
    v_mfma_f32_16x16x32_bf16 v[44:47], v[152:155], a[156:159], v[44:47]
    s_waitcnt lgkmcnt(2)
    v_mfma_f32_16x16x32_bf16 v[48:51], v[156:159], a[144:147], v[48:51]
    ds_read_b64_tr_b16 v[132:133], v161 offset:0
    ds_read_b64_tr_b16 v[134:135], v161 offset:512
    v_mfma_f32_16x16x32_bf16 v[52:55], v[156:159], a[148:151], v[52:55]
    v_mfma_f32_16x16x32_bf16 v[56:59], v[156:159], a[152:155], v[56:59]
    buffer_load_dwordx4 v175, s[16:19], s51 offen offset:3072 lds
    v_mfma_f32_16x16x32_bf16 v[60:63], v[156:159], a[156:159], v[60:63]
    s_waitcnt lgkmcnt(2)
    s_add_u32 s51, s51, 262144
    s_and_b32 s51, s51, 4194303
    v_mfma_f32_16x16x32_bf16 v[0:3], v[128:131], a[160:163], v[0:3]
    ds_read_b64_tr_b16 v[136:137], v162 offset:0
    ds_read_b64_tr_b16 v[138:139], v162 offset:512
    v_mfma_f32_16x16x32_bf16 v[4:7], v[128:131], a[164:167], v[4:7]
    s_add_u32 m0, s75, 147456
    v_mfma_f32_16x16x32_bf16 v[8:11], v[128:131], a[168:171], v[8:11]
    buffer_load_dwordx4 v172, s[16:19], s51 offen lds
    v_mfma_f32_16x16x32_bf16 v[12:15], v[128:131], a[172:175], v[12:15]
    s_waitcnt lgkmcnt(2)
    v_mfma_f32_16x16x32_bf16 v[16:19], v[132:135], a[160:163], v[16:19]
    ds_read_b64_tr_b16 v[140:141], v163 offset:0
    ds_read_b64_tr_b16 v[142:143], v163 offset:512
    v_mfma_f32_16x16x32_bf16 v[20:23], v[132:135], a[164:167], v[20:23]
    v_mfma_f32_16x16x32_bf16 v[24:27], v[132:135], a[168:171], v[24:27]
    buffer_load_dwordx4 v173, s[16:19], s51 offen offset:1024 lds
    v_mfma_f32_16x16x32_bf16 v[28:31], v[132:135], a[172:175], v[28:31]
    s_waitcnt vmcnt(14) lgkmcnt(2)
    v_mfma_f32_16x16x32_bf16 v[32:35], v[136:139], a[160:163], v[32:35]
    ds_read_b64_tr_b16 v[144:145], v160 offset:16384
    ds_read_b64_tr_b16 v[146:147], v160 offset:16896
    v_mfma_f32_16x16x32_bf16 v[36:39], v[136:139], a[164:167], v[36:39]
    v_mfma_f32_16x16x32_bf16 v[40:43], v[136:139], a[168:171], v[40:43]
    buffer_load_dwordx4 v174, s[16:19], s51 offen offset:2048 lds
    v_mfma_f32_16x16x32_bf16 v[44:47], v[136:139], a[172:175], v[44:47]
    s_waitcnt lgkmcnt(2)
    v_mfma_f32_16x16x32_bf16 v[48:51], v[140:143], a[160:163], v[48:51]
    ds_read_b64_tr_b16 v[148:149], v161 offset:16384
    ds_read_b64_tr_b16 v[150:151], v161 offset:16896
    v_mfma_f32_16x16x32_bf16 v[52:55], v[140:143], a[164:167], v[52:55]
    v_mfma_f32_16x16x32_bf16 v[56:59], v[140:143], a[168:171], v[56:59]
    buffer_load_dwordx4 v175, s[16:19], s51 offen offset:3072 lds
    v_mfma_f32_16x16x32_bf16 v[60:63], v[140:143], a[172:175], v[60:63]
    s_waitcnt lgkmcnt(2)
    s_add_u32 s51, s51, 262144
    s_and_b32 s51, s51, 4194303
    v_mfma_f32_16x16x32_bf16 v[0:3], v[144:147], a[176:179], v[0:3]
    ds_read_b64_tr_b16 v[152:153], v162 offset:16384
    ds_read_b64_tr_b16 v[154:155], v162 offset:16896
    v_mfma_f32_16x16x32_bf16 v[4:7], v[144:147], a[180:183], v[4:7]
    s_xor_b32 s51, s51, 128
    s_add_u32 m0, s75, 65536
    v_mfma_f32_16x16x32_bf16 v[8:11], v[144:147], a[184:187], v[8:11]
    buffer_load_dwordx4 v172, s[16:19], s51 offen lds
    v_mfma_f32_16x16x32_bf16 v[12:15], v[144:147], a[188:191], v[12:15]
    s_waitcnt lgkmcnt(2)
    v_mfma_f32_16x16x32_bf16 v[16:19], v[148:151], a[176:179], v[16:19]
    ds_read_b64_tr_b16 v[156:157], v163 offset:16384
    ds_read_b64_tr_b16 v[158:159], v163 offset:16896
    v_mfma_f32_16x16x32_bf16 v[20:23], v[148:151], a[180:183], v[20:23]
    v_mfma_f32_16x16x32_bf16 v[24:27], v[148:151], a[184:187], v[24:27]
    buffer_load_dwordx4 v173, s[16:19], s51 offen offset:1024 lds
    v_mfma_f32_16x16x32_bf16 v[28:31], v[148:151], a[188:191], v[28:31]
    s_waitcnt vmcnt(14) lgkmcnt(2)
    v_mfma_f32_16x16x32_bf16 v[32:35], v[152:155], a[176:179], v[32:35]
    ds_read_b64_tr_b16 v[128:129], v160 offset:32768
    ds_read_b64_tr_b16 v[130:131], v160 offset:33280
    v_mfma_f32_16x16x32_bf16 v[36:39], v[152:155], a[180:183], v[36:39]
    v_mfma_f32_16x16x32_bf16 v[40:43], v[152:155], a[184:187], v[40:43]
    buffer_load_dwordx4 v174, s[16:19], s51 offen offset:2048 lds
    v_mfma_f32_16x16x32_bf16 v[44:47], v[152:155], a[188:191], v[44:47]
    s_waitcnt lgkmcnt(2)
    v_mfma_f32_16x16x32_bf16 v[48:51], v[156:159], a[176:179], v[48:51]
    ds_read_b64_tr_b16 v[132:133], v161 offset:32768
    ds_read_b64_tr_b16 v[134:135], v161 offset:33280
    v_mfma_f32_16x16x32_bf16 v[52:55], v[156:159], a[180:183], v[52:55]
    v_mfma_f32_16x16x32_bf16 v[56:59], v[156:159], a[184:187], v[56:59]
    buffer_load_dwordx4 v175, s[16:19], s51 offen offset:3072 lds
    v_mfma_f32_16x16x32_bf16 v[60:63], v[156:159], a[188:191], v[60:63]
    s_waitcnt lgkmcnt(2)
    s_add_u32 s51, s51, 262144
    s_and_b32 s51, s51, 4194303
    v_mfma_f32_16x16x32_bf16 v[0:3], v[128:131], a[192:195], v[0:3]
    ds_read_b64_tr_b16 v[136:137], v162 offset:32768
    ds_read_b64_tr_b16 v[138:139], v162 offset:33280
    v_mfma_f32_16x16x32_bf16 v[4:7], v[128:131], a[196:199], v[4:7]
    s_add_u32 m0, s75, 81920
    v_mfma_f32_16x16x32_bf16 v[8:11], v[128:131], a[200:203], v[8:11]
    buffer_load_dwordx4 v172, s[16:19], s51 offen lds
    v_mfma_f32_16x16x32_bf16 v[12:15], v[128:131], a[204:207], v[12:15]
    s_waitcnt lgkmcnt(2)
    v_mfma_f32_16x16x32_bf16 v[16:19], v[132:135], a[192:195], v[16:19]
    ds_read_b64_tr_b16 v[140:141], v163 offset:32768
    ds_read_b64_tr_b16 v[142:143], v163 offset:33280
    v_mfma_f32_16x16x32_bf16 v[20:23], v[132:135], a[196:199], v[20:23]
    v_mfma_f32_16x16x32_bf16 v[24:27], v[132:135], a[200:203], v[24:27]
    buffer_load_dwordx4 v173, s[16:19], s51 offen offset:1024 lds
    v_mfma_f32_16x16x32_bf16 v[28:31], v[132:135], a[204:207], v[28:31]
    s_waitcnt vmcnt(14) lgkmcnt(2)
    v_mfma_f32_16x16x32_bf16 v[32:35], v[136:139], a[192:195], v[32:35]
    ds_read_b64_tr_b16 v[144:145], v160 offset:49152
    ds_read_b64_tr_b16 v[146:147], v160 offset:49664
    v_mfma_f32_16x16x32_bf16 v[36:39], v[136:139], a[196:199], v[36:39]
    v_mfma_f32_16x16x32_bf16 v[40:43], v[136:139], a[200:203], v[40:43]
    buffer_load_dwordx4 v174, s[16:19], s51 offen offset:2048 lds
    v_mfma_f32_16x16x32_bf16 v[44:47], v[136:139], a[204:207], v[44:47]
    s_waitcnt lgkmcnt(2)
    v_mfma_f32_16x16x32_bf16 v[48:51], v[140:143], a[192:195], v[48:51]
    ds_read_b64_tr_b16 v[148:149], v161 offset:49152
    ds_read_b64_tr_b16 v[150:151], v161 offset:49664
    v_mfma_f32_16x16x32_bf16 v[52:55], v[140:143], a[196:199], v[52:55]
    v_mfma_f32_16x16x32_bf16 v[56:59], v[140:143], a[200:203], v[56:59]
    buffer_load_dwordx4 v175, s[16:19], s51 offen offset:3072 lds
    v_mfma_f32_16x16x32_bf16 v[60:63], v[140:143], a[204:207], v[60:63]
    s_waitcnt lgkmcnt(2)
    s_add_u32 s51, s51, 262144
    s_and_b32 s51, s51, 4194303
    v_mfma_f32_16x16x32_bf16 v[0:3], v[144:147], a[208:211], v[0:3]
    ds_read_b64_tr_b16 v[152:153], v162 offset:49152
    ds_read_b64_tr_b16 v[154:155], v162 offset:49664
    v_mfma_f32_16x16x32_bf16 v[4:7], v[144:147], a[212:215], v[4:7]
    s_add_u32 m0, s75, 98304
    v_mfma_f32_16x16x32_bf16 v[8:11], v[144:147], a[216:219], v[8:11]
    buffer_load_dwordx4 v172, s[16:19], s51 offen lds
    v_mfma_f32_16x16x32_bf16 v[12:15], v[144:147], a[220:223], v[12:15]
    s_waitcnt lgkmcnt(2)
    v_mfma_f32_16x16x32_bf16 v[16:19], v[148:151], a[208:211], v[16:19]
    ds_read_b64_tr_b16 v[156:157], v163 offset:49152
    ds_read_b64_tr_b16 v[158:159], v163 offset:49664
    v_mfma_f32_16x16x32_bf16 v[20:23], v[148:151], a[212:215], v[20:23]
    v_mfma_f32_16x16x32_bf16 v[24:27], v[148:151], a[216:219], v[24:27]
    buffer_load_dwordx4 v173, s[16:19], s51 offen offset:1024 lds
    v_mfma_f32_16x16x32_bf16 v[28:31], v[148:151], a[220:223], v[28:31]
    s_waitcnt vmcnt(14) lgkmcnt(2)
    v_mfma_f32_16x16x32_bf16 v[32:35], v[152:155], a[208:211], v[32:35]
    ds_read_b64_tr_b16 v[128:129], v164 offset:0
    ds_read_b64_tr_b16 v[130:131], v164 offset:512
    v_mfma_f32_16x16x32_bf16 v[36:39], v[152:155], a[212:215], v[36:39]
    v_mfma_f32_16x16x32_bf16 v[40:43], v[152:155], a[216:219], v[40:43]
    buffer_load_dwordx4 v174, s[16:19], s51 offen offset:2048 lds
    v_mfma_f32_16x16x32_bf16 v[44:47], v[152:155], a[220:223], v[44:47]
    s_waitcnt lgkmcnt(2)
    v_mfma_f32_16x16x32_bf16 v[48:51], v[156:159], a[208:211], v[48:51]
    ds_read_b64_tr_b16 v[132:133], v165 offset:0
    ds_read_b64_tr_b16 v[134:135], v165 offset:512
    v_mfma_f32_16x16x32_bf16 v[52:55], v[156:159], a[212:215], v[52:55]
    v_mfma_f32_16x16x32_bf16 v[56:59], v[156:159], a[216:219], v[56:59]
    buffer_load_dwordx4 v175, s[16:19], s51 offen offset:3072 lds
    v_mfma_f32_16x16x32_bf16 v[60:63], v[156:159], a[220:223], v[60:63]
    s_waitcnt lgkmcnt(2)
    s_add_u32 s51, s51, 262144
    s_and_b32 s51, s51, 4194303
    v_mfma_f32_16x16x32_bf16 v[0:3], v[128:131], a[224:227], v[0:3]
    ds_read_b64_tr_b16 v[136:137], v166 offset:0
    ds_read_b64_tr_b16 v[138:139], v166 offset:512
    v_mfma_f32_16x16x32_bf16 v[4:7], v[128:131], a[228:231], v[4:7]
    s_add_u32 m0, s75, 114688
    v_mfma_f32_16x16x32_bf16 v[8:11], v[128:131], a[232:235], v[8:11]
    buffer_load_dwordx4 v172, s[16:19], s51 offen lds
    v_mfma_f32_16x16x32_bf16 v[12:15], v[128:131], a[236:239], v[12:15]
    s_waitcnt lgkmcnt(2)
    v_mfma_f32_16x16x32_bf16 v[16:19], v[132:135], a[224:227], v[16:19]
    ds_read_b64_tr_b16 v[140:141], v167 offset:0
    ds_read_b64_tr_b16 v[142:143], v167 offset:512
    v_mfma_f32_16x16x32_bf16 v[20:23], v[132:135], a[228:231], v[20:23]
    v_mfma_f32_16x16x32_bf16 v[24:27], v[132:135], a[232:235], v[24:27]
    buffer_load_dwordx4 v173, s[16:19], s51 offen offset:1024 lds
    v_mfma_f32_16x16x32_bf16 v[28:31], v[132:135], a[236:239], v[28:31]
    s_waitcnt vmcnt(14) lgkmcnt(2)
    v_mfma_f32_16x16x32_bf16 v[32:35], v[136:139], a[224:227], v[32:35]
    ds_read_b64_tr_b16 v[144:145], v164 offset:16384
    ds_read_b64_tr_b16 v[146:147], v164 offset:16896
    v_mfma_f32_16x16x32_bf16 v[36:39], v[136:139], a[228:231], v[36:39]
    v_mfma_f32_16x16x32_bf16 v[40:43], v[136:139], a[232:235], v[40:43]
    buffer_load_dwordx4 v174, s[16:19], s51 offen offset:2048 lds
    v_mfma_f32_16x16x32_bf16 v[44:47], v[136:139], a[236:239], v[44:47]
    s_waitcnt lgkmcnt(2)
    v_mfma_f32_16x16x32_bf16 v[48:51], v[140:143], a[224:227], v[48:51]
    ds_read_b64_tr_b16 v[148:149], v165 offset:16384
    ds_read_b64_tr_b16 v[150:151], v165 offset:16896
    v_mfma_f32_16x16x32_bf16 v[52:55], v[140:143], a[228:231], v[52:55]
    v_mfma_f32_16x16x32_bf16 v[56:59], v[140:143], a[232:235], v[56:59]
    buffer_load_dwordx4 v175, s[16:19], s51 offen offset:3072 lds
    v_mfma_f32_16x16x32_bf16 v[60:63], v[140:143], a[236:239], v[60:63]
    s_waitcnt lgkmcnt(2)
    s_add_u32 s51, s51, 262144
    s_and_b32 s51, s51, 4194303
    v_mfma_f32_16x16x32_bf16 v[0:3], v[144:147], a[240:243], v[0:3]
    ds_read_b64_tr_b16 v[152:153], v166 offset:16384
    ds_read_b64_tr_b16 v[154:155], v166 offset:16896
    v_mfma_f32_16x16x32_bf16 v[4:7], v[144:147], a[244:247], v[4:7]
    s_add_u32 m0, s75, 131072
    v_mfma_f32_16x16x32_bf16 v[8:11], v[144:147], a[248:251], v[8:11]
    buffer_load_dwordx4 v172, s[16:19], s51 offen lds
    v_mfma_f32_16x16x32_bf16 v[12:15], v[144:147], a[252:255], v[12:15]
    s_waitcnt lgkmcnt(2)
    v_mfma_f32_16x16x32_bf16 v[16:19], v[148:151], a[240:243], v[16:19]
    ds_read_b64_tr_b16 v[156:157], v167 offset:16384
    ds_read_b64_tr_b16 v[158:159], v167 offset:16896
    v_mfma_f32_16x16x32_bf16 v[20:23], v[148:151], a[244:247], v[20:23]
    v_mfma_f32_16x16x32_bf16 v[24:27], v[148:151], a[248:251], v[24:27]
    buffer_load_dwordx4 v173, s[16:19], s51 offen offset:1024 lds
    v_mfma_f32_16x16x32_bf16 v[28:31], v[148:151], a[252:255], v[28:31]
    s_waitcnt vmcnt(14) lgkmcnt(2)
    v_mfma_f32_16x16x32_bf16 v[32:35], v[152:155], a[240:243], v[32:35]
    ds_read_b64_tr_b16 v[128:129], v160 offset:0
    ds_read_b64_tr_b16 v[130:131], v160 offset:512
    v_mfma_f32_16x16x32_bf16 v[36:39], v[152:155], a[244:247], v[36:39]
    v_mfma_f32_16x16x32_bf16 v[40:43], v[152:155], a[248:251], v[40:43]
    buffer_load_dwordx4 v174, s[16:19], s51 offen offset:2048 lds
    v_mfma_f32_16x16x32_bf16 v[44:47], v[152:155], a[252:255], v[44:47]
    s_waitcnt lgkmcnt(2)
    v_mfma_f32_16x16x32_bf16 v[48:51], v[156:159], a[240:243], v[48:51]
    ds_read_b64_tr_b16 v[132:133], v161 offset:0
    ds_read_b64_tr_b16 v[134:135], v161 offset:512
    v_mfma_f32_16x16x32_bf16 v[52:55], v[156:159], a[244:247], v[52:55]
    v_mfma_f32_16x16x32_bf16 v[56:59], v[156:159], a[248:251], v[56:59]
    buffer_load_dwordx4 v175, s[16:19], s51 offen offset:3072 lds
    v_mfma_f32_16x16x32_bf16 v[60:63], v[156:159], a[252:255], v[60:63]
    s_waitcnt lgkmcnt(2)
    s_add_u32 s51, s51, 262144
    s_and_b32 s51, s51, 4194303
    v_mfma_f32_16x16x32_bf16 v[64:67], v[128:131], a[0:3], 0
    ds_read_b64_tr_b16 v[136:137], v162 offset:0
    ds_read_b64_tr_b16 v[138:139], v162 offset:512
    v_mfma_f32_16x16x32_bf16 v[68:71], v[128:131], a[4:7], 0
    s_add_u32 m0, s75, 147456
    v_mfma_f32_16x16x32_bf16 v[72:75], v[128:131], a[8:11], 0
    buffer_load_dwordx4 v172, s[16:19], s51 offen lds
    v_mfma_f32_16x16x32_bf16 v[76:79], v[128:131], a[12:15], 0
    s_waitcnt lgkmcnt(2)
    v_mfma_f32_16x16x32_bf16 v[80:83], v[132:135], a[0:3], 0
    ds_read_b64_tr_b16 v[140:141], v163 offset:0
    ds_read_b64_tr_b16 v[142:143], v163 offset:512
    v_mfma_f32_16x16x32_bf16 v[84:87], v[132:135], a[4:7], 0
    v_mfma_f32_16x16x32_bf16 v[88:91], v[132:135], a[8:11], 0
    buffer_load_dwordx4 v173, s[16:19], s51 offen offset:1024 lds
    v_mfma_f32_16x16x32_bf16 v[92:95], v[132:135], a[12:15], 0
    s_waitcnt vmcnt(14) lgkmcnt(2)
    v_mfma_f32_16x16x32_bf16 v[96:99], v[136:139], a[0:3], 0
    ds_read_b64_tr_b16 v[144:145], v160 offset:16384
    ds_read_b64_tr_b16 v[146:147], v160 offset:16896
    v_mfma_f32_16x16x32_bf16 v[100:103], v[136:139], a[4:7], 0
    v_mfma_f32_16x16x32_bf16 v[104:107], v[136:139], a[8:11], 0
    buffer_load_dwordx4 v174, s[16:19], s51 offen offset:2048 lds
    v_mfma_f32_16x16x32_bf16 v[108:111], v[136:139], a[12:15], 0
    s_waitcnt lgkmcnt(2)
    v_mfma_f32_16x16x32_bf16 v[112:115], v[140:143], a[0:3], 0
    ds_read_b64_tr_b16 v[148:149], v161 offset:16384
    ds_read_b64_tr_b16 v[150:151], v161 offset:16896
    v_mfma_f32_16x16x32_bf16 v[116:119], v[140:143], a[4:7], 0
    v_mfma_f32_16x16x32_bf16 v[120:123], v[140:143], a[8:11], 0
    buffer_load_dwordx4 v175, s[16:19], s51 offen offset:3072 lds
    v_mfma_f32_16x16x32_bf16 v[124:127], v[140:143], a[12:15], 0
    s_waitcnt lgkmcnt(2)
    s_add_u32 s51, s51, 262144
    s_and_b32 s51, s51, 4194303
    v_mfma_f32_16x16x32_bf16 v[64:67], v[144:147], a[16:19], v[64:67]
    ds_read_b64_tr_b16 v[152:153], v162 offset:16384
    ds_read_b64_tr_b16 v[154:155], v162 offset:16896
    v_mfma_f32_16x16x32_bf16 v[68:71], v[144:147], a[20:23], v[68:71]
    s_add_u32 m0, s75, 65536
    v_mfma_f32_16x16x32_bf16 v[72:75], v[144:147], a[24:27], v[72:75]
    buffer_load_dwordx4 v172, s[16:19], s51 offen lds
    v_mfma_f32_16x16x32_bf16 v[76:79], v[144:147], a[28:31], v[76:79]
    s_waitcnt lgkmcnt(2)
    v_mfma_f32_16x16x32_bf16 v[80:83], v[148:151], a[16:19], v[80:83]
    ds_read_b64_tr_b16 v[156:157], v163 offset:16384
    ds_read_b64_tr_b16 v[158:159], v163 offset:16896
    v_mfma_f32_16x16x32_bf16 v[84:87], v[148:151], a[20:23], v[84:87]
    v_mfma_f32_16x16x32_bf16 v[88:91], v[148:151], a[24:27], v[88:91]
    buffer_load_dwordx4 v173, s[16:19], s51 offen offset:1024 lds
    v_mfma_f32_16x16x32_bf16 v[92:95], v[148:151], a[28:31], v[92:95]
    s_waitcnt vmcnt(14) lgkmcnt(2)
    v_mfma_f32_16x16x32_bf16 v[96:99], v[152:155], a[16:19], v[96:99]
    ds_read_b64_tr_b16 v[128:129], v160 offset:32768
    ds_read_b64_tr_b16 v[130:131], v160 offset:33280
    v_mfma_f32_16x16x32_bf16 v[100:103], v[152:155], a[20:23], v[100:103]
    v_mfma_f32_16x16x32_bf16 v[104:107], v[152:155], a[24:27], v[104:107]
    buffer_load_dwordx4 v174, s[16:19], s51 offen offset:2048 lds
    v_mfma_f32_16x16x32_bf16 v[108:111], v[152:155], a[28:31], v[108:111]
    s_waitcnt lgkmcnt(2)
    v_mfma_f32_16x16x32_bf16 v[112:115], v[156:159], a[16:19], v[112:115]
    ds_read_b64_tr_b16 v[132:133], v161 offset:32768
    ds_read_b64_tr_b16 v[134:135], v161 offset:33280
    v_mfma_f32_16x16x32_bf16 v[116:119], v[156:159], a[20:23], v[116:119]
    v_mfma_f32_16x16x32_bf16 v[120:123], v[156:159], a[24:27], v[120:123]
    buffer_load_dwordx4 v175, s[16:19], s51 offen offset:3072 lds
    v_mfma_f32_16x16x32_bf16 v[124:127], v[156:159], a[28:31], v[124:127]
    s_waitcnt lgkmcnt(2)
    s_add_u32 s51, s51, 262144
    s_and_b32 s51, s51, 4194303
    v_mfma_f32_16x16x32_bf16 v[64:67], v[128:131], a[32:35], v[64:67]
    ds_read_b64_tr_b16 v[136:137], v162 offset:32768
    ds_read_b64_tr_b16 v[138:139], v162 offset:33280
    v_mfma_f32_16x16x32_bf16 v[68:71], v[128:131], a[36:39], v[68:71]
    s_add_u32 m0, s75, 81920
    v_cvt_pk_bf16_f32 v0, v0, v1
    v_cvt_pk_bf16_f32 v1, v2, v3
    v_mfma_f32_16x16x32_bf16 v[72:75], v[128:131], a[40:43], v[72:75]
    buffer_load_dwordx4 v172, s[16:19], s51 offen lds
    v_mfma_f32_16x16x32_bf16 v[76:79], v[128:131], a[44:47], v[76:79]
    s_waitcnt lgkmcnt(2)
    v_cvt_pk_bf16_f32 v16, v16, v17
    v_cvt_pk_bf16_f32 v17, v18, v19
    v_mfma_f32_16x16x32_bf16 v[80:83], v[132:135], a[32:35], v[80:83]
    ds_read_b64_tr_b16 v[140:141], v163 offset:32768
    ds_read_b64_tr_b16 v[142:143], v163 offset:33280
    v_mfma_f32_16x16x32_bf16 v[84:87], v[132:135], a[36:39], v[84:87]
    v_cvt_pk_bf16_f32 v4, v4, v5
    v_cvt_pk_bf16_f32 v5, v6, v7
    v_mfma_f32_16x16x32_bf16 v[88:91], v[132:135], a[40:43], v[88:91]
    buffer_load_dwordx4 v173, s[16:19], s51 offen offset:1024 lds
    v_mfma_f32_16x16x32_bf16 v[92:95], v[132:135], a[44:47], v[92:95]
    s_waitcnt vmcnt(14) lgkmcnt(2)
    v_cvt_pk_bf16_f32 v20, v20, v21
    v_cvt_pk_bf16_f32 v21, v22, v23
    v_mfma_f32_16x16x32_bf16 v[96:99], v[136:139], a[32:35], v[96:99]
    ds_read_b64_tr_b16 v[144:145], v160 offset:49152
    ds_read_b64_tr_b16 v[146:147], v160 offset:49664
    v_mfma_f32_16x16x32_bf16 v[100:103], v[136:139], a[36:39], v[100:103]
    v_cvt_pk_bf16_f32 v8, v8, v9
    v_cvt_pk_bf16_f32 v9, v10, v11
    v_mfma_f32_16x16x32_bf16 v[104:107], v[136:139], a[40:43], v[104:107]
    buffer_load_dwordx4 v174, s[16:19], s51 offen offset:2048 lds
    v_mfma_f32_16x16x32_bf16 v[108:111], v[136:139], a[44:47], v[108:111]
    s_waitcnt lgkmcnt(2)
    v_cvt_pk_bf16_f32 v24, v24, v25
    v_cvt_pk_bf16_f32 v25, v26, v27
    v_mfma_f32_16x16x32_bf16 v[112:115], v[140:143], a[32:35], v[112:115]
    ds_read_b64_tr_b16 v[148:149], v161 offset:49152
    ds_read_b64_tr_b16 v[150:151], v161 offset:49664
    v_mfma_f32_16x16x32_bf16 v[116:119], v[140:143], a[36:39], v[116:119]
    v_cvt_pk_bf16_f32 v12, v12, v13
    v_cvt_pk_bf16_f32 v13, v14, v15
    v_mfma_f32_16x16x32_bf16 v[120:123], v[140:143], a[40:43], v[120:123]
    buffer_load_dwordx4 v175, s[16:19], s51 offen offset:3072 lds
    v_mfma_f32_16x16x32_bf16 v[124:127], v[140:143], a[44:47], v[124:127]
    s_waitcnt lgkmcnt(2)
    s_add_u32 s51, s51, 262144
    s_and_b32 s51, s51, 4194303
    v_mfma_f32_16x16x32_bf16 v[64:67], v[144:147], a[48:51], v[64:67]
    ds_read_b64_tr_b16 v[152:153], v162 offset:49152
    ds_read_b64_tr_b16 v[154:155], v162 offset:49664
    v_mfma_f32_16x16x32_bf16 v[68:71], v[144:147], a[52:55], v[68:71]
    s_add_u32 m0, s75, 98304
    v_cvt_pk_bf16_f32 v28, v28, v29
    v_cvt_pk_bf16_f32 v29, v30, v31
    v_mfma_f32_16x16x32_bf16 v[72:75], v[144:147], a[56:59], v[72:75]
    buffer_load_dwordx4 v172, s[16:19], s51 offen lds
    v_mfma_f32_16x16x32_bf16 v[76:79], v[144:147], a[60:63], v[76:79]
    s_waitcnt lgkmcnt(2)
    v_permlane32_swap_b32 v0, v16
    v_permlane32_swap_b32 v1, v17
    v_mfma_f32_16x16x32_bf16 v[80:83], v[148:151], a[48:51], v[80:83]
    ds_read_b64_tr_b16 v[156:157], v163 offset:49152
    ds_read_b64_tr_b16 v[158:159], v163 offset:49664
    v_mfma_f32_16x16x32_bf16 v[84:87], v[148:151], a[52:55], v[84:87]
    v_permlane32_swap_b32 v4, v20
    v_permlane32_swap_b32 v5, v21
    v_mfma_f32_16x16x32_bf16 v[88:91], v[148:151], a[56:59], v[88:91]
    buffer_load_dwordx4 v173, s[16:19], s51 offen offset:1024 lds
    v_mfma_f32_16x16x32_bf16 v[92:95], v[148:151], a[60:63], v[92:95]
    s_waitcnt vmcnt(14) lgkmcnt(2)
    v_permlane32_swap_b32 v8, v24
    v_permlane32_swap_b32 v9, v25
    v_mfma_f32_16x16x32_bf16 v[96:99], v[152:155], a[48:51], v[96:99]
    ds_read_b64_tr_b16 v[128:129], v164 offset:0
    ds_read_b64_tr_b16 v[130:131], v164 offset:512
    v_mfma_f32_16x16x32_bf16 v[100:103], v[152:155], a[52:55], v[100:103]
    v_permlane32_swap_b32 v12, v28
    v_permlane32_swap_b32 v13, v29
    v_mfma_f32_16x16x32_bf16 v[104:107], v[152:155], a[56:59], v[104:107]
    buffer_load_dwordx4 v174, s[16:19], s51 offen offset:2048 lds
    v_mfma_f32_16x16x32_bf16 v[108:111], v[152:155], a[60:63], v[108:111]
    s_waitcnt lgkmcnt(2)
    v_permlane16_swap_b32 v0, v16
    v_permlane16_swap_b32 v1, v17
    v_mfma_f32_16x16x32_bf16 v[112:115], v[156:159], a[48:51], v[112:115]
    ds_read_b64_tr_b16 v[132:133], v165 offset:0
    ds_read_b64_tr_b16 v[134:135], v165 offset:512
    v_mfma_f32_16x16x32_bf16 v[116:119], v[156:159], a[52:55], v[116:119]
    v_permlane16_swap_b32 v4, v20
    v_permlane16_swap_b32 v5, v21
    v_mfma_f32_16x16x32_bf16 v[120:123], v[156:159], a[56:59], v[120:123]
    buffer_load_dwordx4 v175, s[16:19], s51 offen offset:3072 lds
    v_mfma_f32_16x16x32_bf16 v[124:127], v[156:159], a[60:63], v[124:127]
    s_waitcnt lgkmcnt(2)
    s_add_u32 s51, s51, 262144
    s_and_b32 s51, s51, 4194303
    v_mfma_f32_16x16x32_bf16 v[64:67], v[128:131], a[64:67], v[64:67]
    ds_read_b64_tr_b16 v[136:137], v166 offset:0
    ds_read_b64_tr_b16 v[138:139], v166 offset:512
    v_mfma_f32_16x16x32_bf16 v[68:71], v[128:131], a[68:71], v[68:71]
    s_add_u32 m0, s75, 114688
    v_permlane16_swap_b32 v8, v24
    v_permlane16_swap_b32 v9, v25
    v_mfma_f32_16x16x32_bf16 v[72:75], v[128:131], a[72:75], v[72:75]
    buffer_load_dwordx4 v172, s[16:19], s51 offen lds
    v_mfma_f32_16x16x32_bf16 v[76:79], v[128:131], a[76:79], v[76:79]
    s_waitcnt lgkmcnt(2)
    v_permlane16_swap_b32 v12, v28
    v_permlane16_swap_b32 v13, v29
    v_mfma_f32_16x16x32_bf16 v[80:83], v[132:135], a[64:67], v[80:83]
    ds_read_b64_tr_b16 v[140:141], v167 offset:0
    ds_read_b64_tr_b16 v[142:143], v167 offset:512
    v_mfma_f32_16x16x32_bf16 v[84:87], v[132:135], a[68:71], v[84:87]
    v_accvgpr_write_b32 a0, v0
    v_accvgpr_write_b32 a1, v1
    v_mfma_f32_16x16x32_bf16 v[88:91], v[132:135], a[72:75], v[88:91]
    buffer_load_dwordx4 v173, s[16:19], s51 offen offset:1024 lds
    v_mfma_f32_16x16x32_bf16 v[92:95], v[132:135], a[76:79], v[92:95]
    s_waitcnt vmcnt(14) lgkmcnt(2)
    v_accvgpr_write_b32 a2, v16
    v_accvgpr_write_b32 a3, v17
    v_mfma_f32_16x16x32_bf16 v[96:99], v[136:139], a[64:67], v[96:99]
    ds_read_b64_tr_b16 v[144:145], v164 offset:16384
    ds_read_b64_tr_b16 v[146:147], v164 offset:16896
    v_mfma_f32_16x16x32_bf16 v[100:103], v[136:139], a[68:71], v[100:103]
    v_accvgpr_write_b32 a4, v4
    v_accvgpr_write_b32 a5, v5
    v_mfma_f32_16x16x32_bf16 v[104:107], v[136:139], a[72:75], v[104:107]
    buffer_load_dwordx4 v174, s[16:19], s51 offen offset:2048 lds
    v_mfma_f32_16x16x32_bf16 v[108:111], v[136:139], a[76:79], v[108:111]
    s_waitcnt lgkmcnt(2)
    v_accvgpr_write_b32 a6, v20
    v_accvgpr_write_b32 a7, v21
    v_mfma_f32_16x16x32_bf16 v[112:115], v[140:143], a[64:67], v[112:115]
    ds_read_b64_tr_b16 v[148:149], v165 offset:16384
    ds_read_b64_tr_b16 v[150:151], v165 offset:16896
    v_mfma_f32_16x16x32_bf16 v[116:119], v[140:143], a[68:71], v[116:119]
    v_accvgpr_write_b32 a8, v8
    v_accvgpr_write_b32 a9, v9
    v_mfma_f32_16x16x32_bf16 v[120:123], v[140:143], a[72:75], v[120:123]
    buffer_load_dwordx4 v175, s[16:19], s51 offen offset:3072 lds
    v_mfma_f32_16x16x32_bf16 v[124:127], v[140:143], a[76:79], v[124:127]
    s_waitcnt lgkmcnt(2)
    s_add_u32 s51, s51, 262144
    s_and_b32 s51, s51, 4194303
    v_mfma_f32_16x16x32_bf16 v[64:67], v[144:147], a[80:83], v[64:67]
    ds_read_b64_tr_b16 v[152:153], v166 offset:16384
    ds_read_b64_tr_b16 v[154:155], v166 offset:16896
    v_mfma_f32_16x16x32_bf16 v[68:71], v[144:147], a[84:87], v[68:71]
    s_add_u32 m0, s75, 131072
    v_accvgpr_write_b32 a10, v24
    v_accvgpr_write_b32 a11, v25
    v_mfma_f32_16x16x32_bf16 v[72:75], v[144:147], a[88:91], v[72:75]
    buffer_load_dwordx4 v172, s[16:19], s51 offen lds
    v_mfma_f32_16x16x32_bf16 v[76:79], v[144:147], a[92:95], v[76:79]
    s_waitcnt lgkmcnt(2)
    v_accvgpr_write_b32 a12, v12
    v_accvgpr_write_b32 a13, v13
    v_mfma_f32_16x16x32_bf16 v[80:83], v[148:151], a[80:83], v[80:83]
    ds_read_b64_tr_b16 v[156:157], v167 offset:16384
    ds_read_b64_tr_b16 v[158:159], v167 offset:16896
    v_mfma_f32_16x16x32_bf16 v[84:87], v[148:151], a[84:87], v[84:87]
    v_accvgpr_write_b32 a14, v28
    v_accvgpr_write_b32 a15, v29
    v_mfma_f32_16x16x32_bf16 v[88:91], v[148:151], a[88:91], v[88:91]
    buffer_load_dwordx4 v173, s[16:19], s51 offen offset:1024 lds
    v_mfma_f32_16x16x32_bf16 v[92:95], v[148:151], a[92:95], v[92:95]
    s_waitcnt vmcnt(14) lgkmcnt(2)
    v_cvt_pk_bf16_f32 v32, v32, v33
    v_cvt_pk_bf16_f32 v33, v34, v35
    v_mfma_f32_16x16x32_bf16 v[96:99], v[152:155], a[80:83], v[96:99]
    ds_read_b64_tr_b16 v[128:129], v160 offset:0
    ds_read_b64_tr_b16 v[130:131], v160 offset:512
    v_mfma_f32_16x16x32_bf16 v[100:103], v[152:155], a[84:87], v[100:103]
    v_cvt_pk_bf16_f32 v48, v48, v49
    v_cvt_pk_bf16_f32 v49, v50, v51
    v_mfma_f32_16x16x32_bf16 v[104:107], v[152:155], a[88:91], v[104:107]
    buffer_load_dwordx4 v174, s[16:19], s51 offen offset:2048 lds
    v_mfma_f32_16x16x32_bf16 v[108:111], v[152:155], a[92:95], v[108:111]
    s_waitcnt lgkmcnt(2)
    v_cvt_pk_bf16_f32 v36, v36, v37
    v_cvt_pk_bf16_f32 v37, v38, v39
    v_mfma_f32_16x16x32_bf16 v[112:115], v[156:159], a[80:83], v[112:115]
    ds_read_b64_tr_b16 v[132:133], v161 offset:0
    ds_read_b64_tr_b16 v[134:135], v161 offset:512
    v_mfma_f32_16x16x32_bf16 v[116:119], v[156:159], a[84:87], v[116:119]
    v_cvt_pk_bf16_f32 v52, v52, v53
    v_cvt_pk_bf16_f32 v53, v54, v55
    v_mfma_f32_16x16x32_bf16 v[120:123], v[156:159], a[88:91], v[120:123]
    buffer_load_dwordx4 v175, s[16:19], s51 offen offset:3072 lds
    v_mfma_f32_16x16x32_bf16 v[124:127], v[156:159], a[92:95], v[124:127]
    s_waitcnt lgkmcnt(2)
    s_add_u32 s51, s51, 262144
    s_and_b32 s51, s51, 4194303
    v_mfma_f32_16x16x32_bf16 v[64:67], v[128:131], a[96:99], v[64:67]
    ds_read_b64_tr_b16 v[136:137], v162 offset:0
    ds_read_b64_tr_b16 v[138:139], v162 offset:512
    v_mfma_f32_16x16x32_bf16 v[68:71], v[128:131], a[100:103], v[68:71]
    s_add_u32 m0, s75, 147456
    v_cvt_pk_bf16_f32 v40, v40, v41
    v_cvt_pk_bf16_f32 v41, v42, v43
    v_mfma_f32_16x16x32_bf16 v[72:75], v[128:131], a[104:107], v[72:75]
    buffer_load_dwordx4 v172, s[16:19], s51 offen lds
    v_mfma_f32_16x16x32_bf16 v[76:79], v[128:131], a[108:111], v[76:79]
    s_waitcnt lgkmcnt(2)
    v_cvt_pk_bf16_f32 v56, v56, v57
    v_cvt_pk_bf16_f32 v57, v58, v59
    v_mfma_f32_16x16x32_bf16 v[80:83], v[132:135], a[96:99], v[80:83]
    ds_read_b64_tr_b16 v[140:141], v163 offset:0
    ds_read_b64_tr_b16 v[142:143], v163 offset:512
    v_mfma_f32_16x16x32_bf16 v[84:87], v[132:135], a[100:103], v[84:87]
    v_cvt_pk_bf16_f32 v44, v44, v45
    v_cvt_pk_bf16_f32 v45, v46, v47
    v_mfma_f32_16x16x32_bf16 v[88:91], v[132:135], a[104:107], v[88:91]
    buffer_load_dwordx4 v173, s[16:19], s51 offen offset:1024 lds
    v_mfma_f32_16x16x32_bf16 v[92:95], v[132:135], a[108:111], v[92:95]
    s_waitcnt vmcnt(14) lgkmcnt(2)
    v_cvt_pk_bf16_f32 v60, v60, v61
    v_cvt_pk_bf16_f32 v61, v62, v63
    v_mfma_f32_16x16x32_bf16 v[96:99], v[136:139], a[96:99], v[96:99]
    ds_read_b64_tr_b16 v[144:145], v160 offset:16384
    ds_read_b64_tr_b16 v[146:147], v160 offset:16896
    v_mfma_f32_16x16x32_bf16 v[100:103], v[136:139], a[100:103], v[100:103]
    v_permlane32_swap_b32 v32, v48
    v_permlane32_swap_b32 v33, v49
    v_mfma_f32_16x16x32_bf16 v[104:107], v[136:139], a[104:107], v[104:107]
    buffer_load_dwordx4 v174, s[16:19], s51 offen offset:2048 lds
    v_mfma_f32_16x16x32_bf16 v[108:111], v[136:139], a[108:111], v[108:111]
    s_waitcnt lgkmcnt(2)
    v_permlane32_swap_b32 v36, v52
    v_permlane32_swap_b32 v37, v53
    v_mfma_f32_16x16x32_bf16 v[112:115], v[140:143], a[96:99], v[112:115]
    ds_read_b64_tr_b16 v[148:149], v161 offset:16384
    ds_read_b64_tr_b16 v[150:151], v161 offset:16896
    v_mfma_f32_16x16x32_bf16 v[116:119], v[140:143], a[100:103], v[116:119]
    v_permlane32_swap_b32 v40, v56
    v_permlane32_swap_b32 v41, v57
    v_mfma_f32_16x16x32_bf16 v[120:123], v[140:143], a[104:107], v[120:123]
    buffer_load_dwordx4 v175, s[16:19], s51 offen offset:3072 lds
    v_mfma_f32_16x16x32_bf16 v[124:127], v[140:143], a[108:111], v[124:127]
    s_waitcnt lgkmcnt(2)
    s_add_u32 s51, s51, 262144
    s_and_b32 s51, s51, 4194303
    v_mfma_f32_16x16x32_bf16 v[64:67], v[144:147], a[112:115], v[64:67]
    ds_read_b64_tr_b16 v[152:153], v162 offset:16384
    ds_read_b64_tr_b16 v[154:155], v162 offset:16896
    v_mfma_f32_16x16x32_bf16 v[68:71], v[144:147], a[116:119], v[68:71]
    s_add_u32 m0, s75, 65536
    v_permlane32_swap_b32 v44, v60
    v_permlane32_swap_b32 v45, v61
    v_mfma_f32_16x16x32_bf16 v[72:75], v[144:147], a[120:123], v[72:75]
    buffer_load_dwordx4 v172, s[16:19], s51 offen lds
    v_mfma_f32_16x16x32_bf16 v[76:79], v[144:147], a[124:127], v[76:79]
    s_waitcnt lgkmcnt(2)
    v_permlane16_swap_b32 v32, v48
    v_permlane16_swap_b32 v33, v49
    v_mfma_f32_16x16x32_bf16 v[80:83], v[148:151], a[112:115], v[80:83]
    ds_read_b64_tr_b16 v[156:157], v163 offset:16384
    ds_read_b64_tr_b16 v[158:159], v163 offset:16896
    v_mfma_f32_16x16x32_bf16 v[84:87], v[148:151], a[116:119], v[84:87]
    v_permlane16_swap_b32 v36, v52
    v_permlane16_swap_b32 v37, v53
    v_mfma_f32_16x16x32_bf16 v[88:91], v[148:151], a[120:123], v[88:91]
    buffer_load_dwordx4 v173, s[16:19], s51 offen offset:1024 lds
    v_mfma_f32_16x16x32_bf16 v[92:95], v[148:151], a[124:127], v[92:95]
    s_waitcnt vmcnt(14) lgkmcnt(2)
    v_permlane16_swap_b32 v40, v56
    v_permlane16_swap_b32 v41, v57
    v_mfma_f32_16x16x32_bf16 v[96:99], v[152:155], a[112:115], v[96:99]
    ds_read_b64_tr_b16 v[128:129], v160 offset:32768
    ds_read_b64_tr_b16 v[130:131], v160 offset:33280
    v_mfma_f32_16x16x32_bf16 v[100:103], v[152:155], a[116:119], v[100:103]
    v_permlane16_swap_b32 v44, v60
    v_permlane16_swap_b32 v45, v61
    v_mfma_f32_16x16x32_bf16 v[104:107], v[152:155], a[120:123], v[104:107]
    buffer_load_dwordx4 v174, s[16:19], s51 offen offset:2048 lds
    v_mfma_f32_16x16x32_bf16 v[108:111], v[152:155], a[124:127], v[108:111]
    s_waitcnt lgkmcnt(2)
    v_accvgpr_write_b32 a16, v32
    v_accvgpr_write_b32 a17, v33
    v_mfma_f32_16x16x32_bf16 v[112:115], v[156:159], a[112:115], v[112:115]
    ds_read_b64_tr_b16 v[132:133], v161 offset:32768
    ds_read_b64_tr_b16 v[134:135], v161 offset:33280
    v_mfma_f32_16x16x32_bf16 v[116:119], v[156:159], a[116:119], v[116:119]
    v_accvgpr_write_b32 a18, v48
    v_accvgpr_write_b32 a19, v49
    v_mfma_f32_16x16x32_bf16 v[120:123], v[156:159], a[120:123], v[120:123]
    buffer_load_dwordx4 v175, s[16:19], s51 offen offset:3072 lds
    v_mfma_f32_16x16x32_bf16 v[124:127], v[156:159], a[124:127], v[124:127]
    s_waitcnt lgkmcnt(2)
    s_add_u32 s51, s51, 262144
    s_and_b32 s51, s51, 4194303
    v_mfma_f32_16x16x32_bf16 v[64:67], v[128:131], a[128:131], v[64:67]
    ds_read_b64_tr_b16 v[136:137], v162 offset:32768
    ds_read_b64_tr_b16 v[138:139], v162 offset:33280
    v_mfma_f32_16x16x32_bf16 v[68:71], v[128:131], a[132:135], v[68:71]
    s_add_u32 m0, s75, 81920
    v_accvgpr_write_b32 a20, v36
    v_accvgpr_write_b32 a21, v37
    v_mfma_f32_16x16x32_bf16 v[72:75], v[128:131], a[136:139], v[72:75]
    buffer_load_dwordx4 v172, s[16:19], s51 offen lds
    v_mfma_f32_16x16x32_bf16 v[76:79], v[128:131], a[140:143], v[76:79]
    s_waitcnt lgkmcnt(2)
    v_accvgpr_write_b32 a22, v52
    v_accvgpr_write_b32 a23, v53
    v_mfma_f32_16x16x32_bf16 v[80:83], v[132:135], a[128:131], v[80:83]
    ds_read_b64_tr_b16 v[140:141], v163 offset:32768
    ds_read_b64_tr_b16 v[142:143], v163 offset:33280
    v_mfma_f32_16x16x32_bf16 v[84:87], v[132:135], a[132:135], v[84:87]
    v_accvgpr_write_b32 a24, v40
    v_accvgpr_write_b32 a25, v41
    v_mfma_f32_16x16x32_bf16 v[88:91], v[132:135], a[136:139], v[88:91]
    buffer_load_dwordx4 v173, s[16:19], s51 offen offset:1024 lds
    v_mfma_f32_16x16x32_bf16 v[92:95], v[132:135], a[140:143], v[92:95]
    s_waitcnt vmcnt(14) lgkmcnt(2)
    v_accvgpr_write_b32 a26, v56
    v_accvgpr_write_b32 a27, v57
    v_mfma_f32_16x16x32_bf16 v[96:99], v[136:139], a[128:131], v[96:99]
    ds_read_b64_tr_b16 v[144:145], v160 offset:49152
    ds_read_b64_tr_b16 v[146:147], v160 offset:49664
    v_mfma_f32_16x16x32_bf16 v[100:103], v[136:139], a[132:135], v[100:103]
    v_accvgpr_write_b32 a28, v44
    v_accvgpr_write_b32 a29, v45
    v_mfma_f32_16x16x32_bf16 v[104:107], v[136:139], a[136:139], v[104:107]
    buffer_load_dwordx4 v174, s[16:19], s51 offen offset:2048 lds
    v_mfma_f32_16x16x32_bf16 v[108:111], v[136:139], a[140:143], v[108:111]
    s_waitcnt lgkmcnt(2)
    v_accvgpr_write_b32 a30, v60
    v_accvgpr_write_b32 a31, v61
    v_mfma_f32_16x16x32_bf16 v[112:115], v[140:143], a[128:131], v[112:115]
    ds_read_b64_tr_b16 v[148:149], v161 offset:49152
    ds_read_b64_tr_b16 v[150:151], v161 offset:49664
    v_mfma_f32_16x16x32_bf16 v[116:119], v[140:143], a[132:135], v[116:119]
    v_and_b32 v228, 3, v236
    v_mov_b32 v229, 0x3f803f80
    v_mfma_f32_16x16x32_bf16 v[120:123], v[140:143], a[136:139], v[120:123]
    buffer_load_dwordx4 v175, s[16:19], s51 offen offset:3072 lds
    v_mfma_f32_16x16x32_bf16 v[124:127], v[140:143], a[140:143], v[124:127]
    s_waitcnt lgkmcnt(2)
    s_add_u32 s51, s51, 262144
    s_and_b32 s51, s51, 4194303
    v_mfma_f32_16x16x32_bf16 v[64:67], v[144:147], a[144:147], v[64:67]
    ds_read_b64_tr_b16 v[152:153], v162 offset:49152
    ds_read_b64_tr_b16 v[154:155], v162 offset:49664
    v_mfma_f32_16x16x32_bf16 v[68:71], v[144:147], a[148:151], v[68:71]
    s_add_u32 m0, s75, 98304
    v_cmp_eq_u32 vcc, 0, v228
    s_nop 1
    v_mfma_f32_16x16x32_bf16 v[72:75], v[144:147], a[152:155], v[72:75]
    buffer_load_dwordx4 v172, s[16:19], s51 offen lds
    v_mfma_f32_16x16x32_bf16 v[76:79], v[144:147], a[156:159], v[76:79]
    s_waitcnt lgkmcnt(2)
    v_cndmask_b32 v230, 0, v229, vcc
    v_accvgpr_write_b32 a112, v230
    v_mfma_f32_16x16x32_bf16 v[80:83], v[148:151], a[144:147], v[80:83]
    ds_read_b64_tr_b16 v[156:157], v163 offset:49152
    ds_read_b64_tr_b16 v[158:159], v163 offset:49664
    v_mfma_f32_16x16x32_bf16 v[84:87], v[148:151], a[148:151], v[84:87]
    v_accvgpr_write_b32 a113, v230
    v_accvgpr_write_b32 a114, v230
    v_mfma_f32_16x16x32_bf16 v[88:91], v[148:151], a[152:155], v[88:91]
    buffer_load_dwordx4 v173, s[16:19], s51 offen offset:1024 lds
    v_mfma_f32_16x16x32_bf16 v[92:95], v[148:151], a[156:159], v[92:95]
    s_waitcnt vmcnt(14) lgkmcnt(2)
    v_accvgpr_write_b32 a115, v230
    v_cmp_eq_u32 vcc, 1, v228
    v_mfma_f32_16x16x32_bf16 v[96:99], v[152:155], a[144:147], v[96:99]
    ds_read_b64_tr_b16 v[128:129], v164 offset:0
    ds_read_b64_tr_b16 v[130:131], v164 offset:512
    v_mfma_f32_16x16x32_bf16 v[100:103], v[152:155], a[148:151], v[100:103]
    s_nop 1
    v_cndmask_b32 v230, 0, v229, vcc
    v_mfma_f32_16x16x32_bf16 v[104:107], v[152:155], a[152:155], v[104:107]
    buffer_load_dwordx4 v174, s[16:19], s51 offen offset:2048 lds
    v_mfma_f32_16x16x32_bf16 v[108:111], v[152:155], a[156:159], v[108:111]
    s_waitcnt lgkmcnt(2)
    v_accvgpr_write_b32 a116, v230
    v_accvgpr_write_b32 a117, v230
    v_mfma_f32_16x16x32_bf16 v[112:115], v[156:159], a[144:147], v[112:115]
    ds_read_b64_tr_b16 v[132:133], v165 offset:0
    ds_read_b64_tr_b16 v[134:135], v165 offset:512
    v_mfma_f32_16x16x32_bf16 v[116:119], v[156:159], a[148:151], v[116:119]
    v_accvgpr_write_b32 a118, v230
    v_accvgpr_write_b32 a119, v230
    v_mfma_f32_16x16x32_bf16 v[120:123], v[156:159], a[152:155], v[120:123]
    buffer_load_dwordx4 v175, s[16:19], s51 offen offset:3072 lds
    v_mfma_f32_16x16x32_bf16 v[124:127], v[156:159], a[156:159], v[124:127]
    s_waitcnt lgkmcnt(2)
    s_add_u32 s51, s51, 262144
    s_and_b32 s51, s51, 4194303
    v_mfma_f32_16x16x32_bf16 v[64:67], v[128:131], a[160:163], v[64:67]
    ds_read_b64_tr_b16 v[136:137], v166 offset:0
    ds_read_b64_tr_b16 v[138:139], v166 offset:512
    v_mfma_f32_16x16x32_bf16 v[68:71], v[128:131], a[164:167], v[68:71]
    s_add_u32 m0, s75, 114688
    v_cmp_eq_u32 vcc, 2, v228
    s_nop 1
    v_mfma_f32_16x16x32_bf16 v[72:75], v[128:131], a[168:171], v[72:75]
    buffer_load_dwordx4 v172, s[16:19], s51 offen lds
    v_mfma_f32_16x16x32_bf16 v[76:79], v[128:131], a[172:175], v[76:79]
    s_waitcnt lgkmcnt(2)
    v_cndmask_b32 v230, 0, v229, vcc
    v_accvgpr_write_b32 a120, v230
    v_mfma_f32_16x16x32_bf16 v[80:83], v[132:135], a[160:163], v[80:83]
    ds_read_b64_tr_b16 v[140:141], v167 offset:0
    ds_read_b64_tr_b16 v[142:143], v167 offset:512
    v_mfma_f32_16x16x32_bf16 v[84:87], v[132:135], a[164:167], v[84:87]
    v_accvgpr_write_b32 a121, v230
    v_accvgpr_write_b32 a122, v230
    v_mfma_f32_16x16x32_bf16 v[88:91], v[132:135], a[168:171], v[88:91]
    buffer_load_dwordx4 v173, s[16:19], s51 offen offset:1024 lds
    v_mfma_f32_16x16x32_bf16 v[92:95], v[132:135], a[172:175], v[92:95]
    s_waitcnt vmcnt(14) lgkmcnt(2)
    v_accvgpr_write_b32 a123, v230
    v_cmp_eq_u32 vcc, 3, v228
    v_mfma_f32_16x16x32_bf16 v[96:99], v[136:139], a[160:163], v[96:99]
    ds_read_b64_tr_b16 v[144:145], v164 offset:16384
    ds_read_b64_tr_b16 v[146:147], v164 offset:16896
    v_mfma_f32_16x16x32_bf16 v[100:103], v[136:139], a[164:167], v[100:103]
    s_nop 1
    v_cndmask_b32 v230, 0, v229, vcc
    v_mfma_f32_16x16x32_bf16 v[104:107], v[136:139], a[168:171], v[104:107]
    buffer_load_dwordx4 v174, s[16:19], s51 offen offset:2048 lds
    v_mfma_f32_16x16x32_bf16 v[108:111], v[136:139], a[172:175], v[108:111]
    s_waitcnt lgkmcnt(2)
    v_accvgpr_write_b32 a124, v230
    v_accvgpr_write_b32 a125, v230
    v_mfma_f32_16x16x32_bf16 v[112:115], v[140:143], a[160:163], v[112:115]
    ds_read_b64_tr_b16 v[148:149], v165 offset:16384
    ds_read_b64_tr_b16 v[150:151], v165 offset:16896
    v_mfma_f32_16x16x32_bf16 v[116:119], v[140:143], a[164:167], v[116:119]
    v_accvgpr_write_b32 a126, v230
    v_accvgpr_write_b32 a127, v230
    v_mfma_f32_16x16x32_bf16 v[120:123], v[140:143], a[168:171], v[120:123]
    buffer_load_dwordx4 v175, s[16:19], s51 offen offset:3072 lds
    v_mfma_f32_16x16x32_bf16 v[124:127], v[140:143], a[172:175], v[124:127]
    s_waitcnt lgkmcnt(2)
    s_mov_b32 s78, 0
    s_add_u32 m0, s75, 131072
    v_mfma_f32_16x16x32_bf16 v[64:67], v[144:147], a[176:179], v[64:67]
    ds_read_b64_tr_b16 v[152:153], v166 offset:16384
    ds_read_b64_tr_b16 v[154:155], v166 offset:16896
    v_mfma_f32_16x16x32_bf16 v[68:71], v[144:147], a[180:183], v[68:71]
    v_accvgpr_write_b32 a128, v192
    v_accvgpr_write_b32 a129, v193
    v_mfma_f32_16x16x32_bf16 v[72:75], v[144:147], a[184:187], v[72:75]
    buffer_load_dwordx4 v224, s[8:11], s78 offen lds
    v_mfma_f32_16x16x32_bf16 v[76:79], v[144:147], a[188:191], v[76:79]
    s_waitcnt lgkmcnt(2)
    v_accvgpr_write_b32 a130, v194
    v_accvgpr_write_b32 a131, v195
    v_mfma_f32_16x16x32_bf16 v[80:83], v[148:151], a[176:179], v[80:83]
    ds_read_b64_tr_b16 v[156:157], v167 offset:16384
    ds_read_b64_tr_b16 v[158:159], v167 offset:16896
    v_mfma_f32_16x16x32_bf16 v[84:87], v[148:151], a[180:183], v[84:87]
    v_accvgpr_write_b32 a132, v196
    v_accvgpr_write_b32 a133, v197
    v_mfma_f32_16x16x32_bf16 v[88:91], v[148:151], a[184:187], v[88:91]
    buffer_load_dwordx4 v224, s[8:11], s78 offen offset:1024 lds
    v_mfma_f32_16x16x32_bf16 v[92:95], v[148:151], a[188:191], v[92:95]
    s_waitcnt vmcnt(14) lgkmcnt(2)
    v_accvgpr_write_b32 a134, v198
    v_accvgpr_write_b32 a135, v199
    v_mfma_f32_16x16x32_bf16 v[96:99], v[152:155], a[176:179], v[96:99]
    ds_read_b64_tr_b16 v[128:129], v160 offset:0
    ds_read_b64_tr_b16 v[130:131], v160 offset:512
    v_mfma_f32_16x16x32_bf16 v[100:103], v[152:155], a[180:183], v[100:103]
    v_accvgpr_write_b32 a136, v200
    v_accvgpr_write_b32 a137, v201
    v_mfma_f32_16x16x32_bf16 v[104:107], v[152:155], a[184:187], v[104:107]
    buffer_load_dwordx4 v225, s[8:11], s78 offen offset:2048 lds
    v_mfma_f32_16x16x32_bf16 v[108:111], v[152:155], a[188:191], v[108:111]
    s_waitcnt lgkmcnt(2)
    v_accvgpr_write_b32 a138, v202
    v_accvgpr_write_b32 a139, v203
    v_mfma_f32_16x16x32_bf16 v[112:115], v[156:159], a[176:179], v[112:115]
    ds_read_b64_tr_b16 v[132:133], v161 offset:0
    ds_read_b64_tr_b16 v[134:135], v161 offset:512
    v_mfma_f32_16x16x32_bf16 v[116:119], v[156:159], a[180:183], v[116:119]
    v_accvgpr_write_b32 a140, v204
    v_accvgpr_write_b32 a141, v205
    v_mfma_f32_16x16x32_bf16 v[120:123], v[156:159], a[184:187], v[120:123]
    buffer_load_dwordx4 v225, s[8:11], s78 offen offset:3072 lds
    v_mfma_f32_16x16x32_bf16 v[124:127], v[156:159], a[188:191], v[124:127]
    s_waitcnt lgkmcnt(2)
    s_mov_b32 s78, 16384
    s_add_u32 m0, s75, 147456
    v_mfma_f32_16x16x32_bf16 v[64:67], v[128:131], a[192:195], v[64:67]
    ds_read_b64_tr_b16 v[136:137], v162 offset:0
    ds_read_b64_tr_b16 v[138:139], v162 offset:512
    v_mfma_f32_16x16x32_bf16 v[68:71], v[128:131], a[196:199], v[68:71]
    v_accvgpr_write_b32 a142, v206
    v_accvgpr_write_b32 a143, v207
    v_mfma_f32_16x16x32_bf16 v[72:75], v[128:131], a[200:203], v[72:75]
    buffer_load_dwordx4 v224, s[8:11], s78 offen lds
    v_mfma_f32_16x16x32_bf16 v[76:79], v[128:131], a[204:207], v[76:79]
    s_waitcnt lgkmcnt(2)
    v_accvgpr_write_b32 a144, v176
    v_accvgpr_write_b32 a145, v177
    v_mfma_f32_16x16x32_bf16 v[80:83], v[132:135], a[192:195], v[80:83]
    ds_read_b64_tr_b16 v[140:141], v163 offset:0
    ds_read_b64_tr_b16 v[142:143], v163 offset:512
    v_mfma_f32_16x16x32_bf16 v[84:87], v[132:135], a[196:199], v[84:87]
    v_accvgpr_write_b32 a146, v178
    v_accvgpr_write_b32 a147, v179
    v_mfma_f32_16x16x32_bf16 v[88:91], v[132:135], a[200:203], v[88:91]
    buffer_load_dwordx4 v224, s[8:11], s78 offen offset:1024 lds
    v_mfma_f32_16x16x32_bf16 v[92:95], v[132:135], a[204:207], v[92:95]
    s_waitcnt vmcnt(14) lgkmcnt(2)
    v_accvgpr_write_b32 a148, v180
    v_accvgpr_write_b32 a149, v181
    v_mfma_f32_16x16x32_bf16 v[96:99], v[136:139], a[192:195], v[96:99]
    ds_read_b64_tr_b16 v[144:145], v160 offset:16384
    ds_read_b64_tr_b16 v[146:147], v160 offset:16896
    v_mfma_f32_16x16x32_bf16 v[100:103], v[136:139], a[196:199], v[100:103]
    v_accvgpr_write_b32 a150, v182
    v_accvgpr_write_b32 a151, v183
    v_mfma_f32_16x16x32_bf16 v[104:107], v[136:139], a[200:203], v[104:107]
    buffer_load_dwordx4 v225, s[8:11], s78 offen offset:2048 lds
    v_mfma_f32_16x16x32_bf16 v[108:111], v[136:139], a[204:207], v[108:111]
    s_waitcnt lgkmcnt(2)
    v_accvgpr_write_b32 a152, v184
    v_accvgpr_write_b32 a153, v185
    v_mfma_f32_16x16x32_bf16 v[112:115], v[140:143], a[192:195], v[112:115]
    ds_read_b64_tr_b16 v[148:149], v161 offset:16384
    ds_read_b64_tr_b16 v[150:151], v161 offset:16896
    v_mfma_f32_16x16x32_bf16 v[116:119], v[140:143], a[196:199], v[116:119]
    v_accvgpr_write_b32 a154, v186
    v_accvgpr_write_b32 a155, v187
    v_mfma_f32_16x16x32_bf16 v[120:123], v[140:143], a[200:203], v[120:123]
    buffer_load_dwordx4 v225, s[8:11], s78 offen offset:3072 lds
    v_mfma_f32_16x16x32_bf16 v[124:127], v[140:143], a[204:207], v[124:127]
    s_waitcnt lgkmcnt(2)
    s_mov_b32 s78, 0
    s_add_u32 m0, s75, 65536
    v_mfma_f32_16x16x32_bf16 v[64:67], v[144:147], a[208:211], v[64:67]
    ds_read_b64_tr_b16 v[152:153], v162 offset:16384
    ds_read_b64_tr_b16 v[154:155], v162 offset:16896
    v_mfma_f32_16x16x32_bf16 v[68:71], v[144:147], a[212:215], v[68:71]
    v_accvgpr_write_b32 a156, v208
    v_accvgpr_write_b32 a157, v209
    v_mfma_f32_16x16x32_bf16 v[72:75], v[144:147], a[216:219], v[72:75]
    buffer_load_dwordx4 v226, s[12:15], s78 offen lds
    v_mfma_f32_16x16x32_bf16 v[76:79], v[144:147], a[220:223], v[76:79]
    s_waitcnt lgkmcnt(2)
    v_accvgpr_write_b32 a158, v210
    v_accvgpr_write_b32 a159, v211
    v_mfma_f32_16x16x32_bf16 v[80:83], v[148:151], a[208:211], v[80:83]
    ds_read_b64_tr_b16 v[156:157], v163 offset:16384
    ds_read_b64_tr_b16 v[158:159], v163 offset:16896
    v_mfma_f32_16x16x32_bf16 v[84:87], v[148:151], a[212:215], v[84:87]
    v_mfma_f32_16x16x32_bf16 v[88:91], v[148:151], a[216:219], v[88:91]
    buffer_load_dwordx4 v226, s[12:15], s78 offen offset:1024 lds
    v_mfma_f32_16x16x32_bf16 v[92:95], v[148:151], a[220:223], v[92:95]
    s_waitcnt vmcnt(14) lgkmcnt(2)
    v_mfma_f32_16x16x32_bf16 v[96:99], v[152:155], a[208:211], v[96:99]
    ds_read_b64_tr_b16 v[128:129], v160 offset:32768
    ds_read_b64_tr_b16 v[130:131], v160 offset:33280
    v_mfma_f32_16x16x32_bf16 v[100:103], v[152:155], a[212:215], v[100:103]
    v_mfma_f32_16x16x32_bf16 v[104:107], v[152:155], a[216:219], v[104:107]
    buffer_load_dwordx4 v227, s[12:15], s78 offen offset:2048 lds
    v_mfma_f32_16x16x32_bf16 v[108:111], v[152:155], a[220:223], v[108:111]
    s_waitcnt lgkmcnt(2)
    v_mfma_f32_16x16x32_bf16 v[112:115], v[156:159], a[208:211], v[112:115]
    ds_read_b64_tr_b16 v[132:133], v161 offset:32768
    ds_read_b64_tr_b16 v[134:135], v161 offset:33280
    v_mfma_f32_16x16x32_bf16 v[116:119], v[156:159], a[212:215], v[116:119]
    v_mfma_f32_16x16x32_bf16 v[120:123], v[156:159], a[216:219], v[120:123]
    buffer_load_dwordx4 v227, s[12:15], s78 offen offset:3072 lds
    v_mfma_f32_16x16x32_bf16 v[124:127], v[156:159], a[220:223], v[124:127]
    s_waitcnt lgkmcnt(2)
    s_mov_b32 s78, 16384
    s_add_u32 m0, s75, 81920
    v_mfma_f32_16x16x32_bf16 v[64:67], v[128:131], a[224:227], v[64:67]
    ds_read_b64_tr_b16 v[136:137], v162 offset:32768
    ds_read_b64_tr_b16 v[138:139], v162 offset:33280
    v_mfma_f32_16x16x32_bf16 v[68:71], v[128:131], a[228:231], v[68:71]
    v_mfma_f32_16x16x32_bf16 v[72:75], v[128:131], a[232:235], v[72:75]
    buffer_load_dwordx4 v226, s[12:15], s78 offen lds
    v_mfma_f32_16x16x32_bf16 v[76:79], v[128:131], a[236:239], v[76:79]
    s_waitcnt lgkmcnt(2)
    v_mfma_f32_16x16x32_bf16 v[80:83], v[132:135], a[224:227], v[80:83]
    ds_read_b64_tr_b16 v[140:141], v163 offset:32768
    ds_read_b64_tr_b16 v[142:143], v163 offset:33280
    v_mfma_f32_16x16x32_bf16 v[84:87], v[132:135], a[228:231], v[84:87]
    v_mfma_f32_16x16x32_bf16 v[88:91], v[132:135], a[232:235], v[88:91]
    buffer_load_dwordx4 v226, s[12:15], s78 offen offset:1024 lds
    v_mfma_f32_16x16x32_bf16 v[92:95], v[132:135], a[236:239], v[92:95]
    s_waitcnt vmcnt(14) lgkmcnt(2)
    v_mfma_f32_16x16x32_bf16 v[96:99], v[136:139], a[224:227], v[96:99]
    ds_read_b64_tr_b16 v[144:145], v160 offset:49152
    ds_read_b64_tr_b16 v[146:147], v160 offset:49664
    v_mfma_f32_16x16x32_bf16 v[100:103], v[136:139], a[228:231], v[100:103]
    v_mfma_f32_16x16x32_bf16 v[104:107], v[136:139], a[232:235], v[104:107]
    buffer_load_dwordx4 v227, s[12:15], s78 offen offset:2048 lds
    v_mfma_f32_16x16x32_bf16 v[108:111], v[136:139], a[236:239], v[108:111]
    s_waitcnt lgkmcnt(2)
    v_mfma_f32_16x16x32_bf16 v[112:115], v[140:143], a[224:227], v[112:115]
    ds_read_b64_tr_b16 v[148:149], v161 offset:49152
    ds_read_b64_tr_b16 v[150:151], v161 offset:49664
    v_mfma_f32_16x16x32_bf16 v[116:119], v[140:143], a[228:231], v[116:119]
    v_mfma_f32_16x16x32_bf16 v[120:123], v[140:143], a[232:235], v[120:123]
    buffer_load_dwordx4 v227, s[12:15], s78 offen offset:3072 lds
    v_mfma_f32_16x16x32_bf16 v[124:127], v[140:143], a[236:239], v[124:127]
    s_waitcnt lgkmcnt(2)
    s_mov_b32 s78, 32768
    s_add_u32 m0, s75, 98304
    v_mfma_f32_16x16x32_bf16 v[64:67], v[144:147], a[240:243], v[64:67]
    ds_read_b64_tr_b16 v[152:153], v162 offset:49152
    ds_read_b64_tr_b16 v[154:155], v162 offset:49664
    v_mfma_f32_16x16x32_bf16 v[68:71], v[144:147], a[244:247], v[68:71]
    v_mfma_f32_16x16x32_bf16 v[72:75], v[144:147], a[248:251], v[72:75]
    buffer_load_dwordx4 v224, s[8:11], s78 offen lds
    v_mfma_f32_16x16x32_bf16 v[76:79], v[144:147], a[252:255], v[76:79]
    s_waitcnt lgkmcnt(2)
    s_waitcnt vmcnt(13)
    s_barrier
    v_mfma_f32_16x16x32_bf16 v[80:83], v[148:151], a[240:243], v[80:83]
    ds_read_b64_tr_b16 v[156:157], v163 offset:49152
    ds_read_b64_tr_b16 v[158:159], v163 offset:49664
    v_mfma_f32_16x16x32_bf16 v[84:87], v[148:151], a[244:247], v[84:87]
    ds_read_b128 a[64:67], v212 offset:32768
    ds_read_b128 a[68:71], v213 offset:32768
    v_mfma_f32_16x16x32_bf16 v[88:91], v[148:151], a[248:251], v[88:91]
    buffer_load_dwordx4 v224, s[8:11], s78 offen offset:1024 lds
    v_mfma_f32_16x16x32_bf16 v[92:95], v[148:151], a[252:255], v[92:95]
    s_waitcnt lgkmcnt(4)
    v_mfma_f32_16x16x32_bf16 v[96:99], v[152:155], a[240:243], v[96:99]
    ds_read_b128 a[72:75], v214 offset:32768
    ds_read_b128 a[76:79], v215 offset:32768
    v_mfma_f32_16x16x32_bf16 v[100:103], v[152:155], a[244:247], v[100:103]
    ds_read_b128 a[80:83], v212 offset:33792
    ds_read_b128 a[84:87], v213 offset:33792
    v_mfma_f32_16x16x32_bf16 v[104:107], v[152:155], a[248:251], v[104:107]
    buffer_load_dwordx4 v225, s[8:11], s78 offen offset:2048 lds
    v_mfma_f32_16x16x32_bf16 v[108:111], v[152:155], a[252:255], v[108:111]
    s_waitcnt lgkmcnt(6)
    v_mfma_f32_16x16x32_bf16 v[112:115], v[156:159], a[240:243], v[112:115]
    ds_read_b128 a[88:91], v214 offset:33792
    ds_read_b128 a[92:95], v215 offset:33792
    v_mfma_f32_16x16x32_bf16 v[116:119], v[156:159], a[244:247], v[116:119]
    v_cvt_pk_bf16_f32 v64, v64, v65
    v_cvt_pk_bf16_f32 v65, v66, v67
    v_mfma_f32_16x16x32_bf16 v[120:123], v[156:159], a[248:251], v[120:123]
    buffer_load_dwordx4 v225, s[8:11], s78 offen offset:3072 lds
    v_mfma_f32_16x16x32_bf16 v[124:127], v[156:159], a[252:255], v[124:127]
    v_cvt_pk_bf16_f32 v80, v80, v81
    v_cvt_pk_bf16_f32 v81, v82, v83
    s_mov_b32 s78, 32768
    s_add_u32 m0, s75, 32768
    v_cvt_pk_bf16_f32 v68, v68, v69
    v_cvt_pk_bf16_f32 v69, v70, v71
    v_cvt_pk_bf16_f32 v84, v84, v85
    v_cvt_pk_bf16_f32 v85, v86, v87
    v_cvt_pk_bf16_f32 v72, v72, v73
    v_cvt_pk_bf16_f32 v73, v74, v75
    v_cvt_pk_bf16_f32 v88, v88, v89
    v_cvt_pk_bf16_f32 v89, v90, v91
    v_cvt_pk_bf16_f32 v76, v76, v77
    v_cvt_pk_bf16_f32 v77, v78, v79
    v_cvt_pk_bf16_f32 v92, v92, v93
    buffer_load_dwordx4 v226, s[12:15], s78 offen lds
    v_cvt_pk_bf16_f32 v93, v94, v95
    v_permlane32_swap_b32 v64, v80
    v_permlane32_swap_b32 v65, v81
    v_permlane32_swap_b32 v68, v84
    v_permlane32_swap_b32 v69, v85
    v_permlane32_swap_b32 v72, v88
    v_permlane32_swap_b32 v73, v89
    v_permlane32_swap_b32 v76, v92
    v_permlane32_swap_b32 v77, v93
    v_permlane16_swap_b32 v64, v80
    v_permlane16_swap_b32 v65, v81
    buffer_load_dwordx4 v226, s[12:15], s78 offen offset:1024 lds
    v_permlane16_swap_b32 v68, v84
    v_permlane16_swap_b32 v69, v85
    v_permlane16_swap_b32 v72, v88
    v_permlane16_swap_b32 v73, v89
    v_permlane16_swap_b32 v76, v92
    v_permlane16_swap_b32 v77, v93
    v_accvgpr_write_b32 a32, v64
    v_accvgpr_write_b32 a33, v65
    v_accvgpr_write_b32 a34, v80
    v_accvgpr_write_b32 a35, v81
    v_accvgpr_write_b32 a36, v68
    buffer_load_dwordx4 v227, s[12:15], s78 offen offset:2048 lds
    v_accvgpr_write_b32 a37, v69
    v_accvgpr_write_b32 a38, v84
    v_accvgpr_write_b32 a39, v85
    v_accvgpr_write_b32 a40, v72
    v_accvgpr_write_b32 a41, v73
    v_accvgpr_write_b32 a42, v88
    v_accvgpr_write_b32 a43, v89
    v_accvgpr_write_b32 a44, v76
    v_accvgpr_write_b32 a45, v77
    v_accvgpr_write_b32 a46, v92
    v_accvgpr_write_b32 a47, v93
    buffer_load_dwordx4 v227, s[12:15], s78 offen offset:3072 lds
    s_cmp_lg_u32 s81, 0
    s_cbranch_scc1 L_maxpass
    s_waitcnt lgkmcnt(7)
    v_mfma_f32_16x16x32_bf16 v[128:131], a[64:67], a[0:3], 0
    v_cvt_pk_bf16_f32 v96, v96, v97
    v_cvt_pk_bf16_f32 v97, v98, v99
    v_mfma_f32_16x16x32_bf16 v[136:139], a[64:67], a[4:7], 0
    v_cvt_pk_bf16_f32 v112, v112, v113
    v_cvt_pk_bf16_f32 v113, v114, v115
    v_mfma_f32_16x16x32_bf16 v[144:147], a[64:67], a[8:11], 0
    v_cvt_pk_bf16_f32 v100, v100, v101
    v_cvt_pk_bf16_f32 v101, v102, v103
    v_mfma_f32_16x16x32_bf16 v[152:155], a[64:67], a[12:15], 0
    v_cvt_pk_bf16_f32 v116, v116, v117
    v_cvt_pk_bf16_f32 v117, v118, v119
    s_waitcnt lgkmcnt(3)
    v_mfma_f32_16x16x32_bf16 v[132:135], a[80:83], a[0:3], 0
    v_cvt_pk_bf16_f32 v104, v104, v105
    v_cvt_pk_bf16_f32 v105, v106, v107
    v_mfma_f32_16x16x32_bf16 v[140:143], a[80:83], a[4:7], 0
    v_cvt_pk_bf16_f32 v120, v120, v121
    v_cvt_pk_bf16_f32 v121, v122, v123
    v_mfma_f32_16x16x32_bf16 v[148:151], a[80:83], a[8:11], 0
    v_cvt_pk_bf16_f32 v108, v108, v109
    v_cvt_pk_bf16_f32 v109, v110, v111
    v_mfma_f32_16x16x32_bf16 v[156:159], a[80:83], a[12:15], 0
    v_cvt_pk_bf16_f32 v124, v124, v125
    v_cvt_pk_bf16_f32 v125, v126, v127
    v_mfma_f32_16x16x32_bf16 v[128:131], a[68:71], a[16:19], v[128:131]
    v_permlane32_swap_b32 v96, v112
    v_permlane32_swap_b32 v97, v113
    v_mfma_f32_16x16x32_bf16 v[136:139], a[68:71], a[20:23], v[136:139]
    v_permlane32_swap_b32 v100, v116
    v_permlane32_swap_b32 v101, v117
    v_mfma_f32_16x16x32_bf16 v[144:147], a[68:71], a[24:27], v[144:147]
    v_permlane32_swap_b32 v104, v120
    v_permlane32_swap_b32 v105, v121
    v_mfma_f32_16x16x32_bf16 v[152:155], a[68:71], a[28:31], v[152:155]
    v_permlane32_swap_b32 v108, v124
    v_permlane32_swap_b32 v109, v125
    s_waitcnt lgkmcnt(2)
    v_mfma_f32_16x16x32_bf16 v[132:135], a[84:87], a[16:19], v[132:135]
    v_permlane16_swap_b32 v96, v112
    v_permlane16_swap_b32 v97, v113
    v_mfma_f32_16x16x32_bf16 v[140:143], a[84:87], a[20:23], v[140:143]
    v_permlane16_swap_b32 v100, v116
    v_permlane16_swap_b32 v101, v117
    v_mfma_f32_16x16x32_bf16 v[148:151], a[84:87], a[24:27], v[148:151]
    v_permlane16_swap_b32 v104, v120
    v_permlane16_swap_b32 v105, v121
    v_mfma_f32_16x16x32_bf16 v[156:159], a[84:87], a[28:31], v[156:159]
    v_permlane16_swap_b32 v108, v124
    v_permlane16_swap_b32 v109, v125
    v_mfma_f32_16x16x32_bf16 v[128:131], a[72:75], a[32:35], v[128:131]
    v_accvgpr_write_b32 a48, v96
    v_accvgpr_write_b32 a49, v97
    v_mfma_f32_16x16x32_bf16 v[136:139], a[72:75], a[36:39], v[136:139]
    v_accvgpr_write_b32 a50, v112
    v_accvgpr_write_b32 a51, v113
    v_mfma_f32_16x16x32_bf16 v[144:147], a[72:75], a[40:43], v[144:147]
    v_accvgpr_write_b32 a52, v100
    v_accvgpr_write_b32 a53, v101
    v_mfma_f32_16x16x32_bf16 v[152:155], a[72:75], a[44:47], v[152:155]
    v_accvgpr_write_b32 a54, v116
    v_accvgpr_write_b32 a55, v117
    s_waitcnt lgkmcnt(1)
    v_mfma_f32_16x16x32_bf16 v[132:135], a[88:91], a[32:35], v[132:135]
    v_accvgpr_write_b32 a56, v104
    v_accvgpr_write_b32 a57, v105
    v_mfma_f32_16x16x32_bf16 v[140:143], a[88:91], a[36:39], v[140:143]
    v_accvgpr_write_b32 a58, v120
    v_accvgpr_write_b32 a59, v121
    v_mfma_f32_16x16x32_bf16 v[148:151], a[88:91], a[40:43], v[148:151]
    v_accvgpr_write_b32 a60, v108
    v_accvgpr_write_b32 a61, v109
    v_mfma_f32_16x16x32_bf16 v[156:159], a[88:91], a[44:47], v[156:159]
    v_accvgpr_write_b32 a62, v124
    v_accvgpr_write_b32 a63, v125
    s_nop 0
    v_mfma_f32_16x16x32_bf16 v[128:131], a[76:79], a[48:51], v[128:131]
    v_mfma_f32_16x16x32_bf16 v[136:139], a[76:79], a[52:55], v[136:139]
    v_mfma_f32_16x16x32_bf16 v[144:147], a[76:79], a[56:59], v[144:147]
    v_mfma_f32_16x16x32_bf16 v[152:155], a[76:79], a[60:63], v[152:155]
    s_waitcnt lgkmcnt(0)
    v_mfma_f32_16x16x32_bf16 v[132:135], a[92:95], a[48:51], v[132:135]
    v_mfma_f32_16x16x32_bf16 v[140:143], a[92:95], a[52:55], v[140:143]
    v_mfma_f32_16x16x32_bf16 v[148:151], a[92:95], a[56:59], v[148:151]
    v_mfma_f32_16x16x32_bf16 v[156:159], a[92:95], a[60:63], v[156:159]
    ds_read_b128 a[64:67], v212 offset:40960
    ds_read_b128 a[68:71], v213 offset:40960
    ds_read_b128 a[72:75], v214 offset:40960
    ds_read_b128 a[76:79], v215 offset:40960
    ds_read_b128 a[80:83], v212 offset:41984
    s_nop 2
    v_max3_f32 v228, v128, v129, v130
    v_max3_f32 v228, v228, v131, v132
    v_max3_f32 v228, v228, v133, v134
    v_max_f32 v228, v228, v135
    v_max3_f32 v229, v136, v137, v138
    v_max3_f32 v229, v229, v139, v140
    v_max3_f32 v229, v229, v141, v142
    v_max_f32 v229, v229, v143
    v_max3_f32 v230, v144, v145, v146
    v_max3_f32 v230, v230, v147, v148
    v_max3_f32 v230, v230, v149, v150
    v_max_f32 v230, v230, v151
    v_max3_f32 v231, v152, v153, v154
    v_max3_f32 v231, v231, v155, v156
    v_max3_f32 v231, v231, v157, v158
    v_max_f32 v231, v231, v159
    v_mov_b32 v232, v228
    v_mov_b32 v233, v229
    v_mov_b32 v234, v230
    v_mov_b32 v235, v231
    s_nop 0
    v_permlane32_swap_b32 v232, v228
    v_permlane32_swap_b32 v233, v229
    v_permlane32_swap_b32 v234, v230
    v_permlane32_swap_b32 v235, v231
    v_max_f32 v228, v232, v228
    v_max_f32 v229, v233, v229
    v_max_f32 v230, v234, v230
    v_max_f32 v231, v235, v231
    v_mov_b32 v232, v228
    v_mov_b32 v233, v229
    v_mov_b32 v234, v230
    v_mov_b32 v235, v231
    s_nop 0
    v_permlane16_swap_b32 v232, v228
    v_permlane16_swap_b32 v233, v229
    v_permlane16_swap_b32 v234, v230
    v_permlane16_swap_b32 v235, v231
    v_max_f32 v228, v232, v228
    v_max_f32 v229, v233, v229
    v_max_f32 v230, v234, v230
    v_max_f32 v231, v235, v231
L_havemax:
    v_sub_f32 v192, 0, v228
    v_sub_f32 v193, 0, v228
    v_mov_b64 v[194:195], v[192:193]
    v_pk_add_f32 v[128:129], v[128:129], v[192:193]
    v_pk_add_f32 v[130:131], v[130:131], v[192:193]
    v_pk_add_f32 v[132:133], v[132:133], v[192:193]
    v_pk_add_f32 v[134:135], v[134:135], v[192:193]
    v_sub_f32 v196, 0, v229
    v_sub_f32 v197, 0, v229
    v_mov_b64 v[198:199], v[196:197]
    v_pk_add_f32 v[136:137], v[136:137], v[196:197]
    v_pk_add_f32 v[138:139], v[138:139], v[196:197]
    v_pk_add_f32 v[140:141], v[140:141], v[196:197]
    v_pk_add_f32 v[142:143], v[142:143], v[196:197]
    v_sub_f32 v200, 0, v230
    v_sub_f32 v201, 0, v230
    v_mov_b64 v[202:203], v[200:201]
    v_pk_add_f32 v[144:145], v[144:145], v[200:201]
    v_pk_add_f32 v[146:147], v[146:147], v[200:201]
    v_pk_add_f32 v[148:149], v[148:149], v[200:201]
    v_pk_add_f32 v[150:151], v[150:151], v[200:201]
    v_sub_f32 v204, 0, v231
    v_sub_f32 v205, 0, v231
    v_mov_b64 v[206:207], v[204:205]
    v_pk_add_f32 v[152:153], v[152:153], v[204:205]
    v_pk_add_f32 v[154:155], v[154:155], v[204:205]
    v_pk_add_f32 v[156:157], v[156:157], v[204:205]
    v_pk_add_f32 v[158:159], v[158:159], v[204:205]
    v_mov_b32 v235, 0
    v_mov_b32 v253, 0
    v_exp_f32 v128, v128
    v_exp_f32 v129, v129
    v_exp_f32 v130, v130
    v_exp_f32 v131, v131
    v_exp_f32 v132, v132
    v_exp_f32 v133, v133
    v_exp_f32 v134, v134
    v_exp_f32 v135, v135
    v_exp_f32 v136, v136
    v_exp_f32 v137, v137
    v_exp_f32 v138, v138
    v_exp_f32 v139, v139
    v_exp_f32 v140, v140
    v_exp_f32 v141, v141
    v_exp_f32 v142, v142
    v_exp_f32 v143, v143
    v_exp_f32 v144, v144
    v_exp_f32 v145, v145
    v_exp_f32 v146, v146
    v_exp_f32 v147, v147
    s_nop 0
    v_cvt_pk_bf16_f32 v128, v128, v129
    v_cvt_pk_bf16_f32 v129, v130, v131
    v_cvt_pk_bf16_f32 v130, v132, v133
    v_cvt_pk_bf16_f32 v131, v134, v135
    v_cvt_pk_bf16_f32 v136, v136, v137
    v_cvt_pk_bf16_f32 v137, v138, v139
    v_cvt_pk_bf16_f32 v138, v140, v141
    v_cvt_pk_bf16_f32 v139, v142, v143
    v_cvt_pk_bf16_f32 v144, v144, v145
    v_cvt_pk_bf16_f32 v145, v146, v147
    s_waitcnt lgkmcnt(4)
    v_mfma_f32_16x16x32_bf16 v[160:163], a[64:67], a[0:3], v[192:195]
    s_waitcnt lgkmcnt(2)
    v_exp_f32 v148, v148
    v_mfma_f32_16x16x32_bf16 v[160:163], a[68:71], a[16:19], v[160:163]
    ds_read_b128 a[84:87], v213 offset:41984
    v_mfma_f32_16x16x32_bf16 v[160:163], a[72:75], a[32:35], v[160:163]
    s_waitcnt lgkmcnt(2)
    v_exp_f32 v149, v149
    v_mfma_f32_16x16x32_bf16 v[160:163], a[76:79], a[48:51], v[160:163]
    buffer_store_dwordx4 a[128:131], v237, s[40:43], s56 offen sc1
    v_mfma_f32_16x16x32_bf16 v[168:171], a[64:67], a[4:7], v[196:199]
    v_exp_f32 v150, v150
    v_mfma_f32_16x16x32_bf16 v[168:171], a[68:71], a[20:23], v[168:171]
    ds_read_b128 a[88:91], v214 offset:41984
    v_cvt_pk_bf16_f32 v146, v148, v149
    v_mfma_f32_16x16x32_bf16 v[168:171], a[72:75], a[36:39], v[168:171]
    s_waitcnt vmcnt(13)
    v_exp_f32 v151, v151
    v_mfma_f32_16x16x32_bf16 v[168:171], a[76:79], a[52:55], v[168:171]
    buffer_store_dwordx4 a[132:135], v237, s[40:43], s56 offen offset:1024 sc1
    v_mfma_f32_16x16x32_bf16 v[176:179], a[64:67], a[8:11], v[200:203]
    s_barrier
    v_exp_f32 v152, v152
    v_mfma_f32_16x16x32_bf16 v[176:179], a[68:71], a[24:27], v[176:179]
    ds_read_b128 a[92:95], v215 offset:41984
    v_cvt_pk_bf16_f32 v147, v150, v151
    v_mfma_f32_16x16x32_bf16 v[176:179], a[72:75], a[40:43], v[176:179]
    v_exp_f32 v153, v153
    v_mfma_f32_16x16x32_bf16 v[176:179], a[76:79], a[56:59], v[176:179]
    buffer_store_dwordx4 a[136:139], v237, s[40:43], s56 offen offset:2048 sc1
    v_mfma_f32_16x16x32_bf16 v[184:187], a[64:67], a[12:15], v[204:207]
    v_exp_f32 v154, v154
    v_mfma_f32_16x16x32_bf16 v[184:187], a[68:71], a[28:31], v[184:187]
    v_cvt_pk_bf16_f32 v152, v152, v153
    v_mfma_f32_16x16x32_bf16 v[184:187], a[72:75], a[44:47], v[184:187]
    s_waitcnt lgkmcnt(3)
    v_exp_f32 v155, v155
    v_mfma_f32_16x16x32_bf16 v[184:187], a[76:79], a[60:63], v[184:187]
    buffer_store_dwordx4 a[140:143], v237, s[40:43], s56 offen offset:3072 sc1
    v_mfma_f32_16x16x32_bf16 v[164:167], a[80:83], a[0:3], v[192:195]
    s_waitcnt lgkmcnt(1)
    v_exp_f32 v156, v156
    v_mfma_f32_16x16x32_bf16 v[164:167], a[84:87], a[16:19], v[164:167]
    v_cvt_pk_bf16_f32 v153, v154, v155
    v_mfma_f32_16x16x32_bf16 v[164:167], a[88:91], a[32:35], v[164:167]
    s_waitcnt lgkmcnt(0)
    v_exp_f32 v157, v157
    v_mfma_f32_16x16x32_bf16 v[164:167], a[92:95], a[48:51], v[164:167]
    v_cvt_pk_bf16_f32 v154, v156, v157
    v_mfma_f32_16x16x32_bf16 v[172:175], a[80:83], a[4:7], v[196:199]
    v_exp_f32 v158, v158
    v_mfma_f32_16x16x32_bf16 v[172:175], a[84:87], a[20:23], v[172:175]
    ds_read_b64_tr_b16 a[96:97], v216 offset:32768
    ds_read_b64_tr_b16 a[98:99], v216 offset:33792
    v_mfma_f32_16x16x32_bf16 v[172:175], a[88:91], a[36:39], v[172:175]
    v_exp_f32 v159, v159
    v_mfma_f32_16x16x32_bf16 v[172:175], a[92:95], a[52:55], v[172:175]
    v_cvt_pk_bf16_f32 v155, v158, v159
    v_mfma_f32_16x16x32_bf16 v[180:183], a[80:83], a[8:11], v[200:203]
    v_exp_f32 v160, v160
    v_mfma_f32_16x16x32_bf16 v[180:183], a[84:87], a[24:27], v[180:183]
    ds_read_b64_tr_b16 a[100:101], v217 offset:32768
    ds_read_b64_tr_b16 a[102:103], v217 offset:33792
    v_mfma_f32_16x16x32_bf16 v[180:183], a[88:91], a[40:43], v[180:183]
    v_exp_f32 v161, v161
    v_mfma_f32_16x16x32_bf16 v[180:183], a[92:95], a[56:59], v[180:183]
    v_add_f32 v235, v235, v160
    v_add_f32 v235, v235, v161
    v_mfma_f32_16x16x32_bf16 v[188:191], a[80:83], a[12:15], v[204:207]
    v_exp_f32 v168, v168
    v_mfma_f32_16x16x32_bf16 v[188:191], a[84:87], a[28:31], v[188:191]
    ds_read_b64_tr_b16 a[104:105], v218 offset:32768
    ds_read_b64_tr_b16 a[106:107], v218 offset:33792
    v_mfma_f32_16x16x32_bf16 v[188:191], a[88:91], a[44:47], v[188:191]
    s_waitcnt lgkmcnt(4)
    v_exp_f32 v169, v169
    v_mfma_f32_16x16x32_bf16 v[188:191], a[92:95], a[60:63], v[188:191]
    v_cvt_pk_bf16_f32 v160, v160, v161
    v_cvt_pk_bf16_f32 v168, v168, v169
    s_mov_b32 s79, 0
    s_or_b32 s93, s72, s81
    v_mfma_f32_16x16x32_bf16 v[0:3], a[96:99], v[128:131], 0
    s_add_u32 s56, s56, 4096
    v_exp_f32 v162, v162
    v_mfma_f32_16x16x32_bf16 v[4:7], a[96:99], v[136:139], 0
    ds_read_b64_tr_b16 a[108:109], v219 offset:32768
    ds_read_b64_tr_b16 a[110:111], v219 offset:33792
    v_mfma_f32_16x16x32_bf16 v[8:11], a[96:99], v[144:147], 0
    s_waitcnt lgkmcnt(4)
    v_exp_f32 v163, v163
    v_mfma_f32_16x16x32_bf16 v[12:15], a[96:99], v[152:155], 0
    v_add_f32 v235, v235, v162
    v_add_f32 v235, v235, v163
    v_mfma_f32_16x16x32_bf16 v[16:19], a[100:103], v[128:131], 0
    v_exp_f32 v170, v170
    v_mfma_f32_16x16x32_bf16 v[20:23], a[100:103], v[136:139], 0
    ds_read_b64_tr_b16 a[96:97], v220 offset:32768
    ds_read_b64_tr_b16 a[98:99], v220 offset:33792
    v_mfma_f32_16x16x32_bf16 v[24:27], a[100:103], v[144:147], 0
    s_waitcnt lgkmcnt(4)
    v_exp_f32 v171, v171
    v_mfma_f32_16x16x32_bf16 v[28:31], a[100:103], v[152:155], 0
    v_cvt_pk_bf16_f32 v161, v162, v163
    v_cvt_pk_bf16_f32 v169, v170, v171
    v_mfma_f32_16x16x32_bf16 v[208:211], a[112:115], v[128:131], 0
    buffer_store_dwordx4 a[144:147], v237, s[40:43], s56 offen sc1
    v_mfma_f32_16x16x32_bf16 v[32:35], a[104:107], v[128:131], 0
    v_exp_f32 v164, v164
    v_mfma_f32_16x16x32_bf16 v[36:39], a[104:107], v[136:139], 0
    ds_read_b64_tr_b16 a[100:101], v221 offset:32768
    ds_read_b64_tr_b16 a[102:103], v221 offset:33792
    v_mfma_f32_16x16x32_bf16 v[40:43], a[104:107], v[144:147], 0
    s_waitcnt lgkmcnt(4)
    v_exp_f32 v165, v165
    v_mfma_f32_16x16x32_bf16 v[44:47], a[104:107], v[152:155], 0
    v_add_f32 v235, v235, v164
    v_add_f32 v235, v235, v165
    v_mfma_f32_16x16x32_bf16 v[48:51], a[108:111], v[128:131], 0
    v_exp_f32 v172, v172
    v_mfma_f32_16x16x32_bf16 v[52:55], a[108:111], v[136:139], 0
    ds_read_b64_tr_b16 a[104:105], v222 offset:32768
    ds_read_b64_tr_b16 a[106:107], v222 offset:33792
    v_mfma_f32_16x16x32_bf16 v[56:59], a[108:111], v[144:147], 0
    s_waitcnt lgkmcnt(4)
    v_exp_f32 v173, v173
    v_mfma_f32_16x16x32_bf16 v[60:63], a[108:111], v[152:155], 0
    v_cvt_pk_bf16_f32 v162, v164, v165
    v_cvt_pk_bf16_f32 v170, v172, v173
    v_mfma_f32_16x16x32_bf16 v[208:211], a[116:119], v[136:139], v[208:211]
    buffer_store_dwordx4 a[148:151], v237, s[40:43], s56 offen offset:1024 sc1
    v_mfma_f32_16x16x32_bf16 v[64:67], a[96:99], v[128:131], 0
    v_exp_f32 v166, v166
    v_mfma_f32_16x16x32_bf16 v[68:71], a[96:99], v[136:139], 0
    ds_read_b64_tr_b16 a[108:109], v223 offset:32768
    ds_read_b64_tr_b16 a[110:111], v223 offset:33792
    v_mfma_f32_16x16x32_bf16 v[72:75], a[96:99], v[144:147], 0
    s_waitcnt lgkmcnt(4)
    v_exp_f32 v167, v167
    v_mfma_f32_16x16x32_bf16 v[76:79], a[96:99], v[152:155], 0
    v_add_f32 v235, v235, v166
    v_add_f32 v235, v235, v167
    v_mfma_f32_16x16x32_bf16 v[80:83], a[100:103], v[128:131], 0
    v_exp_f32 v174, v174
    v_mfma_f32_16x16x32_bf16 v[84:87], a[100:103], v[136:139], 0
    ds_read_b128 a[64:67], v212 offset:49152
    ds_read_b128 a[68:71], v213 offset:49152
    v_mfma_f32_16x16x32_bf16 v[88:91], a[100:103], v[144:147], 0
    s_waitcnt lgkmcnt(4)
    v_exp_f32 v175, v175
    v_mfma_f32_16x16x32_bf16 v[92:95], a[100:103], v[152:155], 0
    v_cvt_pk_bf16_f32 v163, v166, v167
    v_cvt_pk_bf16_f32 v171, v174, v175
    v_mfma_f32_16x16x32_bf16 v[208:211], a[120:123], v[144:147], v[208:211]
    buffer_store_dwordx4 a[152:155], v237, s[40:43], s56 offen offset:2048 sc1
    v_mfma_f32_16x16x32_bf16 v[96:99], a[104:107], v[128:131], 0
    v_exp_f32 v176, v176
    v_mfma_f32_16x16x32_bf16 v[100:103], a[104:107], v[136:139], 0
    ds_read_b128 a[72:75], v214 offset:49152
    ds_read_b128 a[76:79], v215 offset:49152
    v_mfma_f32_16x16x32_bf16 v[104:107], a[104:107], v[144:147], 0
    s_waitcnt lgkmcnt(4)
    v_exp_f32 v177, v177
    v_mfma_f32_16x16x32_bf16 v[108:111], a[104:107], v[152:155], 0
    v_add_f32 v253, v253, v176
    v_add_f32 v253, v253, v177
    v_mfma_f32_16x16x32_bf16 v[112:115], a[108:111], v[128:131], 0
    v_exp_f32 v184, v184
    v_mfma_f32_16x16x32_bf16 v[116:119], a[108:111], v[136:139], 0
    ds_read_b128 a[80:83], v212 offset:50176
    v_mfma_f32_16x16x32_bf16 v[120:123], a[108:111], v[144:147], 0
    s_waitcnt lgkmcnt(4)
    v_exp_f32 v185, v185
    v_mfma_f32_16x16x32_bf16 v[124:127], a[108:111], v[152:155], 0
    v_cvt_pk_bf16_f32 v176, v176, v177
    v_cvt_pk_bf16_f32 v184, v184, v185
    v_mfma_f32_16x16x32_bf16 v[208:211], a[124:127], v[152:155], v[208:211]
    buffer_store_dwordx4 a[156:159], v237, s[40:43], s56 offen offset:3072 sc1
    v_mfma_f32_16x16x32_bf16 v[128:131], a[64:67], a[0:3], v[192:195]
    s_mov_b32 s78, 49152
    v_exp_f32 v178, v178
    s_waitcnt lgkmcnt(3)
    v_mfma_f32_16x16x32_bf16 v[128:131], a[68:71], a[16:19], v[128:131]
    ds_read_b128 a[84:87], v213 offset:50176
    s_waitcnt lgkmcnt(3)
    v_mfma_f32_16x16x32_bf16 v[128:131], a[72:75], a[32:35], v[128:131]
    s_waitcnt lgkmcnt(2)
    v_exp_f32 v179, v179
    v_mfma_f32_16x16x32_bf16 v[128:131], a[76:79], a[48:51], v[128:131]
    v_add_f32 v253, v253, v178
    v_add_f32 v253, v253, v179
    v_mfma_f32_16x16x32_bf16 v[136:139], a[64:67], a[4:7], v[196:199]
    s_add_u32 m0, s75, 114688
    v_exp_f32 v186, v186
    v_mfma_f32_16x16x32_bf16 v[136:139], a[68:71], a[20:23], v[136:139]
    ds_read_b128 a[88:91], v214 offset:50176
    v_mfma_f32_16x16x32_bf16 v[136:139], a[72:75], a[36:39], v[136:139]
    v_exp_f32 v187, v187
    v_mfma_f32_16x16x32_bf16 v[136:139], a[76:79], a[52:55], v[136:139]
    v_cvt_pk_bf16_f32 v177, v178, v179
    v_cvt_pk_bf16_f32 v185, v186, v187
    v_mfma_f32_16x16x32_bf16 v[144:147], a[64:67], a[8:11], v[200:203]
    v_exp_f32 v180, v180
    v_mfma_f32_16x16x32_bf16 v[144:147], a[68:71], a[24:27], v[144:147]
    ds_read_b128 a[92:95], v215 offset:50176
    v_mfma_f32_16x16x32_bf16 v[144:147], a[72:75], a[40:43], v[144:147]
    v_exp_f32 v181, v181
    v_mfma_f32_16x16x32_bf16 v[144:147], a[76:79], a[56:59], v[144:147]
    v_add_f32 v253, v253, v180
    v_add_f32 v253, v253, v181
    v_mfma_f32_16x16x32_bf16 v[152:155], a[64:67], a[12:15], v[204:207]
    v_exp_f32 v188, v188
    v_mfma_f32_16x16x32_bf16 v[152:155], a[68:71], a[28:31], v[152:155]
    buffer_load_dwordx4 v224, s[8:11], s78 offen lds
    v_mfma_f32_16x16x32_bf16 v[152:155], a[72:75], a[44:47], v[152:155]
    s_waitcnt lgkmcnt(3)
    v_exp_f32 v189, v189
    v_mfma_f32_16x16x32_bf16 v[152:155], a[76:79], a[60:63], v[152:155]
    v_cvt_pk_bf16_f32 v178, v180, v181
    v_cvt_pk_bf16_f32 v186, v188, v189
    v_mfma_f32_16x16x32_bf16 v[132:135], a[80:83], a[0:3], v[192:195]
    s_waitcnt lgkmcnt(1)
    v_exp_f32 v182, v182
    v_mfma_f32_16x16x32_bf16 v[132:135], a[84:87], a[16:19], v[132:135]
    buffer_load_dwordx4 v224, s[8:11], s78 offen offset:1024 lds
    v_mfma_f32_16x16x32_bf16 v[132:135], a[88:91], a[32:35], v[132:135]
    s_waitcnt lgkmcnt(0)
    v_exp_f32 v183, v183
    v_mfma_f32_16x16x32_bf16 v[132:135], a[92:95], a[48:51], v[132:135]
    v_add_f32 v253, v253, v182
    v_add_f32 v253, v253, v183
    v_mfma_f32_16x16x32_bf16 v[140:143], a[80:83], a[4:7], v[196:199]
    buffer_load_dwordx4 v225, s[8:11], s78 offen offset:2048 lds
    v_exp_f32 v190, v190
    v_mfma_f32_16x16x32_bf16 v[140:143], a[84:87], a[20:23], v[140:143]
    ds_read_b64_tr_b16 a[96:97], v216 offset:40960
    ds_read_b64_tr_b16 a[98:99], v216 offset:41984
    v_mfma_f32_16x16x32_bf16 v[140:143], a[88:91], a[36:39], v[140:143]
    v_exp_f32 v191, v191
    v_mfma_f32_16x16x32_bf16 v[140:143], a[92:95], a[52:55], v[140:143]
    v_cvt_pk_bf16_f32 v179, v182, v183
    v_cvt_pk_bf16_f32 v187, v190, v191
    v_mfma_f32_16x16x32_bf16 v[148:151], a[80:83], a[8:11], v[200:203]
    buffer_load_dwordx4 v225, s[8:11], s78 offen offset:3072 lds
    v_exp_f32 v128, v128
    v_mfma_f32_16x16x32_bf16 v[148:151], a[84:87], a[24:27], v[148:151]
    ds_read_b64_tr_b16 a[100:101], v217 offset:40960
    ds_read_b64_tr_b16 a[102:103], v217 offset:41984
    v_mfma_f32_16x16x32_bf16 v[148:151], a[88:91], a[40:43], v[148:151]
    v_exp_f32 v129, v129
    v_mfma_f32_16x16x32_bf16 v[148:151], a[92:95], a[56:59], v[148:151]
    v_add_f32 v235, v235, v128
    v_add_f32 v235, v235, v129
    v_mfma_f32_16x16x32_bf16 v[156:159], a[80:83], a[12:15], v[204:207]
    v_exp_f32 v136, v136
    v_mfma_f32_16x16x32_bf16 v[156:159], a[84:87], a[28:31], v[156:159]
    ds_read_b64_tr_b16 a[104:105], v218 offset:40960
    ds_read_b64_tr_b16 a[106:107], v218 offset:41984
    v_mfma_f32_16x16x32_bf16 v[156:159], a[88:91], a[44:47], v[156:159]
    s_waitcnt lgkmcnt(4)
    v_exp_f32 v137, v137
    v_mfma_f32_16x16x32_bf16 v[156:159], a[92:95], a[60:63], v[156:159]
    v_cvt_pk_bf16_f32 v128, v128, v129
    v_cvt_pk_bf16_f32 v136, v136, v137
.p2align 3
L_loop:
    v_mfma_f32_16x16x32_bf16 v[0:3], a[96:99], v[160:163], v[0:3]
    v_exp_f32 v130, v130
    v_mfma_f32_16x16x32_bf16 v[4:7], a[96:99], v[168:171], v[4:7]
    ds_read_b64_tr_b16 a[108:109], v219 offset:40960
    ds_read_b64_tr_b16 a[110:111], v219 offset:41984
    v_mfma_f32_16x16x32_bf16 v[8:11], a[96:99], v[176:179], v[8:11]
    s_waitcnt lgkmcnt(4)
    v_exp_f32 v131, v131
    v_mfma_f32_16x16x32_bf16 v[12:15], a[96:99], v[184:187], v[12:15]
    v_add_f32 v235, v235, v130
    v_add_f32 v235, v235, v131
    v_mfma_f32_16x16x32_bf16 v[16:19], a[100:103], v[160:163], v[16:19]
    v_exp_f32 v138, v138
    v_mfma_f32_16x16x32_bf16 v[20:23], a[100:103], v[168:171], v[20:23]
    ds_read_b64_tr_b16 a[96:97], v220 offset:40960
    ds_read_b64_tr_b16 a[98:99], v220 offset:41984
    v_mfma_f32_16x16x32_bf16 v[24:27], a[100:103], v[176:179], v[24:27]
    s_waitcnt lgkmcnt(4)
    v_exp_f32 v139, v139
    v_mfma_f32_16x16x32_bf16 v[28:31], a[100:103], v[184:187], v[28:31]
    v_cvt_pk_bf16_f32 v129, v130, v131
    v_cvt_pk_bf16_f32 v137, v138, v139
    v_mfma_f32_16x16x32_bf16 v[32:35], a[104:107], v[160:163], v[32:35]
    v_exp_f32 v132, v132
    v_mfma_f32_16x16x32_bf16 v[36:39], a[104:107], v[168:171], v[36:39]
    ds_read_b64_tr_b16 a[100:101], v221 offset:40960
    ds_read_b64_tr_b16 a[102:103], v221 offset:41984
    v_mfma_f32_16x16x32_bf16 v[40:43], a[104:107], v[176:179], v[40:43]
    s_waitcnt lgkmcnt(4)
    v_exp_f32 v133, v133
    v_mfma_f32_16x16x32_bf16 v[44:47], a[104:107], v[184:187], v[44:47]
    v_add_f32 v235, v235, v132
    v_add_f32 v235, v235, v133
    v_mfma_f32_16x16x32_bf16 v[48:51], a[108:111], v[160:163], v[48:51]
    s_add_u32 m0, s75, 49152
    v_exp_f32 v140, v140
    v_mfma_f32_16x16x32_bf16 v[52:55], a[108:111], v[168:171], v[52:55]
    ds_read_b64_tr_b16 a[104:105], v222 offset:40960
    ds_read_b64_tr_b16 a[106:107], v222 offset:41984
    v_mfma_f32_16x16x32_bf16 v[56:59], a[108:111], v[176:179], v[56:59]
    s_waitcnt lgkmcnt(4)
    v_exp_f32 v141, v141
    v_mfma_f32_16x16x32_bf16 v[60:63], a[108:111], v[184:187], v[60:63]
    v_cvt_pk_bf16_f32 v130, v132, v133
    v_cvt_pk_bf16_f32 v138, v140, v141
    v_mfma_f32_16x16x32_bf16 v[208:211], a[116:119], v[168:171], v[208:211]
    buffer_load_dwordx4 v226, s[12:15], s78 offen lds
    v_mfma_f32_16x16x32_bf16 v[64:67], a[96:99], v[160:163], v[64:67]
    v_exp_f32 v134, v134
    v_mfma_f32_16x16x32_bf16 v[68:71], a[96:99], v[168:171], v[68:71]
    ds_read_b64_tr_b16 a[108:109], v223 offset:40960
    ds_read_b64_tr_b16 a[110:111], v223 offset:41984
    v_mfma_f32_16x16x32_bf16 v[72:75], a[96:99], v[176:179], v[72:75]
    s_waitcnt lgkmcnt(4)
    v_exp_f32 v135, v135
    v_mfma_f32_16x16x32_bf16 v[76:79], a[96:99], v[184:187], v[76:79]
    v_add_f32 v235, v235, v134
    v_add_f32 v235, v235, v135
    v_mfma_f32_16x16x32_bf16 v[80:83], a[100:103], v[160:163], v[80:83]
    v_exp_f32 v142, v142
    v_mfma_f32_16x16x32_bf16 v[84:87], a[100:103], v[168:171], v[84:87]
    ds_read_b128 a[64:67], v212 offset:57344
    ds_read_b128 a[68:71], v213 offset:57344
    v_mfma_f32_16x16x32_bf16 v[88:91], a[100:103], v[176:179], v[88:91]
    s_waitcnt lgkmcnt(4)
    v_exp_f32 v143, v143
    v_mfma_f32_16x16x32_bf16 v[92:95], a[100:103], v[184:187], v[92:95]
    v_cvt_pk_bf16_f32 v131, v134, v135
    v_cvt_pk_bf16_f32 v139, v142, v143
    v_mfma_f32_16x16x32_bf16 v[96:99], a[104:107], v[160:163], v[96:99]
    v_exp_f32 v144, v144
    v_mfma_f32_16x16x32_bf16 v[100:103], a[104:107], v[168:171], v[100:103]
    ds_read_b128 a[72:75], v214 offset:57344
    ds_read_b128 a[76:79], v215 offset:57344
    v_mfma_f32_16x16x32_bf16 v[104:107], a[104:107], v[176:179], v[104:107]
    s_waitcnt lgkmcnt(4)
    v_exp_f32 v145, v145
    v_mfma_f32_16x16x32_bf16 v[108:111], a[104:107], v[184:187], v[108:111]
    v_add_f32 v253, v253, v144
    v_add_f32 v253, v253, v145
    v_mfma_f32_16x16x32_bf16 v[112:115], a[108:111], v[160:163], v[112:115]
    v_exp_f32 v152, v152
    v_mfma_f32_16x16x32_bf16 v[116:119], a[108:111], v[168:171], v[116:119]
    ds_read_b128 a[80:83], v212 offset:58368
    v_mfma_f32_16x16x32_bf16 v[120:123], a[108:111], v[176:179], v[120:123]
    s_waitcnt lgkmcnt(4)
    v_exp_f32 v153, v153
    v_mfma_f32_16x16x32_bf16 v[124:127], a[108:111], v[184:187], v[124:127]
    v_cvt_pk_bf16_f32 v144, v144, v145
    v_cvt_pk_bf16_f32 v152, v152, v153
    v_mfma_f32_16x16x32_bf16 v[208:211], a[124:127], v[184:187], v[208:211]
    buffer_load_dwordx4 v226, s[12:15], s78 offen offset:1024 lds
    v_mfma_f32_16x16x32_bf16 v[160:163], a[64:67], a[0:3], v[192:195]
    s_waitcnt lgkmcnt(2)
    v_exp_f32 v146, v146
    v_mfma_f32_16x16x32_bf16 v[160:163], a[68:71], a[16:19], v[160:163]
    ds_read_b128 a[84:87], v213 offset:58368
    v_mfma_f32_16x16x32_bf16 v[160:163], a[72:75], a[32:35], v[160:163]
    s_waitcnt lgkmcnt(2)
    v_exp_f32 v147, v147
    v_mfma_f32_16x16x32_bf16 v[160:163], a[76:79], a[48:51], v[160:163]
    v_add_f32 v253, v253, v146
    v_add_f32 v253, v253, v147
    v_mfma_f32_16x16x32_bf16 v[168:171], a[64:67], a[4:7], v[196:199]
    v_exp_f32 v154, v154
    v_mfma_f32_16x16x32_bf16 v[168:171], a[68:71], a[20:23], v[168:171]
    ds_read_b128 a[88:91], v214 offset:58368
    v_mfma_f32_16x16x32_bf16 v[168:171], a[72:75], a[36:39], v[168:171]
    s_waitcnt vmcnt(10)
    v_exp_f32 v155, v155
    v_mfma_f32_16x16x32_bf16 v[168:171], a[76:79], a[52:55], v[168:171]
    v_cvt_pk_bf16_f32 v145, v146, v147
    v_cvt_pk_bf16_f32 v153, v154, v155
    v_mfma_f32_16x16x32_bf16 v[176:179], a[64:67], a[8:11], v[200:203]
    s_barrier
    v_exp_f32 v148, v148
    v_mfma_f32_16x16x32_bf16 v[176:179], a[68:71], a[24:27], v[176:179]
    ds_read_b128 a[92:95], v215 offset:58368
    v_mfma_f32_16x16x32_bf16 v[176:179], a[72:75], a[40:43], v[176:179]
    v_exp_f32 v149, v149
    v_mfma_f32_16x16x32_bf16 v[176:179], a[76:79], a[56:59], v[176:179]
    v_add_f32 v253, v253, v148
    v_add_f32 v253, v253, v149
    v_mfma_f32_16x16x32_bf16 v[184:187], a[64:67], a[12:15], v[204:207]
    v_exp_f32 v156, v156
    v_mfma_f32_16x16x32_bf16 v[184:187], a[68:71], a[28:31], v[184:187]
    buffer_load_dwordx4 v227, s[12:15], s78 offen offset:2048 lds
    v_mfma_f32_16x16x32_bf16 v[184:187], a[72:75], a[44:47], v[184:187]
    s_waitcnt lgkmcnt(3)
    v_exp_f32 v157, v157
    v_mfma_f32_16x16x32_bf16 v[184:187], a[76:79], a[60:63], v[184:187]
    v_cvt_pk_bf16_f32 v146, v148, v149
    v_cvt_pk_bf16_f32 v154, v156, v157
    v_mfma_f32_16x16x32_bf16 v[164:167], a[80:83], a[0:3], v[192:195]
    s_waitcnt lgkmcnt(1)
    v_exp_f32 v150, v150
    v_mfma_f32_16x16x32_bf16 v[164:167], a[84:87], a[16:19], v[164:167]
    buffer_load_dwordx4 v227, s[12:15], s78 offen offset:3072 lds
    v_mfma_f32_16x16x32_bf16 v[164:167], a[88:91], a[32:35], v[164:167]
    s_waitcnt lgkmcnt(0)
    v_exp_f32 v151, v151
    v_mfma_f32_16x16x32_bf16 v[164:167], a[92:95], a[48:51], v[164:167]
    v_add_f32 v253, v253, v150
    v_add_f32 v253, v253, v151
    v_mfma_f32_16x16x32_bf16 v[172:175], a[80:83], a[4:7], v[196:199]
    v_exp_f32 v158, v158
    v_mfma_f32_16x16x32_bf16 v[172:175], a[84:87], a[20:23], v[172:175]
    ds_read_b64_tr_b16 a[96:97], v216 offset:49152
    ds_read_b64_tr_b16 a[98:99], v216 offset:50176
    v_mfma_f32_16x16x32_bf16 v[172:175], a[88:91], a[36:39], v[172:175]
    v_exp_f32 v159, v159
    v_mfma_f32_16x16x32_bf16 v[172:175], a[92:95], a[52:55], v[172:175]
    v_cvt_pk_bf16_f32 v147, v150, v151
    v_cvt_pk_bf16_f32 v155, v158, v159
    v_mfma_f32_16x16x32_bf16 v[180:183], a[80:83], a[8:11], v[200:203]
    s_add_u32 s78, s78, 16384
    v_exp_f32 v160, v160
    v_mfma_f32_16x16x32_bf16 v[180:183], a[84:87], a[24:27], v[180:183]
    ds_read_b64_tr_b16 a[100:101], v217 offset:49152
    ds_read_b64_tr_b16 a[102:103], v217 offset:50176
    v_mfma_f32_16x16x32_bf16 v[180:183], a[88:91], a[40:43], v[180:183]
    v_exp_f32 v161, v161
    v_mfma_f32_16x16x32_bf16 v[180:183], a[92:95], a[56:59], v[180:183]
    v_add_f32 v235, v235, v160
    v_add_f32 v235, v235, v161
    v_mfma_f32_16x16x32_bf16 v[188:191], a[80:83], a[12:15], v[204:207]
    v_exp_f32 v168, v168
    v_mfma_f32_16x16x32_bf16 v[188:191], a[84:87], a[28:31], v[188:191]
    ds_read_b64_tr_b16 a[104:105], v218 offset:49152
    ds_read_b64_tr_b16 a[106:107], v218 offset:50176
    v_mfma_f32_16x16x32_bf16 v[188:191], a[88:91], a[44:47], v[188:191]
    s_waitcnt lgkmcnt(4)
    v_exp_f32 v169, v169
    v_mfma_f32_16x16x32_bf16 v[188:191], a[92:95], a[60:63], v[188:191]
    v_cvt_pk_bf16_f32 v160, v160, v161
    v_cvt_pk_bf16_f32 v168, v168, v169
    v_mfma_f32_16x16x32_bf16 v[0:3], a[96:99], v[128:131], v[0:3]
    v_exp_f32 v162, v162
    v_mfma_f32_16x16x32_bf16 v[4:7], a[96:99], v[136:139], v[4:7]
    ds_read_b64_tr_b16 a[108:109], v219 offset:49152
    ds_read_b64_tr_b16 a[110:111], v219 offset:50176
    v_mfma_f32_16x16x32_bf16 v[8:11], a[96:99], v[144:147], v[8:11]
    s_waitcnt lgkmcnt(4)
    v_exp_f32 v163, v163
    v_mfma_f32_16x16x32_bf16 v[12:15], a[96:99], v[152:155], v[12:15]
    v_add_f32 v235, v235, v162
    v_add_f32 v235, v235, v163
    v_mfma_f32_16x16x32_bf16 v[16:19], a[100:103], v[128:131], v[16:19]
    v_exp_f32 v170, v170
    v_mfma_f32_16x16x32_bf16 v[20:23], a[100:103], v[136:139], v[20:23]
    ds_read_b64_tr_b16 a[96:97], v220 offset:49152
    ds_read_b64_tr_b16 a[98:99], v220 offset:50176
    v_mfma_f32_16x16x32_bf16 v[24:27], a[100:103], v[144:147], v[24:27]
    s_waitcnt lgkmcnt(4)
    v_exp_f32 v171, v171
    v_mfma_f32_16x16x32_bf16 v[28:31], a[100:103], v[152:155], v[28:31]
    v_cvt_pk_bf16_f32 v161, v162, v163
    v_cvt_pk_bf16_f32 v169, v170, v171
    v_mfma_f32_16x16x32_bf16 v[32:35], a[104:107], v[128:131], v[32:35]
    v_exp_f32 v164, v164
    v_mfma_f32_16x16x32_bf16 v[36:39], a[104:107], v[136:139], v[36:39]
    ds_read_b64_tr_b16 a[100:101], v221 offset:49152
    ds_read_b64_tr_b16 a[102:103], v221 offset:50176
    v_mfma_f32_16x16x32_bf16 v[40:43], a[104:107], v[144:147], v[40:43]
    s_waitcnt lgkmcnt(4)
    v_exp_f32 v165, v165
    v_mfma_f32_16x16x32_bf16 v[44:47], a[104:107], v[152:155], v[44:47]
    v_add_f32 v235, v235, v164
    v_add_f32 v235, v235, v165
    v_mfma_f32_16x16x32_bf16 v[48:51], a[108:111], v[128:131], v[48:51]
    s_add_u32 m0, s75, 131072
    v_exp_f32 v172, v172
    v_mfma_f32_16x16x32_bf16 v[52:55], a[108:111], v[136:139], v[52:55]
    ds_read_b64_tr_b16 a[104:105], v222 offset:49152
    ds_read_b64_tr_b16 a[106:107], v222 offset:50176
    v_mfma_f32_16x16x32_bf16 v[56:59], a[108:111], v[144:147], v[56:59]
    s_waitcnt lgkmcnt(4)
    v_exp_f32 v173, v173
    v_mfma_f32_16x16x32_bf16 v[60:63], a[108:111], v[152:155], v[60:63]
    v_cvt_pk_bf16_f32 v162, v164, v165
    v_cvt_pk_bf16_f32 v170, v172, v173
    v_mfma_f32_16x16x32_bf16 v[208:211], a[116:119], v[136:139], v[208:211]
    buffer_load_dwordx4 v224, s[8:11], s78 offen lds
    v_mfma_f32_16x16x32_bf16 v[64:67], a[96:99], v[128:131], v[64:67]
    v_exp_f32 v166, v166
    v_mfma_f32_16x16x32_bf16 v[68:71], a[96:99], v[136:139], v[68:71]
    ds_read_b64_tr_b16 a[108:109], v223 offset:49152
    ds_read_b64_tr_b16 a[110:111], v223 offset:50176
    v_mfma_f32_16x16x32_bf16 v[72:75], a[96:99], v[144:147], v[72:75]
    s_waitcnt lgkmcnt(4)
    v_exp_f32 v167, v167
    v_mfma_f32_16x16x32_bf16 v[76:79], a[96:99], v[152:155], v[76:79]
    v_add_f32 v235, v235, v166
    v_add_f32 v235, v235, v167
    v_mfma_f32_16x16x32_bf16 v[80:83], a[100:103], v[128:131], v[80:83]
    v_exp_f32 v174, v174
    v_mfma_f32_16x16x32_bf16 v[84:87], a[100:103], v[136:139], v[84:87]
    ds_read_b128 a[64:67], v212 offset:0
    ds_read_b128 a[68:71], v213 offset:0
    v_mfma_f32_16x16x32_bf16 v[88:91], a[100:103], v[144:147], v[88:91]
    s_waitcnt lgkmcnt(4)
    v_exp_f32 v175, v175
    v_mfma_f32_16x16x32_bf16 v[92:95], a[100:103], v[152:155], v[92:95]
    v_cvt_pk_bf16_f32 v163, v166, v167
    v_cvt_pk_bf16_f32 v171, v174, v175
    v_mfma_f32_16x16x32_bf16 v[96:99], a[104:107], v[128:131], v[96:99]
    v_exp_f32 v176, v176
    v_mfma_f32_16x16x32_bf16 v[100:103], a[104:107], v[136:139], v[100:103]
    ds_read_b128 a[72:75], v214 offset:0
    ds_read_b128 a[76:79], v215 offset:0
    v_mfma_f32_16x16x32_bf16 v[104:107], a[104:107], v[144:147], v[104:107]
    s_waitcnt lgkmcnt(4)
    v_exp_f32 v177, v177
    v_mfma_f32_16x16x32_bf16 v[108:111], a[104:107], v[152:155], v[108:111]
    v_add_f32 v253, v253, v176
    v_add_f32 v253, v253, v177
    v_mfma_f32_16x16x32_bf16 v[112:115], a[108:111], v[128:131], v[112:115]
    v_exp_f32 v184, v184
    v_mfma_f32_16x16x32_bf16 v[116:119], a[108:111], v[136:139], v[116:119]
    ds_read_b128 a[80:83], v212 offset:1024
    v_mfma_f32_16x16x32_bf16 v[120:123], a[108:111], v[144:147], v[120:123]
    s_waitcnt lgkmcnt(4)
    v_exp_f32 v185, v185
    v_mfma_f32_16x16x32_bf16 v[124:127], a[108:111], v[152:155], v[124:127]
    v_cvt_pk_bf16_f32 v176, v176, v177
    v_cvt_pk_bf16_f32 v184, v184, v185
    v_mfma_f32_16x16x32_bf16 v[208:211], a[124:127], v[152:155], v[208:211]
    buffer_load_dwordx4 v224, s[8:11], s78 offen offset:1024 lds
    v_mfma_f32_16x16x32_bf16 v[128:131], a[64:67], a[0:3], v[192:195]
    s_waitcnt lgkmcnt(2)
    v_exp_f32 v178, v178
    v_mfma_f32_16x16x32_bf16 v[128:131], a[68:71], a[16:19], v[128:131]
    ds_read_b128 a[84:87], v213 offset:1024
    v_mfma_f32_16x16x32_bf16 v[128:131], a[72:75], a[32:35], v[128:131]
    s_waitcnt lgkmcnt(2)
    v_exp_f32 v179, v179
    v_mfma_f32_16x16x32_bf16 v[128:131], a[76:79], a[48:51], v[128:131]
    v_add_f32 v253, v253, v178
    v_add_f32 v253, v253, v179
    v_mfma_f32_16x16x32_bf16 v[136:139], a[64:67], a[4:7], v[196:199]
    v_exp_f32 v186, v186
    v_mfma_f32_16x16x32_bf16 v[136:139], a[68:71], a[20:23], v[136:139]
    ds_read_b128 a[88:91], v214 offset:1024
    v_mfma_f32_16x16x32_bf16 v[136:139], a[72:75], a[36:39], v[136:139]
    v_exp_f32 v187, v187
    v_mfma_f32_16x16x32_bf16 v[136:139], a[76:79], a[52:55], v[136:139]
    v_cvt_pk_bf16_f32 v177, v178, v179
    v_cvt_pk_bf16_f32 v185, v186, v187
    v_mfma_f32_16x16x32_bf16 v[144:147], a[64:67], a[8:11], v[200:203]
    v_exp_f32 v180, v180
    v_mfma_f32_16x16x32_bf16 v[144:147], a[68:71], a[24:27], v[144:147]
    ds_read_b128 a[92:95], v215 offset:1024
    v_mfma_f32_16x16x32_bf16 v[144:147], a[72:75], a[40:43], v[144:147]
    v_exp_f32 v181, v181
    v_mfma_f32_16x16x32_bf16 v[144:147], a[76:79], a[56:59], v[144:147]
    v_add_f32 v253, v253, v180
    v_add_f32 v253, v253, v181
    v_mfma_f32_16x16x32_bf16 v[152:155], a[64:67], a[12:15], v[204:207]
    v_exp_f32 v188, v188
    v_mfma_f32_16x16x32_bf16 v[152:155], a[68:71], a[28:31], v[152:155]
    buffer_load_dwordx4 v225, s[8:11], s78 offen offset:2048 lds
    v_mfma_f32_16x16x32_bf16 v[152:155], a[72:75], a[44:47], v[152:155]
    s_waitcnt lgkmcnt(3)
    v_exp_f32 v189, v189
    v_mfma_f32_16x16x32_bf16 v[152:155], a[76:79], a[60:63], v[152:155]
    v_cvt_pk_bf16_f32 v178, v180, v181
    v_cvt_pk_bf16_f32 v186, v188, v189
    v_mfma_f32_16x16x32_bf16 v[132:135], a[80:83], a[0:3], v[192:195]
    s_waitcnt lgkmcnt(1)
    v_exp_f32 v182, v182
    v_mfma_f32_16x16x32_bf16 v[132:135], a[84:87], a[16:19], v[132:135]
    buffer_load_dwordx4 v225, s[8:11], s78 offen offset:3072 lds
    v_mfma_f32_16x16x32_bf16 v[132:135], a[88:91], a[32:35], v[132:135]
    s_waitcnt lgkmcnt(0)
    v_exp_f32 v183, v183
    v_mfma_f32_16x16x32_bf16 v[132:135], a[92:95], a[48:51], v[132:135]
    v_add_f32 v253, v253, v182
    v_add_f32 v253, v253, v183
    v_mfma_f32_16x16x32_bf16 v[140:143], a[80:83], a[4:7], v[196:199]
    v_exp_f32 v190, v190
    v_mfma_f32_16x16x32_bf16 v[140:143], a[84:87], a[20:23], v[140:143]
    ds_read_b64_tr_b16 a[96:97], v216 offset:57344
    ds_read_b64_tr_b16 a[98:99], v216 offset:58368
    v_mfma_f32_16x16x32_bf16 v[140:143], a[88:91], a[36:39], v[140:143]
    v_exp_f32 v191, v191
    v_mfma_f32_16x16x32_bf16 v[140:143], a[92:95], a[52:55], v[140:143]
    v_cvt_pk_bf16_f32 v179, v182, v183
    v_cvt_pk_bf16_f32 v187, v190, v191
    v_mfma_f32_16x16x32_bf16 v[148:151], a[80:83], a[8:11], v[200:203]
    v_exp_f32 v128, v128
    v_mfma_f32_16x16x32_bf16 v[148:151], a[84:87], a[24:27], v[148:151]
    ds_read_b64_tr_b16 a[100:101], v217 offset:57344
    ds_read_b64_tr_b16 a[102:103], v217 offset:58368
    v_mfma_f32_16x16x32_bf16 v[148:151], a[88:91], a[40:43], v[148:151]
    v_exp_f32 v129, v129
    v_mfma_f32_16x16x32_bf16 v[148:151], a[92:95], a[56:59], v[148:151]
    v_add_f32 v235, v235, v128
    v_add_f32 v235, v235, v129
    v_mfma_f32_16x16x32_bf16 v[156:159], a[80:83], a[12:15], v[204:207]
    v_exp_f32 v136, v136
    v_mfma_f32_16x16x32_bf16 v[156:159], a[84:87], a[28:31], v[156:159]
    ds_read_b64_tr_b16 a[104:105], v218 offset:57344
    ds_read_b64_tr_b16 a[106:107], v218 offset:58368
    v_mfma_f32_16x16x32_bf16 v[156:159], a[88:91], a[44:47], v[156:159]
    s_waitcnt lgkmcnt(4)
    v_exp_f32 v137, v137
    v_mfma_f32_16x16x32_bf16 v[156:159], a[92:95], a[60:63], v[156:159]
    v_cvt_pk_bf16_f32 v128, v128, v129
    v_cvt_pk_bf16_f32 v136, v136, v137
    v_mfma_f32_16x16x32_bf16 v[0:3], a[96:99], v[160:163], v[0:3]
    v_exp_f32 v130, v130
    v_mfma_f32_16x16x32_bf16 v[4:7], a[96:99], v[168:171], v[4:7]
    ds_read_b64_tr_b16 a[108:109], v219 offset:57344
    ds_read_b64_tr_b16 a[110:111], v219 offset:58368
    v_mfma_f32_16x16x32_bf16 v[8:11], a[96:99], v[176:179], v[8:11]
    s_waitcnt lgkmcnt(4)
    v_exp_f32 v131, v131
    v_mfma_f32_16x16x32_bf16 v[12:15], a[96:99], v[184:187], v[12:15]
    v_add_f32 v235, v235, v130
    v_add_f32 v235, v235, v131
    v_mfma_f32_16x16x32_bf16 v[16:19], a[100:103], v[160:163], v[16:19]
    v_exp_f32 v138, v138
    v_mfma_f32_16x16x32_bf16 v[20:23], a[100:103], v[168:171], v[20:23]
    ds_read_b64_tr_b16 a[96:97], v220 offset:57344
    ds_read_b64_tr_b16 a[98:99], v220 offset:58368
    v_mfma_f32_16x16x32_bf16 v[24:27], a[100:103], v[176:179], v[24:27]
    s_waitcnt lgkmcnt(4)
    v_exp_f32 v139, v139
    v_mfma_f32_16x16x32_bf16 v[28:31], a[100:103], v[184:187], v[28:31]
    v_cvt_pk_bf16_f32 v129, v130, v131
    v_cvt_pk_bf16_f32 v137, v138, v139
    v_mfma_f32_16x16x32_bf16 v[32:35], a[104:107], v[160:163], v[32:35]
    v_exp_f32 v132, v132
    v_mfma_f32_16x16x32_bf16 v[36:39], a[104:107], v[168:171], v[36:39]
    ds_read_b64_tr_b16 a[100:101], v221 offset:57344
    ds_read_b64_tr_b16 a[102:103], v221 offset:58368
    v_mfma_f32_16x16x32_bf16 v[40:43], a[104:107], v[176:179], v[40:43]
    s_waitcnt lgkmcnt(4)
    v_exp_f32 v133, v133
    v_mfma_f32_16x16x32_bf16 v[44:47], a[104:107], v[184:187], v[44:47]
    v_add_f32 v235, v235, v132
    v_add_f32 v235, v235, v133
    v_mfma_f32_16x16x32_bf16 v[48:51], a[108:111], v[160:163], v[48:51]
    s_add_u32 m0, s75, 65536
    v_exp_f32 v140, v140
    v_mfma_f32_16x16x32_bf16 v[52:55], a[108:111], v[168:171], v[52:55]
    ds_read_b64_tr_b16 a[104:105], v222 offset:57344
    ds_read_b64_tr_b16 a[106:107], v222 offset:58368
    v_mfma_f32_16x16x32_bf16 v[56:59], a[108:111], v[176:179], v[56:59]
    s_waitcnt lgkmcnt(4)
    v_exp_f32 v141, v141
    v_mfma_f32_16x16x32_bf16 v[60:63], a[108:111], v[184:187], v[60:63]
    v_cvt_pk_bf16_f32 v130, v132, v133
    v_cvt_pk_bf16_f32 v138, v140, v141
    v_mfma_f32_16x16x32_bf16 v[208:211], a[116:119], v[168:171], v[208:211]
    buffer_load_dwordx4 v226, s[12:15], s78 offen lds
    v_mfma_f32_16x16x32_bf16 v[64:67], a[96:99], v[160:163], v[64:67]
    v_exp_f32 v134, v134
    v_mfma_f32_16x16x32_bf16 v[68:71], a[96:99], v[168:171], v[68:71]
    ds_read_b64_tr_b16 a[108:109], v223 offset:57344
    ds_read_b64_tr_b16 a[110:111], v223 offset:58368
    v_mfma_f32_16x16x32_bf16 v[72:75], a[96:99], v[176:179], v[72:75]
    s_waitcnt lgkmcnt(4)
    v_exp_f32 v135, v135
    v_mfma_f32_16x16x32_bf16 v[76:79], a[96:99], v[184:187], v[76:79]
    v_add_f32 v235, v235, v134
    v_add_f32 v235, v235, v135
    v_mfma_f32_16x16x32_bf16 v[80:83], a[100:103], v[160:163], v[80:83]
    v_exp_f32 v142, v142
    v_mfma_f32_16x16x32_bf16 v[84:87], a[100:103], v[168:171], v[84:87]
    ds_read_b128 a[64:67], v212 offset:8192
    ds_read_b128 a[68:71], v213 offset:8192
    v_mfma_f32_16x16x32_bf16 v[88:91], a[100:103], v[176:179], v[88:91]
    s_waitcnt lgkmcnt(4)
    v_exp_f32 v143, v143
    v_mfma_f32_16x16x32_bf16 v[92:95], a[100:103], v[184:187], v[92:95]
    v_cvt_pk_bf16_f32 v131, v134, v135
    v_cvt_pk_bf16_f32 v139, v142, v143
    v_mfma_f32_16x16x32_bf16 v[96:99], a[104:107], v[160:163], v[96:99]
    v_exp_f32 v144, v144
    v_mfma_f32_16x16x32_bf16 v[100:103], a[104:107], v[168:171], v[100:103]
    ds_read_b128 a[72:75], v214 offset:8192
    ds_read_b128 a[76:79], v215 offset:8192
    v_mfma_f32_16x16x32_bf16 v[104:107], a[104:107], v[176:179], v[104:107]
    s_waitcnt lgkmcnt(4)
    v_exp_f32 v145, v145
    v_mfma_f32_16x16x32_bf16 v[108:111], a[104:107], v[184:187], v[108:111]
    v_add_f32 v253, v253, v144
    v_add_f32 v253, v253, v145
    v_mfma_f32_16x16x32_bf16 v[112:115], a[108:111], v[160:163], v[112:115]
    v_exp_f32 v152, v152
    v_mfma_f32_16x16x32_bf16 v[116:119], a[108:111], v[168:171], v[116:119]
    ds_read_b128 a[80:83], v212 offset:9216
    v_mfma_f32_16x16x32_bf16 v[120:123], a[108:111], v[176:179], v[120:123]
    s_waitcnt lgkmcnt(4)
    v_exp_f32 v153, v153
    v_mfma_f32_16x16x32_bf16 v[124:127], a[108:111], v[184:187], v[124:127]
    v_cvt_pk_bf16_f32 v144, v144, v145
    v_cvt_pk_bf16_f32 v152, v152, v153
    v_mfma_f32_16x16x32_bf16 v[208:211], a[124:127], v[184:187], v[208:211]
    buffer_load_dwordx4 v226, s[12:15], s78 offen offset:1024 lds
    v_mfma_f32_16x16x32_bf16 v[160:163], a[64:67], a[0:3], v[192:195]
    s_waitcnt lgkmcnt(2)
    v_exp_f32 v146, v146
    v_mfma_f32_16x16x32_bf16 v[160:163], a[68:71], a[16:19], v[160:163]
    ds_read_b128 a[84:87], v213 offset:9216
    v_mfma_f32_16x16x32_bf16 v[160:163], a[72:75], a[32:35], v[160:163]
    s_waitcnt lgkmcnt(2)
    v_exp_f32 v147, v147
    v_mfma_f32_16x16x32_bf16 v[160:163], a[76:79], a[48:51], v[160:163]
    v_add_f32 v253, v253, v146
    v_add_f32 v253, v253, v147
    v_mfma_f32_16x16x32_bf16 v[168:171], a[64:67], a[4:7], v[196:199]
    v_exp_f32 v154, v154
    v_mfma_f32_16x16x32_bf16 v[168:171], a[68:71], a[20:23], v[168:171]
    ds_read_b128 a[88:91], v214 offset:9216
    v_mfma_f32_16x16x32_bf16 v[168:171], a[72:75], a[36:39], v[168:171]
    s_waitcnt vmcnt(10)
    v_exp_f32 v155, v155
    v_mfma_f32_16x16x32_bf16 v[168:171], a[76:79], a[52:55], v[168:171]
    v_cvt_pk_bf16_f32 v145, v146, v147
    v_cvt_pk_bf16_f32 v153, v154, v155
    v_mfma_f32_16x16x32_bf16 v[176:179], a[64:67], a[8:11], v[200:203]
    s_barrier
    v_exp_f32 v148, v148
    v_mfma_f32_16x16x32_bf16 v[176:179], a[68:71], a[24:27], v[176:179]
    ds_read_b128 a[92:95], v215 offset:9216
    v_mfma_f32_16x16x32_bf16 v[176:179], a[72:75], a[40:43], v[176:179]
    v_exp_f32 v149, v149
    v_mfma_f32_16x16x32_bf16 v[176:179], a[76:79], a[56:59], v[176:179]
    v_add_f32 v253, v253, v148
    v_add_f32 v253, v253, v149
    v_mfma_f32_16x16x32_bf16 v[184:187], a[64:67], a[12:15], v[204:207]
    v_exp_f32 v156, v156
    v_mfma_f32_16x16x32_bf16 v[184:187], a[68:71], a[28:31], v[184:187]
    buffer_load_dwordx4 v227, s[12:15], s78 offen offset:2048 lds
    v_mfma_f32_16x16x32_bf16 v[184:187], a[72:75], a[44:47], v[184:187]
    s_waitcnt lgkmcnt(3)
    v_exp_f32 v157, v157
    v_mfma_f32_16x16x32_bf16 v[184:187], a[76:79], a[60:63], v[184:187]
    v_cvt_pk_bf16_f32 v146, v148, v149
    v_cvt_pk_bf16_f32 v154, v156, v157
    v_mfma_f32_16x16x32_bf16 v[164:167], a[80:83], a[0:3], v[192:195]
    s_waitcnt lgkmcnt(1)
    v_exp_f32 v150, v150
    v_mfma_f32_16x16x32_bf16 v[164:167], a[84:87], a[16:19], v[164:167]
    buffer_load_dwordx4 v227, s[12:15], s78 offen offset:3072 lds
    v_mfma_f32_16x16x32_bf16 v[164:167], a[88:91], a[32:35], v[164:167]
    s_waitcnt lgkmcnt(0)
    v_exp_f32 v151, v151
    v_mfma_f32_16x16x32_bf16 v[164:167], a[92:95], a[48:51], v[164:167]
    v_add_f32 v253, v253, v150
    v_add_f32 v253, v253, v151
    v_mfma_f32_16x16x32_bf16 v[172:175], a[80:83], a[4:7], v[196:199]
    v_exp_f32 v158, v158
    v_mfma_f32_16x16x32_bf16 v[172:175], a[84:87], a[20:23], v[172:175]
    ds_read_b64_tr_b16 a[96:97], v216 offset:0
    ds_read_b64_tr_b16 a[98:99], v216 offset:1024
    v_mfma_f32_16x16x32_bf16 v[172:175], a[88:91], a[36:39], v[172:175]
    v_exp_f32 v159, v159
    v_mfma_f32_16x16x32_bf16 v[172:175], a[92:95], a[52:55], v[172:175]
    v_cvt_pk_bf16_f32 v147, v150, v151
    v_cvt_pk_bf16_f32 v155, v158, v159
    v_mfma_f32_16x16x32_bf16 v[180:183], a[80:83], a[8:11], v[200:203]
    s_add_u32 s78, s78, 16384
    v_exp_f32 v160, v160
    v_mfma_f32_16x16x32_bf16 v[180:183], a[84:87], a[24:27], v[180:183]
    ds_read_b64_tr_b16 a[100:101], v217 offset:0
    ds_read_b64_tr_b16 a[102:103], v217 offset:1024
    v_mfma_f32_16x16x32_bf16 v[180:183], a[88:91], a[40:43], v[180:183]
    v_exp_f32 v161, v161
    v_mfma_f32_16x16x32_bf16 v[180:183], a[92:95], a[56:59], v[180:183]
    v_add_f32 v235, v235, v160
    v_add_f32 v235, v235, v161
    v_mfma_f32_16x16x32_bf16 v[188:191], a[80:83], a[12:15], v[204:207]
    v_exp_f32 v168, v168
    v_mfma_f32_16x16x32_bf16 v[188:191], a[84:87], a[28:31], v[188:191]
    ds_read_b64_tr_b16 a[104:105], v218 offset:0
    ds_read_b64_tr_b16 a[106:107], v218 offset:1024
    v_mfma_f32_16x16x32_bf16 v[188:191], a[88:91], a[44:47], v[188:191]
    s_waitcnt lgkmcnt(4)
    v_exp_f32 v169, v169
    v_mfma_f32_16x16x32_bf16 v[188:191], a[92:95], a[60:63], v[188:191]
    v_cvt_pk_bf16_f32 v160, v160, v161
    v_cvt_pk_bf16_f32 v168, v168, v169
    v_mfma_f32_16x16x32_bf16 v[0:3], a[96:99], v[128:131], v[0:3]
    v_exp_f32 v162, v162
    v_mfma_f32_16x16x32_bf16 v[4:7], a[96:99], v[136:139], v[4:7]
    ds_read_b64_tr_b16 a[108:109], v219 offset:0
    ds_read_b64_tr_b16 a[110:111], v219 offset:1024
    v_mfma_f32_16x16x32_bf16 v[8:11], a[96:99], v[144:147], v[8:11]
    s_waitcnt lgkmcnt(4)
    v_exp_f32 v163, v163
    v_mfma_f32_16x16x32_bf16 v[12:15], a[96:99], v[152:155], v[12:15]
    v_add_f32 v235, v235, v162
    v_add_f32 v235, v235, v163
    v_mfma_f32_16x16x32_bf16 v[16:19], a[100:103], v[128:131], v[16:19]
    v_exp_f32 v170, v170
    v_mfma_f32_16x16x32_bf16 v[20:23], a[100:103], v[136:139], v[20:23]
    ds_read_b64_tr_b16 a[96:97], v220 offset:0
    ds_read_b64_tr_b16 a[98:99], v220 offset:1024
    v_mfma_f32_16x16x32_bf16 v[24:27], a[100:103], v[144:147], v[24:27]
    s_waitcnt lgkmcnt(4)
    v_exp_f32 v171, v171
    v_mfma_f32_16x16x32_bf16 v[28:31], a[100:103], v[152:155], v[28:31]
    v_cvt_pk_bf16_f32 v161, v162, v163
    v_cvt_pk_bf16_f32 v169, v170, v171
    v_mfma_f32_16x16x32_bf16 v[32:35], a[104:107], v[128:131], v[32:35]
    v_exp_f32 v164, v164
    v_mfma_f32_16x16x32_bf16 v[36:39], a[104:107], v[136:139], v[36:39]
    ds_read_b64_tr_b16 a[100:101], v221 offset:0
    ds_read_b64_tr_b16 a[102:103], v221 offset:1024
    v_mfma_f32_16x16x32_bf16 v[40:43], a[104:107], v[144:147], v[40:43]
    s_waitcnt lgkmcnt(4)
    v_exp_f32 v165, v165
    v_mfma_f32_16x16x32_bf16 v[44:47], a[104:107], v[152:155], v[44:47]
    v_add_f32 v235, v235, v164
    v_add_f32 v235, v235, v165
    v_mfma_f32_16x16x32_bf16 v[48:51], a[108:111], v[128:131], v[48:51]
    s_add_u32 m0, s75, 147456
    v_exp_f32 v172, v172
    v_mfma_f32_16x16x32_bf16 v[52:55], a[108:111], v[136:139], v[52:55]
    ds_read_b64_tr_b16 a[104:105], v222 offset:0
    ds_read_b64_tr_b16 a[106:107], v222 offset:1024
    v_mfma_f32_16x16x32_bf16 v[56:59], a[108:111], v[144:147], v[56:59]
    s_waitcnt lgkmcnt(4)
    v_exp_f32 v173, v173
    v_mfma_f32_16x16x32_bf16 v[60:63], a[108:111], v[152:155], v[60:63]
    v_cvt_pk_bf16_f32 v162, v164, v165
    v_cvt_pk_bf16_f32 v170, v172, v173
    v_mfma_f32_16x16x32_bf16 v[208:211], a[116:119], v[136:139], v[208:211]
    buffer_load_dwordx4 v224, s[8:11], s78 offen lds
    v_mfma_f32_16x16x32_bf16 v[64:67], a[96:99], v[128:131], v[64:67]
    v_exp_f32 v166, v166
    v_mfma_f32_16x16x32_bf16 v[68:71], a[96:99], v[136:139], v[68:71]
    ds_read_b64_tr_b16 a[108:109], v223 offset:0
    ds_read_b64_tr_b16 a[110:111], v223 offset:1024
    v_mfma_f32_16x16x32_bf16 v[72:75], a[96:99], v[144:147], v[72:75]
    s_waitcnt lgkmcnt(4)
    v_exp_f32 v167, v167
    v_mfma_f32_16x16x32_bf16 v[76:79], a[96:99], v[152:155], v[76:79]
    v_add_f32 v235, v235, v166
    v_add_f32 v235, v235, v167
    v_mfma_f32_16x16x32_bf16 v[80:83], a[100:103], v[128:131], v[80:83]
    v_exp_f32 v174, v174
    v_mfma_f32_16x16x32_bf16 v[84:87], a[100:103], v[136:139], v[84:87]
    ds_read_b128 a[64:67], v212 offset:16384
    ds_read_b128 a[68:71], v213 offset:16384
    v_mfma_f32_16x16x32_bf16 v[88:91], a[100:103], v[144:147], v[88:91]
    s_waitcnt lgkmcnt(4)
    v_exp_f32 v175, v175
    v_mfma_f32_16x16x32_bf16 v[92:95], a[100:103], v[152:155], v[92:95]
    v_cvt_pk_bf16_f32 v163, v166, v167
    v_cvt_pk_bf16_f32 v171, v174, v175
    v_mfma_f32_16x16x32_bf16 v[96:99], a[104:107], v[128:131], v[96:99]
    v_exp_f32 v176, v176
    v_mfma_f32_16x16x32_bf16 v[100:103], a[104:107], v[136:139], v[100:103]
    ds_read_b128 a[72:75], v214 offset:16384
    ds_read_b128 a[76:79], v215 offset:16384
    v_mfma_f32_16x16x32_bf16 v[104:107], a[104:107], v[144:147], v[104:107]
    s_waitcnt lgkmcnt(4)
    v_exp_f32 v177, v177
    v_mfma_f32_16x16x32_bf16 v[108:111], a[104:107], v[152:155], v[108:111]
    v_add_f32 v253, v253, v176
    v_add_f32 v253, v253, v177
    v_mfma_f32_16x16x32_bf16 v[112:115], a[108:111], v[128:131], v[112:115]
    v_exp_f32 v184, v184
    v_mfma_f32_16x16x32_bf16 v[116:119], a[108:111], v[136:139], v[116:119]
    ds_read_b128 a[80:83], v212 offset:17408
    v_mfma_f32_16x16x32_bf16 v[120:123], a[108:111], v[144:147], v[120:123]
    s_waitcnt lgkmcnt(4)
    v_exp_f32 v185, v185
    v_mfma_f32_16x16x32_bf16 v[124:127], a[108:111], v[152:155], v[124:127]
    v_cvt_pk_bf16_f32 v176, v176, v177
    v_cvt_pk_bf16_f32 v184, v184, v185
    v_mfma_f32_16x16x32_bf16 v[208:211], a[124:127], v[152:155], v[208:211]
    buffer_load_dwordx4 v224, s[8:11], s78 offen offset:1024 lds
    v_mfma_f32_16x16x32_bf16 v[128:131], a[64:67], a[0:3], v[192:195]
    s_waitcnt lgkmcnt(2)
    v_exp_f32 v178, v178
    v_mfma_f32_16x16x32_bf16 v[128:131], a[68:71], a[16:19], v[128:131]
    ds_read_b128 a[84:87], v213 offset:17408
    v_mfma_f32_16x16x32_bf16 v[128:131], a[72:75], a[32:35], v[128:131]
    s_waitcnt lgkmcnt(2)
    v_exp_f32 v179, v179
    v_mfma_f32_16x16x32_bf16 v[128:131], a[76:79], a[48:51], v[128:131]
    v_add_f32 v253, v253, v178
    v_add_f32 v253, v253, v179
    v_mfma_f32_16x16x32_bf16 v[136:139], a[64:67], a[4:7], v[196:199]
    v_exp_f32 v186, v186
    v_mfma_f32_16x16x32_bf16 v[136:139], a[68:71], a[20:23], v[136:139]
    ds_read_b128 a[88:91], v214 offset:17408
    v_mfma_f32_16x16x32_bf16 v[136:139], a[72:75], a[36:39], v[136:139]
    v_exp_f32 v187, v187
    v_mfma_f32_16x16x32_bf16 v[136:139], a[76:79], a[52:55], v[136:139]
    v_cvt_pk_bf16_f32 v177, v178, v179
    v_cvt_pk_bf16_f32 v185, v186, v187
    v_mfma_f32_16x16x32_bf16 v[144:147], a[64:67], a[8:11], v[200:203]
    v_exp_f32 v180, v180
    v_mfma_f32_16x16x32_bf16 v[144:147], a[68:71], a[24:27], v[144:147]
    ds_read_b128 a[92:95], v215 offset:17408
    v_mfma_f32_16x16x32_bf16 v[144:147], a[72:75], a[40:43], v[144:147]
    v_exp_f32 v181, v181
    v_mfma_f32_16x16x32_bf16 v[144:147], a[76:79], a[56:59], v[144:147]
    v_add_f32 v253, v253, v180
    v_add_f32 v253, v253, v181
    v_mfma_f32_16x16x32_bf16 v[152:155], a[64:67], a[12:15], v[204:207]
    v_exp_f32 v188, v188
    v_mfma_f32_16x16x32_bf16 v[152:155], a[68:71], a[28:31], v[152:155]
    buffer_load_dwordx4 v225, s[8:11], s78 offen offset:2048 lds
    v_mfma_f32_16x16x32_bf16 v[152:155], a[72:75], a[44:47], v[152:155]
    s_waitcnt lgkmcnt(3)
    v_exp_f32 v189, v189
    v_mfma_f32_16x16x32_bf16 v[152:155], a[76:79], a[60:63], v[152:155]
    v_cvt_pk_bf16_f32 v178, v180, v181
    v_cvt_pk_bf16_f32 v186, v188, v189
    v_mfma_f32_16x16x32_bf16 v[132:135], a[80:83], a[0:3], v[192:195]
    s_waitcnt lgkmcnt(1)
    v_exp_f32 v182, v182
    v_mfma_f32_16x16x32_bf16 v[132:135], a[84:87], a[16:19], v[132:135]
    buffer_load_dwordx4 v225, s[8:11], s78 offen offset:3072 lds
    v_mfma_f32_16x16x32_bf16 v[132:135], a[88:91], a[32:35], v[132:135]
    s_waitcnt lgkmcnt(0)
    v_exp_f32 v183, v183
    v_mfma_f32_16x16x32_bf16 v[132:135], a[92:95], a[48:51], v[132:135]
    v_add_f32 v253, v253, v182
    v_add_f32 v253, v253, v183
    v_mfma_f32_16x16x32_bf16 v[140:143], a[80:83], a[4:7], v[196:199]
    v_exp_f32 v190, v190
    v_mfma_f32_16x16x32_bf16 v[140:143], a[84:87], a[20:23], v[140:143]
    ds_read_b64_tr_b16 a[96:97], v216 offset:8192
    ds_read_b64_tr_b16 a[98:99], v216 offset:9216
    v_mfma_f32_16x16x32_bf16 v[140:143], a[88:91], a[36:39], v[140:143]
    v_exp_f32 v191, v191
    v_mfma_f32_16x16x32_bf16 v[140:143], a[92:95], a[52:55], v[140:143]
    v_cvt_pk_bf16_f32 v179, v182, v183
    v_cvt_pk_bf16_f32 v187, v190, v191
    v_mfma_f32_16x16x32_bf16 v[148:151], a[80:83], a[8:11], v[200:203]
    v_exp_f32 v128, v128
    v_mfma_f32_16x16x32_bf16 v[148:151], a[84:87], a[24:27], v[148:151]
    ds_read_b64_tr_b16 a[100:101], v217 offset:8192
    ds_read_b64_tr_b16 a[102:103], v217 offset:9216
    v_mfma_f32_16x16x32_bf16 v[148:151], a[88:91], a[40:43], v[148:151]
    v_exp_f32 v129, v129
    v_mfma_f32_16x16x32_bf16 v[148:151], a[92:95], a[56:59], v[148:151]
    v_add_f32 v235, v235, v128
    v_add_f32 v235, v235, v129
    v_mfma_f32_16x16x32_bf16 v[156:159], a[80:83], a[12:15], v[204:207]
    v_exp_f32 v136, v136
    v_mfma_f32_16x16x32_bf16 v[156:159], a[84:87], a[28:31], v[156:159]
    ds_read_b64_tr_b16 a[104:105], v218 offset:8192
    ds_read_b64_tr_b16 a[106:107], v218 offset:9216
    v_mfma_f32_16x16x32_bf16 v[156:159], a[88:91], a[44:47], v[156:159]
    s_waitcnt lgkmcnt(4)
    v_exp_f32 v137, v137
    v_mfma_f32_16x16x32_bf16 v[156:159], a[92:95], a[60:63], v[156:159]
    v_cvt_pk_bf16_f32 v128, v128, v129
    v_cvt_pk_bf16_f32 v136, v136, v137
    v_mfma_f32_16x16x32_bf16 v[0:3], a[96:99], v[160:163], v[0:3]
    v_exp_f32 v130, v130
    v_mfma_f32_16x16x32_bf16 v[4:7], a[96:99], v[168:171], v[4:7]
    ds_read_b64_tr_b16 a[108:109], v219 offset:8192
    ds_read_b64_tr_b16 a[110:111], v219 offset:9216
    v_mfma_f32_16x16x32_bf16 v[8:11], a[96:99], v[176:179], v[8:11]
    s_waitcnt lgkmcnt(4)
    v_exp_f32 v131, v131
    v_mfma_f32_16x16x32_bf16 v[12:15], a[96:99], v[184:187], v[12:15]
    v_add_f32 v235, v235, v130
    v_add_f32 v235, v235, v131
    v_mfma_f32_16x16x32_bf16 v[16:19], a[100:103], v[160:163], v[16:19]
    v_exp_f32 v138, v138
    v_mfma_f32_16x16x32_bf16 v[20:23], a[100:103], v[168:171], v[20:23]
    ds_read_b64_tr_b16 a[96:97], v220 offset:8192
    ds_read_b64_tr_b16 a[98:99], v220 offset:9216
    v_mfma_f32_16x16x32_bf16 v[24:27], a[100:103], v[176:179], v[24:27]
    s_waitcnt lgkmcnt(4)
    v_exp_f32 v139, v139
    v_mfma_f32_16x16x32_bf16 v[28:31], a[100:103], v[184:187], v[28:31]
    v_cvt_pk_bf16_f32 v129, v130, v131
    v_cvt_pk_bf16_f32 v137, v138, v139
    v_mfma_f32_16x16x32_bf16 v[32:35], a[104:107], v[160:163], v[32:35]
    v_exp_f32 v132, v132
    v_mfma_f32_16x16x32_bf16 v[36:39], a[104:107], v[168:171], v[36:39]
    ds_read_b64_tr_b16 a[100:101], v221 offset:8192
    ds_read_b64_tr_b16 a[102:103], v221 offset:9216
    v_mfma_f32_16x16x32_bf16 v[40:43], a[104:107], v[176:179], v[40:43]
    s_waitcnt lgkmcnt(4)
    v_exp_f32 v133, v133
    v_mfma_f32_16x16x32_bf16 v[44:47], a[104:107], v[184:187], v[44:47]
    v_add_f32 v235, v235, v132
    v_add_f32 v235, v235, v133
    v_mfma_f32_16x16x32_bf16 v[48:51], a[108:111], v[160:163], v[48:51]
    s_add_u32 m0, s75, 81920
    v_exp_f32 v140, v140
    v_mfma_f32_16x16x32_bf16 v[52:55], a[108:111], v[168:171], v[52:55]
    ds_read_b64_tr_b16 a[104:105], v222 offset:8192
    ds_read_b64_tr_b16 a[106:107], v222 offset:9216
    v_mfma_f32_16x16x32_bf16 v[56:59], a[108:111], v[176:179], v[56:59]
    s_waitcnt lgkmcnt(4)
    v_exp_f32 v141, v141
    v_mfma_f32_16x16x32_bf16 v[60:63], a[108:111], v[184:187], v[60:63]
    v_cvt_pk_bf16_f32 v130, v132, v133
    v_cvt_pk_bf16_f32 v138, v140, v141
    v_mfma_f32_16x16x32_bf16 v[208:211], a[116:119], v[168:171], v[208:211]
    buffer_load_dwordx4 v226, s[12:15], s78 offen lds
    v_mfma_f32_16x16x32_bf16 v[64:67], a[96:99], v[160:163], v[64:67]
    v_exp_f32 v134, v134
    v_mfma_f32_16x16x32_bf16 v[68:71], a[96:99], v[168:171], v[68:71]
    ds_read_b64_tr_b16 a[108:109], v223 offset:8192
    ds_read_b64_tr_b16 a[110:111], v223 offset:9216
    v_mfma_f32_16x16x32_bf16 v[72:75], a[96:99], v[176:179], v[72:75]
    s_waitcnt lgkmcnt(4)
    v_exp_f32 v135, v135
    v_mfma_f32_16x16x32_bf16 v[76:79], a[96:99], v[184:187], v[76:79]
    v_add_f32 v235, v235, v134
    v_add_f32 v235, v235, v135
    v_mfma_f32_16x16x32_bf16 v[80:83], a[100:103], v[160:163], v[80:83]
    v_exp_f32 v142, v142
    v_mfma_f32_16x16x32_bf16 v[84:87], a[100:103], v[168:171], v[84:87]
    ds_read_b128 a[64:67], v212 offset:24576
    ds_read_b128 a[68:71], v213 offset:24576
    v_mfma_f32_16x16x32_bf16 v[88:91], a[100:103], v[176:179], v[88:91]
    s_waitcnt lgkmcnt(4)
    v_exp_f32 v143, v143
    v_mfma_f32_16x16x32_bf16 v[92:95], a[100:103], v[184:187], v[92:95]
    v_cvt_pk_bf16_f32 v131, v134, v135
    v_cvt_pk_bf16_f32 v139, v142, v143
    v_mfma_f32_16x16x32_bf16 v[96:99], a[104:107], v[160:163], v[96:99]
    v_exp_f32 v144, v144
    v_mfma_f32_16x16x32_bf16 v[100:103], a[104:107], v[168:171], v[100:103]
    ds_read_b128 a[72:75], v214 offset:24576
    ds_read_b128 a[76:79], v215 offset:24576
    v_mfma_f32_16x16x32_bf16 v[104:107], a[104:107], v[176:179], v[104:107]
    s_waitcnt lgkmcnt(4)
    v_exp_f32 v145, v145
    v_mfma_f32_16x16x32_bf16 v[108:111], a[104:107], v[184:187], v[108:111]
    v_add_f32 v253, v253, v144
    v_add_f32 v253, v253, v145
    v_mfma_f32_16x16x32_bf16 v[112:115], a[108:111], v[160:163], v[112:115]
    v_exp_f32 v152, v152
    v_mfma_f32_16x16x32_bf16 v[116:119], a[108:111], v[168:171], v[116:119]
    ds_read_b128 a[80:83], v212 offset:25600
    v_mfma_f32_16x16x32_bf16 v[120:123], a[108:111], v[176:179], v[120:123]
    s_waitcnt lgkmcnt(4)
    v_exp_f32 v153, v153
    v_mfma_f32_16x16x32_bf16 v[124:127], a[108:111], v[184:187], v[124:127]
    v_cvt_pk_bf16_f32 v144, v144, v145
    v_cvt_pk_bf16_f32 v152, v152, v153
    v_mfma_f32_16x16x32_bf16 v[208:211], a[124:127], v[184:187], v[208:211]
    buffer_load_dwordx4 v226, s[12:15], s78 offen offset:1024 lds
    v_mfma_f32_16x16x32_bf16 v[160:163], a[64:67], a[0:3], v[192:195]
    s_waitcnt lgkmcnt(2)
    v_exp_f32 v146, v146
    v_mfma_f32_16x16x32_bf16 v[160:163], a[68:71], a[16:19], v[160:163]
    ds_read_b128 a[84:87], v213 offset:25600
    v_mfma_f32_16x16x32_bf16 v[160:163], a[72:75], a[32:35], v[160:163]
    s_waitcnt lgkmcnt(2)
    v_exp_f32 v147, v147
    v_mfma_f32_16x16x32_bf16 v[160:163], a[76:79], a[48:51], v[160:163]
    v_add_f32 v253, v253, v146
    v_add_f32 v253, v253, v147
    v_mfma_f32_16x16x32_bf16 v[168:171], a[64:67], a[4:7], v[196:199]
    v_exp_f32 v154, v154
    v_mfma_f32_16x16x32_bf16 v[168:171], a[68:71], a[20:23], v[168:171]
    ds_read_b128 a[88:91], v214 offset:25600
    v_mfma_f32_16x16x32_bf16 v[168:171], a[72:75], a[36:39], v[168:171]
    s_waitcnt vmcnt(10)
    v_exp_f32 v155, v155
    v_mfma_f32_16x16x32_bf16 v[168:171], a[76:79], a[52:55], v[168:171]
    v_cvt_pk_bf16_f32 v145, v146, v147
    v_cvt_pk_bf16_f32 v153, v154, v155
    v_mfma_f32_16x16x32_bf16 v[176:179], a[64:67], a[8:11], v[200:203]
    s_barrier
    v_exp_f32 v148, v148
    v_mfma_f32_16x16x32_bf16 v[176:179], a[68:71], a[24:27], v[176:179]
    ds_read_b128 a[92:95], v215 offset:25600
    v_mfma_f32_16x16x32_bf16 v[176:179], a[72:75], a[40:43], v[176:179]
    v_exp_f32 v149, v149
    v_mfma_f32_16x16x32_bf16 v[176:179], a[76:79], a[56:59], v[176:179]
    v_add_f32 v253, v253, v148
    v_add_f32 v253, v253, v149
    v_mfma_f32_16x16x32_bf16 v[184:187], a[64:67], a[12:15], v[204:207]
    v_exp_f32 v156, v156
    v_mfma_f32_16x16x32_bf16 v[184:187], a[68:71], a[28:31], v[184:187]
    buffer_load_dwordx4 v227, s[12:15], s78 offen offset:2048 lds
    v_mfma_f32_16x16x32_bf16 v[184:187], a[72:75], a[44:47], v[184:187]
    s_waitcnt lgkmcnt(3)
    v_exp_f32 v157, v157
    v_mfma_f32_16x16x32_bf16 v[184:187], a[76:79], a[60:63], v[184:187]
    v_cvt_pk_bf16_f32 v146, v148, v149
    v_cvt_pk_bf16_f32 v154, v156, v157
    v_mfma_f32_16x16x32_bf16 v[164:167], a[80:83], a[0:3], v[192:195]
    s_waitcnt lgkmcnt(1)
    v_exp_f32 v150, v150
    v_mfma_f32_16x16x32_bf16 v[164:167], a[84:87], a[16:19], v[164:167]
    buffer_load_dwordx4 v227, s[12:15], s78 offen offset:3072 lds
    v_mfma_f32_16x16x32_bf16 v[164:167], a[88:91], a[32:35], v[164:167]
    s_waitcnt lgkmcnt(0)
    v_exp_f32 v151, v151
    v_mfma_f32_16x16x32_bf16 v[164:167], a[92:95], a[48:51], v[164:167]
    v_add_f32 v253, v253, v150
    v_add_f32 v253, v253, v151
    v_mfma_f32_16x16x32_bf16 v[172:175], a[80:83], a[4:7], v[196:199]
    v_exp_f32 v158, v158
    v_mfma_f32_16x16x32_bf16 v[172:175], a[84:87], a[20:23], v[172:175]
    ds_read_b64_tr_b16 a[96:97], v216 offset:16384
    ds_read_b64_tr_b16 a[98:99], v216 offset:17408
    v_mfma_f32_16x16x32_bf16 v[172:175], a[88:91], a[36:39], v[172:175]
    v_exp_f32 v159, v159
    v_mfma_f32_16x16x32_bf16 v[172:175], a[92:95], a[52:55], v[172:175]
    v_cvt_pk_bf16_f32 v147, v150, v151
    v_cvt_pk_bf16_f32 v155, v158, v159
    v_mfma_f32_16x16x32_bf16 v[180:183], a[80:83], a[8:11], v[200:203]
    s_add_u32 s78, s78, 16384
    v_exp_f32 v160, v160
    v_mfma_f32_16x16x32_bf16 v[180:183], a[84:87], a[24:27], v[180:183]
    ds_read_b64_tr_b16 a[100:101], v217 offset:16384
    ds_read_b64_tr_b16 a[102:103], v217 offset:17408
    v_mfma_f32_16x16x32_bf16 v[180:183], a[88:91], a[40:43], v[180:183]
    v_exp_f32 v161, v161
    v_mfma_f32_16x16x32_bf16 v[180:183], a[92:95], a[56:59], v[180:183]
    v_add_f32 v235, v235, v160
    v_add_f32 v235, v235, v161
    v_mfma_f32_16x16x32_bf16 v[188:191], a[80:83], a[12:15], v[204:207]
    v_exp_f32 v168, v168
    v_mfma_f32_16x16x32_bf16 v[188:191], a[84:87], a[28:31], v[188:191]
    ds_read_b64_tr_b16 a[104:105], v218 offset:16384
    ds_read_b64_tr_b16 a[106:107], v218 offset:17408
    v_mfma_f32_16x16x32_bf16 v[188:191], a[88:91], a[44:47], v[188:191]
    s_waitcnt lgkmcnt(4)
    v_exp_f32 v169, v169
    v_mfma_f32_16x16x32_bf16 v[188:191], a[92:95], a[60:63], v[188:191]
    v_cvt_pk_bf16_f32 v160, v160, v161
    v_cvt_pk_bf16_f32 v168, v168, v169
    v_mfma_f32_16x16x32_bf16 v[0:3], a[96:99], v[128:131], v[0:3]
    v_exp_f32 v162, v162
    v_mfma_f32_16x16x32_bf16 v[4:7], a[96:99], v[136:139], v[4:7]
    ds_read_b64_tr_b16 a[108:109], v219 offset:16384
    ds_read_b64_tr_b16 a[110:111], v219 offset:17408
    v_mfma_f32_16x16x32_bf16 v[8:11], a[96:99], v[144:147], v[8:11]
    s_waitcnt lgkmcnt(4)
    v_exp_f32 v163, v163
    v_mfma_f32_16x16x32_bf16 v[12:15], a[96:99], v[152:155], v[12:15]
    v_add_f32 v235, v235, v162
    v_add_f32 v235, v235, v163
    v_mfma_f32_16x16x32_bf16 v[16:19], a[100:103], v[128:131], v[16:19]
    v_exp_f32 v170, v170
    v_mfma_f32_16x16x32_bf16 v[20:23], a[100:103], v[136:139], v[20:23]
    ds_read_b64_tr_b16 a[96:97], v220 offset:16384
    ds_read_b64_tr_b16 a[98:99], v220 offset:17408
    v_mfma_f32_16x16x32_bf16 v[24:27], a[100:103], v[144:147], v[24:27]
    s_waitcnt lgkmcnt(4)
    v_exp_f32 v171, v171
    v_mfma_f32_16x16x32_bf16 v[28:31], a[100:103], v[152:155], v[28:31]
    v_cvt_pk_bf16_f32 v161, v162, v163
    v_cvt_pk_bf16_f32 v169, v170, v171
    v_mfma_f32_16x16x32_bf16 v[32:35], a[104:107], v[128:131], v[32:35]
    v_exp_f32 v164, v164
    v_mfma_f32_16x16x32_bf16 v[36:39], a[104:107], v[136:139], v[36:39]
    ds_read_b64_tr_b16 a[100:101], v221 offset:16384
    ds_read_b64_tr_b16 a[102:103], v221 offset:17408
    v_mfma_f32_16x16x32_bf16 v[40:43], a[104:107], v[144:147], v[40:43]
    s_waitcnt lgkmcnt(4)
    v_exp_f32 v165, v165
    v_mfma_f32_16x16x32_bf16 v[44:47], a[104:107], v[152:155], v[44:47]
    v_add_f32 v235, v235, v164
    v_add_f32 v235, v235, v165
    v_mfma_f32_16x16x32_bf16 v[48:51], a[108:111], v[128:131], v[48:51]
    s_add_u32 m0, s75, 98304
    v_exp_f32 v172, v172
    v_mfma_f32_16x16x32_bf16 v[52:55], a[108:111], v[136:139], v[52:55]
    ds_read_b64_tr_b16 a[104:105], v222 offset:16384
    ds_read_b64_tr_b16 a[106:107], v222 offset:17408
    v_mfma_f32_16x16x32_bf16 v[56:59], a[108:111], v[144:147], v[56:59]
    s_waitcnt lgkmcnt(4)
    v_exp_f32 v173, v173
    v_mfma_f32_16x16x32_bf16 v[60:63], a[108:111], v[152:155], v[60:63]
    v_cvt_pk_bf16_f32 v162, v164, v165
    v_cvt_pk_bf16_f32 v170, v172, v173
    v_mfma_f32_16x16x32_bf16 v[208:211], a[116:119], v[136:139], v[208:211]
    buffer_load_dwordx4 v224, s[8:11], s78 offen lds
    v_mfma_f32_16x16x32_bf16 v[64:67], a[96:99], v[128:131], v[64:67]
    v_exp_f32 v166, v166
    v_mfma_f32_16x16x32_bf16 v[68:71], a[96:99], v[136:139], v[68:71]
    ds_read_b64_tr_b16 a[108:109], v223 offset:16384
    ds_read_b64_tr_b16 a[110:111], v223 offset:17408
    v_mfma_f32_16x16x32_bf16 v[72:75], a[96:99], v[144:147], v[72:75]
    s_waitcnt lgkmcnt(4)
    v_exp_f32 v167, v167
    v_mfma_f32_16x16x32_bf16 v[76:79], a[96:99], v[152:155], v[76:79]
    v_add_f32 v235, v235, v166
    v_add_f32 v235, v235, v167
    v_mfma_f32_16x16x32_bf16 v[80:83], a[100:103], v[128:131], v[80:83]
    v_exp_f32 v174, v174
    v_mfma_f32_16x16x32_bf16 v[84:87], a[100:103], v[136:139], v[84:87]
    ds_read_b128 a[64:67], v212 offset:32768
    ds_read_b128 a[68:71], v213 offset:32768
    v_mfma_f32_16x16x32_bf16 v[88:91], a[100:103], v[144:147], v[88:91]
    s_waitcnt lgkmcnt(4)
    v_exp_f32 v175, v175
    v_mfma_f32_16x16x32_bf16 v[92:95], a[100:103], v[152:155], v[92:95]
    v_cvt_pk_bf16_f32 v163, v166, v167
    v_cvt_pk_bf16_f32 v171, v174, v175
    v_mfma_f32_16x16x32_bf16 v[96:99], a[104:107], v[128:131], v[96:99]
    v_exp_f32 v176, v176
    v_mfma_f32_16x16x32_bf16 v[100:103], a[104:107], v[136:139], v[100:103]
    ds_read_b128 a[72:75], v214 offset:32768
    ds_read_b128 a[76:79], v215 offset:32768
    v_mfma_f32_16x16x32_bf16 v[104:107], a[104:107], v[144:147], v[104:107]
    s_waitcnt lgkmcnt(4)
    v_exp_f32 v177, v177
    v_mfma_f32_16x16x32_bf16 v[108:111], a[104:107], v[152:155], v[108:111]
    v_add_f32 v253, v253, v176
    v_add_f32 v253, v253, v177
    v_mfma_f32_16x16x32_bf16 v[112:115], a[108:111], v[128:131], v[112:115]
    v_exp_f32 v184, v184
    v_mfma_f32_16x16x32_bf16 v[116:119], a[108:111], v[136:139], v[116:119]
    ds_read_b128 a[80:83], v212 offset:33792
    v_mfma_f32_16x16x32_bf16 v[120:123], a[108:111], v[144:147], v[120:123]
    s_waitcnt lgkmcnt(4)
    v_exp_f32 v185, v185
    v_mfma_f32_16x16x32_bf16 v[124:127], a[108:111], v[152:155], v[124:127]
    v_cvt_pk_bf16_f32 v176, v176, v177
    v_cvt_pk_bf16_f32 v184, v184, v185
    v_mfma_f32_16x16x32_bf16 v[208:211], a[124:127], v[152:155], v[208:211]
    buffer_load_dwordx4 v224, s[8:11], s78 offen offset:1024 lds
    v_mfma_f32_16x16x32_bf16 v[128:131], a[64:67], a[0:3], v[192:195]
    s_waitcnt lgkmcnt(2)
    v_exp_f32 v178, v178
    v_mfma_f32_16x16x32_bf16 v[128:131], a[68:71], a[16:19], v[128:131]
    ds_read_b128 a[84:87], v213 offset:33792
    v_mfma_f32_16x16x32_bf16 v[128:131], a[72:75], a[32:35], v[128:131]
    s_waitcnt lgkmcnt(2)
    v_exp_f32 v179, v179
    v_mfma_f32_16x16x32_bf16 v[128:131], a[76:79], a[48:51], v[128:131]
    v_add_f32 v253, v253, v178
    v_add_f32 v253, v253, v179
    v_mfma_f32_16x16x32_bf16 v[136:139], a[64:67], a[4:7], v[196:199]
    v_exp_f32 v186, v186
    v_mfma_f32_16x16x32_bf16 v[136:139], a[68:71], a[20:23], v[136:139]
    ds_read_b128 a[88:91], v214 offset:33792
    v_mfma_f32_16x16x32_bf16 v[136:139], a[72:75], a[36:39], v[136:139]
    v_exp_f32 v187, v187
    v_mfma_f32_16x16x32_bf16 v[136:139], a[76:79], a[52:55], v[136:139]
    v_cvt_pk_bf16_f32 v177, v178, v179
    v_cvt_pk_bf16_f32 v185, v186, v187
    v_mfma_f32_16x16x32_bf16 v[144:147], a[64:67], a[8:11], v[200:203]
    v_exp_f32 v180, v180
    v_mfma_f32_16x16x32_bf16 v[144:147], a[68:71], a[24:27], v[144:147]
    ds_read_b128 a[92:95], v215 offset:33792
    v_mfma_f32_16x16x32_bf16 v[144:147], a[72:75], a[40:43], v[144:147]
    v_exp_f32 v181, v181
    v_mfma_f32_16x16x32_bf16 v[144:147], a[76:79], a[56:59], v[144:147]
    v_add_f32 v253, v253, v180
    v_add_f32 v253, v253, v181
    v_mfma_f32_16x16x32_bf16 v[152:155], a[64:67], a[12:15], v[204:207]
    v_exp_f32 v188, v188
    v_mfma_f32_16x16x32_bf16 v[152:155], a[68:71], a[28:31], v[152:155]
    buffer_load_dwordx4 v225, s[8:11], s78 offen offset:2048 lds
    v_mfma_f32_16x16x32_bf16 v[152:155], a[72:75], a[44:47], v[152:155]
    s_waitcnt lgkmcnt(3)
    v_exp_f32 v189, v189
    v_mfma_f32_16x16x32_bf16 v[152:155], a[76:79], a[60:63], v[152:155]
    v_cvt_pk_bf16_f32 v178, v180, v181
    v_cvt_pk_bf16_f32 v186, v188, v189
    v_mfma_f32_16x16x32_bf16 v[132:135], a[80:83], a[0:3], v[192:195]
    s_waitcnt lgkmcnt(1)
    v_exp_f32 v182, v182
    v_mfma_f32_16x16x32_bf16 v[132:135], a[84:87], a[16:19], v[132:135]
    buffer_load_dwordx4 v225, s[8:11], s78 offen offset:3072 lds
    v_mfma_f32_16x16x32_bf16 v[132:135], a[88:91], a[32:35], v[132:135]
    s_waitcnt lgkmcnt(0)
    v_exp_f32 v183, v183
    v_mfma_f32_16x16x32_bf16 v[132:135], a[92:95], a[48:51], v[132:135]
    v_add_f32 v253, v253, v182
    v_add_f32 v253, v253, v183
    v_mfma_f32_16x16x32_bf16 v[140:143], a[80:83], a[4:7], v[196:199]
    v_exp_f32 v190, v190
    v_mfma_f32_16x16x32_bf16 v[140:143], a[84:87], a[20:23], v[140:143]
    ds_read_b64_tr_b16 a[96:97], v216 offset:24576
    ds_read_b64_tr_b16 a[98:99], v216 offset:25600
    v_mfma_f32_16x16x32_bf16 v[140:143], a[88:91], a[36:39], v[140:143]
    v_exp_f32 v191, v191
    v_mfma_f32_16x16x32_bf16 v[140:143], a[92:95], a[52:55], v[140:143]
    v_cvt_pk_bf16_f32 v179, v182, v183
    v_cvt_pk_bf16_f32 v187, v190, v191
    v_mfma_f32_16x16x32_bf16 v[148:151], a[80:83], a[8:11], v[200:203]
    v_exp_f32 v128, v128
    v_mfma_f32_16x16x32_bf16 v[148:151], a[84:87], a[24:27], v[148:151]
    ds_read_b64_tr_b16 a[100:101], v217 offset:24576
    ds_read_b64_tr_b16 a[102:103], v217 offset:25600
    v_mfma_f32_16x16x32_bf16 v[148:151], a[88:91], a[40:43], v[148:151]
    v_exp_f32 v129, v129
    v_mfma_f32_16x16x32_bf16 v[148:151], a[92:95], a[56:59], v[148:151]
    v_add_f32 v235, v235, v128
    v_add_f32 v235, v235, v129
    v_mfma_f32_16x16x32_bf16 v[156:159], a[80:83], a[12:15], v[204:207]
    v_exp_f32 v136, v136
    v_mfma_f32_16x16x32_bf16 v[156:159], a[84:87], a[28:31], v[156:159]
    ds_read_b64_tr_b16 a[104:105], v218 offset:24576
    ds_read_b64_tr_b16 a[106:107], v218 offset:25600
    v_mfma_f32_16x16x32_bf16 v[156:159], a[88:91], a[44:47], v[156:159]
    s_waitcnt lgkmcnt(4)
    v_exp_f32 v137, v137
    v_mfma_f32_16x16x32_bf16 v[156:159], a[92:95], a[60:63], v[156:159]
    v_cvt_pk_bf16_f32 v128, v128, v129
    v_cvt_pk_bf16_f32 v136, v136, v137
    v_mfma_f32_16x16x32_bf16 v[0:3], a[96:99], v[160:163], v[0:3]
    v_exp_f32 v130, v130
    v_mfma_f32_16x16x32_bf16 v[4:7], a[96:99], v[168:171], v[4:7]
    ds_read_b64_tr_b16 a[108:109], v219 offset:24576
    ds_read_b64_tr_b16 a[110:111], v219 offset:25600
    v_mfma_f32_16x16x32_bf16 v[8:11], a[96:99], v[176:179], v[8:11]
    s_waitcnt lgkmcnt(4)
    v_exp_f32 v131, v131
    v_mfma_f32_16x16x32_bf16 v[12:15], a[96:99], v[184:187], v[12:15]
    v_add_f32 v235, v235, v130
    v_add_f32 v235, v235, v131
    v_mfma_f32_16x16x32_bf16 v[16:19], a[100:103], v[160:163], v[16:19]
    v_exp_f32 v138, v138
    v_mfma_f32_16x16x32_bf16 v[20:23], a[100:103], v[168:171], v[20:23]
    ds_read_b64_tr_b16 a[96:97], v220 offset:24576
    ds_read_b64_tr_b16 a[98:99], v220 offset:25600
    v_mfma_f32_16x16x32_bf16 v[24:27], a[100:103], v[176:179], v[24:27]
    s_waitcnt lgkmcnt(4)
    v_exp_f32 v139, v139
    v_mfma_f32_16x16x32_bf16 v[28:31], a[100:103], v[184:187], v[28:31]
    v_cvt_pk_bf16_f32 v129, v130, v131
    v_cvt_pk_bf16_f32 v137, v138, v139
    v_mfma_f32_16x16x32_bf16 v[32:35], a[104:107], v[160:163], v[32:35]
    v_exp_f32 v132, v132
    v_mfma_f32_16x16x32_bf16 v[36:39], a[104:107], v[168:171], v[36:39]
    ds_read_b64_tr_b16 a[100:101], v221 offset:24576
    ds_read_b64_tr_b16 a[102:103], v221 offset:25600
    v_mfma_f32_16x16x32_bf16 v[40:43], a[104:107], v[176:179], v[40:43]
    s_waitcnt lgkmcnt(4)
    v_exp_f32 v133, v133
    v_mfma_f32_16x16x32_bf16 v[44:47], a[104:107], v[184:187], v[44:47]
    v_add_f32 v235, v235, v132
    v_add_f32 v235, v235, v133
    v_mfma_f32_16x16x32_bf16 v[48:51], a[108:111], v[160:163], v[48:51]
    s_add_u32 m0, s75, 32768
    v_exp_f32 v140, v140
    v_mfma_f32_16x16x32_bf16 v[52:55], a[108:111], v[168:171], v[52:55]
    ds_read_b64_tr_b16 a[104:105], v222 offset:24576
    ds_read_b64_tr_b16 a[106:107], v222 offset:25600
    v_mfma_f32_16x16x32_bf16 v[56:59], a[108:111], v[176:179], v[56:59]
    s_waitcnt lgkmcnt(4)
    v_exp_f32 v141, v141
    v_mfma_f32_16x16x32_bf16 v[60:63], a[108:111], v[184:187], v[60:63]
    v_cvt_pk_bf16_f32 v130, v132, v133
    v_cvt_pk_bf16_f32 v138, v140, v141
    v_mfma_f32_16x16x32_bf16 v[208:211], a[116:119], v[168:171], v[208:211]
    buffer_load_dwordx4 v226, s[12:15], s78 offen lds
    v_mfma_f32_16x16x32_bf16 v[64:67], a[96:99], v[160:163], v[64:67]
    v_exp_f32 v134, v134
    v_mfma_f32_16x16x32_bf16 v[68:71], a[96:99], v[168:171], v[68:71]
    ds_read_b64_tr_b16 a[108:109], v223 offset:24576
    ds_read_b64_tr_b16 a[110:111], v223 offset:25600
    v_mfma_f32_16x16x32_bf16 v[72:75], a[96:99], v[176:179], v[72:75]
    s_waitcnt lgkmcnt(4)
    v_exp_f32 v135, v135
    v_mfma_f32_16x16x32_bf16 v[76:79], a[96:99], v[184:187], v[76:79]
    v_add_f32 v235, v235, v134
    v_add_f32 v235, v235, v135
    v_mfma_f32_16x16x32_bf16 v[80:83], a[100:103], v[160:163], v[80:83]
    v_exp_f32 v142, v142
    v_mfma_f32_16x16x32_bf16 v[84:87], a[100:103], v[168:171], v[84:87]
    ds_read_b128 a[64:67], v212 offset:40960
    ds_read_b128 a[68:71], v213 offset:40960
    v_mfma_f32_16x16x32_bf16 v[88:91], a[100:103], v[176:179], v[88:91]
    s_waitcnt lgkmcnt(4)
    v_exp_f32 v143, v143
    v_mfma_f32_16x16x32_bf16 v[92:95], a[100:103], v[184:187], v[92:95]
    v_cvt_pk_bf16_f32 v131, v134, v135
    v_cvt_pk_bf16_f32 v139, v142, v143
    v_mfma_f32_16x16x32_bf16 v[96:99], a[104:107], v[160:163], v[96:99]
    v_exp_f32 v144, v144
    v_mfma_f32_16x16x32_bf16 v[100:103], a[104:107], v[168:171], v[100:103]
    ds_read_b128 a[72:75], v214 offset:40960
    ds_read_b128 a[76:79], v215 offset:40960
    v_mfma_f32_16x16x32_bf16 v[104:107], a[104:107], v[176:179], v[104:107]
    s_waitcnt lgkmcnt(4)
    v_exp_f32 v145, v145
    v_mfma_f32_16x16x32_bf16 v[108:111], a[104:107], v[184:187], v[108:111]
    v_add_f32 v253, v253, v144
    v_add_f32 v253, v253, v145
    v_mfma_f32_16x16x32_bf16 v[112:115], a[108:111], v[160:163], v[112:115]
    v_exp_f32 v152, v152
    v_mfma_f32_16x16x32_bf16 v[116:119], a[108:111], v[168:171], v[116:119]
    ds_read_b128 a[80:83], v212 offset:41984
    v_mfma_f32_16x16x32_bf16 v[120:123], a[108:111], v[176:179], v[120:123]
    s_waitcnt lgkmcnt(4)
    v_exp_f32 v153, v153
    v_mfma_f32_16x16x32_bf16 v[124:127], a[108:111], v[184:187], v[124:127]
    v_cvt_pk_bf16_f32 v144, v144, v145
    v_cvt_pk_bf16_f32 v152, v152, v153
    v_mfma_f32_16x16x32_bf16 v[208:211], a[124:127], v[184:187], v[208:211]
    buffer_load_dwordx4 v226, s[12:15], s78 offen offset:1024 lds
    v_mfma_f32_16x16x32_bf16 v[160:163], a[64:67], a[0:3], v[192:195]
    s_waitcnt lgkmcnt(2)
    v_exp_f32 v146, v146
    v_mfma_f32_16x16x32_bf16 v[160:163], a[68:71], a[16:19], v[160:163]
    ds_read_b128 a[84:87], v213 offset:41984
    v_mfma_f32_16x16x32_bf16 v[160:163], a[72:75], a[32:35], v[160:163]
    s_waitcnt lgkmcnt(2)
    v_exp_f32 v147, v147
    v_mfma_f32_16x16x32_bf16 v[160:163], a[76:79], a[48:51], v[160:163]
    v_add_f32 v253, v253, v146
    v_add_f32 v253, v253, v147
    v_mfma_f32_16x16x32_bf16 v[168:171], a[64:67], a[4:7], v[196:199]
    v_exp_f32 v154, v154
    v_mfma_f32_16x16x32_bf16 v[168:171], a[68:71], a[20:23], v[168:171]
    ds_read_b128 a[88:91], v214 offset:41984
    v_mfma_f32_16x16x32_bf16 v[168:171], a[72:75], a[36:39], v[168:171]
    s_waitcnt vmcnt(10)
    v_exp_f32 v155, v155
    v_mfma_f32_16x16x32_bf16 v[168:171], a[76:79], a[52:55], v[168:171]
    v_cvt_pk_bf16_f32 v145, v146, v147
    v_cvt_pk_bf16_f32 v153, v154, v155
    v_mfma_f32_16x16x32_bf16 v[176:179], a[64:67], a[8:11], v[200:203]
    s_barrier
    v_exp_f32 v148, v148
    v_mfma_f32_16x16x32_bf16 v[176:179], a[68:71], a[24:27], v[176:179]
    ds_read_b128 a[92:95], v215 offset:41984
    v_mfma_f32_16x16x32_bf16 v[176:179], a[72:75], a[40:43], v[176:179]
    v_exp_f32 v149, v149
    v_mfma_f32_16x16x32_bf16 v[176:179], a[76:79], a[56:59], v[176:179]
    v_add_f32 v253, v253, v148
    v_add_f32 v253, v253, v149
    v_mfma_f32_16x16x32_bf16 v[184:187], a[64:67], a[12:15], v[204:207]
    v_exp_f32 v156, v156
    v_mfma_f32_16x16x32_bf16 v[184:187], a[68:71], a[28:31], v[184:187]
    buffer_load_dwordx4 v227, s[12:15], s78 offen offset:2048 lds
    v_mfma_f32_16x16x32_bf16 v[184:187], a[72:75], a[44:47], v[184:187]
    s_waitcnt lgkmcnt(3)
    v_exp_f32 v157, v157
    v_mfma_f32_16x16x32_bf16 v[184:187], a[76:79], a[60:63], v[184:187]
    v_cvt_pk_bf16_f32 v146, v148, v149
    v_cvt_pk_bf16_f32 v154, v156, v157
    v_mfma_f32_16x16x32_bf16 v[164:167], a[80:83], a[0:3], v[192:195]
    s_waitcnt lgkmcnt(1)
    v_exp_f32 v150, v150
    v_mfma_f32_16x16x32_bf16 v[164:167], a[84:87], a[16:19], v[164:167]
    buffer_load_dwordx4 v227, s[12:15], s78 offen offset:3072 lds
    v_mfma_f32_16x16x32_bf16 v[164:167], a[88:91], a[32:35], v[164:167]
    s_waitcnt lgkmcnt(0)
    v_exp_f32 v151, v151
    v_mfma_f32_16x16x32_bf16 v[164:167], a[92:95], a[48:51], v[164:167]
    v_add_f32 v253, v253, v150
    v_add_f32 v253, v253, v151
    v_mfma_f32_16x16x32_bf16 v[172:175], a[80:83], a[4:7], v[196:199]
    v_exp_f32 v158, v158
    v_mfma_f32_16x16x32_bf16 v[172:175], a[84:87], a[20:23], v[172:175]
    ds_read_b64_tr_b16 a[96:97], v216 offset:32768
    ds_read_b64_tr_b16 a[98:99], v216 offset:33792
    v_mfma_f32_16x16x32_bf16 v[172:175], a[88:91], a[36:39], v[172:175]
    v_exp_f32 v159, v159
    v_mfma_f32_16x16x32_bf16 v[172:175], a[92:95], a[52:55], v[172:175]
    v_cvt_pk_bf16_f32 v147, v150, v151
    v_cvt_pk_bf16_f32 v155, v158, v159
    v_mfma_f32_16x16x32_bf16 v[180:183], a[80:83], a[8:11], v[200:203]
    s_add_u32 s78, s78, 16384
    v_exp_f32 v160, v160
    v_mfma_f32_16x16x32_bf16 v[180:183], a[84:87], a[24:27], v[180:183]
    ds_read_b64_tr_b16 a[100:101], v217 offset:32768
    ds_read_b64_tr_b16 a[102:103], v217 offset:33792
    v_mfma_f32_16x16x32_bf16 v[180:183], a[88:91], a[40:43], v[180:183]
    v_exp_f32 v161, v161
    v_mfma_f32_16x16x32_bf16 v[180:183], a[92:95], a[56:59], v[180:183]
    v_add_f32 v235, v235, v160
    v_add_f32 v235, v235, v161
    v_mfma_f32_16x16x32_bf16 v[188:191], a[80:83], a[12:15], v[204:207]
    v_exp_f32 v168, v168
    v_mfma_f32_16x16x32_bf16 v[188:191], a[84:87], a[28:31], v[188:191]
    ds_read_b64_tr_b16 a[104:105], v218 offset:32768
    ds_read_b64_tr_b16 a[106:107], v218 offset:33792
    v_mfma_f32_16x16x32_bf16 v[188:191], a[88:91], a[44:47], v[188:191]
    s_waitcnt lgkmcnt(4)
    v_exp_f32 v169, v169
    v_mfma_f32_16x16x32_bf16 v[188:191], a[92:95], a[60:63], v[188:191]
    v_cvt_pk_bf16_f32 v160, v160, v161
    v_cvt_pk_bf16_f32 v168, v168, v169
    v_mfma_f32_16x16x32_bf16 v[0:3], a[96:99], v[128:131], v[0:3]
    v_exp_f32 v162, v162
    v_mfma_f32_16x16x32_bf16 v[4:7], a[96:99], v[136:139], v[4:7]
    ds_read_b64_tr_b16 a[108:109], v219 offset:32768
    ds_read_b64_tr_b16 a[110:111], v219 offset:33792
    v_mfma_f32_16x16x32_bf16 v[8:11], a[96:99], v[144:147], v[8:11]
    s_waitcnt lgkmcnt(4)
    v_exp_f32 v163, v163
    v_mfma_f32_16x16x32_bf16 v[12:15], a[96:99], v[152:155], v[12:15]
    v_add_f32 v235, v235, v162
    v_add_f32 v235, v235, v163
    v_mfma_f32_16x16x32_bf16 v[16:19], a[100:103], v[128:131], v[16:19]
    v_exp_f32 v170, v170
    v_mfma_f32_16x16x32_bf16 v[20:23], a[100:103], v[136:139], v[20:23]
    ds_read_b64_tr_b16 a[96:97], v220 offset:32768
    ds_read_b64_tr_b16 a[98:99], v220 offset:33792
    v_mfma_f32_16x16x32_bf16 v[24:27], a[100:103], v[144:147], v[24:27]
    s_waitcnt lgkmcnt(4)
    v_exp_f32 v171, v171
    v_mfma_f32_16x16x32_bf16 v[28:31], a[100:103], v[152:155], v[28:31]
    v_cvt_pk_bf16_f32 v161, v162, v163
    v_cvt_pk_bf16_f32 v169, v170, v171
    v_mfma_f32_16x16x32_bf16 v[32:35], a[104:107], v[128:131], v[32:35]
    v_exp_f32 v164, v164
    v_mfma_f32_16x16x32_bf16 v[36:39], a[104:107], v[136:139], v[36:39]
    ds_read_b64_tr_b16 a[100:101], v221 offset:32768
    ds_read_b64_tr_b16 a[102:103], v221 offset:33792
    v_mfma_f32_16x16x32_bf16 v[40:43], a[104:107], v[144:147], v[40:43]
    s_waitcnt lgkmcnt(4)
    v_exp_f32 v165, v165
    v_mfma_f32_16x16x32_bf16 v[44:47], a[104:107], v[152:155], v[44:47]
    v_add_f32 v235, v235, v164
    v_add_f32 v235, v235, v165
    v_mfma_f32_16x16x32_bf16 v[48:51], a[108:111], v[128:131], v[48:51]
    s_add_u32 m0, s75, 114688
    v_exp_f32 v172, v172
    v_mfma_f32_16x16x32_bf16 v[52:55], a[108:111], v[136:139], v[52:55]
    ds_read_b64_tr_b16 a[104:105], v222 offset:32768
    ds_read_b64_tr_b16 a[106:107], v222 offset:33792
    v_mfma_f32_16x16x32_bf16 v[56:59], a[108:111], v[144:147], v[56:59]
    s_waitcnt lgkmcnt(4)
    v_exp_f32 v173, v173
    v_mfma_f32_16x16x32_bf16 v[60:63], a[108:111], v[152:155], v[60:63]
    v_cvt_pk_bf16_f32 v162, v164, v165
    v_cvt_pk_bf16_f32 v170, v172, v173
    v_mfma_f32_16x16x32_bf16 v[208:211], a[116:119], v[136:139], v[208:211]
    buffer_load_dwordx4 v224, s[8:11], s78 offen lds
    v_mfma_f32_16x16x32_bf16 v[64:67], a[96:99], v[128:131], v[64:67]
    v_exp_f32 v166, v166
    v_mfma_f32_16x16x32_bf16 v[68:71], a[96:99], v[136:139], v[68:71]
    ds_read_b64_tr_b16 a[108:109], v223 offset:32768
    ds_read_b64_tr_b16 a[110:111], v223 offset:33792
    v_mfma_f32_16x16x32_bf16 v[72:75], a[96:99], v[144:147], v[72:75]
    s_waitcnt lgkmcnt(4)
    v_exp_f32 v167, v167
    v_mfma_f32_16x16x32_bf16 v[76:79], a[96:99], v[152:155], v[76:79]
    v_add_f32 v235, v235, v166
    v_add_f32 v235, v235, v167
    v_mfma_f32_16x16x32_bf16 v[80:83], a[100:103], v[128:131], v[80:83]
    v_exp_f32 v174, v174
    v_mfma_f32_16x16x32_bf16 v[84:87], a[100:103], v[136:139], v[84:87]
    ds_read_b128 a[64:67], v212 offset:49152
    ds_read_b128 a[68:71], v213 offset:49152
    v_mfma_f32_16x16x32_bf16 v[88:91], a[100:103], v[144:147], v[88:91]
    s_waitcnt lgkmcnt(4)
    v_exp_f32 v175, v175
    v_mfma_f32_16x16x32_bf16 v[92:95], a[100:103], v[152:155], v[92:95]
    v_cvt_pk_bf16_f32 v163, v166, v167
    v_cvt_pk_bf16_f32 v171, v174, v175
    v_mfma_f32_16x16x32_bf16 v[96:99], a[104:107], v[128:131], v[96:99]
    v_exp_f32 v176, v176
    v_mfma_f32_16x16x32_bf16 v[100:103], a[104:107], v[136:139], v[100:103]
    ds_read_b128 a[72:75], v214 offset:49152
    ds_read_b128 a[76:79], v215 offset:49152
    v_mfma_f32_16x16x32_bf16 v[104:107], a[104:107], v[144:147], v[104:107]
    s_waitcnt lgkmcnt(4)
    v_exp_f32 v177, v177
    v_mfma_f32_16x16x32_bf16 v[108:111], a[104:107], v[152:155], v[108:111]
    v_add_f32 v253, v253, v176
    v_add_f32 v253, v253, v177
    v_mfma_f32_16x16x32_bf16 v[112:115], a[108:111], v[128:131], v[112:115]
    v_exp_f32 v184, v184
    v_mfma_f32_16x16x32_bf16 v[116:119], a[108:111], v[136:139], v[116:119]
    ds_read_b128 a[80:83], v212 offset:50176
    v_mfma_f32_16x16x32_bf16 v[120:123], a[108:111], v[144:147], v[120:123]
    s_waitcnt lgkmcnt(4)
    v_exp_f32 v185, v185
    v_mfma_f32_16x16x32_bf16 v[124:127], a[108:111], v[152:155], v[124:127]
    v_cvt_pk_bf16_f32 v176, v176, v177
    v_cvt_pk_bf16_f32 v184, v184, v185
    v_mfma_f32_16x16x32_bf16 v[208:211], a[124:127], v[152:155], v[208:211]
    buffer_load_dwordx4 v224, s[8:11], s78 offen offset:1024 lds
    v_mfma_f32_16x16x32_bf16 v[128:131], a[64:67], a[0:3], v[192:195]
    s_waitcnt lgkmcnt(2)
    v_exp_f32 v178, v178
    v_mfma_f32_16x16x32_bf16 v[128:131], a[68:71], a[16:19], v[128:131]
    ds_read_b128 a[84:87], v213 offset:50176
    v_mfma_f32_16x16x32_bf16 v[128:131], a[72:75], a[32:35], v[128:131]
    s_waitcnt lgkmcnt(2)
    v_exp_f32 v179, v179
    v_mfma_f32_16x16x32_bf16 v[128:131], a[76:79], a[48:51], v[128:131]
    v_add_f32 v253, v253, v178
    v_add_f32 v253, v253, v179
    v_mfma_f32_16x16x32_bf16 v[136:139], a[64:67], a[4:7], v[196:199]
    v_exp_f32 v186, v186
    v_mfma_f32_16x16x32_bf16 v[136:139], a[68:71], a[20:23], v[136:139]
    ds_read_b128 a[88:91], v214 offset:50176
    v_mfma_f32_16x16x32_bf16 v[136:139], a[72:75], a[36:39], v[136:139]
    v_exp_f32 v187, v187
    v_mfma_f32_16x16x32_bf16 v[136:139], a[76:79], a[52:55], v[136:139]
    v_cvt_pk_bf16_f32 v177, v178, v179
    v_cvt_pk_bf16_f32 v185, v186, v187
    v_mfma_f32_16x16x32_bf16 v[144:147], a[64:67], a[8:11], v[200:203]
    v_exp_f32 v180, v180
    v_mfma_f32_16x16x32_bf16 v[144:147], a[68:71], a[24:27], v[144:147]
    ds_read_b128 a[92:95], v215 offset:50176
    v_mfma_f32_16x16x32_bf16 v[144:147], a[72:75], a[40:43], v[144:147]
    v_exp_f32 v181, v181
    v_mfma_f32_16x16x32_bf16 v[144:147], a[76:79], a[56:59], v[144:147]
    v_add_f32 v253, v253, v180
    v_add_f32 v253, v253, v181
    v_mfma_f32_16x16x32_bf16 v[152:155], a[64:67], a[12:15], v[204:207]
    v_exp_f32 v188, v188
    v_mfma_f32_16x16x32_bf16 v[152:155], a[68:71], a[28:31], v[152:155]
    buffer_load_dwordx4 v225, s[8:11], s78 offen offset:2048 lds
    v_mfma_f32_16x16x32_bf16 v[152:155], a[72:75], a[44:47], v[152:155]
    s_waitcnt lgkmcnt(3)
    v_exp_f32 v189, v189
    v_mfma_f32_16x16x32_bf16 v[152:155], a[76:79], a[60:63], v[152:155]
    v_cvt_pk_bf16_f32 v178, v180, v181
    v_cvt_pk_bf16_f32 v186, v188, v189
    v_mfma_f32_16x16x32_bf16 v[132:135], a[80:83], a[0:3], v[192:195]
    s_waitcnt lgkmcnt(1)
    v_exp_f32 v182, v182
    v_mfma_f32_16x16x32_bf16 v[132:135], a[84:87], a[16:19], v[132:135]
    buffer_load_dwordx4 v225, s[8:11], s78 offen offset:3072 lds
    v_mfma_f32_16x16x32_bf16 v[132:135], a[88:91], a[32:35], v[132:135]
    s_waitcnt lgkmcnt(0)
    v_exp_f32 v183, v183
    v_mfma_f32_16x16x32_bf16 v[132:135], a[92:95], a[48:51], v[132:135]
    v_add_f32 v253, v253, v182
    v_add_f32 v253, v253, v183
    v_mfma_f32_16x16x32_bf16 v[140:143], a[80:83], a[4:7], v[196:199]
    v_exp_f32 v190, v190
    v_mfma_f32_16x16x32_bf16 v[140:143], a[84:87], a[20:23], v[140:143]
    ds_read_b64_tr_b16 a[96:97], v216 offset:40960
    ds_read_b64_tr_b16 a[98:99], v216 offset:41984
    v_mfma_f32_16x16x32_bf16 v[140:143], a[88:91], a[36:39], v[140:143]
    v_exp_f32 v191, v191
    v_mfma_f32_16x16x32_bf16 v[140:143], a[92:95], a[52:55], v[140:143]
    v_cvt_pk_bf16_f32 v179, v182, v183
    v_cvt_pk_bf16_f32 v187, v190, v191
    v_mfma_f32_16x16x32_bf16 v[148:151], a[80:83], a[8:11], v[200:203]
    v_exp_f32 v128, v128
    v_mfma_f32_16x16x32_bf16 v[148:151], a[84:87], a[24:27], v[148:151]
    ds_read_b64_tr_b16 a[100:101], v217 offset:40960
    ds_read_b64_tr_b16 a[102:103], v217 offset:41984
    v_mfma_f32_16x16x32_bf16 v[148:151], a[88:91], a[40:43], v[148:151]
    v_exp_f32 v129, v129
    v_mfma_f32_16x16x32_bf16 v[148:151], a[92:95], a[56:59], v[148:151]
    v_add_f32 v235, v235, v128
    v_add_f32 v235, v235, v129
    v_mfma_f32_16x16x32_bf16 v[156:159], a[80:83], a[12:15], v[204:207]
    v_exp_f32 v136, v136
    v_mfma_f32_16x16x32_bf16 v[156:159], a[84:87], a[28:31], v[156:159]
    ds_read_b64_tr_b16 a[104:105], v218 offset:40960
    ds_read_b64_tr_b16 a[106:107], v218 offset:41984
    v_mfma_f32_16x16x32_bf16 v[156:159], a[88:91], a[44:47], v[156:159]
    s_waitcnt lgkmcnt(4)
    v_exp_f32 v137, v137
    v_mfma_f32_16x16x32_bf16 v[156:159], a[92:95], a[60:63], v[156:159]
    v_cvt_pk_bf16_f32 v128, v128, v129
    v_cvt_pk_bf16_f32 v136, v136, v137
    s_or_b32 s76, s79, s93
    s_cbranch_scc0 L_signal
L_signalled:
    s_add_u32 s79, s79, 1
    s_cmp_lt_u32 s79, 6
    s_cbranch_scc1 L_loop
    buffer_load_dword v252, off, s[44:47], s96 offset:4 sc1
    v_mfma_f32_16x16x32_bf16 v[0:3], a[96:99], v[160:163], v[0:3]
    s_lshl_b32 s52, s72, 1
    v_exp_f32 v130, v130
    v_mfma_f32_16x16x32_bf16 v[4:7], a[96:99], v[168:171], v[4:7]
    ds_read_b64_tr_b16 a[108:109], v219 offset:40960
    ds_read_b64_tr_b16 a[110:111], v219 offset:41984
    v_mfma_f32_16x16x32_bf16 v[8:11], a[96:99], v[176:179], v[8:11]
    s_add_u32 s52, s52, s92
    v_exp_f32 v131, v131
    v_mfma_f32_16x16x32_bf16 v[12:15], a[96:99], v[184:187], v[12:15]
    s_lshl_b32 s59, s74, 3
    v_add_f32 v235, v235, v130
    v_add_f32 v235, v235, v131
    s_waitcnt lgkmcnt(4)
    v_mfma_f32_16x16x32_bf16 v[16:19], a[100:103], v[160:163], v[16:19]
    s_add_u32 s59, s59, s52
    v_exp_f32 v138, v138
    v_mfma_f32_16x16x32_bf16 v[20:23], a[100:103], v[168:171], v[20:23]
    ds_read_b64_tr_b16 a[96:97], v220 offset:40960
    ds_read_b64_tr_b16 a[98:99], v220 offset:41984
    v_mfma_f32_16x16x32_bf16 v[24:27], a[100:103], v[176:179], v[24:27]
    s_lshl_b32 s59, s59, 3
    v_exp_f32 v139, v139
    v_mfma_f32_16x16x32_bf16 v[28:31], a[100:103], v[184:187], v[28:31]
    s_add_u32 s59, s59, s73
    v_cvt_pk_bf16_f32 v129, v130, v131
    v_cvt_pk_bf16_f32 v137, v138, v139
    s_waitcnt lgkmcnt(4)
    v_mfma_f32_16x16x32_bf16 v[32:35], a[104:107], v[160:163], v[32:35]
    s_lshl_b32 s59, s59, 13
    v_exp_f32 v132, v132
    v_mfma_f32_16x16x32_bf16 v[36:39], a[104:107], v[168:171], v[36:39]
    ds_read_b64_tr_b16 a[100:101], v221 offset:40960
    ds_read_b64_tr_b16 a[102:103], v221 offset:41984
    v_mfma_f32_16x16x32_bf16 v[40:43], a[104:107], v[176:179], v[40:43]
    s_add_u32 s59, s59, 8388608
    v_exp_f32 v133, v133
    v_mfma_f32_16x16x32_bf16 v[44:47], a[104:107], v[184:187], v[44:47]
    s_lshl_b32 s52, s52, 7
    v_add_f32 v235, v235, v132
    v_add_f32 v235, v235, v133
    s_waitcnt lgkmcnt(4)
    v_mfma_f32_16x16x32_bf16 v[48:51], a[108:111], v[160:163], v[48:51]
    s_add_u32 m0, s75, 49152
    v_exp_f32 v140, v140
    v_mfma_f32_16x16x32_bf16 v[52:55], a[108:111], v[168:171], v[52:55]
    ds_read_b64_tr_b16 a[104:105], v222 offset:40960
    ds_read_b64_tr_b16 a[106:107], v222 offset:41984
    v_mfma_f32_16x16x32_bf16 v[56:59], a[108:111], v[176:179], v[56:59]
    s_lshl_b32 s76, s80, 15
    v_exp_f32 v141, v141
    v_mfma_f32_16x16x32_bf16 v[60:63], a[108:111], v[184:187], v[60:63]
    s_add_u32 s52, s52, s76
    v_cvt_pk_bf16_f32 v130, v132, v133
    v_cvt_pk_bf16_f32 v138, v140, v141
    v_mfma_f32_16x16x32_bf16 v[208:211], a[116:119], v[168:171], v[208:211]
    buffer_load_dwordx4 v226, s[12:15], s78 offen lds
    s_waitcnt lgkmcnt(4)
    v_mfma_f32_16x16x32_bf16 v[64:67], a[96:99], v[160:163], v[64:67]
    s_add_u32 s77, s80, s92
    v_exp_f32 v134, v134
    v_mfma_f32_16x16x32_bf16 v[68:71], a[96:99], v[168:171], v[68:71]
    ds_read_b64_tr_b16 a[108:109], v223 offset:40960
    ds_read_b64_tr_b16 a[110:111], v223 offset:41984
    v_mfma_f32_16x16x32_bf16 v[72:75], a[96:99], v[176:179], v[72:75]
    s_cmp_ge_u32 s77, 14
    v_exp_f32 v135, v135
    v_mfma_f32_16x16x32_bf16 v[76:79], a[96:99], v[184:187], v[76:79]
    s_cselect_b32 s76, 14, 0
    v_add_f32 v235, v235, v134
    v_add_f32 v235, v235, v135
    s_waitcnt lgkmcnt(4)
    v_mfma_f32_16x16x32_bf16 v[80:83], a[100:103], v[160:163], v[80:83]
    s_sub_u32 s77, s77, s76
    v_exp_f32 v142, v142
    v_mfma_f32_16x16x32_bf16 v[84:87], a[100:103], v[168:171], v[84:87]
    ds_read_b128 a[64:67], v212 offset:57344
    ds_read_b128 a[68:71], v213 offset:57344
    v_mfma_f32_16x16x32_bf16 v[88:91], a[100:103], v[176:179], v[88:91]
    s_mul_i32 s54, s72, 458752
    v_exp_f32 v143, v143
    v_mfma_f32_16x16x32_bf16 v[92:95], a[100:103], v[184:187], v[92:95]
    s_lshl_b32 s76, s73, 7
    v_cvt_pk_bf16_f32 v131, v134, v135
    v_cvt_pk_bf16_f32 v139, v142, v143
    s_waitcnt lgkmcnt(4)
    v_mfma_f32_16x16x32_bf16 v[96:99], a[104:107], v[160:163], v[96:99]
    s_add_u32 s54, s54, s76
    v_exp_f32 v144, v144
    v_mfma_f32_16x16x32_bf16 v[100:103], a[104:107], v[168:171], v[100:103]
    ds_read_b128 a[72:75], v214 offset:57344
    ds_read_b128 a[76:79], v215 offset:57344
    v_mfma_f32_16x16x32_bf16 v[104:107], a[104:107], v[176:179], v[104:107]
    s_add_u32 s55, s54, 458752
    v_exp_f32 v145, v145
    v_mfma_f32_16x16x32_bf16 v[108:111], a[104:107], v[184:187], v[108:111]
    s_lshl_b32 s53, s77, 15
    v_add_f32 v253, v253, v144
    v_add_f32 v253, v253, v145
    s_waitcnt lgkmcnt(4)
    v_mfma_f32_16x16x32_bf16 v[112:115], a[108:111], v[160:163], v[112:115]
    s_add_u32 s53, s53, s54
    v_exp_f32 v152, v152
    v_mfma_f32_16x16x32_bf16 v[116:119], a[108:111], v[168:171], v[116:119]
    ds_read_b128 a[80:83], v212 offset:58368
    v_mfma_f32_16x16x32_bf16 v[120:123], a[108:111], v[176:179], v[120:123]
    s_mul_i32 s57, s74, 229376
    v_exp_f32 v153, v153
    v_mfma_f32_16x16x32_bf16 v[124:127], a[108:111], v[184:187], v[124:127]
    s_mul_i32 s76, s72, 57344
    v_cvt_pk_bf16_f32 v144, v144, v145
    v_cvt_pk_bf16_f32 v152, v152, v153
    v_mfma_f32_16x16x32_bf16 v[208:211], a[124:127], v[184:187], v[208:211]
    buffer_load_dwordx4 v226, s[12:15], s78 offen offset:1024 lds
    s_waitcnt lgkmcnt(4)
    v_mfma_f32_16x16x32_bf16 v[160:163], a[64:67], a[0:3], v[192:195]
    s_add_u32 s57, s57, s76
    v_exp_f32 v146, v146
    s_waitcnt lgkmcnt(3)
    v_mfma_f32_16x16x32_bf16 v[160:163], a[68:71], a[16:19], v[160:163]
    s_add_u32 s58, s57, 57344
    ds_read_b128 a[84:87], v213 offset:58368
    s_waitcnt lgkmcnt(3)
    v_mfma_f32_16x16x32_bf16 v[160:163], a[72:75], a[32:35], v[160:163]
    s_lshl_b32 s56, s77, 12
    v_exp_f32 v147, v147
    s_waitcnt lgkmcnt(2)
    v_mfma_f32_16x16x32_bf16 v[160:163], a[76:79], a[48:51], v[160:163]
    s_add_u32 s56, s56, s57
    v_add_f32 v253, v253, v146
    v_add_f32 v253, v253, v147
    v_mfma_f32_16x16x32_bf16 v[168:171], a[64:67], a[4:7], v[196:199]
    s_add_u32 s76, s72, 0
    v_exp_f32 v154, v154
    v_mfma_f32_16x16x32_bf16 v[168:171], a[68:71], a[20:23], v[168:171]
    s_and_b32 s76, s76, 3
    ds_read_b128 a[88:91], v214 offset:58368
    v_mfma_f32_16x16x32_bf16 v[168:171], a[72:75], a[36:39], v[168:171]
    s_waitcnt vmcnt(11)
    v_exp_f32 v155, v155
    v_mfma_f32_16x16x32_bf16 v[168:171], a[76:79], a[52:55], v[168:171]
    s_lshl_b32 s76, s76, 10
    v_cvt_pk_bf16_f32 v145, v146, v147
    v_cvt_pk_bf16_f32 v153, v154, v155
    v_mfma_f32_16x16x32_bf16 v[176:179], a[64:67], a[8:11], v[200:203]
    s_barrier
    v_exp_f32 v148, v148
    v_mfma_f32_16x16x32_bf16 v[176:179], a[68:71], a[24:27], v[176:179]
    ds_read_b128 a[92:95], v215 offset:58368
    v_mfma_f32_16x16x32_bf16 v[176:179], a[72:75], a[40:43], v[176:179]
    v_add_u32 v238, s76, v237
    v_exp_f32 v149, v149
    v_mfma_f32_16x16x32_bf16 v[176:179], a[76:79], a[56:59], v[176:179]
    s_add_u32 s76, s72, 1
    v_add_f32 v253, v253, v148
    v_add_f32 v253, v253, v149
    v_mfma_f32_16x16x32_bf16 v[184:187], a[64:67], a[12:15], v[204:207]
    s_and_b32 s76, s76, 3
    v_exp_f32 v156, v156
    v_mfma_f32_16x16x32_bf16 v[184:187], a[68:71], a[28:31], v[184:187]
    buffer_load_dwordx4 v227, s[12:15], s78 offen offset:2048 lds
    v_mfma_f32_16x16x32_bf16 v[184:187], a[72:75], a[44:47], v[184:187]
    s_lshl_b32 s76, s76, 10
    v_exp_f32 v157, v157
    v_mfma_f32_16x16x32_bf16 v[184:187], a[76:79], a[60:63], v[184:187]
    v_add_u32 v232, s76, v237
    v_cvt_pk_bf16_f32 v146, v148, v149
    v_cvt_pk_bf16_f32 v154, v156, v157
    s_waitcnt lgkmcnt(3)
    v_mfma_f32_16x16x32_bf16 v[164:167], a[80:83], a[0:3], v[192:195]
    s_add_u32 s76, s72, 2
    v_exp_f32 v150, v150
    s_waitcnt lgkmcnt(2)
    v_mfma_f32_16x16x32_bf16 v[164:167], a[84:87], a[16:19], v[164:167]
    buffer_load_dwordx4 v227, s[12:15], s78 offen offset:3072 lds
    s_waitcnt lgkmcnt(1)
    v_mfma_f32_16x16x32_bf16 v[164:167], a[88:91], a[32:35], v[164:167]
    s_and_b32 s76, s76, 3
    v_exp_f32 v151, v151
    s_waitcnt lgkmcnt(0)
    v_mfma_f32_16x16x32_bf16 v[164:167], a[92:95], a[48:51], v[164:167]
    s_lshl_b32 s76, s76, 10
    v_add_f32 v253, v253, v150
    v_add_f32 v253, v253, v151
    v_mfma_f32_16x16x32_bf16 v[172:175], a[80:83], a[4:7], v[196:199]
    v_add_u32 v233, s76, v237
    v_exp_f32 v158, v158
    v_mfma_f32_16x16x32_bf16 v[172:175], a[84:87], a[20:23], v[172:175]
    ds_read_b64_tr_b16 a[96:97], v216 offset:49152
    ds_read_b64_tr_b16 a[98:99], v216 offset:50176
    v_mfma_f32_16x16x32_bf16 v[172:175], a[88:91], a[36:39], v[172:175]
    s_add_u32 s76, s72, 3
    v_exp_f32 v159, v159
    v_mfma_f32_16x16x32_bf16 v[172:175], a[92:95], a[52:55], v[172:175]
    s_and_b32 s76, s76, 3
    v_cvt_pk_bf16_f32 v147, v150, v151
    v_cvt_pk_bf16_f32 v155, v158, v159
    v_mfma_f32_16x16x32_bf16 v[180:183], a[80:83], a[8:11], v[200:203]
    s_add_u32 s78, s78, 16384
    v_exp_f32 v160, v160
    v_mfma_f32_16x16x32_bf16 v[180:183], a[84:87], a[24:27], v[180:183]
    ds_read_b64_tr_b16 a[100:101], v217 offset:49152
    ds_read_b64_tr_b16 a[102:103], v217 offset:50176
    v_mfma_f32_16x16x32_bf16 v[180:183], a[88:91], a[40:43], v[180:183]
    s_lshl_b32 s76, s76, 10
    v_exp_f32 v161, v161
    v_mfma_f32_16x16x32_bf16 v[180:183], a[92:95], a[56:59], v[180:183]
    v_add_u32 v234, s76, v237
    v_cvt_pk_bf16_f32 v160, v160, v161
    v_mfma_f32_16x16x32_bf16 v[188:191], a[80:83], a[12:15], v[204:207]
    v_exp_f32 v162, v162
    v_mfma_f32_16x16x32_bf16 v[188:191], a[84:87], a[28:31], v[188:191]
    ds_read_b64_tr_b16 a[104:105], v218 offset:49152
    ds_read_b64_tr_b16 a[106:107], v218 offset:50176
    v_mfma_f32_16x16x32_bf16 v[188:191], a[88:91], a[44:47], v[188:191]
    s_waitcnt vmcnt(4)
    v_readfirstlane_b32 s76, v252
    s_nop 0
    s_cmp_ge_u32 s76, 8
    s_cbranch_scc0 L_spin_h
L_h_ok:
    v_exp_f32 v163, v163
    v_mfma_f32_16x16x32_bf16 v[188:191], a[92:95], a[60:63], v[188:191]
    v_cvt_pk_bf16_f32 v161, v162, v163
    s_waitcnt lgkmcnt(4)
    v_mfma_f32_16x16x32_bf16 v[0:3], a[96:99], v[128:131], v[0:3]
    v_exp_f32 v164, v164
    v_mfma_f32_16x16x32_bf16 v[4:7], a[96:99], v[136:139], v[4:7]
    ds_read_b64_tr_b16 a[108:109], v219 offset:49152
    ds_read_b64_tr_b16 a[110:111], v219 offset:50176
    v_mfma_f32_16x16x32_bf16 v[8:11], a[96:99], v[144:147], v[8:11]
    s_waitcnt lgkmcnt(4)
    v_exp_f32 v165, v165
    v_mfma_f32_16x16x32_bf16 v[12:15], a[96:99], v[152:155], v[12:15]
    v_cvt_pk_bf16_f32 v162, v164, v165
    v_mfma_f32_16x16x32_bf16 v[16:19], a[100:103], v[128:131], v[16:19]
    v_exp_f32 v166, v166
    v_mfma_f32_16x16x32_bf16 v[20:23], a[100:103], v[136:139], v[20:23]
    ds_read_b64_tr_b16 a[96:97], v220 offset:49152
    ds_read_b64_tr_b16 a[98:99], v220 offset:50176
    v_mfma_f32_16x16x32_bf16 v[24:27], a[100:103], v[144:147], v[24:27]
    s_waitcnt lgkmcnt(4)
    v_exp_f32 v167, v167
    v_mfma_f32_16x16x32_bf16 v[28:31], a[100:103], v[152:155], v[28:31]
    v_cvt_pk_bf16_f32 v163, v166, v167
    v_mfma_f32_16x16x32_bf16 v[32:35], a[104:107], v[128:131], v[32:35]
    s_and_b32 s76, s74, 15
    v_exp_f32 v168, v168
    v_mfma_f32_16x16x32_bf16 v[36:39], a[104:107], v[136:139], v[36:39]
    ds_read_b64_tr_b16 a[100:101], v221 offset:49152
    ds_read_b64_tr_b16 a[102:103], v221 offset:50176
    v_mfma_f32_16x16x32_bf16 v[40:43], a[104:107], v[144:147], v[40:43]
    s_waitcnt lgkmcnt(4)
    v_exp_f32 v169, v169
    v_mfma_f32_16x16x32_bf16 v[44:47], a[104:107], v[152:155], v[44:47]
    s_mul_i32 s76, s76, 28672
    v_cvt_pk_bf16_f32 v168, v168, v169
    v_mfma_f32_16x16x32_bf16 v[48:51], a[108:111], v[128:131], v[48:51]
    s_add_u32 s76, s76, s54
    v_exp_f32 v170, v170
    v_mfma_f32_16x16x32_bf16 v[52:55], a[108:111], v[136:139], v[52:55]
    ds_read_b64_tr_b16 a[104:105], v222 offset:49152
    ds_read_b64_tr_b16 a[106:107], v222 offset:50176
    v_mfma_f32_16x16x32_bf16 v[56:59], a[108:111], v[144:147], v[56:59]
    v_lshrrev_b32 v228, 1, v236
    v_exp_f32 v171, v171
    v_mfma_f32_16x16x32_bf16 v[60:63], a[108:111], v[152:155], v[60:63]
    v_and_b32 v229, 1, v236
    v_lshlrev_b32 v229, 6, v229
    v_lshl_add_u32 v228, v228, 10, v229
    v_cvt_pk_bf16_f32 v169, v170, v171
    v_mfma_f32_16x16x32_bf16 v[208:211], a[116:119], v[136:139], v[208:211]
    buffer_load_dword v229, v228, s[32:35], s76 offen
    s_waitcnt lgkmcnt(4)
    v_mfma_f32_16x16x32_bf16 v[64:67], a[96:99], v[128:131], v[64:67]
    v_exp_f32 v172, v172
    v_mfma_f32_16x16x32_bf16 v[68:71], a[96:99], v[136:139], v[68:71]
    ds_read_b64_tr_b16 a[108:109], v223 offset:49152
    ds_read_b64_tr_b16 a[110:111], v223 offset:50176
    v_mfma_f32_16x16x32_bf16 v[72:75], a[96:99], v[144:147], v[72:75]
    s_waitcnt lgkmcnt(4)
    v_exp_f32 v173, v173
    v_mfma_f32_16x16x32_bf16 v[76:79], a[96:99], v[152:155], v[76:79]
    v_cvt_pk_bf16_f32 v170, v172, v173
    v_mfma_f32_16x16x32_bf16 v[80:83], a[100:103], v[128:131], v[80:83]
    s_add_u32 m0, s75, 131072
    v_exp_f32 v174, v174
    v_mfma_f32_16x16x32_bf16 v[84:87], a[100:103], v[136:139], v[84:87]
    ds_read_b128 a[64:67], v212 offset:0
    ds_read_b128 a[68:71], v213 offset:0
    v_mfma_f32_16x16x32_bf16 v[88:91], a[100:103], v[144:147], v[88:91]
    s_waitcnt lgkmcnt(4)
    v_exp_f32 v175, v175
    v_mfma_f32_16x16x32_bf16 v[92:95], a[100:103], v[152:155], v[92:95]
    buffer_load_dwordx4 v224, s[8:11], s78 offen lds
    v_mfma_f32_16x16x32_bf16 v[96:99], a[104:107], v[128:131], v[96:99]
    v_exp_f32 v176, v176
    v_mfma_f32_16x16x32_bf16 v[100:103], a[104:107], v[136:139], v[100:103]
    ds_read_b128 a[72:75], v214 offset:0
    ds_read_b128 a[76:79], v215 offset:0
    v_mfma_f32_16x16x32_bf16 v[104:107], a[104:107], v[144:147], v[104:107]
    s_waitcnt lgkmcnt(4)
    v_exp_f32 v177, v177
    v_mfma_f32_16x16x32_bf16 v[108:111], a[104:107], v[152:155], v[108:111]
    buffer_load_dwordx4 v224, s[8:11], s78 offen offset:1024 lds
    v_mfma_f32_16x16x32_bf16 v[112:115], a[108:111], v[128:131], v[112:115]
    v_exp_f32 v178, v178
    v_mfma_f32_16x16x32_bf16 v[116:119], a[108:111], v[136:139], v[116:119]
    ds_read_b128 a[80:83], v212 offset:1024
    v_cvt_pk_bf16_f32 v171, v174, v175
    v_mfma_f32_16x16x32_bf16 v[120:123], a[108:111], v[144:147], v[120:123]
    s_waitcnt lgkmcnt(4)
    v_exp_f32 v179, v179
    v_mfma_f32_16x16x32_bf16 v[124:127], a[108:111], v[152:155], v[124:127]
    buffer_load_dwordx4 v225, s[8:11], s78 offen offset:2048 lds
    v_mfma_f32_16x16x32_bf16 v[208:211], a[124:127], v[152:155], v[208:211]
    v_mfma_f32_16x16x32_bf16 v[128:131], a[64:67], a[0:3], v[192:195]
    s_waitcnt lgkmcnt(2)
    v_exp_f32 v180, v180
    v_mfma_f32_16x16x32_bf16 v[128:131], a[68:71], a[16:19], v[128:131]
    ds_read_b128 a[84:87], v213 offset:1024
    v_cvt_pk_bf16_f32 v176, v176, v177
    v_mfma_f32_16x16x32_bf16 v[128:131], a[72:75], a[32:35], v[128:131]
    s_waitcnt lgkmcnt(2)
    v_exp_f32 v181, v181
    v_mfma_f32_16x16x32_bf16 v[128:131], a[76:79], a[48:51], v[128:131]
    buffer_load_dwordx4 v225, s[8:11], s78 offen offset:3072 lds
    v_mfma_f32_16x16x32_bf16 v[136:139], a[64:67], a[4:7], v[196:199]
    s_add_u32 m0, s75, 65536
    v_exp_f32 v182, v182
    v_mfma_f32_16x16x32_bf16 v[136:139], a[68:71], a[20:23], v[136:139]
    ds_read_b128 a[88:91], v214 offset:1024
    v_cvt_pk_bf16_f32 v177, v178, v179
    v_mfma_f32_16x16x32_bf16 v[136:139], a[72:75], a[36:39], v[136:139]
    v_exp_f32 v183, v183
    v_mfma_f32_16x16x32_bf16 v[136:139], a[76:79], a[52:55], v[136:139]
    buffer_load_dwordx4 v226, s[12:15], s78 offen lds
    v_mfma_f32_16x16x32_bf16 v[144:147], a[64:67], a[8:11], v[200:203]
    v_exp_f32 v184, v184
    v_mfma_f32_16x16x32_bf16 v[144:147], a[68:71], a[24:27], v[144:147]
    ds_read_b128 a[92:95], v215 offset:1024
    v_cvt_pk_bf16_f32 v178, v180, v181
    v_mfma_f32_16x16x32_bf16 v[144:147], a[72:75], a[40:43], v[144:147]
    v_exp_f32 v185, v185
    v_mfma_f32_16x16x32_bf16 v[144:147], a[76:79], a[56:59], v[144:147]
    buffer_load_dwordx4 v226, s[12:15], s78 offen offset:1024 lds
    v_mfma_f32_16x16x32_bf16 v[152:155], a[64:67], a[12:15], v[204:207]
    v_exp_f32 v186, v186
    v_mfma_f32_16x16x32_bf16 v[152:155], a[68:71], a[28:31], v[152:155]
    v_cvt_pk_bf16_f32 v179, v182, v183
    v_cvt_pk_bf16_f32 v184, v184, v185
    v_mfma_f32_16x16x32_bf16 v[152:155], a[72:75], a[44:47], v[152:155]
    s_waitcnt lgkmcnt(3)
    v_exp_f32 v187, v187
    v_mfma_f32_16x16x32_bf16 v[152:155], a[76:79], a[60:63], v[152:155]
    buffer_load_dwordx4 v227, s[12:15], s78 offen offset:2048 lds
    v_mfma_f32_16x16x32_bf16 v[132:135], a[80:83], a[0:3], v[192:195]
    s_waitcnt lgkmcnt(1)
    v_exp_f32 v188, v188
    v_mfma_f32_16x16x32_bf16 v[132:135], a[84:87], a[16:19], v[132:135]
    v_cvt_pk_bf16_f32 v185, v186, v187
    v_mfma_f32_16x16x32_bf16 v[132:135], a[88:91], a[32:35], v[132:135]
    s_waitcnt lgkmcnt(0)
    v_exp_f32 v189, v189
    v_mfma_f32_16x16x32_bf16 v[132:135], a[92:95], a[48:51], v[132:135]
    buffer_load_dwordx4 v227, s[12:15], s78 offen offset:3072 lds
    v_mfma_f32_16x16x32_bf16 v[140:143], a[80:83], a[4:7], v[196:199]
    v_exp_f32 v190, v190
    v_mfma_f32_16x16x32_bf16 v[140:143], a[84:87], a[20:23], v[140:143]
    ds_read_b64_tr_b16 a[96:97], v216 offset:57344
    ds_read_b64_tr_b16 a[98:99], v216 offset:58368
    v_mfma_f32_16x16x32_bf16 v[140:143], a[88:91], a[36:39], v[140:143]
    v_exp_f32 v191, v191
    v_mfma_f32_16x16x32_bf16 v[140:143], a[92:95], a[52:55], v[140:143]
    v_cvt_pk_bf16_f32 v186, v188, v189
    v_cvt_pk_bf16_f32 v187, v190, v191
    v_mfma_f32_16x16x32_bf16 v[148:151], a[80:83], a[8:11], v[200:203]
    s_add_u32 s78, s78, 16384
    v_exp_f32 v128, v128
    v_mfma_f32_16x16x32_bf16 v[148:151], a[84:87], a[24:27], v[148:151]
    ds_read_b64_tr_b16 a[100:101], v217 offset:57344
    ds_read_b64_tr_b16 a[102:103], v217 offset:58368
    v_mfma_f32_16x16x32_bf16 v[148:151], a[88:91], a[40:43], v[148:151]
    v_exp_f32 v129, v129
    v_mfma_f32_16x16x32_bf16 v[148:151], a[92:95], a[56:59], v[148:151]
    v_cvt_pk_bf16_f32 v128, v128, v129
    v_mfma_f32_16x16x32_bf16 v[156:159], a[80:83], a[12:15], v[204:207]
    v_exp_f32 v130, v130
    v_mfma_f32_16x16x32_bf16 v[156:159], a[84:87], a[28:31], v[156:159]
    ds_read_b64_tr_b16 a[104:105], v218 offset:57344
    ds_read_b64_tr_b16 a[106:107], v218 offset:58368
    v_mfma_f32_16x16x32_bf16 v[156:159], a[88:91], a[44:47], v[156:159]
    s_waitcnt lgkmcnt(4)
    v_exp_f32 v131, v131
    v_mfma_f32_16x16x32_bf16 v[156:159], a[92:95], a[60:63], v[156:159]
    v_cvt_pk_bf16_f32 v129, v130, v131
    v_mfma_f32_16x16x32_bf16 v[0:3], a[96:99], v[160:163], v[0:3]
    v_exp_f32 v132, v132
    v_mfma_f32_16x16x32_bf16 v[4:7], a[96:99], v[168:171], v[4:7]
    ds_read_b64_tr_b16 a[108:109], v219 offset:57344
    ds_read_b64_tr_b16 a[110:111], v219 offset:58368
    v_mfma_f32_16x16x32_bf16 v[8:11], a[96:99], v[176:179], v[8:11]
    s_waitcnt lgkmcnt(4)
    v_exp_f32 v133, v133
    v_mfma_f32_16x16x32_bf16 v[12:15], a[96:99], v[184:187], v[12:15]
    v_cvt_pk_bf16_f32 v130, v132, v133
    v_mfma_f32_16x16x32_bf16 v[16:19], a[100:103], v[160:163], v[16:19]
    v_exp_f32 v134, v134
    v_mfma_f32_16x16x32_bf16 v[20:23], a[100:103], v[168:171], v[20:23]
    ds_read_b64_tr_b16 a[96:97], v220 offset:57344
    ds_read_b64_tr_b16 a[98:99], v220 offset:58368
    v_mfma_f32_16x16x32_bf16 v[24:27], a[100:103], v[176:179], v[24:27]
    s_waitcnt lgkmcnt(4)
    v_exp_f32 v135, v135
    v_mfma_f32_16x16x32_bf16 v[28:31], a[100:103], v[184:187], v[28:31]
    v_cvt_pk_bf16_f32 v131, v134, v135
    v_mfma_f32_16x16x32_bf16 v[208:211], a[112:115], v[160:163], v[208:211]
    buffer_load_dwordx4 a[128:131], v238, s[40:43], s56 offen sc1
    v_mfma_f32_16x16x32_bf16 v[32:35], a[104:107], v[160:163], v[32:35]
    v_exp_f32 v136, v136
    v_mfma_f32_16x16x32_bf16 v[36:39], a[104:107], v[168:171], v[36:39]
    ds_read_b64_tr_b16 a[100:101], v221 offset:57344
    ds_read_b64_tr_b16 a[102:103], v221 offset:58368
    v_mfma_f32_16x16x32_bf16 v[40:43], a[104:107], v[176:179], v[40:43]
    s_waitcnt lgkmcnt(4)
    v_exp_f32 v137, v137
    v_mfma_f32_16x16x32_bf16 v[44:47], a[104:107], v[184:187], v[44:47]
    v_cvt_pk_bf16_f32 v136, v136, v137
    v_mfma_f32_16x16x32_bf16 v[48:51], a[108:111], v[160:163], v[48:51]
    v_exp_f32 v138, v138
    v_mfma_f32_16x16x32_bf16 v[52:55], a[108:111], v[168:171], v[52:55]
    ds_read_b64_tr_b16 a[104:105], v222 offset:57344
    ds_read_b64_tr_b16 a[106:107], v222 offset:58368
    v_mfma_f32_16x16x32_bf16 v[56:59], a[108:111], v[176:179], v[56:59]
    s_waitcnt lgkmcnt(4)
    v_exp_f32 v139, v139
    v_mfma_f32_16x16x32_bf16 v[60:63], a[108:111], v[184:187], v[60:63]
    v_cvt_pk_bf16_f32 v137, v138, v139
    v_mfma_f32_16x16x32_bf16 v[208:211], a[116:119], v[168:171], v[208:211]
    buffer_load_dwordx4 a[132:135], v232, s[40:43], s56 offen sc1
    v_mfma_f32_16x16x32_bf16 v[64:67], a[96:99], v[160:163], v[64:67]
    v_exp_f32 v140, v140
    v_mfma_f32_16x16x32_bf16 v[68:71], a[96:99], v[168:171], v[68:71]
    ds_read_b64_tr_b16 a[108:109], v223 offset:57344
    ds_read_b64_tr_b16 a[110:111], v223 offset:58368
    v_mfma_f32_16x16x32_bf16 v[72:75], a[96:99], v[176:179], v[72:75]
    s_waitcnt lgkmcnt(4)
    v_exp_f32 v141, v141
    v_mfma_f32_16x16x32_bf16 v[76:79], a[96:99], v[184:187], v[76:79]
    v_cvt_pk_bf16_f32 v138, v140, v141
    v_mfma_f32_16x16x32_bf16 v[80:83], a[100:103], v[160:163], v[80:83]
    v_exp_f32 v142, v142
    v_mfma_f32_16x16x32_bf16 v[84:87], a[100:103], v[168:171], v[84:87]
    ds_read_b128 a[64:67], v212 offset:8192
    ds_read_b128 a[68:71], v213 offset:8192
    v_mfma_f32_16x16x32_bf16 v[88:91], a[100:103], v[176:179], v[88:91]
    s_waitcnt lgkmcnt(4)
    v_exp_f32 v143, v143
    v_mfma_f32_16x16x32_bf16 v[92:95], a[100:103], v[184:187], v[92:95]
    v_cvt_pk_bf16_f32 v139, v142, v143
    v_mfma_f32_16x16x32_bf16 v[208:211], a[120:123], v[176:179], v[208:211]
    buffer_load_dwordx4 a[136:139], v233, s[40:43], s56 offen sc1
    v_mfma_f32_16x16x32_bf16 v[96:99], a[104:107], v[160:163], v[96:99]
    v_exp_f32 v144, v144
    v_mfma_f32_16x16x32_bf16 v[100:103], a[104:107], v[168:171], v[100:103]
    ds_read_b128 a[72:75], v214 offset:8192
    ds_read_b128 a[76:79], v215 offset:8192
    v_mfma_f32_16x16x32_bf16 v[104:107], a[104:107], v[176:179], v[104:107]
    s_waitcnt lgkmcnt(4)
    v_exp_f32 v145, v145
    v_mfma_f32_16x16x32_bf16 v[108:111], a[104:107], v[184:187], v[108:111]
    v_cvt_pk_bf16_f32 v144, v144, v145
    v_mfma_f32_16x16x32_bf16 v[112:115], a[108:111], v[160:163], v[112:115]
    v_exp_f32 v146, v146
    v_mfma_f32_16x16x32_bf16 v[116:119], a[108:111], v[168:171], v[116:119]
    ds_read_b128 a[80:83], v212 offset:9216
    v_mfma_f32_16x16x32_bf16 v[120:123], a[108:111], v[176:179], v[120:123]
    s_waitcnt lgkmcnt(4)
    v_exp_f32 v147, v147
    v_mfma_f32_16x16x32_bf16 v[124:127], a[108:111], v[184:187], v[124:127]
    v_cvt_pk_bf16_f32 v145, v146, v147
    v_mfma_f32_16x16x32_bf16 v[208:211], a[124:127], v[184:187], v[208:211]
    buffer_load_dwordx4 a[140:143], v234, s[40:43], s56 offen sc1
    v_mfma_f32_16x16x32_bf16 v[160:163], a[64:67], a[0:3], v[192:195]
    s_waitcnt lgkmcnt(2)
    v_exp_f32 v148, v148
    v_mfma_f32_16x16x32_bf16 v[160:163], a[68:71], a[16:19], v[160:163]
    ds_read_b128 a[84:87], v213 offset:9216
    v_mfma_f32_16x16x32_bf16 v[160:163], a[72:75], a[32:35], v[160:163]
    s_waitcnt lgkmcnt(2)
    v_exp_f32 v149, v149
    v_mfma_f32_16x16x32_bf16 v[160:163], a[76:79], a[48:51], v[160:163]
    v_cvt_pk_bf16_f32 v146, v148, v149
    v_mfma_f32_16x16x32_bf16 v[168:171], a[64:67], a[4:7], v[196:199]
    v_exp_f32 v150, v150
    v_mfma_f32_16x16x32_bf16 v[168:171], a[68:71], a[20:23], v[168:171]
    ds_read_b128 a[88:91], v214 offset:9216
    v_mfma_f32_16x16x32_bf16 v[168:171], a[72:75], a[36:39], v[168:171]
    v_exp_f32 v151, v151
    v_mfma_f32_16x16x32_bf16 v[168:171], a[76:79], a[52:55], v[168:171]
    v_cvt_pk_bf16_f32 v147, v150, v151
    v_mfma_f32_16x16x32_bf16 v[176:179], a[64:67], a[8:11], v[200:203]
    s_barrier
    v_exp_f32 v152, v152
    v_mfma_f32_16x16x32_bf16 v[176:179], a[68:71], a[24:27], v[176:179]
    ds_read_b128 a[92:95], v215 offset:9216
    v_mfma_f32_16x16x32_bf16 v[176:179], a[72:75], a[40:43], v[176:179]
    v_exp_f32 v153, v153
    v_mfma_f32_16x16x32_bf16 v[176:179], a[76:79], a[56:59], v[176:179]
    v_cvt_pk_bf16_f32 v152, v152, v153
    v_mfma_f32_16x16x32_bf16 v[184:187], a[64:67], a[12:15], v[204:207]
    v_exp_f32 v154, v154
    v_mfma_f32_16x16x32_bf16 v[184:187], a[68:71], a[28:31], v[184:187]
    v_mfma_f32_16x16x32_bf16 v[184:187], a[72:75], a[44:47], v[184:187]
    s_waitcnt lgkmcnt(3)
    v_exp_f32 v155, v155
    v_mfma_f32_16x16x32_bf16 v[184:187], a[76:79], a[60:63], v[184:187]
    v_cvt_pk_bf16_f32 v153, v154, v155
    v_mfma_f32_16x16x32_bf16 v[164:167], a[80:83], a[0:3], v[192:195]
    s_waitcnt lgkmcnt(1)
    v_exp_f32 v156, v156
    v_mfma_f32_16x16x32_bf16 v[164:167], a[84:87], a[16:19], v[164:167]
    v_mfma_f32_16x16x32_bf16 v[164:167], a[88:91], a[32:35], v[164:167]
    s_waitcnt lgkmcnt(0)
    v_exp_f32 v157, v157
    v_mfma_f32_16x16x32_bf16 v[164:167], a[92:95], a[48:51], v[164:167]
    v_cvt_pk_bf16_f32 v154, v156, v157
    v_mfma_f32_16x16x32_bf16 v[172:175], a[80:83], a[4:7], v[196:199]
    v_exp_f32 v158, v158
    v_mfma_f32_16x16x32_bf16 v[172:175], a[84:87], a[20:23], v[172:175]
    ds_read_b64_tr_b16 a[96:97], v216 offset:0
    ds_read_b64_tr_b16 a[98:99], v216 offset:1024
    v_mfma_f32_16x16x32_bf16 v[172:175], a[88:91], a[36:39], v[172:175]
    v_exp_f32 v159, v159
    v_mfma_f32_16x16x32_bf16 v[172:175], a[92:95], a[52:55], v[172:175]
    v_cvt_pk_bf16_f32 v155, v158, v159
    v_mfma_f32_16x16x32_bf16 v[180:183], a[80:83], a[8:11], v[200:203]
    v_exp_f32 v160, v160
    v_mfma_f32_16x16x32_bf16 v[180:183], a[84:87], a[24:27], v[180:183]
    ds_read_b64_tr_b16 a[100:101], v217 offset:0
    ds_read_b64_tr_b16 a[102:103], v217 offset:1024
    v_mfma_f32_16x16x32_bf16 v[180:183], a[88:91], a[40:43], v[180:183]
    v_exp_f32 v161, v161
    v_mfma_f32_16x16x32_bf16 v[180:183], a[92:95], a[56:59], v[180:183]
    v_cvt_pk_bf16_f32 v160, v160, v161
    v_mfma_f32_16x16x32_bf16 v[188:191], a[80:83], a[12:15], v[204:207]
    v_exp_f32 v162, v162
    v_mfma_f32_16x16x32_bf16 v[188:191], a[84:87], a[28:31], v[188:191]
    ds_read_b64_tr_b16 a[104:105], v218 offset:0
    ds_read_b64_tr_b16 a[106:107], v218 offset:1024
    v_mfma_f32_16x16x32_bf16 v[188:191], a[88:91], a[44:47], v[188:191]
    s_waitcnt lgkmcnt(4)
    v_exp_f32 v163, v163
    v_mfma_f32_16x16x32_bf16 v[188:191], a[92:95], a[60:63], v[188:191]
    v_cvt_pk_bf16_f32 v161, v162, v163
    v_mfma_f32_16x16x32_bf16 v[0:3], a[96:99], v[128:131], v[0:3]
    s_add_u32 s56, s56, 4096
    v_exp_f32 v164, v164
    v_mfma_f32_16x16x32_bf16 v[4:7], a[96:99], v[136:139], v[4:7]
    ds_read_b64_tr_b16 a[108:109], v219 offset:0
    ds_read_b64_tr_b16 a[110:111], v219 offset:1024
    v_mfma_f32_16x16x32_bf16 v[8:11], a[96:99], v[144:147], v[8:11]
    s_waitcnt lgkmcnt(4)
    v_exp_f32 v165, v165
    v_mfma_f32_16x16x32_bf16 v[12:15], a[96:99], v[152:155], v[12:15]
    s_cmp_lt_u32 s56, s58
    v_cvt_pk_bf16_f32 v162, v164, v165
    v_mfma_f32_16x16x32_bf16 v[16:19], a[100:103], v[128:131], v[16:19]
    s_cselect_b32 s56, s56, s57
    v_exp_f32 v166, v166
    v_mfma_f32_16x16x32_bf16 v[20:23], a[100:103], v[136:139], v[20:23]
    ds_read_b64_tr_b16 a[96:97], v220 offset:0
    ds_read_b64_tr_b16 a[98:99], v220 offset:1024
    v_mfma_f32_16x16x32_bf16 v[24:27], a[100:103], v[144:147], v[24:27]
    s_waitcnt lgkmcnt(4)
    v_exp_f32 v167, v167
    v_mfma_f32_16x16x32_bf16 v[28:31], a[100:103], v[152:155], v[28:31]
    v_cvt_pk_bf16_f32 v163, v166, v167
    v_mfma_f32_16x16x32_bf16 v[208:211], a[112:115], v[128:131], v[208:211]
    buffer_load_dwordx4 a[144:147], v238, s[40:43], s56 offen sc1
    v_mfma_f32_16x16x32_bf16 v[32:35], a[104:107], v[128:131], v[32:35]
    v_exp_f32 v168, v168
    v_mfma_f32_16x16x32_bf16 v[36:39], a[104:107], v[136:139], v[36:39]
    ds_read_b64_tr_b16 a[100:101], v221 offset:0
    ds_read_b64_tr_b16 a[102:103], v221 offset:1024
    v_mfma_f32_16x16x32_bf16 v[40:43], a[104:107], v[144:147], v[40:43]
    s_waitcnt lgkmcnt(4)
    v_exp_f32 v169, v169
    v_mfma_f32_16x16x32_bf16 v[44:47], a[104:107], v[152:155], v[44:47]
    v_cvt_pk_bf16_f32 v168, v168, v169
    v_mfma_f32_16x16x32_bf16 v[48:51], a[108:111], v[128:131], v[48:51]
    v_exp_f32 v170, v170
    v_mfma_f32_16x16x32_bf16 v[52:55], a[108:111], v[136:139], v[52:55]
    ds_read_b64_tr_b16 a[104:105], v222 offset:0
    ds_read_b64_tr_b16 a[106:107], v222 offset:1024
    v_mfma_f32_16x16x32_bf16 v[56:59], a[108:111], v[144:147], v[56:59]
    s_waitcnt lgkmcnt(4)
    v_exp_f32 v171, v171
    v_mfma_f32_16x16x32_bf16 v[60:63], a[108:111], v[152:155], v[60:63]
    v_cvt_pk_bf16_f32 v169, v170, v171
    v_mfma_f32_16x16x32_bf16 v[208:211], a[116:119], v[136:139], v[208:211]
    buffer_load_dwordx4 a[148:151], v232, s[40:43], s56 offen sc1
    v_mfma_f32_16x16x32_bf16 v[64:67], a[96:99], v[128:131], v[64:67]
    v_exp_f32 v172, v172
    v_mfma_f32_16x16x32_bf16 v[68:71], a[96:99], v[136:139], v[68:71]
    ds_read_b64_tr_b16 a[108:109], v223 offset:0
    ds_read_b64_tr_b16 a[110:111], v223 offset:1024
    v_mfma_f32_16x16x32_bf16 v[72:75], a[96:99], v[144:147], v[72:75]
    s_waitcnt lgkmcnt(4)
    v_exp_f32 v173, v173
    v_mfma_f32_16x16x32_bf16 v[76:79], a[96:99], v[152:155], v[76:79]
    v_cvt_pk_bf16_f32 v170, v172, v173
    v_mfma_f32_16x16x32_bf16 v[80:83], a[100:103], v[128:131], v[80:83]
    s_add_u32 m0, s75, 147456
    v_exp_f32 v174, v174
    v_mfma_f32_16x16x32_bf16 v[84:87], a[100:103], v[136:139], v[84:87]
    ds_read_b128 a[64:67], v212 offset:16384
    ds_read_b128 a[68:71], v213 offset:16384
    v_mfma_f32_16x16x32_bf16 v[88:91], a[100:103], v[144:147], v[88:91]
    s_waitcnt lgkmcnt(4)
    v_exp_f32 v175, v175
    v_mfma_f32_16x16x32_bf16 v[92:95], a[100:103], v[152:155], v[92:95]
    buffer_load_dwordx4 v224, s[8:11], s78 offen lds
    v_mfma_f32_16x16x32_bf16 v[208:211], a[120:123], v[144:147], v[208:211]
    v_mfma_f32_16x16x32_bf16 v[96:99], a[104:107], v[128:131], v[96:99]
    v_exp_f32 v176, v176
    v_mfma_f32_16x16x32_bf16 v[100:103], a[104:107], v[136:139], v[100:103]
    ds_read_b128 a[72:75], v214 offset:16384
    ds_read_b128 a[76:79], v215 offset:16384
    v_mfma_f32_16x16x32_bf16 v[104:107], a[104:107], v[144:147], v[104:107]
    s_waitcnt lgkmcnt(4)
    v_exp_f32 v177, v177
    v_mfma_f32_16x16x32_bf16 v[108:111], a[104:107], v[152:155], v[108:111]
    buffer_load_dwordx4 v224, s[8:11], s78 offen offset:1024 lds
    v_mfma_f32_16x16x32_bf16 v[112:115], a[108:111], v[128:131], v[112:115]
    v_exp_f32 v178, v178
    v_mfma_f32_16x16x32_bf16 v[116:119], a[108:111], v[136:139], v[116:119]
    ds_read_b128 a[80:83], v212 offset:17408
    v_cvt_pk_bf16_f32 v171, v174, v175
    v_mfma_f32_16x16x32_bf16 v[120:123], a[108:111], v[144:147], v[120:123]
    s_waitcnt lgkmcnt(4)
    v_exp_f32 v179, v179
    v_mfma_f32_16x16x32_bf16 v[124:127], a[108:111], v[152:155], v[124:127]
    buffer_load_dwordx4 v225, s[8:11], s78 offen offset:2048 lds
    v_mfma_f32_16x16x32_bf16 v[208:211], a[124:127], v[152:155], v[208:211]
    v_mfma_f32_16x16x32_bf16 v[128:131], a[64:67], a[0:3], v[192:195]
    s_waitcnt lgkmcnt(2)
    v_exp_f32 v180, v180
    v_mfma_f32_16x16x32_bf16 v[128:131], a[68:71], a[16:19], v[128:131]
    ds_read_b128 a[84:87], v213 offset:17408
    v_cvt_pk_bf16_f32 v176, v176, v177
    v_mfma_f32_16x16x32_bf16 v[128:131], a[72:75], a[32:35], v[128:131]
    s_waitcnt lgkmcnt(2)
    v_exp_f32 v181, v181
    v_mfma_f32_16x16x32_bf16 v[128:131], a[76:79], a[48:51], v[128:131]
    buffer_load_dwordx4 v225, s[8:11], s78 offen offset:3072 lds
    v_mfma_f32_16x16x32_bf16 v[136:139], a[64:67], a[4:7], v[196:199]
    s_add_u32 m0, s75, 81920
    v_exp_f32 v182, v182
    v_mfma_f32_16x16x32_bf16 v[136:139], a[68:71], a[20:23], v[136:139]
    ds_read_b128 a[88:91], v214 offset:17408
    v_cvt_pk_bf16_f32 v177, v178, v179
    v_mfma_f32_16x16x32_bf16 v[136:139], a[72:75], a[36:39], v[136:139]
    v_exp_f32 v183, v183
    v_mfma_f32_16x16x32_bf16 v[136:139], a[76:79], a[52:55], v[136:139]
    buffer_load_dwordx4 v226, s[12:15], s78 offen lds
    v_mfma_f32_16x16x32_bf16 v[144:147], a[64:67], a[8:11], v[200:203]
    v_exp_f32 v184, v184
    v_mfma_f32_16x16x32_bf16 v[144:147], a[68:71], a[24:27], v[144:147]
    ds_read_b128 a[92:95], v215 offset:17408
    v_cvt_pk_bf16_f32 v178, v180, v181
    v_mfma_f32_16x16x32_bf16 v[144:147], a[72:75], a[40:43], v[144:147]
    v_exp_f32 v185, v185
    v_mfma_f32_16x16x32_bf16 v[144:147], a[76:79], a[56:59], v[144:147]
    buffer_load_dwordx4 v226, s[12:15], s78 offen offset:1024 lds
    v_mfma_f32_16x16x32_bf16 v[152:155], a[64:67], a[12:15], v[204:207]
    v_exp_f32 v186, v186
    v_mfma_f32_16x16x32_bf16 v[152:155], a[68:71], a[28:31], v[152:155]
    v_cvt_pk_bf16_f32 v179, v182, v183
    v_cvt_pk_bf16_f32 v184, v184, v185
    v_mfma_f32_16x16x32_bf16 v[152:155], a[72:75], a[44:47], v[152:155]
    s_waitcnt lgkmcnt(3)
    v_exp_f32 v187, v187
    v_mfma_f32_16x16x32_bf16 v[152:155], a[76:79], a[60:63], v[152:155]
    buffer_load_dwordx4 v227, s[12:15], s78 offen offset:2048 lds
    v_mfma_f32_16x16x32_bf16 v[132:135], a[80:83], a[0:3], v[192:195]
    s_waitcnt lgkmcnt(1)
    v_exp_f32 v188, v188
    v_mfma_f32_16x16x32_bf16 v[132:135], a[84:87], a[16:19], v[132:135]
    v_cvt_pk_bf16_f32 v185, v186, v187
    v_mfma_f32_16x16x32_bf16 v[132:135], a[88:91], a[32:35], v[132:135]
    s_waitcnt lgkmcnt(0)
    v_exp_f32 v189, v189
    v_mfma_f32_16x16x32_bf16 v[132:135], a[92:95], a[48:51], v[132:135]
    buffer_load_dwordx4 v227, s[12:15], s78 offen offset:3072 lds
    v_mfma_f32_16x16x32_bf16 v[140:143], a[80:83], a[4:7], v[196:199]
    v_exp_f32 v190, v190
    v_mfma_f32_16x16x32_bf16 v[140:143], a[84:87], a[20:23], v[140:143]
    ds_read_b64_tr_b16 a[96:97], v216 offset:8192
    ds_read_b64_tr_b16 a[98:99], v216 offset:9216
    v_mfma_f32_16x16x32_bf16 v[140:143], a[88:91], a[36:39], v[140:143]
    v_exp_f32 v191, v191
    v_mfma_f32_16x16x32_bf16 v[140:143], a[92:95], a[52:55], v[140:143]
    v_cvt_pk_bf16_f32 v186, v188, v189
    v_cvt_pk_bf16_f32 v187, v190, v191
    v_mfma_f32_16x16x32_bf16 v[148:151], a[80:83], a[8:11], v[200:203]
    s_add_u32 s78, s78, 16384
    v_exp_f32 v128, v128
    v_mfma_f32_16x16x32_bf16 v[148:151], a[84:87], a[24:27], v[148:151]
    ds_read_b64_tr_b16 a[100:101], v217 offset:8192
    ds_read_b64_tr_b16 a[102:103], v217 offset:9216
    v_mfma_f32_16x16x32_bf16 v[148:151], a[88:91], a[40:43], v[148:151]
    v_exp_f32 v129, v129
    v_mfma_f32_16x16x32_bf16 v[148:151], a[92:95], a[56:59], v[148:151]
    v_cvt_pk_bf16_f32 v128, v128, v129
    v_mfma_f32_16x16x32_bf16 v[156:159], a[80:83], a[12:15], v[204:207]
    v_exp_f32 v130, v130
    v_mfma_f32_16x16x32_bf16 v[156:159], a[84:87], a[28:31], v[156:159]
    ds_read_b64_tr_b16 a[104:105], v218 offset:8192
    ds_read_b64_tr_b16 a[106:107], v218 offset:9216
    v_mfma_f32_16x16x32_bf16 v[156:159], a[88:91], a[44:47], v[156:159]
    s_waitcnt lgkmcnt(4)
    v_exp_f32 v131, v131
    v_mfma_f32_16x16x32_bf16 v[156:159], a[92:95], a[60:63], v[156:159]
    v_cvt_pk_bf16_f32 v129, v130, v131
    v_mfma_f32_16x16x32_bf16 v[0:3], a[96:99], v[160:163], v[0:3]
    v_exp_f32 v132, v132
    v_mfma_f32_16x16x32_bf16 v[4:7], a[96:99], v[168:171], v[4:7]
    ds_read_b64_tr_b16 a[108:109], v219 offset:8192
    ds_read_b64_tr_b16 a[110:111], v219 offset:9216
    v_mfma_f32_16x16x32_bf16 v[8:11], a[96:99], v[176:179], v[8:11]
    s_waitcnt lgkmcnt(4)
    v_exp_f32 v133, v133
    v_mfma_f32_16x16x32_bf16 v[12:15], a[96:99], v[184:187], v[12:15]
    v_cvt_pk_bf16_f32 v130, v132, v133
    v_mov_b32 v230, v235
    v_mfma_f32_16x16x32_bf16 v[16:19], a[100:103], v[160:163], v[16:19]
    v_exp_f32 v134, v134
    v_mfma_f32_16x16x32_bf16 v[20:23], a[100:103], v[168:171], v[20:23]
    ds_read_b64_tr_b16 a[96:97], v220 offset:8192
    ds_read_b64_tr_b16 a[98:99], v220 offset:9216
    v_mfma_f32_16x16x32_bf16 v[24:27], a[100:103], v[176:179], v[24:27]
    s_waitcnt lgkmcnt(4)
    v_exp_f32 v135, v135
    v_mfma_f32_16x16x32_bf16 v[28:31], a[100:103], v[184:187], v[28:31]
    v_cvt_pk_bf16_f32 v131, v134, v135
    v_mov_b32 v231, v253
    v_mfma_f32_16x16x32_bf16 v[208:211], a[112:115], v[160:163], v[208:211]
    buffer_load_dwordx4 a[152:155], v233, s[40:43], s56 offen sc1
    v_mfma_f32_16x16x32_bf16 v[32:35], a[104:107], v[160:163], v[32:35]
    v_exp_f32 v136, v136
    v_mfma_f32_16x16x32_bf16 v[36:39], a[104:107], v[168:171], v[36:39]
    ds_read_b64_tr_b16 a[100:101], v221 offset:8192
    ds_read_b64_tr_b16 a[102:103], v221 offset:9216
    v_mfma_f32_16x16x32_bf16 v[40:43], a[104:107], v[176:179], v[40:43]
    s_waitcnt lgkmcnt(4)
    v_exp_f32 v137, v137
    v_mfma_f32_16x16x32_bf16 v[44:47], a[104:107], v[184:187], v[44:47]
    v_cvt_pk_bf16_f32 v136, v136, v137
    s_nop 0
    v_mfma_f32_16x16x32_bf16 v[48:51], a[108:111], v[160:163], v[48:51]
    v_exp_f32 v138, v138
    v_mfma_f32_16x16x32_bf16 v[52:55], a[108:111], v[168:171], v[52:55]
    ds_read_b64_tr_b16 a[104:105], v222 offset:8192
    ds_read_b64_tr_b16 a[106:107], v222 offset:9216
    v_mfma_f32_16x16x32_bf16 v[56:59], a[108:111], v[176:179], v[56:59]
    s_waitcnt lgkmcnt(4)
    v_exp_f32 v139, v139
    v_mfma_f32_16x16x32_bf16 v[60:63], a[108:111], v[184:187], v[60:63]
    v_cvt_pk_bf16_f32 v137, v138, v139
    v_permlane32_swap_b32 v230, v235
    v_mfma_f32_16x16x32_bf16 v[208:211], a[116:119], v[168:171], v[208:211]
    buffer_load_dwordx4 a[156:159], v234, s[40:43], s56 offen sc1
    v_mfma_f32_16x16x32_bf16 v[64:67], a[96:99], v[160:163], v[64:67]
    s_add_u32 s56, s56, 4096
    v_exp_f32 v140, v140
    v_mfma_f32_16x16x32_bf16 v[68:71], a[96:99], v[168:171], v[68:71]
    ds_read_b64_tr_b16 a[108:109], v223 offset:8192
    ds_read_b64_tr_b16 a[110:111], v223 offset:9216
    v_mfma_f32_16x16x32_bf16 v[72:75], a[96:99], v[176:179], v[72:75]
    s_waitcnt lgkmcnt(4)
    v_exp_f32 v141, v141
    v_mfma_f32_16x16x32_bf16 v[76:79], a[96:99], v[184:187], v[76:79]
    s_cmp_lt_u32 s56, s58
    v_cvt_pk_bf16_f32 v138, v140, v141
    v_permlane32_swap_b32 v231, v253
    v_mfma_f32_16x16x32_bf16 v[80:83], a[100:103], v[160:163], v[80:83]
    s_cselect_b32 s56, s56, s57
    v_exp_f32 v142, v142
    v_mfma_f32_16x16x32_bf16 v[84:87], a[100:103], v[168:171], v[84:87]
    ds_read_b128 a[64:67], v212 offset:24576
    ds_read_b128 a[68:71], v213 offset:24576
    v_mfma_f32_16x16x32_bf16 v[88:91], a[100:103], v[176:179], v[88:91]
    s_waitcnt lgkmcnt(4)
    v_exp_f32 v143, v143
    v_mfma_f32_16x16x32_bf16 v[92:95], a[100:103], v[184:187], v[92:95]
    v_cvt_pk_bf16_f32 v139, v142, v143
    v_add_f32 v235, v230, v235
    v_mfma_f32_16x16x32_bf16 v[208:211], a[120:123], v[176:179], v[208:211]
    buffer_load_dwordx4 a[160:163], v238, s[40:43], s56 offen sc1
    v_mfma_f32_16x16x32_bf16 v[96:99], a[104:107], v[160:163], v[96:99]
    v_exp_f32 v144, v144
    v_mfma_f32_16x16x32_bf16 v[100:103], a[104:107], v[168:171], v[100:103]
    ds_read_b128 a[72:75], v214 offset:24576
    ds_read_b128 a[76:79], v215 offset:24576
    v_mfma_f32_16x16x32_bf16 v[104:107], a[104:107], v[176:179], v[104:107]
    s_waitcnt lgkmcnt(4)
    v_exp_f32 v145, v145
    v_mfma_f32_16x16x32_bf16 v[108:111], a[104:107], v[184:187], v[108:111]
    v_cvt_pk_bf16_f32 v144, v144, v145
    v_add_f32 v253, v231, v253
    v_mfma_f32_16x16x32_bf16 v[112:115], a[108:111], v[160:163], v[112:115]
    v_exp_f32 v146, v146
    v_mfma_f32_16x16x32_bf16 v[116:119], a[108:111], v[168:171], v[116:119]
    ds_read_b128 a[80:83], v212 offset:25600
    v_mov_b32 v230, v235
    v_mfma_f32_16x16x32_bf16 v[120:123], a[108:111], v[176:179], v[120:123]
    s_waitcnt lgkmcnt(4)
    v_exp_f32 v147, v147
    v_mfma_f32_16x16x32_bf16 v[124:127], a[108:111], v[184:187], v[124:127]
    v_cvt_pk_bf16_f32 v145, v146, v147
    v_mov_b32 v231, v253
    v_mfma_f32_16x16x32_bf16 v[208:211], a[124:127], v[184:187], v[208:211]
    buffer_load_dwordx4 a[164:167], v232, s[40:43], s56 offen sc1
    v_mfma_f32_16x16x32_bf16 v[160:163], a[64:67], a[0:3], v[192:195]
    s_waitcnt lgkmcnt(2)
    v_exp_f32 v148, v148
    v_mfma_f32_16x16x32_bf16 v[160:163], a[68:71], a[16:19], v[160:163]
    ds_read_b128 a[84:87], v213 offset:25600
    s_nop 0
    v_mfma_f32_16x16x32_bf16 v[160:163], a[72:75], a[32:35], v[160:163]
    s_waitcnt lgkmcnt(2)
    v_exp_f32 v149, v149
    v_mfma_f32_16x16x32_bf16 v[160:163], a[76:79], a[48:51], v[160:163]
    v_cvt_pk_bf16_f32 v146, v148, v149
    v_permlane16_swap_b32 v230, v235
    v_mfma_f32_16x16x32_bf16 v[168:171], a[64:67], a[4:7], v[196:199]
    v_exp_f32 v150, v150
    v_mfma_f32_16x16x32_bf16 v[168:171], a[68:71], a[20:23], v[168:171]
    ds_read_b128 a[88:91], v214 offset:25600
    v_permlane16_swap_b32 v231, v253
    v_mfma_f32_16x16x32_bf16 v[168:171], a[72:75], a[36:39], v[168:171]
    s_waitcnt vmcnt(22)
    v_exp_f32 v151, v151
    v_mfma_f32_16x16x32_bf16 v[168:171], a[76:79], a[52:55], v[168:171]
    v_cvt_pk_bf16_f32 v147, v150, v151
    v_add_f32 v235, v230, v235
    v_mfma_f32_16x16x32_bf16 v[176:179], a[64:67], a[8:11], v[200:203]
    s_barrier
    v_exp_f32 v152, v152
    v_mfma_f32_16x16x32_bf16 v[176:179], a[68:71], a[24:27], v[176:179]
    ds_read_b128 a[92:95], v215 offset:25600
    v_add_f32 v253, v231, v253
    v_mfma_f32_16x16x32_bf16 v[176:179], a[72:75], a[40:43], v[176:179]
    v_exp_f32 v153, v153
    v_mfma_f32_16x16x32_bf16 v[176:179], a[76:79], a[56:59], v[176:179]
    v_cvt_pk_bf16_f32 v152, v152, v153
    v_mfma_f32_16x16x32_bf16 v[184:187], a[64:67], a[12:15], v[204:207]
    v_exp_f32 v154, v154
    v_mfma_f32_16x16x32_bf16 v[184:187], a[68:71], a[28:31], v[184:187]
    v_mfma_f32_16x16x32_bf16 v[184:187], a[72:75], a[44:47], v[184:187]
    s_waitcnt lgkmcnt(3)
    v_exp_f32 v155, v155
    v_mfma_f32_16x16x32_bf16 v[184:187], a[76:79], a[60:63], v[184:187]
    v_cvt_pk_bf16_f32 v153, v154, v155
    v_mfma_f32_16x16x32_bf16 v[164:167], a[80:83], a[0:3], v[192:195]
    s_waitcnt lgkmcnt(1)
    v_exp_f32 v156, v156
    v_mfma_f32_16x16x32_bf16 v[164:167], a[84:87], a[16:19], v[164:167]
    v_mfma_f32_16x16x32_bf16 v[164:167], a[88:91], a[32:35], v[164:167]
    s_waitcnt lgkmcnt(0)
    v_exp_f32 v157, v157
    v_mfma_f32_16x16x32_bf16 v[164:167], a[92:95], a[48:51], v[164:167]
    v_cvt_pk_bf16_f32 v154, v156, v157
    v_mfma_f32_16x16x32_bf16 v[172:175], a[80:83], a[4:7], v[196:199]
    v_exp_f32 v158, v158
    v_mfma_f32_16x16x32_bf16 v[172:175], a[84:87], a[20:23], v[172:175]
    ds_read_b64_tr_b16 a[96:97], v216 offset:16384
    ds_read_b64_tr_b16 a[98:99], v216 offset:17408
    v_mfma_f32_16x16x32_bf16 v[172:175], a[88:91], a[36:39], v[172:175]
    v_exp_f32 v159, v159
    v_mfma_f32_16x16x32_bf16 v[172:175], a[92:95], a[52:55], v[172:175]
    v_cvt_pk_bf16_f32 v155, v158, v159
    v_mfma_f32_16x16x32_bf16 v[180:183], a[80:83], a[8:11], v[200:203]
    v_exp_f32 v160, v160
    v_mfma_f32_16x16x32_bf16 v[180:183], a[84:87], a[24:27], v[180:183]
    ds_read_b64_tr_b16 a[100:101], v217 offset:16384
    ds_read_b64_tr_b16 a[102:103], v217 offset:17408
    v_mfma_f32_16x16x32_bf16 v[180:183], a[88:91], a[40:43], v[180:183]
    v_exp_f32 v161, v161
    v_mfma_f32_16x16x32_bf16 v[180:183], a[92:95], a[56:59], v[180:183]
    v_cvt_pk_bf16_f32 v160, v160, v161
    v_mfma_f32_16x16x32_bf16 v[188:191], a[80:83], a[12:15], v[204:207]
    v_exp_f32 v162, v162
    v_mfma_f32_16x16x32_bf16 v[188:191], a[84:87], a[28:31], v[188:191]
    ds_read_b64_tr_b16 a[104:105], v218 offset:16384
    ds_read_b64_tr_b16 a[106:107], v218 offset:17408
    v_mfma_f32_16x16x32_bf16 v[188:191], a[88:91], a[44:47], v[188:191]
    s_waitcnt lgkmcnt(4)
    v_exp_f32 v163, v163
    v_mfma_f32_16x16x32_bf16 v[188:191], a[92:95], a[60:63], v[188:191]
    v_cvt_pk_bf16_f32 v161, v162, v163
    v_mfma_f32_16x16x32_bf16 v[0:3], a[96:99], v[128:131], v[0:3]
    v_exp_f32 v164, v164
    v_mfma_f32_16x16x32_bf16 v[4:7], a[96:99], v[136:139], v[4:7]
    ds_read_b64_tr_b16 a[108:109], v219 offset:16384
    ds_read_b64_tr_b16 a[110:111], v219 offset:17408
    v_mfma_f32_16x16x32_bf16 v[8:11], a[96:99], v[144:147], v[8:11]
    s_waitcnt lgkmcnt(4)
    v_exp_f32 v165, v165
    v_mfma_f32_16x16x32_bf16 v[12:15], a[96:99], v[152:155], v[12:15]
    v_cvt_pk_bf16_f32 v162, v164, v165
    v_mfma_f32_16x16x32_bf16 v[16:19], a[100:103], v[128:131], v[16:19]
    v_exp_f32 v166, v166
    v_mfma_f32_16x16x32_bf16 v[20:23], a[100:103], v[136:139], v[20:23]
    ds_read_b64_tr_b16 a[96:97], v220 offset:16384
    ds_read_b64_tr_b16 a[98:99], v220 offset:17408
    v_mfma_f32_16x16x32_bf16 v[24:27], a[100:103], v[144:147], v[24:27]
    s_waitcnt lgkmcnt(4)
    v_exp_f32 v167, v167
    v_mfma_f32_16x16x32_bf16 v[28:31], a[100:103], v[152:155], v[28:31]
    v_cvt_pk_bf16_f32 v163, v166, v167
    v_mfma_f32_16x16x32_bf16 v[208:211], a[112:115], v[128:131], v[208:211]
    buffer_load_dwordx4 a[168:171], v233, s[40:43], s56 offen sc1
    v_mfma_f32_16x16x32_bf16 v[32:35], a[104:107], v[128:131], v[32:35]
    v_exp_f32 v168, v168
    v_mfma_f32_16x16x32_bf16 v[36:39], a[104:107], v[136:139], v[36:39]
    ds_read_b64_tr_b16 a[100:101], v221 offset:16384
    ds_read_b64_tr_b16 a[102:103], v221 offset:17408
    v_mfma_f32_16x16x32_bf16 v[40:43], a[104:107], v[144:147], v[40:43]
    s_waitcnt lgkmcnt(4)
    v_exp_f32 v169, v169
    v_mfma_f32_16x16x32_bf16 v[44:47], a[104:107], v[152:155], v[44:47]
    v_cvt_pk_bf16_f32 v168, v168, v169
    v_mfma_f32_16x16x32_bf16 v[48:51], a[108:111], v[128:131], v[48:51]
    v_exp_f32 v170, v170
    v_mfma_f32_16x16x32_bf16 v[52:55], a[108:111], v[136:139], v[52:55]
    ds_read_b64_tr_b16 a[104:105], v222 offset:16384
    ds_read_b64_tr_b16 a[106:107], v222 offset:17408
    v_mfma_f32_16x16x32_bf16 v[56:59], a[108:111], v[144:147], v[56:59]
    s_waitcnt lgkmcnt(4)
    v_exp_f32 v171, v171
    v_mfma_f32_16x16x32_bf16 v[60:63], a[108:111], v[152:155], v[60:63]
    v_cvt_pk_bf16_f32 v169, v170, v171
    v_mfma_f32_16x16x32_bf16 v[208:211], a[116:119], v[136:139], v[208:211]
    buffer_load_dwordx4 a[172:175], v234, s[40:43], s56 offen sc1
    v_mfma_f32_16x16x32_bf16 v[64:67], a[96:99], v[128:131], v[64:67]
    v_exp_f32 v172, v172
    v_mfma_f32_16x16x32_bf16 v[68:71], a[96:99], v[136:139], v[68:71]
    ds_read_b64_tr_b16 a[108:109], v223 offset:16384
    ds_read_b64_tr_b16 a[110:111], v223 offset:17408
    v_mfma_f32_16x16x32_bf16 v[72:75], a[96:99], v[144:147], v[72:75]
    s_waitcnt lgkmcnt(4)
    v_exp_f32 v173, v173
    v_mfma_f32_16x16x32_bf16 v[76:79], a[96:99], v[152:155], v[76:79]
    v_cvt_pk_bf16_f32 v170, v172, v173
    v_mfma_f32_16x16x32_bf16 v[80:83], a[100:103], v[128:131], v[80:83]
    s_add_u32 m0, s75, 98304
    v_exp_f32 v174, v174
    v_mfma_f32_16x16x32_bf16 v[84:87], a[100:103], v[136:139], v[84:87]
    ds_read_b128 a[64:67], v212 offset:32768
    ds_read_b128 a[68:71], v213 offset:32768
    v_mfma_f32_16x16x32_bf16 v[88:91], a[100:103], v[144:147], v[88:91]
    s_waitcnt lgkmcnt(4)
    v_exp_f32 v175, v175
    v_mfma_f32_16x16x32_bf16 v[92:95], a[100:103], v[152:155], v[92:95]
    buffer_load_dwordx4 v224, s[8:11], s78 offen lds
    v_mfma_f32_16x16x32_bf16 v[208:211], a[120:123], v[144:147], v[208:211]
    v_mfma_f32_16x16x32_bf16 v[96:99], a[104:107], v[128:131], v[96:99]
    v_exp_f32 v176, v176
    v_mfma_f32_16x16x32_bf16 v[100:103], a[104:107], v[136:139], v[100:103]
    ds_read_b128 a[72:75], v214 offset:32768
    ds_read_b128 a[76:79], v215 offset:32768
    v_mfma_f32_16x16x32_bf16 v[104:107], a[104:107], v[144:147], v[104:107]
    s_waitcnt lgkmcnt(4)
    v_exp_f32 v177, v177
    v_mfma_f32_16x16x32_bf16 v[108:111], a[104:107], v[152:155], v[108:111]
    buffer_load_dwordx4 v224, s[8:11], s78 offen offset:1024 lds
    v_mfma_f32_16x16x32_bf16 v[112:115], a[108:111], v[128:131], v[112:115]
    v_exp_f32 v178, v178
    v_mfma_f32_16x16x32_bf16 v[116:119], a[108:111], v[136:139], v[116:119]
    ds_read_b128 a[80:83], v212 offset:33792
    v_cvt_pk_bf16_f32 v171, v174, v175
    v_mfma_f32_16x16x32_bf16 v[120:123], a[108:111], v[144:147], v[120:123]
    s_waitcnt lgkmcnt(4)
    v_exp_f32 v179, v179
    v_mfma_f32_16x16x32_bf16 v[124:127], a[108:111], v[152:155], v[124:127]
    buffer_load_dwordx4 v225, s[8:11], s78 offen offset:2048 lds
    v_mfma_f32_16x16x32_bf16 v[208:211], a[124:127], v[152:155], v[208:211]
    v_mfma_f32_16x16x32_bf16 v[128:131], a[64:67], a[0:3], v[192:195]
    s_waitcnt lgkmcnt(2)
    v_exp_f32 v180, v180
    v_mfma_f32_16x16x32_bf16 v[128:131], a[68:71], a[16:19], v[128:131]
    ds_read_b128 a[84:87], v213 offset:33792
    v_cvt_pk_bf16_f32 v176, v176, v177
    v_mfma_f32_16x16x32_bf16 v[128:131], a[72:75], a[32:35], v[128:131]
    s_waitcnt lgkmcnt(2)
    v_exp_f32 v181, v181
    v_mfma_f32_16x16x32_bf16 v[128:131], a[76:79], a[48:51], v[128:131]
    buffer_load_dwordx4 v225, s[8:11], s78 offen offset:3072 lds
    v_mfma_f32_16x16x32_bf16 v[136:139], a[64:67], a[4:7], v[196:199]
    s_add_u32 m0, s75, 32768
    v_exp_f32 v182, v182
    v_mfma_f32_16x16x32_bf16 v[136:139], a[68:71], a[20:23], v[136:139]
    ds_read_b128 a[88:91], v214 offset:33792
    v_cvt_pk_bf16_f32 v177, v178, v179
    v_mfma_f32_16x16x32_bf16 v[136:139], a[72:75], a[36:39], v[136:139]
    v_exp_f32 v183, v183
    v_mfma_f32_16x16x32_bf16 v[136:139], a[76:79], a[52:55], v[136:139]
    buffer_load_dwordx4 v226, s[12:15], s78 offen lds
    v_mfma_f32_16x16x32_bf16 v[144:147], a[64:67], a[8:11], v[200:203]
    v_exp_f32 v184, v184
    v_mfma_f32_16x16x32_bf16 v[144:147], a[68:71], a[24:27], v[144:147]
    ds_read_b128 a[92:95], v215 offset:33792
    v_cvt_pk_bf16_f32 v178, v180, v181
    v_mfma_f32_16x16x32_bf16 v[144:147], a[72:75], a[40:43], v[144:147]
    v_exp_f32 v185, v185
    v_mfma_f32_16x16x32_bf16 v[144:147], a[76:79], a[56:59], v[144:147]
    buffer_load_dwordx4 v226, s[12:15], s78 offen offset:1024 lds
    v_mfma_f32_16x16x32_bf16 v[152:155], a[64:67], a[12:15], v[204:207]
    v_exp_f32 v186, v186
    v_mfma_f32_16x16x32_bf16 v[152:155], a[68:71], a[28:31], v[152:155]
    v_cvt_pk_bf16_f32 v179, v182, v183
    v_cvt_pk_bf16_f32 v184, v184, v185
    v_mfma_f32_16x16x32_bf16 v[152:155], a[72:75], a[44:47], v[152:155]
    s_waitcnt lgkmcnt(3)
    v_exp_f32 v187, v187
    v_mfma_f32_16x16x32_bf16 v[152:155], a[76:79], a[60:63], v[152:155]
    buffer_load_dwordx4 v227, s[12:15], s78 offen offset:2048 lds
    v_mfma_f32_16x16x32_bf16 v[132:135], a[80:83], a[0:3], v[192:195]
    s_waitcnt lgkmcnt(1)
    v_exp_f32 v188, v188
    v_mfma_f32_16x16x32_bf16 v[132:135], a[84:87], a[16:19], v[132:135]
    v_cvt_pk_bf16_f32 v185, v186, v187
    v_mfma_f32_16x16x32_bf16 v[132:135], a[88:91], a[32:35], v[132:135]
    s_waitcnt lgkmcnt(0)
    v_exp_f32 v189, v189
    v_mfma_f32_16x16x32_bf16 v[132:135], a[92:95], a[48:51], v[132:135]
    buffer_load_dwordx4 v227, s[12:15], s78 offen offset:3072 lds
    v_mfma_f32_16x16x32_bf16 v[140:143], a[80:83], a[4:7], v[196:199]
    v_exp_f32 v190, v190
    v_mfma_f32_16x16x32_bf16 v[140:143], a[84:87], a[20:23], v[140:143]
    ds_read_b64_tr_b16 a[96:97], v216 offset:24576
    ds_read_b64_tr_b16 a[98:99], v216 offset:25600
    v_mfma_f32_16x16x32_bf16 v[140:143], a[88:91], a[36:39], v[140:143]
    v_exp_f32 v191, v191
    v_mfma_f32_16x16x32_bf16 v[140:143], a[92:95], a[52:55], v[140:143]
    v_cvt_pk_bf16_f32 v186, v188, v189
    v_cvt_pk_bf16_f32 v187, v190, v191
    v_mfma_f32_16x16x32_bf16 v[148:151], a[80:83], a[8:11], v[200:203]
    s_add_u32 s78, s78, 16384
    v_exp_f32 v128, v128
    v_mfma_f32_16x16x32_bf16 v[148:151], a[84:87], a[24:27], v[148:151]
    ds_read_b64_tr_b16 a[100:101], v217 offset:24576
    ds_read_b64_tr_b16 a[102:103], v217 offset:25600
    v_mfma_f32_16x16x32_bf16 v[148:151], a[88:91], a[40:43], v[148:151]
    v_exp_f32 v129, v129
    v_mfma_f32_16x16x32_bf16 v[148:151], a[92:95], a[56:59], v[148:151]
    v_cvt_pk_bf16_f32 v128, v128, v129
    v_mfma_f32_16x16x32_bf16 v[156:159], a[80:83], a[12:15], v[204:207]
    v_exp_f32 v130, v130
    v_mfma_f32_16x16x32_bf16 v[156:159], a[84:87], a[28:31], v[156:159]
    ds_read_b64_tr_b16 a[104:105], v218 offset:24576
    ds_read_b64_tr_b16 a[106:107], v218 offset:25600
    v_mfma_f32_16x16x32_bf16 v[156:159], a[88:91], a[44:47], v[156:159]
    s_waitcnt lgkmcnt(4)
    v_exp_f32 v131, v131
    v_mfma_f32_16x16x32_bf16 v[156:159], a[92:95], a[60:63], v[156:159]
    v_cvt_pk_bf16_f32 v129, v130, v131
    v_mfma_f32_16x16x32_bf16 v[0:3], a[96:99], v[160:163], v[0:3]
    s_add_u32 s56, s56, 4096
    v_exp_f32 v132, v132
    v_mfma_f32_16x16x32_bf16 v[4:7], a[96:99], v[168:171], v[4:7]
    ds_read_b64_tr_b16 a[108:109], v219 offset:24576
    ds_read_b64_tr_b16 a[110:111], v219 offset:25600
    v_mfma_f32_16x16x32_bf16 v[8:11], a[96:99], v[176:179], v[8:11]
    s_waitcnt lgkmcnt(4)
    v_exp_f32 v133, v133
    v_mfma_f32_16x16x32_bf16 v[12:15], a[96:99], v[184:187], v[12:15]
    s_cmp_lt_u32 s56, s58
    v_cvt_pk_bf16_f32 v130, v132, v133
    v_mfma_f32_16x16x32_bf16 v[16:19], a[100:103], v[160:163], v[16:19]
    s_cselect_b32 s56, s56, s57
    v_exp_f32 v134, v134
    v_mfma_f32_16x16x32_bf16 v[20:23], a[100:103], v[168:171], v[20:23]
    ds_read_b64_tr_b16 a[96:97], v220 offset:24576
    ds_read_b64_tr_b16 a[98:99], v220 offset:25600
    v_mfma_f32_16x16x32_bf16 v[24:27], a[100:103], v[176:179], v[24:27]
    s_waitcnt lgkmcnt(4)
    v_exp_f32 v135, v135
    v_mfma_f32_16x16x32_bf16 v[28:31], a[100:103], v[184:187], v[28:31]
    v_cvt_pk_bf16_f32 v131, v134, v135
    v_mfma_f32_16x16x32_bf16 v[208:211], a[112:115], v[160:163], v[208:211]
    buffer_load_dwordx4 a[176:179], v238, s[40:43], s56 offen sc1
    v_mfma_f32_16x16x32_bf16 v[32:35], a[104:107], v[160:163], v[32:35]
    v_exp_f32 v136, v136
    v_mfma_f32_16x16x32_bf16 v[36:39], a[104:107], v[168:171], v[36:39]
    ds_read_b64_tr_b16 a[100:101], v221 offset:24576
    ds_read_b64_tr_b16 a[102:103], v221 offset:25600
    v_mfma_f32_16x16x32_bf16 v[40:43], a[104:107], v[176:179], v[40:43]
    s_waitcnt lgkmcnt(4)
    v_exp_f32 v137, v137
    v_mfma_f32_16x16x32_bf16 v[44:47], a[104:107], v[184:187], v[44:47]
    v_cvt_pk_bf16_f32 v136, v136, v137
    v_mfma_f32_16x16x32_bf16 v[48:51], a[108:111], v[160:163], v[48:51]
    v_exp_f32 v138, v138
    v_mfma_f32_16x16x32_bf16 v[52:55], a[108:111], v[168:171], v[52:55]
    ds_read_b64_tr_b16 a[104:105], v222 offset:24576
    ds_read_b64_tr_b16 a[106:107], v222 offset:25600
    v_mfma_f32_16x16x32_bf16 v[56:59], a[108:111], v[176:179], v[56:59]
    s_waitcnt lgkmcnt(4)
    v_exp_f32 v139, v139
    v_mfma_f32_16x16x32_bf16 v[60:63], a[108:111], v[184:187], v[60:63]
    v_cvt_pk_bf16_f32 v137, v138, v139
    v_mfma_f32_16x16x32_bf16 v[208:211], a[116:119], v[168:171], v[208:211]
    buffer_load_dwordx4 a[180:183], v232, s[40:43], s56 offen sc1
    v_mfma_f32_16x16x32_bf16 v[64:67], a[96:99], v[160:163], v[64:67]
    v_exp_f32 v140, v140
    v_mfma_f32_16x16x32_bf16 v[68:71], a[96:99], v[168:171], v[68:71]
    ds_read_b64_tr_b16 a[108:109], v223 offset:24576
    ds_read_b64_tr_b16 a[110:111], v223 offset:25600
    v_mfma_f32_16x16x32_bf16 v[72:75], a[96:99], v[176:179], v[72:75]
    s_waitcnt lgkmcnt(4)
    v_exp_f32 v141, v141
    v_mfma_f32_16x16x32_bf16 v[76:79], a[96:99], v[184:187], v[76:79]
    v_cvt_pk_bf16_f32 v138, v140, v141
    v_mfma_f32_16x16x32_bf16 v[80:83], a[100:103], v[160:163], v[80:83]
    v_exp_f32 v142, v142
    v_mfma_f32_16x16x32_bf16 v[84:87], a[100:103], v[168:171], v[84:87]
    ds_read_b128 a[64:67], v212 offset:40960
    ds_read_b128 a[68:71], v213 offset:40960
    v_mfma_f32_16x16x32_bf16 v[88:91], a[100:103], v[176:179], v[88:91]
    s_waitcnt lgkmcnt(4)
    v_exp_f32 v143, v143
    v_mfma_f32_16x16x32_bf16 v[92:95], a[100:103], v[184:187], v[92:95]
    v_cvt_pk_bf16_f32 v139, v142, v143
    v_mfma_f32_16x16x32_bf16 v[208:211], a[120:123], v[176:179], v[208:211]
    buffer_load_dwordx4 a[184:187], v233, s[40:43], s56 offen sc1
    v_mfma_f32_16x16x32_bf16 v[96:99], a[104:107], v[160:163], v[96:99]
    v_exp_f32 v144, v144
    v_mfma_f32_16x16x32_bf16 v[100:103], a[104:107], v[168:171], v[100:103]
    ds_read_b128 a[72:75], v214 offset:40960
    ds_read_b128 a[76:79], v215 offset:40960
    v_mfma_f32_16x16x32_bf16 v[104:107], a[104:107], v[176:179], v[104:107]
    s_waitcnt lgkmcnt(4)
    v_exp_f32 v145, v145
    v_mfma_f32_16x16x32_bf16 v[108:111], a[104:107], v[184:187], v[108:111]
    v_cvt_pk_bf16_f32 v144, v144, v145
    v_mfma_f32_16x16x32_bf16 v[112:115], a[108:111], v[160:163], v[112:115]
    v_exp_f32 v146, v146
    v_mfma_f32_16x16x32_bf16 v[116:119], a[108:111], v[168:171], v[116:119]
    ds_read_b128 a[80:83], v212 offset:41984
    v_mfma_f32_16x16x32_bf16 v[120:123], a[108:111], v[176:179], v[120:123]
    s_waitcnt lgkmcnt(4)
    v_exp_f32 v147, v147
    v_mfma_f32_16x16x32_bf16 v[124:127], a[108:111], v[184:187], v[124:127]
    v_cvt_pk_bf16_f32 v145, v146, v147
    v_mfma_f32_16x16x32_bf16 v[208:211], a[124:127], v[184:187], v[208:211]
    v_mfma_f32_16x16x32_bf16 v[160:163], a[64:67], a[0:3], v[192:195]
    s_waitcnt lgkmcnt(2)
    v_exp_f32 v148, v148
    v_mfma_f32_16x16x32_bf16 v[160:163], a[68:71], a[16:19], v[160:163]
    ds_read_b128 a[84:87], v213 offset:41984
    v_mfma_f32_16x16x32_bf16 v[160:163], a[72:75], a[32:35], v[160:163]
    s_waitcnt lgkmcnt(2)
    v_exp_f32 v149, v149
    v_mfma_f32_16x16x32_bf16 v[160:163], a[76:79], a[48:51], v[160:163]
    v_cvt_pk_bf16_f32 v146, v148, v149
    v_mfma_f32_16x16x32_bf16 v[168:171], a[64:67], a[4:7], v[196:199]
    v_exp_f32 v150, v150
    v_mfma_f32_16x16x32_bf16 v[168:171], a[68:71], a[20:23], v[168:171]
    ds_read_b128 a[88:91], v214 offset:41984
    v_mfma_f32_16x16x32_bf16 v[168:171], a[72:75], a[36:39], v[168:171]
    s_waitcnt vmcnt(21)
    v_exp_f32 v151, v151
    v_mfma_f32_16x16x32_bf16 v[168:171], a[76:79], a[52:55], v[168:171]
    v_cvt_pk_bf16_f32 v147, v150, v151
    v_mfma_f32_16x16x32_bf16 v[176:179], a[64:67], a[8:11], v[200:203]
    s_barrier
    v_exp_f32 v152, v152
    v_mfma_f32_16x16x32_bf16 v[176:179], a[68:71], a[24:27], v[176:179]
    ds_read_b128 a[92:95], v215 offset:41984
    v_mfma_f32_16x16x32_bf16 v[176:179], a[72:75], a[40:43], v[176:179]
    v_exp_f32 v153, v153
    v_mfma_f32_16x16x32_bf16 v[176:179], a[76:79], a[56:59], v[176:179]
    v_cvt_pk_bf16_f32 v152, v152, v153
    v_mfma_f32_16x16x32_bf16 v[184:187], a[64:67], a[12:15], v[204:207]
    v_exp_f32 v154, v154
    v_mfma_f32_16x16x32_bf16 v[184:187], a[68:71], a[28:31], v[184:187]
    v_mfma_f32_16x16x32_bf16 v[184:187], a[72:75], a[44:47], v[184:187]
    s_waitcnt lgkmcnt(3)
    v_exp_f32 v155, v155
    v_mfma_f32_16x16x32_bf16 v[184:187], a[76:79], a[60:63], v[184:187]
    v_cvt_pk_bf16_f32 v153, v154, v155
    v_mfma_f32_16x16x32_bf16 v[164:167], a[80:83], a[0:3], v[192:195]
    s_waitcnt lgkmcnt(1)
    v_exp_f32 v156, v156
    v_mfma_f32_16x16x32_bf16 v[164:167], a[84:87], a[16:19], v[164:167]
    v_mfma_f32_16x16x32_bf16 v[164:167], a[88:91], a[32:35], v[164:167]
    s_waitcnt lgkmcnt(0)
    v_exp_f32 v157, v157
    v_mfma_f32_16x16x32_bf16 v[164:167], a[92:95], a[48:51], v[164:167]
    v_cvt_pk_bf16_f32 v154, v156, v157
    v_mfma_f32_16x16x32_bf16 v[172:175], a[80:83], a[4:7], v[196:199]
    v_exp_f32 v158, v158
    v_mfma_f32_16x16x32_bf16 v[172:175], a[84:87], a[20:23], v[172:175]
    ds_read_b64_tr_b16 a[96:97], v216 offset:32768
    ds_read_b64_tr_b16 a[98:99], v216 offset:33792
    v_mfma_f32_16x16x32_bf16 v[172:175], a[88:91], a[36:39], v[172:175]
    v_exp_f32 v159, v159
    v_mfma_f32_16x16x32_bf16 v[172:175], a[92:95], a[52:55], v[172:175]
    v_cvt_pk_bf16_f32 v155, v158, v159
    v_mfma_f32_16x16x32_bf16 v[180:183], a[80:83], a[8:11], v[200:203]
    v_exp_f32 v160, v160
    v_mfma_f32_16x16x32_bf16 v[180:183], a[84:87], a[24:27], v[180:183]
    ds_read_b64_tr_b16 a[100:101], v217 offset:32768
    ds_read_b64_tr_b16 a[102:103], v217 offset:33792
    v_mfma_f32_16x16x32_bf16 v[180:183], a[88:91], a[40:43], v[180:183]
    v_exp_f32 v161, v161
    v_mfma_f32_16x16x32_bf16 v[180:183], a[92:95], a[56:59], v[180:183]
    v_cvt_pk_bf16_f32 v160, v160, v161
    v_mfma_f32_16x16x32_bf16 v[188:191], a[80:83], a[12:15], v[204:207]
    v_exp_f32 v162, v162
    v_mfma_f32_16x16x32_bf16 v[188:191], a[84:87], a[28:31], v[188:191]
    ds_read_b64_tr_b16 a[104:105], v218 offset:32768
    ds_read_b64_tr_b16 a[106:107], v218 offset:33792
    v_mfma_f32_16x16x32_bf16 v[188:191], a[88:91], a[44:47], v[188:191]
    s_waitcnt lgkmcnt(4)
    v_exp_f32 v163, v163
    v_mfma_f32_16x16x32_bf16 v[188:191], a[92:95], a[60:63], v[188:191]
    v_cvt_pk_bf16_f32 v161, v162, v163
    v_mfma_f32_16x16x32_bf16 v[0:3], a[96:99], v[128:131], v[0:3]
    v_exp_f32 v164, v164
    v_mfma_f32_16x16x32_bf16 v[4:7], a[96:99], v[136:139], v[4:7]
    ds_read_b64_tr_b16 a[108:109], v219 offset:32768
    ds_read_b64_tr_b16 a[110:111], v219 offset:33792
    v_mfma_f32_16x16x32_bf16 v[8:11], a[96:99], v[144:147], v[8:11]
    s_waitcnt lgkmcnt(4)
    v_exp_f32 v165, v165
    v_mfma_f32_16x16x32_bf16 v[12:15], a[96:99], v[152:155], v[12:15]
    v_cvt_pk_bf16_f32 v162, v164, v165
    v_mfma_f32_16x16x32_bf16 v[16:19], a[100:103], v[128:131], v[16:19]
    v_exp_f32 v166, v166
    v_mfma_f32_16x16x32_bf16 v[20:23], a[100:103], v[136:139], v[20:23]
    ds_read_b64_tr_b16 a[96:97], v220 offset:32768
    ds_read_b64_tr_b16 a[98:99], v220 offset:33792
    v_mfma_f32_16x16x32_bf16 v[24:27], a[100:103], v[144:147], v[24:27]
    s_waitcnt lgkmcnt(4)
    v_exp_f32 v167, v167
    v_mfma_f32_16x16x32_bf16 v[28:31], a[100:103], v[152:155], v[28:31]
    v_cvt_pk_bf16_f32 v163, v166, v167
    v_mfma_f32_16x16x32_bf16 v[208:211], a[112:115], v[128:131], v[208:211]
    buffer_load_dwordx4 a[188:191], v234, s[40:43], s56 offen sc1
    v_mfma_f32_16x16x32_bf16 v[32:35], a[104:107], v[128:131], v[32:35]
    v_exp_f32 v168, v168
    v_mfma_f32_16x16x32_bf16 v[36:39], a[104:107], v[136:139], v[36:39]
    ds_read_b64_tr_b16 a[100:101], v221 offset:32768
    ds_read_b64_tr_b16 a[102:103], v221 offset:33792
    v_mfma_f32_16x16x32_bf16 v[40:43], a[104:107], v[144:147], v[40:43]
    s_waitcnt lgkmcnt(4)
    v_exp_f32 v169, v169
    v_mfma_f32_16x16x32_bf16 v[44:47], a[104:107], v[152:155], v[44:47]
    v_cvt_pk_bf16_f32 v168, v168, v169
    v_mfma_f32_16x16x32_bf16 v[48:51], a[108:111], v[128:131], v[48:51]
    v_exp_f32 v170, v170
    v_mfma_f32_16x16x32_bf16 v[52:55], a[108:111], v[136:139], v[52:55]
    ds_read_b64_tr_b16 a[104:105], v222 offset:32768
    ds_read_b64_tr_b16 a[106:107], v222 offset:33792
    v_mfma_f32_16x16x32_bf16 v[56:59], a[108:111], v[144:147], v[56:59]
    s_waitcnt lgkmcnt(4)
    v_exp_f32 v171, v171
    v_mfma_f32_16x16x32_bf16 v[60:63], a[108:111], v[152:155], v[60:63]
    v_cvt_pk_bf16_f32 v169, v170, v171
    v_mfma_f32_16x16x32_bf16 v[208:211], a[116:119], v[136:139], v[208:211]
    v_mfma_f32_16x16x32_bf16 v[64:67], a[96:99], v[128:131], v[64:67]
    v_exp_f32 v172, v172
    v_mfma_f32_16x16x32_bf16 v[68:71], a[96:99], v[136:139], v[68:71]
    ds_read_b64_tr_b16 a[108:109], v223 offset:32768
    ds_read_b64_tr_b16 a[110:111], v223 offset:33792
    v_mfma_f32_16x16x32_bf16 v[72:75], a[96:99], v[144:147], v[72:75]
    s_waitcnt lgkmcnt(4)
    v_exp_f32 v173, v173
    v_mfma_f32_16x16x32_bf16 v[76:79], a[96:99], v[152:155], v[76:79]
    v_cvt_pk_bf16_f32 v170, v172, v173
    v_mfma_f32_16x16x32_bf16 v[80:83], a[100:103], v[128:131], v[80:83]
    s_add_u32 m0, s75, 114688
    v_exp_f32 v174, v174
    v_mfma_f32_16x16x32_bf16 v[84:87], a[100:103], v[136:139], v[84:87]
    ds_read_b128 a[64:67], v212 offset:49152
    ds_read_b128 a[68:71], v213 offset:49152
    v_mfma_f32_16x16x32_bf16 v[88:91], a[100:103], v[144:147], v[88:91]
    s_waitcnt lgkmcnt(4)
    v_exp_f32 v175, v175
    v_mfma_f32_16x16x32_bf16 v[92:95], a[100:103], v[152:155], v[92:95]
    buffer_load_dwordx4 v224, s[8:11], s78 offen lds
    v_mfma_f32_16x16x32_bf16 v[208:211], a[120:123], v[144:147], v[208:211]
    v_mfma_f32_16x16x32_bf16 v[96:99], a[104:107], v[128:131], v[96:99]
    v_exp_f32 v176, v176
    v_mfma_f32_16x16x32_bf16 v[100:103], a[104:107], v[136:139], v[100:103]
    ds_read_b128 a[72:75], v214 offset:49152
    ds_read_b128 a[76:79], v215 offset:49152
    v_mfma_f32_16x16x32_bf16 v[104:107], a[104:107], v[144:147], v[104:107]
    s_waitcnt lgkmcnt(4)
    v_exp_f32 v177, v177
    v_mfma_f32_16x16x32_bf16 v[108:111], a[104:107], v[152:155], v[108:111]
    buffer_load_dwordx4 v224, s[8:11], s78 offen offset:1024 lds
    v_mfma_f32_16x16x32_bf16 v[112:115], a[108:111], v[128:131], v[112:115]
    v_exp_f32 v178, v178
    v_mfma_f32_16x16x32_bf16 v[116:119], a[108:111], v[136:139], v[116:119]
    ds_read_b128 a[80:83], v212 offset:50176
    v_cvt_pk_bf16_f32 v171, v174, v175
    v_mfma_f32_16x16x32_bf16 v[120:123], a[108:111], v[144:147], v[120:123]
    s_waitcnt lgkmcnt(4)
    v_exp_f32 v179, v179
    v_mfma_f32_16x16x32_bf16 v[124:127], a[108:111], v[152:155], v[124:127]
    buffer_load_dwordx4 v225, s[8:11], s78 offen offset:2048 lds
    v_mfma_f32_16x16x32_bf16 v[208:211], a[124:127], v[152:155], v[208:211]
    v_mfma_f32_16x16x32_bf16 v[128:131], a[64:67], a[0:3], v[192:195]
    s_waitcnt lgkmcnt(2)
    v_exp_f32 v180, v180
    v_mfma_f32_16x16x32_bf16 v[128:131], a[68:71], a[16:19], v[128:131]
    ds_read_b128 a[84:87], v213 offset:50176
    v_cvt_pk_bf16_f32 v176, v176, v177
    v_mfma_f32_16x16x32_bf16 v[128:131], a[72:75], a[32:35], v[128:131]
    s_waitcnt lgkmcnt(2)
    v_exp_f32 v181, v181
    v_mfma_f32_16x16x32_bf16 v[128:131], a[76:79], a[48:51], v[128:131]
    buffer_load_dwordx4 v225, s[8:11], s78 offen offset:3072 lds
    v_mfma_f32_16x16x32_bf16 v[136:139], a[64:67], a[4:7], v[196:199]
    s_add_u32 m0, s75, 49152
    v_exp_f32 v182, v182
    v_mfma_f32_16x16x32_bf16 v[136:139], a[68:71], a[20:23], v[136:139]
    ds_read_b128 a[88:91], v214 offset:50176
    v_cvt_pk_bf16_f32 v177, v178, v179
    v_mfma_f32_16x16x32_bf16 v[136:139], a[72:75], a[36:39], v[136:139]
    v_exp_f32 v183, v183
    v_mfma_f32_16x16x32_bf16 v[136:139], a[76:79], a[52:55], v[136:139]
    buffer_load_dwordx4 v226, s[12:15], s78 offen lds
    v_mfma_f32_16x16x32_bf16 v[144:147], a[64:67], a[8:11], v[200:203]
    v_exp_f32 v184, v184
    v_mfma_f32_16x16x32_bf16 v[144:147], a[68:71], a[24:27], v[144:147]
    ds_read_b128 a[92:95], v215 offset:50176
    v_cvt_pk_bf16_f32 v178, v180, v181
    v_mfma_f32_16x16x32_bf16 v[144:147], a[72:75], a[40:43], v[144:147]
    v_exp_f32 v185, v185
    v_mfma_f32_16x16x32_bf16 v[144:147], a[76:79], a[56:59], v[144:147]
    buffer_load_dwordx4 v226, s[12:15], s78 offen offset:1024 lds
    v_mfma_f32_16x16x32_bf16 v[152:155], a[64:67], a[12:15], v[204:207]
    v_exp_f32 v186, v186
    v_mfma_f32_16x16x32_bf16 v[152:155], a[68:71], a[28:31], v[152:155]
    v_cvt_pk_bf16_f32 v179, v182, v183
    v_cvt_pk_bf16_f32 v184, v184, v185
    v_mfma_f32_16x16x32_bf16 v[152:155], a[72:75], a[44:47], v[152:155]
    s_waitcnt lgkmcnt(3)
    v_exp_f32 v187, v187
    v_mfma_f32_16x16x32_bf16 v[152:155], a[76:79], a[60:63], v[152:155]
    buffer_load_dwordx4 v227, s[12:15], s78 offen offset:2048 lds
    v_mfma_f32_16x16x32_bf16 v[132:135], a[80:83], a[0:3], v[192:195]
    s_waitcnt lgkmcnt(1)
    v_exp_f32 v188, v188
    v_mfma_f32_16x16x32_bf16 v[132:135], a[84:87], a[16:19], v[132:135]
    v_cvt_pk_bf16_f32 v185, v186, v187
    v_mfma_f32_16x16x32_bf16 v[132:135], a[88:91], a[32:35], v[132:135]
    s_waitcnt lgkmcnt(0)
    v_exp_f32 v189, v189
    v_mfma_f32_16x16x32_bf16 v[132:135], a[92:95], a[48:51], v[132:135]
    buffer_load_dwordx4 v227, s[12:15], s78 offen offset:3072 lds
    v_mfma_f32_16x16x32_bf16 v[140:143], a[80:83], a[4:7], v[196:199]
    v_exp_f32 v190, v190
    v_mfma_f32_16x16x32_bf16 v[140:143], a[84:87], a[20:23], v[140:143]
    ds_read_b64_tr_b16 a[96:97], v216 offset:40960
    ds_read_b64_tr_b16 a[98:99], v216 offset:41984
    v_mfma_f32_16x16x32_bf16 v[140:143], a[88:91], a[36:39], v[140:143]
    v_exp_f32 v191, v191
    v_mfma_f32_16x16x32_bf16 v[140:143], a[92:95], a[52:55], v[140:143]
    v_cvt_pk_bf16_f32 v186, v188, v189
    v_cvt_pk_bf16_f32 v187, v190, v191
    v_mfma_f32_16x16x32_bf16 v[148:151], a[80:83], a[8:11], v[200:203]
    s_add_u32 s78, s78, 16384
    v_exp_f32 v128, v128
    v_mfma_f32_16x16x32_bf16 v[148:151], a[84:87], a[24:27], v[148:151]
    ds_read_b64_tr_b16 a[100:101], v217 offset:40960
    ds_read_b64_tr_b16 a[102:103], v217 offset:41984
    v_mfma_f32_16x16x32_bf16 v[148:151], a[88:91], a[40:43], v[148:151]
    v_exp_f32 v129, v129
    v_mfma_f32_16x16x32_bf16 v[148:151], a[92:95], a[56:59], v[148:151]
    v_cvt_pk_bf16_f32 v128, v128, v129
    v_mfma_f32_16x16x32_bf16 v[156:159], a[80:83], a[12:15], v[204:207]
    v_exp_f32 v130, v130
    v_mfma_f32_16x16x32_bf16 v[156:159], a[84:87], a[28:31], v[156:159]
    ds_read_b64_tr_b16 a[104:105], v218 offset:40960
    ds_read_b64_tr_b16 a[106:107], v218 offset:41984
    v_mfma_f32_16x16x32_bf16 v[156:159], a[88:91], a[44:47], v[156:159]
    s_waitcnt lgkmcnt(4)
    v_exp_f32 v131, v131
    v_mfma_f32_16x16x32_bf16 v[156:159], a[92:95], a[60:63], v[156:159]
    v_cvt_pk_bf16_f32 v129, v130, v131
    v_mfma_f32_16x16x32_bf16 v[0:3], a[96:99], v[160:163], v[0:3]
    s_add_u32 s56, s56, 4096
    v_exp_f32 v132, v132
    v_mfma_f32_16x16x32_bf16 v[4:7], a[96:99], v[168:171], v[4:7]
    ds_read_b64_tr_b16 a[108:109], v219 offset:40960
    ds_read_b64_tr_b16 a[110:111], v219 offset:41984
    v_mfma_f32_16x16x32_bf16 v[8:11], a[96:99], v[176:179], v[8:11]
    s_waitcnt lgkmcnt(4)
    v_exp_f32 v133, v133
    v_mfma_f32_16x16x32_bf16 v[12:15], a[96:99], v[184:187], v[12:15]
    s_cmp_lt_u32 s56, s58
    v_cvt_pk_bf16_f32 v130, v132, v133
    v_mfma_f32_16x16x32_bf16 v[16:19], a[100:103], v[160:163], v[16:19]
    s_cselect_b32 s56, s56, s57
    v_exp_f32 v134, v134
    v_mfma_f32_16x16x32_bf16 v[20:23], a[100:103], v[168:171], v[20:23]
    ds_read_b64_tr_b16 a[96:97], v220 offset:40960
    ds_read_b64_tr_b16 a[98:99], v220 offset:41984
    v_mfma_f32_16x16x32_bf16 v[24:27], a[100:103], v[176:179], v[24:27]
    s_waitcnt lgkmcnt(4)
    v_exp_f32 v135, v135
    v_mfma_f32_16x16x32_bf16 v[28:31], a[100:103], v[184:187], v[28:31]
    s_add_u32 m0, s75, 0
    v_cvt_pk_bf16_f32 v131, v134, v135
    v_mfma_f32_16x16x32_bf16 v[208:211], a[112:115], v[160:163], v[208:211]
    buffer_load_dwordx4 v238, s[40:43], s56 offen sc1 lds
    v_mfma_f32_16x16x32_bf16 v[32:35], a[104:107], v[160:163], v[32:35]
    s_add_u32 m0, s75, 1024
    v_exp_f32 v136, v136
    v_mfma_f32_16x16x32_bf16 v[36:39], a[104:107], v[168:171], v[36:39]
    ds_read_b64_tr_b16 a[100:101], v221 offset:40960
    ds_read_b64_tr_b16 a[102:103], v221 offset:41984
    v_mfma_f32_16x16x32_bf16 v[40:43], a[104:107], v[176:179], v[40:43]
    s_waitcnt lgkmcnt(4)
    v_exp_f32 v137, v137
    v_mfma_f32_16x16x32_bf16 v[44:47], a[104:107], v[184:187], v[44:47]
    v_cvt_pk_bf16_f32 v136, v136, v137
    v_mfma_f32_16x16x32_bf16 v[48:51], a[108:111], v[160:163], v[48:51]
    v_exp_f32 v138, v138
    v_mfma_f32_16x16x32_bf16 v[52:55], a[108:111], v[168:171], v[52:55]
    ds_read_b64_tr_b16 a[104:105], v222 offset:40960
    ds_read_b64_tr_b16 a[106:107], v222 offset:41984
    v_mfma_f32_16x16x32_bf16 v[56:59], a[108:111], v[176:179], v[56:59]
    s_waitcnt lgkmcnt(4)
    v_exp_f32 v139, v139
    v_mfma_f32_16x16x32_bf16 v[60:63], a[108:111], v[184:187], v[60:63]
    v_cvt_pk_bf16_f32 v137, v138, v139
    v_mfma_f32_16x16x32_bf16 v[208:211], a[116:119], v[168:171], v[208:211]
    buffer_load_dwordx4 v232, s[40:43], s56 offen sc1 lds
    v_mfma_f32_16x16x32_bf16 v[64:67], a[96:99], v[160:163], v[64:67]
    s_add_u32 m0, s75, 2048
    v_exp_f32 v140, v140
    v_mfma_f32_16x16x32_bf16 v[68:71], a[96:99], v[168:171], v[68:71]
    ds_read_b64_tr_b16 a[108:109], v223 offset:40960
    ds_read_b64_tr_b16 a[110:111], v223 offset:41984
    v_mfma_f32_16x16x32_bf16 v[72:75], a[96:99], v[176:179], v[72:75]
    s_waitcnt lgkmcnt(4)
    v_exp_f32 v141, v141
    v_mfma_f32_16x16x32_bf16 v[76:79], a[96:99], v[184:187], v[76:79]
    v_cvt_pk_bf16_f32 v138, v140, v141
    v_mfma_f32_16x16x32_bf16 v[80:83], a[100:103], v[160:163], v[80:83]
    v_exp_f32 v142, v142
    v_mfma_f32_16x16x32_bf16 v[84:87], a[100:103], v[168:171], v[84:87]
    ds_read_b128 a[64:67], v212 offset:57344
    ds_read_b128 a[68:71], v213 offset:57344
    v_mfma_f32_16x16x32_bf16 v[88:91], a[100:103], v[176:179], v[88:91]
    s_waitcnt lgkmcnt(4)
    v_exp_f32 v143, v143
    v_mfma_f32_16x16x32_bf16 v[92:95], a[100:103], v[184:187], v[92:95]
    v_cvt_pk_bf16_f32 v139, v142, v143
    v_mfma_f32_16x16x32_bf16 v[208:211], a[120:123], v[176:179], v[208:211]
    buffer_load_dwordx4 v233, s[40:43], s56 offen sc1 lds
    v_mfma_f32_16x16x32_bf16 v[96:99], a[104:107], v[160:163], v[96:99]
    s_add_u32 m0, s75, 3072
    v_exp_f32 v144, v144
    v_mfma_f32_16x16x32_bf16 v[100:103], a[104:107], v[168:171], v[100:103]
    ds_read_b128 a[72:75], v214 offset:57344
    ds_read_b128 a[76:79], v215 offset:57344
    v_mfma_f32_16x16x32_bf16 v[104:107], a[104:107], v[176:179], v[104:107]
    s_waitcnt lgkmcnt(4)
    v_exp_f32 v145, v145
    v_mfma_f32_16x16x32_bf16 v[108:111], a[104:107], v[184:187], v[108:111]
    v_cvt_pk_bf16_f32 v144, v144, v145
    v_mfma_f32_16x16x32_bf16 v[112:115], a[108:111], v[160:163], v[112:115]
    v_exp_f32 v146, v146
    v_mfma_f32_16x16x32_bf16 v[116:119], a[108:111], v[168:171], v[116:119]
    ds_read_b128 a[80:83], v212 offset:58368
    v_mfma_f32_16x16x32_bf16 v[120:123], a[108:111], v[176:179], v[120:123]
    s_waitcnt lgkmcnt(4)
    v_exp_f32 v147, v147
    v_mfma_f32_16x16x32_bf16 v[124:127], a[108:111], v[184:187], v[124:127]
    v_cvt_pk_bf16_f32 v145, v146, v147
    v_mfma_f32_16x16x32_bf16 v[208:211], a[124:127], v[184:187], v[208:211]
    buffer_load_dwordx4 v234, s[40:43], s56 offen sc1 lds
    v_mfma_f32_16x16x32_bf16 v[160:163], a[64:67], a[0:3], v[192:195]
    s_add_u32 s56, s56, 4096
    s_cmp_lt_u32 s56, s58
    s_cselect_b32 s56, s56, s57
    s_add_u32 m0, s75, 16384
    v_exp_f32 v148, v148
    s_waitcnt lgkmcnt(3)
    v_mfma_f32_16x16x32_bf16 v[160:163], a[68:71], a[16:19], v[160:163]
    ds_read_b128 a[84:87], v213 offset:58368
    s_waitcnt lgkmcnt(3)
    v_mfma_f32_16x16x32_bf16 v[160:163], a[72:75], a[32:35], v[160:163]
    s_waitcnt lgkmcnt(2)
    v_exp_f32 v149, v149
    v_mfma_f32_16x16x32_bf16 v[160:163], a[76:79], a[48:51], v[160:163]
    buffer_load_dwordx4 v238, s[40:43], s56 offen sc1 lds
    v_mfma_f32_16x16x32_bf16 v[168:171], a[64:67], a[4:7], v[196:199]
    s_add_u32 m0, s75, 17408
    v_exp_f32 v150, v150
    v_mfma_f32_16x16x32_bf16 v[168:171], a[68:71], a[20:23], v[168:171]
    ds_read_b128 a[88:91], v214 offset:58368
    v_cvt_pk_bf16_f32 v146, v148, v149
    v_mfma_f32_16x16x32_bf16 v[168:171], a[72:75], a[36:39], v[168:171]
    s_waitcnt vmcnt(21)
    v_exp_f32 v151, v151
    v_mfma_f32_16x16x32_bf16 v[168:171], a[76:79], a[52:55], v[168:171]
    buffer_load_dwordx4 v232, s[40:43], s56 offen sc1 lds
    v_mfma_f32_16x16x32_bf16 v[176:179], a[64:67], a[8:11], v[200:203]
    s_barrier
    s_add_u32 m0, s75, 18432
    v_exp_f32 v152, v152
    v_mfma_f32_16x16x32_bf16 v[176:179], a[68:71], a[24:27], v[176:179]
    ds_read_b128 a[92:95], v215 offset:58368
    v_cvt_pk_bf16_f32 v147, v150, v151
    v_mfma_f32_16x16x32_bf16 v[176:179], a[72:75], a[40:43], v[176:179]
    v_exp_f32 v153, v153
    v_mfma_f32_16x16x32_bf16 v[176:179], a[76:79], a[56:59], v[176:179]
    buffer_load_dwordx4 v233, s[40:43], s56 offen sc1 lds
    v_mfma_f32_16x16x32_bf16 v[184:187], a[64:67], a[12:15], v[204:207]
    s_add_u32 m0, s75, 19456
    v_exp_f32 v154, v154
    v_mfma_f32_16x16x32_bf16 v[184:187], a[68:71], a[28:31], v[184:187]
    v_cvt_pk_bf16_f32 v152, v152, v153
    v_mfma_f32_16x16x32_bf16 v[184:187], a[72:75], a[44:47], v[184:187]
    s_waitcnt lgkmcnt(3)
    v_exp_f32 v155, v155
    v_mfma_f32_16x16x32_bf16 v[184:187], a[76:79], a[60:63], v[184:187]
    buffer_load_dwordx4 v234, s[40:43], s56 offen sc1 lds
    v_mfma_f32_16x16x32_bf16 v[164:167], a[80:83], a[0:3], v[192:195]
    s_waitcnt lgkmcnt(1)
    v_exp_f32 v156, v156
    v_mfma_f32_16x16x32_bf16 v[164:167], a[84:87], a[16:19], v[164:167]
    v_cvt_pk_bf16_f32 v153, v154, v155
    v_mfma_f32_16x16x32_bf16 v[164:167], a[88:91], a[32:35], v[164:167]
    s_waitcnt lgkmcnt(0)
    v_exp_f32 v157, v157
    v_mfma_f32_16x16x32_bf16 v[164:167], a[92:95], a[48:51], v[164:167]
    v_cvt_pk_bf16_f32 v154, v156, v157
    v_mfma_f32_16x16x32_bf16 v[172:175], a[80:83], a[4:7], v[196:199]
    v_exp_f32 v158, v158
    v_mfma_f32_16x16x32_bf16 v[172:175], a[84:87], a[20:23], v[172:175]
    ds_read_b64_tr_b16 a[96:97], v216 offset:49152
    ds_read_b64_tr_b16 a[98:99], v216 offset:50176
    v_mfma_f32_16x16x32_bf16 v[172:175], a[88:91], a[36:39], v[172:175]
    v_exp_f32 v159, v159
    v_mfma_f32_16x16x32_bf16 v[172:175], a[92:95], a[52:55], v[172:175]
    v_cvt_pk_bf16_f32 v155, v158, v159
    v_mfma_f32_16x16x32_bf16 v[180:183], a[80:83], a[8:11], v[200:203]
    v_exp_f32 v160, v160
    v_mfma_f32_16x16x32_bf16 v[180:183], a[84:87], a[24:27], v[180:183]
    ds_read_b64_tr_b16 a[100:101], v217 offset:49152
    ds_read_b64_tr_b16 a[102:103], v217 offset:50176
    v_mfma_f32_16x16x32_bf16 v[180:183], a[88:91], a[40:43], v[180:183]
    v_exp_f32 v161, v161
    v_mfma_f32_16x16x32_bf16 v[180:183], a[92:95], a[56:59], v[180:183]
    v_cvt_pk_bf16_f32 v160, v160, v161
    v_mfma_f32_16x16x32_bf16 v[188:191], a[80:83], a[12:15], v[204:207]
    v_exp_f32 v162, v162
    v_mfma_f32_16x16x32_bf16 v[188:191], a[84:87], a[28:31], v[188:191]
    ds_read_b64_tr_b16 a[104:105], v218 offset:49152
    ds_read_b64_tr_b16 a[106:107], v218 offset:50176
    v_mfma_f32_16x16x32_bf16 v[188:191], a[88:91], a[44:47], v[188:191]
    s_waitcnt lgkmcnt(4)
    v_exp_f32 v163, v163
    v_mfma_f32_16x16x32_bf16 v[188:191], a[92:95], a[60:63], v[188:191]
    v_cvt_pk_bf16_f32 v161, v162, v163
    v_mfma_f32_16x16x32_bf16 v[0:3], a[96:99], v[128:131], v[0:3]
    s_add_u32 s56, s56, 4096
    v_exp_f32 v164, v164
    v_mfma_f32_16x16x32_bf16 v[4:7], a[96:99], v[136:139], v[4:7]
    ds_read_b64_tr_b16 a[108:109], v219 offset:49152
    ds_read_b64_tr_b16 a[110:111], v219 offset:50176
    v_mfma_f32_16x16x32_bf16 v[8:11], a[96:99], v[144:147], v[8:11]
    s_waitcnt lgkmcnt(4)
    v_exp_f32 v165, v165
    v_mfma_f32_16x16x32_bf16 v[12:15], a[96:99], v[152:155], v[12:15]
    s_cmp_lt_u32 s56, s58
    v_cvt_pk_bf16_f32 v162, v164, v165
    v_mfma_f32_16x16x32_bf16 v[16:19], a[100:103], v[128:131], v[16:19]
    s_cselect_b32 s56, s56, s57
    v_exp_f32 v166, v166
    v_mfma_f32_16x16x32_bf16 v[20:23], a[100:103], v[136:139], v[20:23]
    ds_read_b64_tr_b16 a[96:97], v220 offset:49152
    ds_read_b64_tr_b16 a[98:99], v220 offset:50176
    v_mfma_f32_16x16x32_bf16 v[24:27], a[100:103], v[144:147], v[24:27]
    s_waitcnt lgkmcnt(4)
    v_exp_f32 v167, v167
    v_mfma_f32_16x16x32_bf16 v[28:31], a[100:103], v[152:155], v[28:31]
    v_cvt_pk_bf16_f32 v163, v166, v167
    v_mfma_f32_16x16x32_bf16 v[208:211], a[112:115], v[128:131], v[208:211]
    buffer_load_dwordx4 a[192:195], v238, s[40:43], s56 offen sc1
    v_mfma_f32_16x16x32_bf16 v[32:35], a[104:107], v[128:131], v[32:35]
    v_exp_f32 v168, v168
    v_mfma_f32_16x16x32_bf16 v[36:39], a[104:107], v[136:139], v[36:39]
    ds_read_b64_tr_b16 a[100:101], v221 offset:49152
    ds_read_b64_tr_b16 a[102:103], v221 offset:50176
    v_mfma_f32_16x16x32_bf16 v[40:43], a[104:107], v[144:147], v[40:43]
    s_waitcnt lgkmcnt(4)
    v_exp_f32 v169, v169
    v_mfma_f32_16x16x32_bf16 v[44:47], a[104:107], v[152:155], v[44:47]
    v_cvt_pk_bf16_f32 v168, v168, v169
    v_mfma_f32_16x16x32_bf16 v[48:51], a[108:111], v[128:131], v[48:51]
    v_exp_f32 v170, v170
    v_mfma_f32_16x16x32_bf16 v[52:55], a[108:111], v[136:139], v[52:55]
    ds_read_b64_tr_b16 a[104:105], v222 offset:49152
    ds_read_b64_tr_b16 a[106:107], v222 offset:50176
    v_mfma_f32_16x16x32_bf16 v[56:59], a[108:111], v[144:147], v[56:59]
    s_waitcnt lgkmcnt(4)
    v_exp_f32 v171, v171
    v_mfma_f32_16x16x32_bf16 v[60:63], a[108:111], v[152:155], v[60:63]
    v_cvt_pk_bf16_f32 v169, v170, v171
    v_mfma_f32_16x16x32_bf16 v[208:211], a[116:119], v[136:139], v[208:211]
    buffer_load_dwordx4 a[196:199], v232, s[40:43], s56 offen sc1
    v_mfma_f32_16x16x32_bf16 v[64:67], a[96:99], v[128:131], v[64:67]
    v_exp_f32 v172, v172
    v_mfma_f32_16x16x32_bf16 v[68:71], a[96:99], v[136:139], v[68:71]
    ds_read_b64_tr_b16 a[108:109], v223 offset:49152
    ds_read_b64_tr_b16 a[110:111], v223 offset:50176
    v_mfma_f32_16x16x32_bf16 v[72:75], a[96:99], v[144:147], v[72:75]
    s_waitcnt lgkmcnt(4)
    v_exp_f32 v173, v173
    v_mfma_f32_16x16x32_bf16 v[76:79], a[96:99], v[152:155], v[76:79]
    v_cvt_pk_bf16_f32 v170, v172, v173
    v_mfma_f32_16x16x32_bf16 v[80:83], a[100:103], v[128:131], v[80:83]
    s_add_u32 m0, s75, 131072
    v_exp_f32 v174, v174
    v_mfma_f32_16x16x32_bf16 v[84:87], a[100:103], v[136:139], v[84:87]
    ds_read_b128 a[64:67], v212 offset:0
    ds_read_b128 a[68:71], v213 offset:0
    v_mfma_f32_16x16x32_bf16 v[88:91], a[100:103], v[144:147], v[88:91]
    s_waitcnt lgkmcnt(4)
    v_exp_f32 v175, v175
    v_mfma_f32_16x16x32_bf16 v[92:95], a[100:103], v[152:155], v[92:95]
    buffer_load_dwordx4 v240, s[20:23], s52 offen lds
    v_mfma_f32_16x16x32_bf16 v[208:211], a[120:123], v[144:147], v[208:211]
    buffer_load_dwordx4 a[200:203], v233, s[40:43], s56 offen sc1
    v_mfma_f32_16x16x32_bf16 v[96:99], a[104:107], v[128:131], v[96:99]
    v_exp_f32 v176, v176
    v_mfma_f32_16x16x32_bf16 v[100:103], a[104:107], v[136:139], v[100:103]
    ds_read_b128 a[72:75], v214 offset:0
    ds_read_b128 a[76:79], v215 offset:0
    v_mfma_f32_16x16x32_bf16 v[104:107], a[104:107], v[144:147], v[104:107]
    s_waitcnt lgkmcnt(4)
    v_exp_f32 v177, v177
    v_mfma_f32_16x16x32_bf16 v[108:111], a[104:107], v[152:155], v[108:111]
    buffer_load_dwordx4 v241, s[20:23], s52 offen offset:1024 lds
    v_mfma_f32_16x16x32_bf16 v[112:115], a[108:111], v[128:131], v[112:115]
    v_exp_f32 v178, v178
    v_mfma_f32_16x16x32_bf16 v[116:119], a[108:111], v[136:139], v[116:119]
    ds_read_b128 a[80:83], v212 offset:1024
    v_cvt_pk_bf16_f32 v171, v174, v175
    v_mfma_f32_16x16x32_bf16 v[120:123], a[108:111], v[144:147], v[120:123]
    s_waitcnt lgkmcnt(4)
    v_exp_f32 v179, v179
    v_mfma_f32_16x16x32_bf16 v[124:127], a[108:111], v[152:155], v[124:127]
    buffer_load_dwordx4 v242, s[20:23], s52 offen offset:2048 lds
    v_mfma_f32_16x16x32_bf16 v[208:211], a[124:127], v[152:155], v[208:211]
    buffer_load_dwordx4 a[204:207], v234, s[40:43], s56 offen sc1
    v_mfma_f32_16x16x32_bf16 v[128:131], a[64:67], a[0:3], v[192:195]
    s_waitcnt lgkmcnt(2)
    v_exp_f32 v180, v180
    v_mfma_f32_16x16x32_bf16 v[128:131], a[68:71], a[16:19], v[128:131]
    ds_read_b128 a[84:87], v213 offset:1024
    v_cvt_pk_bf16_f32 v176, v176, v177
    v_mfma_f32_16x16x32_bf16 v[128:131], a[72:75], a[32:35], v[128:131]
    s_waitcnt lgkmcnt(2)
    v_exp_f32 v181, v181
    v_mfma_f32_16x16x32_bf16 v[128:131], a[76:79], a[48:51], v[128:131]
    buffer_load_dwordx4 v243, s[20:23], s52 offen offset:3072 lds
    v_mfma_f32_16x16x32_bf16 v[136:139], a[64:67], a[4:7], v[196:199]
    s_add_u32 s52, s52, 32768
    s_and_b32 s52, s52, 524287
    s_add_u32 m0, s75, 65536
    v_exp_f32 v182, v182
    v_mfma_f32_16x16x32_bf16 v[136:139], a[68:71], a[20:23], v[136:139]
    ds_read_b128 a[88:91], v214 offset:1024
    v_cvt_pk_bf16_f32 v177, v178, v179
    v_mfma_f32_16x16x32_bf16 v[136:139], a[72:75], a[36:39], v[136:139]
    v_exp_f32 v183, v183
    v_mfma_f32_16x16x32_bf16 v[136:139], a[76:79], a[52:55], v[136:139]
    buffer_load_dwordx4 v240, s[20:23], s52 offen lds
    v_mfma_f32_16x16x32_bf16 v[144:147], a[64:67], a[8:11], v[200:203]
    v_exp_f32 v184, v184
    v_mfma_f32_16x16x32_bf16 v[144:147], a[68:71], a[24:27], v[144:147]
    ds_read_b128 a[92:95], v215 offset:1024
    v_cvt_pk_bf16_f32 v178, v180, v181
    v_mfma_f32_16x16x32_bf16 v[144:147], a[72:75], a[40:43], v[144:147]
    v_exp_f32 v185, v185
    v_mfma_f32_16x16x32_bf16 v[144:147], a[76:79], a[56:59], v[144:147]
    buffer_load_dwordx4 v241, s[20:23], s52 offen offset:1024 lds
    v_mfma_f32_16x16x32_bf16 v[152:155], a[64:67], a[12:15], v[204:207]
    v_exp_f32 v186, v186
    v_mfma_f32_16x16x32_bf16 v[152:155], a[68:71], a[28:31], v[152:155]
    v_cvt_pk_bf16_f32 v179, v182, v183
    v_cvt_pk_bf16_f32 v184, v184, v185
    v_mfma_f32_16x16x32_bf16 v[152:155], a[72:75], a[44:47], v[152:155]
    s_waitcnt lgkmcnt(3)
    v_exp_f32 v187, v187
    v_mfma_f32_16x16x32_bf16 v[152:155], a[76:79], a[60:63], v[152:155]
    buffer_load_dwordx4 v242, s[20:23], s52 offen offset:2048 lds
    v_mfma_f32_16x16x32_bf16 v[132:135], a[80:83], a[0:3], v[192:195]
    s_waitcnt lgkmcnt(1)
    v_exp_f32 v188, v188
    v_mfma_f32_16x16x32_bf16 v[132:135], a[84:87], a[16:19], v[132:135]
    v_cvt_pk_bf16_f32 v185, v186, v187
    v_mfma_f32_16x16x32_bf16 v[132:135], a[88:91], a[32:35], v[132:135]
    s_waitcnt lgkmcnt(0)
    v_exp_f32 v189, v189
    v_mfma_f32_16x16x32_bf16 v[132:135], a[92:95], a[48:51], v[132:135]
    buffer_load_dwordx4 v243, s[20:23], s52 offen offset:3072 lds
    v_mfma_f32_16x16x32_bf16 v[140:143], a[80:83], a[4:7], v[196:199]
    v_exp_f32 v190, v190
    v_mfma_f32_16x16x32_bf16 v[140:143], a[84:87], a[20:23], v[140:143]
    ds_read_b64_tr_b16 a[96:97], v216 offset:57344
    ds_read_b64_tr_b16 a[98:99], v216 offset:58368
    v_mfma_f32_16x16x32_bf16 v[140:143], a[88:91], a[36:39], v[140:143]
    v_exp_f32 v191, v191
    v_mfma_f32_16x16x32_bf16 v[140:143], a[92:95], a[52:55], v[140:143]
    v_cvt_pk_bf16_f32 v186, v188, v189
    v_cvt_pk_bf16_f32 v187, v190, v191
    v_mfma_f32_16x16x32_bf16 v[148:151], a[80:83], a[8:11], v[200:203]
    v_exp_f32 v128, v128
    v_mfma_f32_16x16x32_bf16 v[148:151], a[84:87], a[24:27], v[148:151]
    ds_read_b64_tr_b16 a[100:101], v217 offset:57344
    ds_read_b64_tr_b16 a[102:103], v217 offset:58368
    v_mfma_f32_16x16x32_bf16 v[148:151], a[88:91], a[40:43], v[148:151]
    v_exp_f32 v129, v129
    v_mfma_f32_16x16x32_bf16 v[148:151], a[92:95], a[56:59], v[148:151]
    v_cvt_pk_bf16_f32 v128, v128, v129
    v_mfma_f32_16x16x32_bf16 v[156:159], a[80:83], a[12:15], v[204:207]
    v_exp_f32 v130, v130
    v_mfma_f32_16x16x32_bf16 v[156:159], a[84:87], a[28:31], v[156:159]
    ds_read_b64_tr_b16 a[104:105], v218 offset:57344
    ds_read_b64_tr_b16 a[106:107], v218 offset:58368
    v_mfma_f32_16x16x32_bf16 v[156:159], a[88:91], a[44:47], v[156:159]
    s_waitcnt lgkmcnt(4)
    v_exp_f32 v131, v131
    v_mfma_f32_16x16x32_bf16 v[156:159], a[92:95], a[60:63], v[156:159]
    v_cvt_pk_bf16_f32 v129, v130, v131
    v_mfma_f32_16x16x32_bf16 v[0:3], a[96:99], v[160:163], v[0:3]
    s_add_u32 s56, s56, 4096
    v_exp_f32 v132, v132
    v_mfma_f32_16x16x32_bf16 v[4:7], a[96:99], v[168:171], v[4:7]
    ds_read_b64_tr_b16 a[108:109], v219 offset:57344
    ds_read_b64_tr_b16 a[110:111], v219 offset:58368
    v_mfma_f32_16x16x32_bf16 v[8:11], a[96:99], v[176:179], v[8:11]
    s_waitcnt lgkmcnt(4)
    v_exp_f32 v133, v133
    v_mfma_f32_16x16x32_bf16 v[12:15], a[96:99], v[184:187], v[12:15]
    s_cmp_lt_u32 s56, s58
    v_cvt_pk_bf16_f32 v130, v132, v133
    v_mfma_f32_16x16x32_bf16 v[16:19], a[100:103], v[160:163], v[16:19]
    s_cselect_b32 s56, s56, s57
    v_exp_f32 v134, v134
    v_mfma_f32_16x16x32_bf16 v[20:23], a[100:103], v[168:171], v[20:23]
    ds_read_b64_tr_b16 a[96:97], v220 offset:57344
    ds_read_b64_tr_b16 a[98:99], v220 offset:58368
    v_mfma_f32_16x16x32_bf16 v[24:27], a[100:103], v[176:179], v[24:27]
    s_waitcnt lgkmcnt(4)
    v_exp_f32 v135, v135
    v_mfma_f32_16x16x32_bf16 v[28:31], a[100:103], v[184:187], v[28:31]
    v_cvt_pk_bf16_f32 v131, v134, v135
    v_mfma_f32_16x16x32_bf16 v[208:211], a[112:115], v[160:163], v[208:211]
    buffer_load_dwordx4 a[208:211], v238, s[40:43], s56 offen sc1
    v_mfma_f32_16x16x32_bf16 v[32:35], a[104:107], v[160:163], v[32:35]
    v_exp_f32 v136, v136
    v_mfma_f32_16x16x32_bf16 v[36:39], a[104:107], v[168:171], v[36:39]
    ds_read_b64_tr_b16 a[100:101], v221 offset:57344
    ds_read_b64_tr_b16 a[102:103], v221 offset:58368
    v_mfma_f32_16x16x32_bf16 v[40:43], a[104:107], v[176:179], v[40:43]
    s_waitcnt lgkmcnt(4)
    v_exp_f32 v137, v137
    v_mfma_f32_16x16x32_bf16 v[44:47], a[104:107], v[184:187], v[44:47]
    v_cvt_pk_bf16_f32 v136, v136, v137
    v_mfma_f32_16x16x32_bf16 v[48:51], a[108:111], v[160:163], v[48:51]
    v_exp_f32 v138, v138
    v_mfma_f32_16x16x32_bf16 v[52:55], a[108:111], v[168:171], v[52:55]
    ds_read_b64_tr_b16 a[104:105], v222 offset:57344
    ds_read_b64_tr_b16 a[106:107], v222 offset:58368
    v_mfma_f32_16x16x32_bf16 v[56:59], a[108:111], v[176:179], v[56:59]
    s_waitcnt lgkmcnt(4)
    v_exp_f32 v139, v139
    v_mfma_f32_16x16x32_bf16 v[60:63], a[108:111], v[184:187], v[60:63]
    v_cvt_pk_bf16_f32 v137, v138, v139
    v_mfma_f32_16x16x32_bf16 v[208:211], a[116:119], v[168:171], v[208:211]
    buffer_load_dwordx4 a[212:215], v232, s[40:43], s56 offen sc1
    v_mfma_f32_16x16x32_bf16 v[64:67], a[96:99], v[160:163], v[64:67]
    v_exp_f32 v140, v140
    v_mfma_f32_16x16x32_bf16 v[68:71], a[96:99], v[168:171], v[68:71]
    ds_read_b64_tr_b16 a[108:109], v223 offset:57344
    ds_read_b64_tr_b16 a[110:111], v223 offset:58368
    v_mfma_f32_16x16x32_bf16 v[72:75], a[96:99], v[176:179], v[72:75]
    s_waitcnt lgkmcnt(4)
    v_exp_f32 v141, v141
    v_mfma_f32_16x16x32_bf16 v[76:79], a[96:99], v[184:187], v[76:79]
    v_cvt_pk_bf16_f32 v138, v140, v141
    v_mfma_f32_16x16x32_bf16 v[80:83], a[100:103], v[160:163], v[80:83]
    v_exp_f32 v142, v142
    v_mfma_f32_16x16x32_bf16 v[84:87], a[100:103], v[168:171], v[84:87]
    ds_read_b128 a[64:67], v212 offset:8192
    ds_read_b128 a[68:71], v213 offset:8192
    v_mfma_f32_16x16x32_bf16 v[88:91], a[100:103], v[176:179], v[88:91]
    s_waitcnt lgkmcnt(4)
    v_exp_f32 v143, v143
    v_mfma_f32_16x16x32_bf16 v[92:95], a[100:103], v[184:187], v[92:95]
    v_cvt_pk_bf16_f32 v139, v142, v143
    v_mfma_f32_16x16x32_bf16 v[208:211], a[120:123], v[176:179], v[208:211]
    buffer_load_dwordx4 a[216:219], v233, s[40:43], s56 offen sc1
    v_mfma_f32_16x16x32_bf16 v[96:99], a[104:107], v[160:163], v[96:99]
    v_exp_f32 v144, v144
    v_mfma_f32_16x16x32_bf16 v[100:103], a[104:107], v[168:171], v[100:103]
    ds_read_b128 a[72:75], v214 offset:8192
    ds_read_b128 a[76:79], v215 offset:8192
    v_mfma_f32_16x16x32_bf16 v[104:107], a[104:107], v[176:179], v[104:107]
    s_waitcnt lgkmcnt(4)
    v_exp_f32 v145, v145
    v_mfma_f32_16x16x32_bf16 v[108:111], a[104:107], v[184:187], v[108:111]
    v_cvt_pk_bf16_f32 v144, v144, v145
    v_mfma_f32_16x16x32_bf16 v[112:115], a[108:111], v[160:163], v[112:115]
    v_exp_f32 v146, v146
    v_mfma_f32_16x16x32_bf16 v[116:119], a[108:111], v[168:171], v[116:119]
    ds_read_b128 a[80:83], v212 offset:9216
    v_mfma_f32_16x16x32_bf16 v[120:123], a[108:111], v[176:179], v[120:123]
    s_waitcnt lgkmcnt(4)
    v_exp_f32 v147, v147
    v_mfma_f32_16x16x32_bf16 v[124:127], a[108:111], v[184:187], v[124:127]
    v_cvt_pk_bf16_f32 v145, v146, v147
    v_mfma_f32_16x16x32_bf16 v[208:211], a[124:127], v[184:187], v[208:211]
    buffer_load_dwordx4 a[220:223], v234, s[40:43], s56 offen sc1
    v_mfma_f32_16x16x32_bf16 v[160:163], a[64:67], a[0:3], v[192:195]
    s_add_u32 s56, s56, 4096
    s_cmp_lt_u32 s56, s58
    s_cselect_b32 s56, s56, s57
    v_exp_f32 v148, v148
    s_waitcnt lgkmcnt(3)
    v_mfma_f32_16x16x32_bf16 v[160:163], a[68:71], a[16:19], v[160:163]
    ds_read_b128 a[84:87], v213 offset:9216
    s_waitcnt lgkmcnt(3)
    v_mfma_f32_16x16x32_bf16 v[160:163], a[72:75], a[32:35], v[160:163]
    s_waitcnt lgkmcnt(2)
    v_exp_f32 v149, v149
    v_mfma_f32_16x16x32_bf16 v[160:163], a[76:79], a[48:51], v[160:163]
    buffer_load_dwordx4 a[224:227], v238, s[40:43], s56 offen sc1
    v_mfma_f32_16x16x32_bf16 v[168:171], a[64:67], a[4:7], v[196:199]
    v_exp_f32 v150, v150
    v_mfma_f32_16x16x32_bf16 v[168:171], a[68:71], a[20:23], v[168:171]
    ds_read_b128 a[88:91], v214 offset:9216
    v_cvt_pk_bf16_f32 v146, v148, v149
    v_mfma_f32_16x16x32_bf16 v[168:171], a[72:75], a[36:39], v[168:171]
    s_waitcnt vmcnt(29)
    v_exp_f32 v151, v151
    v_mfma_f32_16x16x32_bf16 v[168:171], a[76:79], a[52:55], v[168:171]
    buffer_load_dwordx4 a[228:231], v232, s[40:43], s56 offen sc1
    v_mfma_f32_16x16x32_bf16 v[176:179], a[64:67], a[8:11], v[200:203]
    s_barrier
    v_exp_f32 v152, v152
    v_mfma_f32_16x16x32_bf16 v[176:179], a[68:71], a[24:27], v[176:179]
    ds_read_b128 a[92:95], v215 offset:9216
    v_cvt_pk_bf16_f32 v147, v150, v151
    v_mfma_f32_16x16x32_bf16 v[176:179], a[72:75], a[40:43], v[176:179]
    v_exp_f32 v153, v153
    v_mfma_f32_16x16x32_bf16 v[176:179], a[76:79], a[56:59], v[176:179]
    buffer_load_dwordx4 a[232:235], v233, s[40:43], s56 offen sc1
    v_mfma_f32_16x16x32_bf16 v[184:187], a[64:67], a[12:15], v[204:207]
    v_exp_f32 v154, v154
    v_mfma_f32_16x16x32_bf16 v[184:187], a[68:71], a[28:31], v[184:187]
    v_cvt_pk_bf16_f32 v152, v152, v153
    v_mfma_f32_16x16x32_bf16 v[184:187], a[72:75], a[44:47], v[184:187]
    s_waitcnt lgkmcnt(3)
    v_exp_f32 v155, v155
    v_mfma_f32_16x16x32_bf16 v[184:187], a[76:79], a[60:63], v[184:187]
    buffer_load_dwordx4 a[236:239], v234, s[40:43], s56 offen sc1
    v_mfma_f32_16x16x32_bf16 v[164:167], a[80:83], a[0:3], v[192:195]
    s_waitcnt lgkmcnt(1)
    v_exp_f32 v156, v156
    v_mfma_f32_16x16x32_bf16 v[164:167], a[84:87], a[16:19], v[164:167]
    v_cvt_pk_bf16_f32 v153, v154, v155
    v_mfma_f32_16x16x32_bf16 v[164:167], a[88:91], a[32:35], v[164:167]
    s_waitcnt lgkmcnt(0)
    v_exp_f32 v157, v157
    v_mfma_f32_16x16x32_bf16 v[164:167], a[92:95], a[48:51], v[164:167]
    v_cvt_pk_bf16_f32 v154, v156, v157
    v_mfma_f32_16x16x32_bf16 v[172:175], a[80:83], a[4:7], v[196:199]
    v_exp_f32 v158, v158
    v_mfma_f32_16x16x32_bf16 v[172:175], a[84:87], a[20:23], v[172:175]
    ds_read_b64_tr_b16 a[96:97], v216 offset:0
    ds_read_b64_tr_b16 a[98:99], v216 offset:1024
    v_mfma_f32_16x16x32_bf16 v[172:175], a[88:91], a[36:39], v[172:175]
    v_exp_f32 v159, v159
    v_mfma_f32_16x16x32_bf16 v[172:175], a[92:95], a[52:55], v[172:175]
    v_cvt_pk_bf16_f32 v155, v158, v159
    v_mfma_f32_16x16x32_bf16 v[180:183], a[80:83], a[8:11], v[200:203]
    v_exp_f32 v160, v160
    v_mfma_f32_16x16x32_bf16 v[180:183], a[84:87], a[24:27], v[180:183]
    ds_read_b64_tr_b16 a[100:101], v217 offset:0
    ds_read_b64_tr_b16 a[102:103], v217 offset:1024
    v_mfma_f32_16x16x32_bf16 v[180:183], a[88:91], a[40:43], v[180:183]
    v_exp_f32 v161, v161
    v_mfma_f32_16x16x32_bf16 v[180:183], a[92:95], a[56:59], v[180:183]
    v_cvt_pk_bf16_f32 v160, v160, v161
    v_mfma_f32_16x16x32_bf16 v[188:191], a[80:83], a[12:15], v[204:207]
    v_exp_f32 v162, v162
    v_mfma_f32_16x16x32_bf16 v[188:191], a[84:87], a[28:31], v[188:191]
    ds_read_b64_tr_b16 a[104:105], v218 offset:0
    ds_read_b64_tr_b16 a[106:107], v218 offset:1024
    v_mfma_f32_16x16x32_bf16 v[188:191], a[88:91], a[44:47], v[188:191]
    s_waitcnt lgkmcnt(4)
    v_exp_f32 v163, v163
    v_mfma_f32_16x16x32_bf16 v[188:191], a[92:95], a[60:63], v[188:191]
    v_cvt_pk_bf16_f32 v161, v162, v163
    v_mfma_f32_16x16x32_bf16 v[0:3], a[96:99], v[128:131], v[0:3]
    s_add_u32 s56, s56, 4096
    v_exp_f32 v164, v164
    v_mfma_f32_16x16x32_bf16 v[4:7], a[96:99], v[136:139], v[4:7]
    ds_read_b64_tr_b16 a[108:109], v219 offset:0
    ds_read_b64_tr_b16 a[110:111], v219 offset:1024
    v_mfma_f32_16x16x32_bf16 v[8:11], a[96:99], v[144:147], v[8:11]
    s_waitcnt lgkmcnt(4)
    v_exp_f32 v165, v165
    v_mfma_f32_16x16x32_bf16 v[12:15], a[96:99], v[152:155], v[12:15]
    s_cmp_lt_u32 s56, s58
    v_cvt_pk_bf16_f32 v162, v164, v165
    v_mfma_f32_16x16x32_bf16 v[16:19], a[100:103], v[128:131], v[16:19]
    s_cselect_b32 s56, s56, s57
    v_exp_f32 v166, v166
    v_mfma_f32_16x16x32_bf16 v[20:23], a[100:103], v[136:139], v[20:23]
    ds_read_b64_tr_b16 a[96:97], v220 offset:0
    ds_read_b64_tr_b16 a[98:99], v220 offset:1024
    v_mfma_f32_16x16x32_bf16 v[24:27], a[100:103], v[144:147], v[24:27]
    s_waitcnt lgkmcnt(4)
    v_exp_f32 v167, v167
    v_mfma_f32_16x16x32_bf16 v[28:31], a[100:103], v[152:155], v[28:31]
    v_cvt_pk_bf16_f32 v163, v166, v167
    v_mfma_f32_16x16x32_bf16 v[208:211], a[112:115], v[128:131], v[208:211]
    buffer_load_dwordx4 a[240:243], v238, s[40:43], s56 offen sc1
    v_mfma_f32_16x16x32_bf16 v[32:35], a[104:107], v[128:131], v[32:35]
    v_exp_f32 v168, v168
    v_mfma_f32_16x16x32_bf16 v[36:39], a[104:107], v[136:139], v[36:39]
    ds_read_b64_tr_b16 a[100:101], v221 offset:0
    ds_read_b64_tr_b16 a[102:103], v221 offset:1024
    v_mfma_f32_16x16x32_bf16 v[40:43], a[104:107], v[144:147], v[40:43]
    s_waitcnt lgkmcnt(4)
    v_exp_f32 v169, v169
    v_mfma_f32_16x16x32_bf16 v[44:47], a[104:107], v[152:155], v[44:47]
    v_cvt_pk_bf16_f32 v168, v168, v169
    v_mfma_f32_16x16x32_bf16 v[48:51], a[108:111], v[128:131], v[48:51]
    v_exp_f32 v170, v170
    v_mfma_f32_16x16x32_bf16 v[52:55], a[108:111], v[136:139], v[52:55]
    ds_read_b64_tr_b16 a[104:105], v222 offset:0
    ds_read_b64_tr_b16 a[106:107], v222 offset:1024
    v_mfma_f32_16x16x32_bf16 v[56:59], a[108:111], v[144:147], v[56:59]
    s_waitcnt lgkmcnt(4)
    v_exp_f32 v171, v171
    v_mfma_f32_16x16x32_bf16 v[60:63], a[108:111], v[152:155], v[60:63]
    v_cvt_pk_bf16_f32 v169, v170, v171
    v_mfma_f32_16x16x32_bf16 v[208:211], a[116:119], v[136:139], v[208:211]
    buffer_load_dwordx4 a[244:247], v232, s[40:43], s56 offen sc1
    v_mfma_f32_16x16x32_bf16 v[64:67], a[96:99], v[128:131], v[64:67]
    v_exp_f32 v172, v172
    v_mfma_f32_16x16x32_bf16 v[68:71], a[96:99], v[136:139], v[68:71]
    ds_read_b64_tr_b16 a[108:109], v223 offset:0
    ds_read_b64_tr_b16 a[110:111], v223 offset:1024
    v_mfma_f32_16x16x32_bf16 v[72:75], a[96:99], v[144:147], v[72:75]
    s_waitcnt lgkmcnt(4)
    v_exp_f32 v173, v173
    v_mfma_f32_16x16x32_bf16 v[76:79], a[96:99], v[152:155], v[76:79]
    v_cvt_pk_bf16_f32 v170, v172, v173
    v_mfma_f32_16x16x32_bf16 v[80:83], a[100:103], v[128:131], v[80:83]
    s_add_u32 s52, s52, 32768
    s_and_b32 s52, s52, 524287
    s_add_u32 m0, s75, 147456
    v_exp_f32 v174, v174
    v_mfma_f32_16x16x32_bf16 v[84:87], a[100:103], v[136:139], v[84:87]
    ds_read_b128 a[64:67], v212 offset:16384
    ds_read_b128 a[68:71], v213 offset:16384
    v_mfma_f32_16x16x32_bf16 v[88:91], a[100:103], v[144:147], v[88:91]
    s_waitcnt lgkmcnt(4)
    v_exp_f32 v175, v175
    v_mfma_f32_16x16x32_bf16 v[92:95], a[100:103], v[152:155], v[92:95]
    buffer_load_dwordx4 v240, s[20:23], s52 offen lds
    v_mfma_f32_16x16x32_bf16 v[208:211], a[120:123], v[144:147], v[208:211]
    buffer_load_dwordx4 a[248:251], v233, s[40:43], s56 offen sc1
    v_mfma_f32_16x16x32_bf16 v[96:99], a[104:107], v[128:131], v[96:99]
    v_exp_f32 v176, v176
    v_mfma_f32_16x16x32_bf16 v[100:103], a[104:107], v[136:139], v[100:103]
    ds_read_b128 a[72:75], v214 offset:16384
    ds_read_b128 a[76:79], v215 offset:16384
    v_mfma_f32_16x16x32_bf16 v[104:107], a[104:107], v[144:147], v[104:107]
    s_waitcnt lgkmcnt(4)
    v_exp_f32 v177, v177
    v_mfma_f32_16x16x32_bf16 v[108:111], a[104:107], v[152:155], v[108:111]
    buffer_load_dwordx4 v241, s[20:23], s52 offen offset:1024 lds
    v_mfma_f32_16x16x32_bf16 v[112:115], a[108:111], v[128:131], v[112:115]
    v_exp_f32 v178, v178
    v_mfma_f32_16x16x32_bf16 v[116:119], a[108:111], v[136:139], v[116:119]
    ds_read_b128 a[80:83], v212 offset:17408
    v_cvt_pk_bf16_f32 v171, v174, v175
    v_mfma_f32_16x16x32_bf16 v[120:123], a[108:111], v[144:147], v[120:123]
    s_waitcnt lgkmcnt(4)
    v_exp_f32 v179, v179
    v_mfma_f32_16x16x32_bf16 v[124:127], a[108:111], v[152:155], v[124:127]
    buffer_load_dwordx4 v242, s[20:23], s52 offen offset:2048 lds
    v_mfma_f32_16x16x32_bf16 v[208:211], a[124:127], v[152:155], v[208:211]
    buffer_load_dwordx4 a[252:255], v234, s[40:43], s56 offen sc1
    v_mfma_f32_16x16x32_bf16 v[128:131], a[64:67], a[0:3], v[192:195]
    s_waitcnt lgkmcnt(2)
    v_exp_f32 v180, v180
    v_mfma_f32_16x16x32_bf16 v[128:131], a[68:71], a[16:19], v[128:131]
    ds_read_b128 a[84:87], v213 offset:17408
    v_cvt_pk_bf16_f32 v176, v176, v177
    v_mfma_f32_16x16x32_bf16 v[128:131], a[72:75], a[32:35], v[128:131]
    s_waitcnt lgkmcnt(2)
    v_exp_f32 v181, v181
    v_mfma_f32_16x16x32_bf16 v[128:131], a[76:79], a[48:51], v[128:131]
    buffer_load_dwordx4 v243, s[20:23], s52 offen offset:3072 lds
    v_mfma_f32_16x16x32_bf16 v[136:139], a[64:67], a[4:7], v[196:199]
    s_add_u32 s52, s52, 32768
    s_and_b32 s52, s52, 524287
    s_add_u32 m0, s75, 81920
    v_exp_f32 v182, v182
    v_mfma_f32_16x16x32_bf16 v[136:139], a[68:71], a[20:23], v[136:139]
    ds_read_b128 a[88:91], v214 offset:17408
    v_cvt_pk_bf16_f32 v177, v178, v179
    v_mfma_f32_16x16x32_bf16 v[136:139], a[72:75], a[36:39], v[136:139]
    v_exp_f32 v183, v183
    v_mfma_f32_16x16x32_bf16 v[136:139], a[76:79], a[52:55], v[136:139]
    buffer_load_dwordx4 v240, s[20:23], s52 offen lds
    v_mfma_f32_16x16x32_bf16 v[144:147], a[64:67], a[8:11], v[200:203]
    v_exp_f32 v184, v184
    v_mfma_f32_16x16x32_bf16 v[144:147], a[68:71], a[24:27], v[144:147]
    ds_read_b128 a[92:95], v215 offset:17408
    v_cvt_pk_bf16_f32 v178, v180, v181
    v_mfma_f32_16x16x32_bf16 v[144:147], a[72:75], a[40:43], v[144:147]
    v_exp_f32 v185, v185
    v_mfma_f32_16x16x32_bf16 v[144:147], a[76:79], a[56:59], v[144:147]
    buffer_load_dwordx4 v241, s[20:23], s52 offen offset:1024 lds
    v_mfma_f32_16x16x32_bf16 v[152:155], a[64:67], a[12:15], v[204:207]
    v_exp_f32 v186, v186
    v_mfma_f32_16x16x32_bf16 v[152:155], a[68:71], a[28:31], v[152:155]
    v_cvt_pk_bf16_f32 v179, v182, v183
    v_cvt_pk_bf16_f32 v184, v184, v185
    v_mfma_f32_16x16x32_bf16 v[152:155], a[72:75], a[44:47], v[152:155]
    s_waitcnt lgkmcnt(3)
    v_exp_f32 v187, v187
    v_mfma_f32_16x16x32_bf16 v[152:155], a[76:79], a[60:63], v[152:155]
    buffer_load_dwordx4 v242, s[20:23], s52 offen offset:2048 lds
    v_mfma_f32_16x16x32_bf16 v[132:135], a[80:83], a[0:3], v[192:195]
    s_waitcnt lgkmcnt(1)
    v_exp_f32 v188, v188
    v_mfma_f32_16x16x32_bf16 v[132:135], a[84:87], a[16:19], v[132:135]
    v_cvt_pk_bf16_f32 v185, v186, v187
    v_mfma_f32_16x16x32_bf16 v[132:135], a[88:91], a[32:35], v[132:135]
    s_waitcnt lgkmcnt(0)
    v_exp_f32 v189, v189
    v_mfma_f32_16x16x32_bf16 v[132:135], a[92:95], a[48:51], v[132:135]
    buffer_load_dwordx4 v243, s[20:23], s52 offen offset:3072 lds
    v_mfma_f32_16x16x32_bf16 v[140:143], a[80:83], a[4:7], v[196:199]
    v_exp_f32 v190, v190
    v_mfma_f32_16x16x32_bf16 v[140:143], a[84:87], a[20:23], v[140:143]
    ds_read_b64_tr_b16 a[96:97], v216 offset:8192
    ds_read_b64_tr_b16 a[98:99], v216 offset:9216
    v_mfma_f32_16x16x32_bf16 v[140:143], a[88:91], a[36:39], v[140:143]
    v_exp_f32 v191, v191
    v_mfma_f32_16x16x32_bf16 v[140:143], a[92:95], a[52:55], v[140:143]
    v_cvt_pk_bf16_f32 v186, v188, v189
    v_cvt_pk_bf16_f32 v187, v190, v191
    v_mfma_f32_16x16x32_bf16 v[148:151], a[80:83], a[8:11], v[200:203]
    v_exp_f32 v128, v128
    v_mfma_f32_16x16x32_bf16 v[148:151], a[84:87], a[24:27], v[148:151]
    ds_read_b64_tr_b16 a[100:101], v217 offset:8192
    ds_read_b64_tr_b16 a[102:103], v217 offset:9216
    v_mfma_f32_16x16x32_bf16 v[148:151], a[88:91], a[40:43], v[148:151]
    v_exp_f32 v129, v129
    v_mfma_f32_16x16x32_bf16 v[148:151], a[92:95], a[56:59], v[148:151]
    v_cvt_pk_bf16_f32 v128, v128, v129
    v_mfma_f32_16x16x32_bf16 v[156:159], a[80:83], a[12:15], v[204:207]
    v_exp_f32 v130, v130
    v_mfma_f32_16x16x32_bf16 v[156:159], a[84:87], a[28:31], v[156:159]
    ds_read_b64_tr_b16 a[104:105], v218 offset:8192
    ds_read_b64_tr_b16 a[106:107], v218 offset:9216
    v_mfma_f32_16x16x32_bf16 v[156:159], a[88:91], a[44:47], v[156:159]
    s_waitcnt lgkmcnt(4)
    v_exp_f32 v131, v131
    v_mfma_f32_16x16x32_bf16 v[156:159], a[92:95], a[60:63], v[156:159]
    v_cvt_pk_bf16_f32 v129, v130, v131
    v_mfma_f32_16x16x32_bf16 v[0:3], a[96:99], v[160:163], v[0:3]
    s_lshl_b32 s76, s73, 7
    v_exp_f32 v132, v132
    v_mfma_f32_16x16x32_bf16 v[4:7], a[96:99], v[168:171], v[4:7]
    ds_read_b64_tr_b16 a[108:109], v219 offset:8192
    ds_read_b64_tr_b16 a[110:111], v219 offset:9216
    v_mfma_f32_16x16x32_bf16 v[8:11], a[96:99], v[176:179], v[8:11]
    s_waitcnt lgkmcnt(4)
    v_exp_f32 v133, v133
    v_mfma_f32_16x16x32_bf16 v[12:15], a[96:99], v[184:187], v[12:15]
    v_cvt_pk_bf16_f32 v130, v132, v133
    v_mfma_f32_16x16x32_bf16 v[16:19], a[100:103], v[160:163], v[16:19]
    s_add_u32 s82, s82, s76
    v_exp_f32 v134, v134
    v_mfma_f32_16x16x32_bf16 v[20:23], a[100:103], v[168:171], v[20:23]
    ds_read_b64_tr_b16 a[96:97], v220 offset:8192
    ds_read_b64_tr_b16 a[98:99], v220 offset:9216
    v_mfma_f32_16x16x32_bf16 v[24:27], a[100:103], v[176:179], v[24:27]
    s_waitcnt lgkmcnt(4)
    v_exp_f32 v135, v135
    v_mfma_f32_16x16x32_bf16 v[28:31], a[100:103], v[184:187], v[28:31]
    v_cvt_pk_bf16_f32 v131, v134, v135
    v_mfma_f32_16x16x32_bf16 v[208:211], a[112:115], v[160:163], v[208:211]
    buffer_load_dwordx2 v[224:225], v239, s[4:7], s82 offen offset:0
    v_mfma_f32_16x16x32_bf16 v[32:35], a[104:107], v[160:163], v[32:35]
    v_exp_f32 v136, v136
    v_mfma_f32_16x16x32_bf16 v[36:39], a[104:107], v[168:171], v[36:39]
    ds_read_b64_tr_b16 a[100:101], v221 offset:8192
    ds_read_b64_tr_b16 a[102:103], v221 offset:9216
    v_mfma_f32_16x16x32_bf16 v[40:43], a[104:107], v[176:179], v[40:43]
    s_waitcnt lgkmcnt(4)
    v_exp_f32 v137, v137
    v_mfma_f32_16x16x32_bf16 v[44:47], a[104:107], v[184:187], v[44:47]
    v_cvt_pk_bf16_f32 v136, v136, v137
    v_mfma_f32_16x16x32_bf16 v[48:51], a[108:111], v[160:163], v[48:51]
    v_exp_f32 v138, v138
    v_mfma_f32_16x16x32_bf16 v[52:55], a[108:111], v[168:171], v[52:55]
    ds_read_b64_tr_b16 a[104:105], v222 offset:8192
    ds_read_b64_tr_b16 a[106:107], v222 offset:9216
    v_mfma_f32_16x16x32_bf16 v[56:59], a[108:111], v[176:179], v[56:59]
    s_waitcnt lgkmcnt(4)
    v_exp_f32 v139, v139
    v_mfma_f32_16x16x32_bf16 v[60:63], a[108:111], v[184:187], v[60:63]
    v_cvt_pk_bf16_f32 v137, v138, v139
    v_mfma_f32_16x16x32_bf16 v[208:211], a[116:119], v[168:171], v[208:211]
    buffer_load_dwordx2 v[226:227], v239, s[4:7], s82 offen offset:32
    v_mfma_f32_16x16x32_bf16 v[64:67], a[96:99], v[160:163], v[64:67]
    v_exp_f32 v140, v140
    v_mfma_f32_16x16x32_bf16 v[68:71], a[96:99], v[168:171], v[68:71]
    ds_read_b64_tr_b16 a[108:109], v223 offset:8192
    ds_read_b64_tr_b16 a[110:111], v223 offset:9216
    v_mfma_f32_16x16x32_bf16 v[72:75], a[96:99], v[176:179], v[72:75]
    s_waitcnt lgkmcnt(4)
    v_exp_f32 v141, v141
    v_mfma_f32_16x16x32_bf16 v[76:79], a[96:99], v[184:187], v[76:79]
    v_cvt_pk_bf16_f32 v138, v140, v141
    v_mfma_f32_16x16x32_bf16 v[80:83], a[100:103], v[160:163], v[80:83]
    v_exp_f32 v142, v142
    v_mfma_f32_16x16x32_bf16 v[84:87], a[100:103], v[168:171], v[84:87]
    ds_read_b128 a[64:67], v212 offset:24576
    ds_read_b128 a[68:71], v213 offset:24576
    v_mfma_f32_16x16x32_bf16 v[88:91], a[100:103], v[176:179], v[88:91]
    s_waitcnt lgkmcnt(4)
    v_exp_f32 v143, v143
    v_mfma_f32_16x16x32_bf16 v[92:95], a[100:103], v[184:187], v[92:95]
    v_cvt_pk_bf16_f32 v139, v142, v143
    v_mfma_f32_16x16x32_bf16 v[208:211], a[120:123], v[176:179], v[208:211]
    buffer_load_dwordx2 v[228:229], v239, s[4:7], s82 offen offset:64
    v_mfma_f32_16x16x32_bf16 v[96:99], a[104:107], v[160:163], v[96:99]
    v_exp_f32 v144, v144
    v_mfma_f32_16x16x32_bf16 v[100:103], a[104:107], v[168:171], v[100:103]
    ds_read_b128 a[72:75], v214 offset:24576
    ds_read_b128 a[76:79], v215 offset:24576
    v_mfma_f32_16x16x32_bf16 v[104:107], a[104:107], v[176:179], v[104:107]
    s_waitcnt lgkmcnt(4)
    v_exp_f32 v145, v145
    v_mfma_f32_16x16x32_bf16 v[108:111], a[104:107], v[184:187], v[108:111]
    v_cvt_pk_bf16_f32 v144, v144, v145
    v_mfma_f32_16x16x32_bf16 v[112:115], a[108:111], v[160:163], v[112:115]
    v_exp_f32 v146, v146
    v_mfma_f32_16x16x32_bf16 v[116:119], a[108:111], v[168:171], v[116:119]
    ds_read_b128 a[80:83], v212 offset:25600
    v_mfma_f32_16x16x32_bf16 v[120:123], a[108:111], v[176:179], v[120:123]
    s_waitcnt lgkmcnt(4)
    v_exp_f32 v147, v147
    v_mfma_f32_16x16x32_bf16 v[124:127], a[108:111], v[184:187], v[124:127]
    v_cvt_pk_bf16_f32 v145, v146, v147
    v_mfma_f32_16x16x32_bf16 v[208:211], a[124:127], v[184:187], v[208:211]
    buffer_load_dwordx2 v[230:231], v239, s[4:7], s82 offen offset:96
    v_mfma_f32_16x16x32_bf16 v[160:163], a[64:67], a[0:3], v[192:195]
    s_add_u32 s52, s52, 32768
    s_and_b32 s52, s52, 524287
    s_add_u32 m0, s75, 98304
    v_exp_f32 v148, v148
    s_waitcnt lgkmcnt(3)
    v_mfma_f32_16x16x32_bf16 v[160:163], a[68:71], a[16:19], v[160:163]
    ds_read_b128 a[84:87], v213 offset:25600
    s_waitcnt lgkmcnt(3)
    v_mfma_f32_16x16x32_bf16 v[160:163], a[72:75], a[32:35], v[160:163]
    s_waitcnt lgkmcnt(2)
    v_exp_f32 v149, v149
    v_mfma_f32_16x16x32_bf16 v[160:163], a[76:79], a[48:51], v[160:163]
    buffer_load_dwordx4 v240, s[20:23], s52 offen lds
    v_mfma_f32_16x16x32_bf16 v[168:171], a[64:67], a[4:7], v[196:199]
    v_exp_f32 v150, v150
    v_mfma_f32_16x16x32_bf16 v[168:171], a[68:71], a[20:23], v[168:171]
    ds_read_b128 a[88:91], v214 offset:25600
    v_cvt_pk_bf16_f32 v146, v148, v149
    v_mfma_f32_16x16x32_bf16 v[168:171], a[72:75], a[36:39], v[168:171]
    s_waitcnt vmcnt(45)
    v_exp_f32 v151, v151
    v_mfma_f32_16x16x32_bf16 v[168:171], a[76:79], a[52:55], v[168:171]
    buffer_load_dwordx4 v241, s[20:23], s52 offen offset:1024 lds
    v_mfma_f32_16x16x32_bf16 v[176:179], a[64:67], a[8:11], v[200:203]
    s_barrier
    v_exp_f32 v152, v152
    v_mfma_f32_16x16x32_bf16 v[176:179], a[68:71], a[24:27], v[176:179]
    ds_read_b128 a[92:95], v215 offset:25600
    v_cvt_pk_bf16_f32 v147, v150, v151
    v_mfma_f32_16x16x32_bf16 v[176:179], a[72:75], a[40:43], v[176:179]
    v_exp_f32 v153, v153
    v_mfma_f32_16x16x32_bf16 v[176:179], a[76:79], a[56:59], v[176:179]
    buffer_load_dwordx4 v242, s[20:23], s52 offen offset:2048 lds
    v_mfma_f32_16x16x32_bf16 v[184:187], a[64:67], a[12:15], v[204:207]
    v_exp_f32 v154, v154
    v_mfma_f32_16x16x32_bf16 v[184:187], a[68:71], a[28:31], v[184:187]
    v_cvt_pk_bf16_f32 v152, v152, v153
    v_mfma_f32_16x16x32_bf16 v[184:187], a[72:75], a[44:47], v[184:187]
    s_waitcnt lgkmcnt(3)
    v_exp_f32 v155, v155
    v_mfma_f32_16x16x32_bf16 v[184:187], a[76:79], a[60:63], v[184:187]
    buffer_load_dwordx4 v243, s[20:23], s52 offen offset:3072 lds
    v_mfma_f32_16x16x32_bf16 v[164:167], a[80:83], a[0:3], v[192:195]
    s_waitcnt lgkmcnt(1)
    v_exp_f32 v156, v156
    v_mfma_f32_16x16x32_bf16 v[164:167], a[84:87], a[16:19], v[164:167]
    v_cvt_pk_bf16_f32 v153, v154, v155
    v_mfma_f32_16x16x32_bf16 v[164:167], a[88:91], a[32:35], v[164:167]
    s_waitcnt lgkmcnt(0)
    v_exp_f32 v157, v157
    v_mfma_f32_16x16x32_bf16 v[164:167], a[92:95], a[48:51], v[164:167]
    v_cvt_pk_bf16_f32 v154, v156, v157
    v_mfma_f32_16x16x32_bf16 v[172:175], a[80:83], a[4:7], v[196:199]
    v_exp_f32 v158, v158
    v_mfma_f32_16x16x32_bf16 v[172:175], a[84:87], a[20:23], v[172:175]
    ds_read_b64_tr_b16 a[96:97], v216 offset:16384
    ds_read_b64_tr_b16 a[98:99], v216 offset:17408
    v_mfma_f32_16x16x32_bf16 v[172:175], a[88:91], a[36:39], v[172:175]
    v_exp_f32 v159, v159
    v_mfma_f32_16x16x32_bf16 v[172:175], a[92:95], a[52:55], v[172:175]
    v_cvt_pk_bf16_f32 v155, v158, v159
    v_mfma_f32_16x16x32_bf16 v[180:183], a[80:83], a[8:11], v[200:203]
    v_exp_f32 v160, v160
    v_mfma_f32_16x16x32_bf16 v[180:183], a[84:87], a[24:27], v[180:183]
    ds_read_b64_tr_b16 a[100:101], v217 offset:16384
    ds_read_b64_tr_b16 a[102:103], v217 offset:17408
    v_mfma_f32_16x16x32_bf16 v[180:183], a[88:91], a[40:43], v[180:183]
    v_exp_f32 v161, v161
    v_mfma_f32_16x16x32_bf16 v[180:183], a[92:95], a[56:59], v[180:183]
    v_cvt_pk_bf16_f32 v160, v160, v161
    v_mfma_f32_16x16x32_bf16 v[188:191], a[80:83], a[12:15], v[204:207]
    v_exp_f32 v162, v162
    v_mfma_f32_16x16x32_bf16 v[188:191], a[84:87], a[28:31], v[188:191]
    ds_read_b64_tr_b16 a[104:105], v218 offset:16384
    ds_read_b64_tr_b16 a[106:107], v218 offset:17408
    v_mfma_f32_16x16x32_bf16 v[188:191], a[88:91], a[44:47], v[188:191]
    s_waitcnt lgkmcnt(4)
    v_exp_f32 v163, v163
    v_mfma_f32_16x16x32_bf16 v[188:191], a[92:95], a[60:63], v[188:191]
    v_cvt_pk_bf16_f32 v161, v162, v163
    v_mfma_f32_16x16x32_bf16 v[0:3], a[96:99], v[128:131], v[0:3]
    s_waitcnt vmcnt(40)
    v_exp_f32 v164, v164
    v_mfma_f32_16x16x32_bf16 v[4:7], a[96:99], v[136:139], v[4:7]
    ds_read_b64_tr_b16 a[108:109], v219 offset:16384
    ds_read_b64_tr_b16 a[110:111], v219 offset:17408
    v_mfma_f32_16x16x32_bf16 v[8:11], a[96:99], v[144:147], v[8:11]
    s_waitcnt lgkmcnt(4)
    v_exp_f32 v165, v165
    v_mfma_f32_16x16x32_bf16 v[12:15], a[96:99], v[152:155], v[12:15]
    v_cvt_pk_bf16_f32 v162, v164, v165
    v_mfma_f32_16x16x32_bf16 v[16:19], a[100:103], v[128:131], v[16:19]
    v_exp_f32 v166, v166
    v_mfma_f32_16x16x32_bf16 v[20:23], a[100:103], v[136:139], v[20:23]
    ds_read_b64_tr_b16 a[96:97], v220 offset:16384
    ds_read_b64_tr_b16 a[98:99], v220 offset:17408
    v_mfma_f32_16x16x32_bf16 v[24:27], a[100:103], v[144:147], v[24:27]
    s_waitcnt lgkmcnt(4)
    v_exp_f32 v167, v167
    v_mfma_f32_16x16x32_bf16 v[28:31], a[100:103], v[152:155], v[28:31]
    v_cvt_pk_bf16_f32 v163, v166, v167
    v_mfma_f32_16x16x32_bf16 v[208:211], a[112:115], v[128:131], v[208:211]
    ds_read_b64_tr_b16 a[64:65], v216 offset:24576
    ds_read_b64_tr_b16 a[66:67], v216 offset:25600
    v_mfma_f32_16x16x32_bf16 v[32:35], a[104:107], v[128:131], v[32:35]
    v_exp_f32 v168, v168
    v_mfma_f32_16x16x32_bf16 v[36:39], a[104:107], v[136:139], v[36:39]
    ds_read_b64_tr_b16 a[100:101], v221 offset:16384
    ds_read_b64_tr_b16 a[102:103], v221 offset:17408
    v_mfma_f32_16x16x32_bf16 v[40:43], a[104:107], v[144:147], v[40:43]
    s_waitcnt lgkmcnt(6)
    v_exp_f32 v169, v169
    v_mfma_f32_16x16x32_bf16 v[44:47], a[104:107], v[152:155], v[44:47]
    v_cvt_pk_bf16_f32 v168, v168, v169
    v_mfma_f32_16x16x32_bf16 v[48:51], a[108:111], v[128:131], v[48:51]
    v_exp_f32 v170, v170
    v_mfma_f32_16x16x32_bf16 v[52:55], a[108:111], v[136:139], v[52:55]
    ds_read_b64_tr_b16 a[104:105], v222 offset:16384
    ds_read_b64_tr_b16 a[106:107], v222 offset:17408
    v_mfma_f32_16x16x32_bf16 v[56:59], a[108:111], v[144:147], v[56:59]
    s_waitcnt lgkmcnt(6)
    v_exp_f32 v171, v171
    v_mfma_f32_16x16x32_bf16 v[60:63], a[108:111], v[152:155], v[60:63]
    v_cvt_pk_bf16_f32 v169, v170, v171
    v_mfma_f32_16x16x32_bf16 v[208:211], a[116:119], v[136:139], v[208:211]
    ds_read_b64_tr_b16 a[68:69], v217 offset:24576
    ds_read_b64_tr_b16 a[70:71], v217 offset:25600
    v_mfma_f32_16x16x32_bf16 v[64:67], a[96:99], v[128:131], v[64:67]
    v_add_u32 v252, s75, v237
    v_exp_f32 v172, v172
    v_mfma_f32_16x16x32_bf16 v[68:71], a[96:99], v[136:139], v[68:71]
    ds_read_b64_tr_b16 a[108:109], v223 offset:16384
    ds_read_b64_tr_b16 a[110:111], v223 offset:17408
    v_mfma_f32_16x16x32_bf16 v[72:75], a[96:99], v[144:147], v[72:75]
    s_waitcnt lgkmcnt(6)
    v_exp_f32 v173, v173
    v_mfma_f32_16x16x32_bf16 v[76:79], a[96:99], v[152:155], v[76:79]
    v_cvt_pk_bf16_f32 v170, v172, v173
    v_mfma_f32_16x16x32_bf16 v[80:83], a[100:103], v[128:131], v[80:83]
    v_exp_f32 v174, v174
    v_mfma_f32_16x16x32_bf16 v[84:87], a[100:103], v[136:139], v[84:87]
    ds_read_b64_tr_b16 a[72:73], v218 offset:24576
    ds_read_b64_tr_b16 a[74:75], v218 offset:25600
    v_mfma_f32_16x16x32_bf16 v[88:91], a[100:103], v[144:147], v[88:91]
    s_waitcnt lgkmcnt(6)
    v_exp_f32 v175, v175
    v_mfma_f32_16x16x32_bf16 v[92:95], a[100:103], v[152:155], v[92:95]
    v_cvt_pk_bf16_f32 v171, v174, v175
    v_mfma_f32_16x16x32_bf16 v[208:211], a[120:123], v[144:147], v[208:211]
    ds_read_b64_tr_b16 a[76:77], v219 offset:24576
    ds_read_b64_tr_b16 a[78:79], v219 offset:25600
    v_mfma_f32_16x16x32_bf16 v[96:99], a[104:107], v[128:131], v[96:99]
    v_exp_f32 v176, v176
    v_mfma_f32_16x16x32_bf16 v[100:103], a[104:107], v[136:139], v[100:103]
    ds_read_b64_tr_b16 a[80:81], v220 offset:24576
    ds_read_b64_tr_b16 a[82:83], v220 offset:25600
    v_mfma_f32_16x16x32_bf16 v[104:107], a[104:107], v[144:147], v[104:107]
    s_waitcnt lgkmcnt(6)
    v_exp_f32 v177, v177
    v_mfma_f32_16x16x32_bf16 v[108:111], a[104:107], v[152:155], v[108:111]
    v_cvt_pk_bf16_f32 v176, v176, v177
    v_mfma_f32_16x16x32_bf16 v[112:115], a[108:111], v[128:131], v[112:115]
    v_exp_f32 v178, v178
    v_mfma_f32_16x16x32_bf16 v[116:119], a[108:111], v[136:139], v[116:119]
    ds_read_b64_tr_b16 a[84:85], v221 offset:24576
    ds_read_b64_tr_b16 a[86:87], v221 offset:25600
    v_mfma_f32_16x16x32_bf16 v[120:123], a[108:111], v[144:147], v[120:123]
    v_exp_f32 v179, v179
    v_mfma_f32_16x16x32_bf16 v[124:127], a[108:111], v[152:155], v[124:127]
    v_cvt_pk_bf16_f32 v177, v178, v179
    v_mfma_f32_16x16x32_bf16 v[208:211], a[124:127], v[152:155], v[208:211]
    ds_read_b64_tr_b16 a[88:89], v222 offset:24576
    ds_read_b64_tr_b16 a[90:91], v222 offset:25600
    v_mfma_f32_16x16x32_bf16 v[0:3], a[64:67], v[160:163], v[0:3]
    s_add_u32 s56, s56, 4096
    s_cmp_lt_u32 s56, s58
    s_cselect_b32 s56, s56, s57
    v_exp_f32 v180, v180
    v_mfma_f32_16x16x32_bf16 v[16:19], a[68:71], v[160:163], v[16:19]
    ds_read_b64_tr_b16 a[92:93], v223 offset:24576
    ds_read_b64_tr_b16 a[94:95], v223 offset:25600
    s_waitcnt lgkmcnt(10)
    v_mfma_f32_16x16x32_bf16 v[32:35], a[72:75], v[160:163], v[32:35]
    s_waitcnt lgkmcnt(8)
    v_exp_f32 v181, v181
    v_mfma_f32_16x16x32_bf16 v[48:51], a[76:79], v[160:163], v[48:51]
    buffer_load_dwordx4 a[0:3], v238, s[40:43], s56 offen sc1
    v_mfma_f32_16x16x32_bf16 v[4:7], a[64:67], v[168:171], v[4:7]
    v_exp_f32 v182, v182
    v_mfma_f32_16x16x32_bf16 v[20:23], a[68:71], v[168:171], v[20:23]
    v_cvt_pk_bf16_f32 v178, v180, v181
    v_mfma_f32_16x16x32_bf16 v[36:39], a[72:75], v[168:171], v[36:39]
    s_waitcnt lgkmcnt(6)
    v_exp_f32 v183, v183
    v_mfma_f32_16x16x32_bf16 v[52:55], a[76:79], v[168:171], v[52:55]
    v_cvt_pk_bf16_f32 v179, v182, v183
    v_mfma_f32_16x16x32_bf16 v[208:211], a[112:115], v[160:163], v[208:211]
    buffer_load_dwordx4 a[4:7], v232, s[40:43], s56 offen sc1
    v_mfma_f32_16x16x32_bf16 v[64:67], a[80:83], v[160:163], v[64:67]
    s_waitcnt lgkmcnt(2)
    v_exp_f32 v184, v184
    v_mfma_f32_16x16x32_bf16 v[80:83], a[84:87], v[160:163], v[80:83]
    v_mfma_f32_16x16x32_bf16 v[96:99], a[88:91], v[160:163], v[96:99]
    s_waitcnt lgkmcnt(0)
    v_exp_f32 v185, v185
    v_mfma_f32_16x16x32_bf16 v[112:115], a[92:95], v[160:163], v[112:115]
    buffer_load_dwordx4 a[8:11], v233, s[40:43], s56 offen sc1
    v_mfma_f32_16x16x32_bf16 v[208:211], a[116:119], v[168:171], v[208:211]
    buffer_load_dwordx4 a[12:15], v234, s[40:43], s56 offen sc1
    v_mfma_f32_16x16x32_bf16 v[68:71], a[80:83], v[168:171], v[68:71]
    s_add_u32 s56, s56, 4096
    s_cmp_lt_u32 s56, s58
    s_cselect_b32 s56, s56, s57
    v_exp_f32 v186, v186
    v_mfma_f32_16x16x32_bf16 v[84:87], a[84:87], v[168:171], v[84:87]
    v_cvt_pk_bf16_f32 v184, v184, v185
    v_mfma_f32_16x16x32_bf16 v[100:103], a[88:91], v[168:171], v[100:103]
    v_exp_f32 v187, v187
    v_mfma_f32_16x16x32_bf16 v[116:119], a[92:95], v[168:171], v[116:119]
    buffer_load_dwordx4 a[16:19], v238, s[40:43], s56 offen sc1
    v_mfma_f32_16x16x32_bf16 v[208:211], a[120:123], v[176:179], v[208:211]
    buffer_load_dwordx4 a[20:23], v232, s[40:43], s56 offen sc1
    v_mfma_f32_16x16x32_bf16 v[8:11], a[64:67], v[176:179], v[8:11]
    v_exp_f32 v188, v188
    v_mfma_f32_16x16x32_bf16 v[24:27], a[68:71], v[176:179], v[24:27]
    ds_read_b128 a[96:99], v252 offset:0
    ds_read_b128 a[100:103], v252 offset:1024
    v_mfma_f32_16x16x32_bf16 v[40:43], a[72:75], v[176:179], v[40:43]
    v_exp_f32 v189, v189
    v_mfma_f32_16x16x32_bf16 v[56:59], a[76:79], v[176:179], v[56:59]
    v_cvt_pk_bf16_f32 v185, v186, v187
    v_cvt_pk_bf16_f32 v186, v188, v189
    v_mfma_f32_16x16x32_bf16 v[72:75], a[80:83], v[176:179], v[72:75]
    v_exp_f32 v190, v190
    v_mfma_f32_16x16x32_bf16 v[88:91], a[84:87], v[176:179], v[88:91]
    ds_read_b128 a[104:107], v252 offset:2048
    ds_read_b128 a[108:111], v252 offset:3072
    v_mfma_f32_16x16x32_bf16 v[104:107], a[88:91], v[176:179], v[104:107]
    v_exp_f32 v191, v191
    v_mfma_f32_16x16x32_bf16 v[120:123], a[92:95], v[176:179], v[120:123]
    v_cvt_pk_bf16_f32 v187, v190, v191
    s_nop 1
    v_mfma_f32_16x16x32_bf16 v[208:211], a[124:127], v[184:187], v[208:211]
    v_mfma_f32_16x16x32_bf16 v[12:15], a[64:67], v[184:187], v[12:15]
    buffer_load_dwordx4 a[24:27], v233, s[40:43], s56 offen sc1
    v_mfma_f32_16x16x32_bf16 v[28:31], a[68:71], v[184:187], v[28:31]
    ds_read_b128 a[112:115], v252 offset:16384
    ds_read_b128 a[116:119], v252 offset:17408
    v_mfma_f32_16x16x32_bf16 v[44:47], a[72:75], v[184:187], v[44:47]
    buffer_load_dwordx4 a[28:31], v234, s[40:43], s56 offen sc1
    v_mfma_f32_16x16x32_bf16 v[60:63], a[76:79], v[184:187], v[60:63]
    ds_read_b128 a[120:123], v252 offset:18432
    ds_read_b128 a[124:127], v252 offset:19456
    v_mfma_f32_16x16x32_bf16 v[76:79], a[80:83], v[184:187], v[76:79]
    s_lshl_b32 s76, s72, 2
    s_add_u32 s76, s76, 114688
    v_mfma_f32_16x16x32_bf16 v[92:95], a[84:87], v[184:187], v[92:95]
    v_lshl_add_u32 v194, v236, 12, s76
    v_add_f32 v235, v235, v208
    v_mfma_f32_16x16x32_bf16 v[108:111], a[88:91], v[184:187], v[108:111]
    v_add_f32 v253, v253, v210
    v_add_f32 v198, v235, v209
    v_mfma_f32_16x16x32_bf16 v[124:127], a[92:95], v[184:187], v[124:127]
    v_add_f32 v202, v253, v211
    v_add_f32 v198, v198, v202
    v_cmp_nge_f32 vcc, 0x53800000, v198
    v_rcp_f32 v192, v235
    v_rcp_f32 v196, v209
    v_rcp_f32 v200, v253
    v_rcp_f32 v204, v211
    s_cmp_lg_u64 vcc, 0
    s_cselect_b32 s76, 1, 0
    s_andn2_b32 s76, s76, s81
    v_mov_b32 v198, s76
    s_mov_b64 exec, 15
    ds_write_b32 v194, v198
    s_mov_b64 exec, -1
    v_mov_b32 v193, v192
    v_mov_b32 v197, v196
    v_mov_b32 v201, v200
    v_mov_b32 v205, v204
    s_lshl_b32 s77, s72, 2
    s_sub_u32 s77, s77, s80
    s_and_b32 s76, s77, 15
    s_lshl_b32 s76, s76, 12
    v_add_u32 v208, s76, v237
    s_add_u32 s77, s77, 1
    s_and_b32 s76, s77, 15
    s_lshl_b32 s76, s76, 12
    v_add_u32 v209, s76, v237
    s_add_u32 s77, s77, 1
    s_and_b32 s76, s77, 15
    s_lshl_b32 s76, s76, 12
    v_add_u32 v210, s76, v237
    s_add_u32 s77, s77, 1
    s_and_b32 s76, s77, 15
    s_lshl_b32 s76, s76, 12
    v_add_u32 v211, s76, v237
    s_add_u32 s77, s77, 1
    v_pk_mul_f32 v[0:1], v[0:1], v[192:193]
    v_pk_mul_f32 v[2:3], v[2:3], v[192:193]
    v_pk_mul_f32 v[16:17], v[16:17], v[192:193]
    v_pk_mul_f32 v[18:19], v[18:19], v[192:193]
    v_cvt_pk_bf16_f32 v0, v0, v1
    v_cvt_pk_bf16_f32 v1, v2, v3
    v_cvt_pk_bf16_f32 v2, v16, v17
    v_cvt_pk_bf16_f32 v3, v18, v19
    s_add_u32 s56, s56, 4096
    s_cmp_lt_u32 s56, s58
    s_cselect_b32 s56, s56, s57
    buffer_load_dwordx4 a[32:35], v238, s[40:43], s56 offen sc1
    v_pk_mul_f32 v[32:33], v[32:33], v[192:193]
    v_pk_mul_f32 v[34:35], v[34:35], v[192:193]
    v_pk_mul_f32 v[48:49], v[48:49], v[192:193]
    v_pk_mul_f32 v[50:51], v[50:51], v[192:193]
    s_waitcnt lgkmcnt(1)
    s_barrier
    ds_write_b128 v208, v[0:3] offset:0
    v_cvt_pk_bf16_f32 v32, v32, v33
    v_cvt_pk_bf16_f32 v33, v34, v35
    v_cvt_pk_bf16_f32 v34, v48, v49
    v_cvt_pk_bf16_f32 v35, v50, v51
    v_pk_mul_f32 v[64:65], v[64:65], v[192:193]
    v_pk_mul_f32 v[66:67], v[66:67], v[192:193]
    v_pk_mul_f32 v[80:81], v[80:81], v[192:193]
    v_pk_mul_f32 v[82:83], v[82:83], v[192:193]
    ds_write_b128 v209, v[32:35] offset:0
    v_cvt_pk_bf16_f32 v64, v64, v65
    v_cvt_pk_bf16_f32 v65, v66, v67
    v_cvt_pk_bf16_f32 v66, v80, v81
    v_cvt_pk_bf16_f32 v67, v82, v83
    buffer_load_dwordx4 a[36:39], v232, s[40:43], s56 offen sc1
    v_pk_mul_f32 v[96:97], v[96:97], v[192:193]
    v_pk_mul_f32 v[98:99], v[98:99], v[192:193]
    v_pk_mul_f32 v[112:113], v[112:113], v[192:193]
    v_pk_mul_f32 v[114:115], v[114:115], v[192:193]
    ds_write_b128 v210, v[64:67] offset:0
    v_cvt_pk_bf16_f32 v96, v96, v97
    v_cvt_pk_bf16_f32 v97, v98, v99
    v_cvt_pk_bf16_f32 v98, v112, v113
    v_cvt_pk_bf16_f32 v99, v114, v115
    v_pk_mul_f32 v[4:5], v[4:5], v[196:197]
    v_pk_mul_f32 v[6:7], v[6:7], v[196:197]
    v_pk_mul_f32 v[20:21], v[20:21], v[196:197]
    v_pk_mul_f32 v[22:23], v[22:23], v[196:197]
    ds_write_b128 v211, v[96:99] offset:0
    v_cvt_pk_bf16_f32 v4, v4, v5
    v_cvt_pk_bf16_f32 v5, v6, v7
    v_cvt_pk_bf16_f32 v6, v20, v21
    v_cvt_pk_bf16_f32 v7, v22, v23
    buffer_load_dwordx4 a[40:43], v233, s[40:43], s56 offen sc1
    v_pk_mul_f32 v[36:37], v[36:37], v[196:197]
    v_pk_mul_f32 v[38:39], v[38:39], v[196:197]
    v_pk_mul_f32 v[52:53], v[52:53], v[196:197]
    v_pk_mul_f32 v[54:55], v[54:55], v[196:197]
    ds_write_b128 v208, v[4:7] offset:1024
    v_cvt_pk_bf16_f32 v36, v36, v37
    v_cvt_pk_bf16_f32 v37, v38, v39
    v_cvt_pk_bf16_f32 v38, v52, v53
    v_cvt_pk_bf16_f32 v39, v54, v55
    v_pk_mul_f32 v[68:69], v[68:69], v[196:197]
    v_pk_mul_f32 v[70:71], v[70:71], v[196:197]
    v_pk_mul_f32 v[84:85], v[84:85], v[196:197]
    v_pk_mul_f32 v[86:87], v[86:87], v[196:197]
    ds_write_b128 v209, v[36:39] offset:1024
    v_cvt_pk_bf16_f32 v68, v68, v69
    v_cvt_pk_bf16_f32 v69, v70, v71
    v_cvt_pk_bf16_f32 v70, v84, v85
    v_cvt_pk_bf16_f32 v71, v86, v87
    buffer_load_dwordx4 a[44:47], v234, s[40:43], s56 offen sc1
    v_pk_mul_f32 v[100:101], v[100:101], v[196:197]
    v_pk_mul_f32 v[102:103], v[102:103], v[196:197]
    v_pk_mul_f32 v[116:117], v[116:117], v[196:197]
    v_pk_mul_f32 v[118:119], v[118:119], v[196:197]
    ds_write_b128 v210, v[68:71] offset:1024
    v_cvt_pk_bf16_f32 v100, v100, v101
    v_cvt_pk_bf16_f32 v101, v102, v103
    v_cvt_pk_bf16_f32 v102, v116, v117
    v_cvt_pk_bf16_f32 v103, v118, v119
    v_pk_mul_f32 v[8:9], v[8:9], v[200:201]
    v_pk_mul_f32 v[10:11], v[10:11], v[200:201]
    v_pk_mul_f32 v[24:25], v[24:25], v[200:201]
    v_pk_mul_f32 v[26:27], v[26:27], v[200:201]
    ds_write_b128 v211, v[100:103] offset:1024
    v_cvt_pk_bf16_f32 v8, v8, v9
    v_cvt_pk_bf16_f32 v9, v10, v11
    v_cvt_pk_bf16_f32 v10, v24, v25
    v_cvt_pk_bf16_f32 v11, v26, v27
    s_add_u32 s56, s56, 4096
    s_cmp_lt_u32 s56, s58
    s_cselect_b32 s56, s56, s57
    buffer_load_dwordx4 a[48:51], v238, s[40:43], s56 offen sc1
    v_pk_mul_f32 v[40:41], v[40:41], v[200:201]
    v_pk_mul_f32 v[42:43], v[42:43], v[200:201]
    v_pk_mul_f32 v[56:57], v[56:57], v[200:201]
    v_pk_mul_f32 v[58:59], v[58:59], v[200:201]
    ds_write_b128 v208, v[8:11] offset:2048
    v_cvt_pk_bf16_f32 v40, v40, v41
    v_cvt_pk_bf16_f32 v41, v42, v43
    v_cvt_pk_bf16_f32 v42, v56, v57
    v_cvt_pk_bf16_f32 v43, v58, v59
    v_pk_mul_f32 v[72:73], v[72:73], v[200:201]
    v_pk_mul_f32 v[74:75], v[74:75], v[200:201]
    v_pk_mul_f32 v[88:89], v[88:89], v[200:201]
    v_pk_mul_f32 v[90:91], v[90:91], v[200:201]
    ds_write_b128 v209, v[40:43] offset:2048
    v_cvt_pk_bf16_f32 v72, v72, v73
    v_cvt_pk_bf16_f32 v73, v74, v75
    v_cvt_pk_bf16_f32 v74, v88, v89
    v_cvt_pk_bf16_f32 v75, v90, v91
    buffer_load_dwordx4 a[52:55], v232, s[40:43], s56 offen sc1
    v_pk_mul_f32 v[104:105], v[104:105], v[200:201]
    v_pk_mul_f32 v[106:107], v[106:107], v[200:201]
    v_pk_mul_f32 v[120:121], v[120:121], v[200:201]
    v_pk_mul_f32 v[122:123], v[122:123], v[200:201]
    ds_write_b128 v210, v[72:75] offset:2048
    v_cvt_pk_bf16_f32 v104, v104, v105
    v_cvt_pk_bf16_f32 v105, v106, v107
    v_cvt_pk_bf16_f32 v106, v120, v121
    v_cvt_pk_bf16_f32 v107, v122, v123
    v_pk_mul_f32 v[12:13], v[12:13], v[204:205]
    v_pk_mul_f32 v[14:15], v[14:15], v[204:205]
    v_pk_mul_f32 v[28:29], v[28:29], v[204:205]
    v_pk_mul_f32 v[30:31], v[30:31], v[204:205]
    ds_write_b128 v211, v[104:107] offset:2048
    v_cvt_pk_bf16_f32 v12, v12, v13
    v_cvt_pk_bf16_f32 v13, v14, v15
    v_cvt_pk_bf16_f32 v14, v28, v29
    v_cvt_pk_bf16_f32 v15, v30, v31
    buffer_load_dwordx4 a[56:59], v233, s[40:43], s56 offen sc1
    v_pk_mul_f32 v[44:45], v[44:45], v[204:205]
    v_pk_mul_f32 v[46:47], v[46:47], v[204:205]
    v_pk_mul_f32 v[60:61], v[60:61], v[204:205]
    v_pk_mul_f32 v[62:63], v[62:63], v[204:205]
    ds_write_b128 v208, v[12:15] offset:3072
    v_cvt_pk_bf16_f32 v44, v44, v45
    v_cvt_pk_bf16_f32 v45, v46, v47
    v_cvt_pk_bf16_f32 v46, v60, v61
    v_cvt_pk_bf16_f32 v47, v62, v63
    s_waitcnt lgkmcnt(8)
    v_pk_mul_f32 v[76:77], v[76:77], v[204:205]
    v_pk_mul_f32 v[78:79], v[78:79], v[204:205]
    v_pk_mul_f32 v[92:93], v[92:93], v[204:205]
    v_pk_mul_f32 v[94:95], v[94:95], v[204:205]
    ds_write_b128 v209, v[44:47] offset:3072
    v_cvt_pk_bf16_f32 v76, v76, v77
    v_cvt_pk_bf16_f32 v77, v78, v79
    v_cvt_pk_bf16_f32 v78, v92, v93
    v_cvt_pk_bf16_f32 v79, v94, v95
    buffer_load_dwordx4 a[60:63], v234, s[40:43], s56 offen sc1
    v_pk_mul_f32 v[108:109], v[108:109], v[204:205]
    v_pk_mul_f32 v[110:111], v[110:111], v[204:205]
    v_pk_mul_f32 v[124:125], v[124:125], v[204:205]
    v_pk_mul_f32 v[126:127], v[126:127], v[204:205]
    ds_write_b128 v210, v[76:79] offset:3072
    v_cvt_pk_bf16_f32 v108, v108, v109
    v_cvt_pk_bf16_f32 v109, v110, v111
    v_cvt_pk_bf16_f32 v110, v124, v125
    v_cvt_pk_bf16_f32 v111, v126, v127
    ds_write_b128 v211, v[108:111] offset:3072
    s_add_u32 s76, s75, 114688
    v_mov_b32 v252, s76
    s_waitcnt vmcnt(48)
    ds_read_b64_tr_b16 v[128:129], v248 offset:0
    ds_read_b64_tr_b16 v[130:131], v248 offset:2048
    ds_read_b64_tr_b16 v[132:133], v249 offset:0
    ds_read_b64_tr_b16 v[134:135], v249 offset:2048
    s_waitcnt lgkmcnt(4)
    s_barrier
    ds_read_b128 v[64:67], v252
    ds_read_b128 v[160:163], v237 offset:0
    ds_read_b128 v[164:167], v237 offset:1024
    ds_read_b128 v[168:171], v237 offset:2048
    ds_read_b128 v[172:175], v237 offset:3072
    s_waitcnt lgkmcnt(4)
    v_or_b32 v64, v64, v65
    v_or3_b32 v64, v64, v66, v67
    s_nop 0
    v_readfirstlane_b32 s76, v64
    s_nop 0
    s_cmp_lg_u32 s76, 0
    s_cbranch_scc1 L_slow
    s_waitcnt lgkmcnt(3)
    v_mfma_f32_16x16x32_bf16 v[0:3], v[128:131], v[160:163], 0
    ds_read_b64_tr_b16 v[136:137], v250 offset:0
    ds_read_b64_tr_b16 v[138:139], v250 offset:2048
    s_waitcnt lgkmcnt(4)
    v_mfma_f32_16x16x32_bf16 v[4:7], v[128:131], v[164:167], 0
    ds_read_b128 v[176:179], v237 offset:4096
    ds_read_b128 v[180:183], v237 offset:5120
    s_add_u32 s52, s52, 32768
    s_and_b32 s52, s52, 524287
    s_add_u32 m0, s75, 114688
    s_waitcnt lgkmcnt(5)
    v_mfma_f32_16x16x32_bf16 v[8:11], v[128:131], v[168:171], 0
    buffer_load_dwordx4 v240, s[20:23], s52 offen lds
    s_waitcnt lgkmcnt(4)
    v_mfma_f32_16x16x32_bf16 v[12:15], v[128:131], v[172:175], 0
    v_mfma_f32_16x16x32_bf16 v[16:19], v[132:135], v[160:163], 0
    ds_read_b64_tr_b16 v[140:141], v251 offset:0
    ds_read_b64_tr_b16 v[142:143], v251 offset:2048
    v_mfma_f32_16x16x32_bf16 v[20:23], v[132:135], v[164:167], 0
    v_mfma_f32_16x16x32_bf16 v[24:27], v[132:135], v[168:171], 0
    buffer_load_dwordx4 v241, s[20:23], s52 offen offset:1024 lds
    v_mfma_f32_16x16x32_bf16 v[28:31], v[132:135], v[172:175], 0
    s_waitcnt vmcnt(46) lgkmcnt(4)
    v_mfma_f32_16x16x32_bf16 v[32:35], v[136:139], v[160:163], 0
    ds_read_b64_tr_b16 v[144:145], v244 offset:0
    ds_read_b64_tr_b16 v[146:147], v244 offset:2048
    v_mfma_f32_16x16x32_bf16 v[36:39], v[136:139], v[164:167], 0
    ds_read_b128 v[184:187], v237 offset:6144
    ds_read_b128 v[188:191], v237 offset:7168
    v_mfma_f32_16x16x32_bf16 v[40:43], v[136:139], v[168:171], 0
    buffer_load_dwordx4 v242, s[20:23], s52 offen offset:2048 lds
    v_mfma_f32_16x16x32_bf16 v[44:47], v[136:139], v[172:175], 0
    s_waitcnt lgkmcnt(4)
    s_lshl_b32 s48, s74, 2
    s_lshr_b32 s76, s73, 1
    v_mfma_f32_16x16x32_bf16 v[48:51], v[140:143], v[160:163], 0
    ds_read_b64_tr_b16 v[148:149], v245 offset:0
    ds_read_b64_tr_b16 v[150:151], v245 offset:2048
    v_mfma_f32_16x16x32_bf16 v[52:55], v[140:143], v[164:167], 0
    s_add_u32 s48, s48, s76
    s_lshl_b32 s48, s48, 5
    v_mfma_f32_16x16x32_bf16 v[56:59], v[140:143], v[168:171], 0
    buffer_load_dwordx4 v243, s[20:23], s52 offen offset:3072 lds
    v_mfma_f32_16x16x32_bf16 v[60:63], v[140:143], v[172:175], 0
    s_waitcnt lgkmcnt(2)
    s_add_u32 s52, s52, 32768
    s_and_b32 s52, s52, 524287
    v_mfma_f32_16x16x32_bf16 v[0:3], v[144:147], v[176:179], v[0:3]
    ds_read_b64_tr_b16 v[152:153], v246 offset:0
    ds_read_b64_tr_b16 v[154:155], v246 offset:2048
    v_mfma_f32_16x16x32_bf16 v[4:7], v[144:147], v[180:183], v[4:7]
    ds_read_b128 v[160:163], v237 offset:8192
    ds_read_b128 v[164:167], v237 offset:9216
    s_add_u32 m0, s75, 131072
    v_mfma_f32_16x16x32_bf16 v[8:11], v[144:147], v[184:187], v[8:11]
    buffer_load_dwordx4 v240, s[20:23], s52 offen lds
    v_mfma_f32_16x16x32_bf16 v[12:15], v[144:147], v[188:191], v[12:15]
    s_waitcnt lgkmcnt(4)
    s_add_u32 s48, s48, 33554432
    v_and_b32 v232, 7, v236
    v_mfma_f32_16x16x32_bf16 v[16:19], v[148:151], v[176:179], v[16:19]
    ds_read_b64_tr_b16 v[156:157], v247 offset:0
    ds_read_b64_tr_b16 v[158:159], v247 offset:2048
    v_mfma_f32_16x16x32_bf16 v[20:23], v[148:151], v[180:183], v[20:23]
    v_lshlrev_b32 v232, 2, v232
    s_lshl_b32 s49, s74, 3
    v_mfma_f32_16x16x32_bf16 v[24:27], v[148:151], v[184:187], v[24:27]
    buffer_load_dwordx4 v241, s[20:23], s52 offen offset:1024 lds
    v_mfma_f32_16x16x32_bf16 v[28:31], v[148:151], v[188:191], v[28:31]
    s_waitcnt vmcnt(34) lgkmcnt(4)
    s_add_u32 s49, s49, s73
    s_lshl_b32 s49, s49, 16
    v_mfma_f32_16x16x32_bf16 v[32:35], v[152:155], v[176:179], v[32:35]
    ds_read_b64_tr_b16 v[128:129], v248 offset:16384
    ds_read_b64_tr_b16 v[130:131], v248 offset:18432
    v_mfma_f32_16x16x32_bf16 v[36:39], v[152:155], v[180:183], v[36:39]
    ds_read_b128 v[168:171], v237 offset:10240
    ds_read_b128 v[172:175], v237 offset:11264
    v_mfma_f32_16x16x32_bf16 v[40:43], v[152:155], v[184:187], v[40:43]
    buffer_load_dwordx4 v242, s[20:23], s52 offen offset:2048 lds
    v_mfma_f32_16x16x32_bf16 v[44:47], v[152:155], v[188:191], v[44:47]
    s_waitcnt lgkmcnt(4)
    s_lshl_b32 s76, s72, 11
    s_add_u32 s49, s49, s76
    v_mfma_f32_16x16x32_bf16 v[48:51], v[156:159], v[176:179], v[48:51]
    ds_read_b64_tr_b16 v[132:133], v249 offset:16384
    ds_read_b64_tr_b16 v[134:135], v249 offset:18432
    v_mfma_f32_16x16x32_bf16 v[52:55], v[156:159], v[180:183], v[52:55]
    s_add_u32 s49, s49, 8388608
    s_add_u32 s76, s72, 1
    v_mfma_f32_16x16x32_bf16 v[56:59], v[156:159], v[184:187], v[56:59]
    buffer_load_dwordx4 v243, s[20:23], s52 offen offset:3072 lds
    v_mfma_f32_16x16x32_bf16 v[60:63], v[156:159], v[188:191], v[60:63]
    s_waitcnt lgkmcnt(2)
    s_add_u32 s52, s52, 32768
    s_and_b32 s52, s52, 524287
    v_mfma_f32_16x16x32_bf16 v[0:3], v[128:131], v[160:163], v[0:3]
    ds_read_b64_tr_b16 v[136:137], v250 offset:16384
    ds_read_b64_tr_b16 v[138:139], v250 offset:18432
    v_mfma_f32_16x16x32_bf16 v[4:7], v[128:131], v[164:167], v[4:7]
    ds_read_b128 v[176:179], v237 offset:12288
    ds_read_b128 v[180:183], v237 offset:13312
    s_add_u32 m0, s75, 65536
    v_mfma_f32_16x16x32_bf16 v[8:11], v[128:131], v[168:171], v[8:11]
    buffer_load_dwordx4 v240, s[20:23], s52 offen lds
    v_mfma_f32_16x16x32_bf16 v[12:15], v[128:131], v[172:175], v[12:15]
    s_waitcnt lgkmcnt(4)
    s_and_b32 s76, s76, 3
    s_lshl_b32 s76, s76, 14
    v_mfma_f32_16x16x32_bf16 v[16:19], v[132:135], v[160:163], v[16:19]
    ds_read_b64_tr_b16 v[140:141], v251 offset:16384
    ds_read_b64_tr_b16 v[142:143], v251 offset:18432
    v_mfma_f32_16x16x32_bf16 v[20:23], v[132:135], v[164:167], v[20:23]
    v_add_u32 v233, s76, v237
    s_add_u32 s76, s72, 2
    v_mfma_f32_16x16x32_bf16 v[24:27], v[132:135], v[168:171], v[24:27]
    buffer_load_dwordx4 v241, s[20:23], s52 offen offset:1024 lds
    v_mfma_f32_16x16x32_bf16 v[28:31], v[132:135], v[172:175], v[28:31]
    s_waitcnt vmcnt(34) lgkmcnt(4)
    s_and_b32 s76, s76, 3
    s_lshl_b32 s76, s76, 14
    v_mfma_f32_16x16x32_bf16 v[32:35], v[136:139], v[160:163], v[32:35]
    ds_read_b64_tr_b16 v[144:145], v244 offset:16384
    ds_read_b64_tr_b16 v[146:147], v244 offset:18432
    v_mfma_f32_16x16x32_bf16 v[36:39], v[136:139], v[164:167], v[36:39]
    ds_read_b128 v[184:187], v237 offset:14336
    ds_read_b128 v[188:191], v237 offset:15360
    v_mfma_f32_16x16x32_bf16 v[40:43], v[136:139], v[168:171], v[40:43]
    buffer_load_dwordx4 v242, s[20:23], s52 offen offset:2048 lds
    v_mfma_f32_16x16x32_bf16 v[44:47], v[136:139], v[172:175], v[44:47]
    s_waitcnt lgkmcnt(4)
    v_add_u32 v234, s76, v237
    s_add_u32 s76, s72, 3
    v_mfma_f32_16x16x32_bf16 v[48:51], v[140:143], v[160:163], v[48:51]
    ds_read_b64_tr_b16 v[148:149], v245 offset:16384
    ds_read_b64_tr_b16 v[150:151], v245 offset:18432
    v_mfma_f32_16x16x32_bf16 v[52:55], v[140:143], v[164:167], v[52:55]
    s_and_b32 s76, s76, 3
    s_lshl_b32 s76, s76, 14
    v_mfma_f32_16x16x32_bf16 v[56:59], v[140:143], v[168:171], v[56:59]
    buffer_load_dwordx4 v243, s[20:23], s52 offen offset:3072 lds
    v_mfma_f32_16x16x32_bf16 v[60:63], v[140:143], v[172:175], v[60:63]
    s_waitcnt lgkmcnt(2)
    s_add_u32 s52, s52, 32768
    s_and_b32 s52, s52, 524287
    v_mfma_f32_16x16x32_bf16 v[0:3], v[144:147], v[176:179], v[0:3]
    ds_read_b64_tr_b16 v[152:153], v246 offset:16384
    ds_read_b64_tr_b16 v[154:155], v246 offset:18432
    v_mfma_f32_16x16x32_bf16 v[4:7], v[144:147], v[180:183], v[4:7]
    ds_read_b128 v[160:163], v237 offset:16384
    ds_read_b128 v[164:167], v237 offset:17408
    s_add_u32 m0, s75, 147456
    v_mfma_f32_16x16x32_bf16 v[8:11], v[144:147], v[184:187], v[8:11]
    buffer_load_dwordx4 v240, s[20:23], s52 offen lds
    v_mfma_f32_16x16x32_bf16 v[12:15], v[144:147], v[188:191], v[12:15]
    s_waitcnt lgkmcnt(4)
    v_add_u32 v235, s76, v237
    v_bfe_u32 v68, v236, 2, 2
    v_mfma_f32_16x16x32_bf16 v[16:19], v[148:151], v[176:179], v[16:19]
    ds_read_b64_tr_b16 v[156:157], v247 offset:16384
    ds_read_b64_tr_b16 v[158:159], v247 offset:18432
    v_mfma_f32_16x16x32_bf16 v[20:23], v[148:151], v[180:183], v[20:23]
    v_lshrrev_b32 v69, 4, v236
    v_cmp_eq_u32 vcc, v68, v69
    v_mfma_f32_16x16x32_bf16 v[24:27], v[148:151], v[184:187], v[24:27]
    buffer_load_dwordx4 v241, s[20:23], s52 offen offset:1024 lds
    v_mfma_f32_16x16x32_bf16 v[28:31], v[148:151], v[188:191], v[28:31]
    s_waitcnt vmcnt(30) lgkmcnt(4)
    v_and_b32 v68, 1, v236
    v_lshlrev_b32 v68, 4, v68
    v_mfma_f32_16x16x32_bf16 v[32:35], v[152:155], v[176:179], v[32:35]
    ds_read_b64_tr_b16 v[128:129], v244 offset:32768
    ds_read_b64_tr_b16 v[130:131], v244 offset:34816
    v_mfma_f32_16x16x32_bf16 v[36:39], v[152:155], v[180:183], v[36:39]
    ds_read_b128 v[168:171], v237 offset:18432
    ds_read_b128 v[172:175], v237 offset:19456
    v_mfma_f32_16x16x32_bf16 v[40:43], v[152:155], v[184:187], v[40:43]
    buffer_load_dwordx4 v242, s[20:23], s52 offen offset:2048 lds
    v_mfma_f32_16x16x32_bf16 v[44:47], v[152:155], v[188:191], v[44:47]
    s_waitcnt lgkmcnt(4)
    v_mov_b32 v69, 0x3f80
    v_lshlrev_b32 v69, v68, v69
    v_mfma_f32_16x16x32_bf16 v[48:51], v[156:159], v[176:179], v[48:51]
    ds_read_b64_tr_b16 v[132:133], v245 offset:32768
    ds_read_b64_tr_b16 v[134:135], v245 offset:34816
    v_mfma_f32_16x16x32_bf16 v[52:55], v[156:159], v[180:183], v[52:55]
    v_cndmask_b32 v69, 0, v69, vcc
    v_and_b32 v68, 2, v236
    v_mfma_f32_16x16x32_bf16 v[56:59], v[156:159], v[184:187], v[56:59]
    buffer_load_dwordx4 v243, s[20:23], s52 offen offset:3072 lds
    v_mfma_f32_16x16x32_bf16 v[60:63], v[156:159], v[188:191], v[60:63]
    s_waitcnt lgkmcnt(2)
    s_add_u32 s52, s52, 32768
    s_and_b32 s52, s52, 524287
    v_mfma_f32_16x16x32_bf16 v[0:3], v[128:131], v[160:163], v[0:3]
    ds_read_b64_tr_b16 v[136:137], v246 offset:32768
    ds_read_b64_tr_b16 v[138:139], v246 offset:34816
    v_mfma_f32_16x16x32_bf16 v[4:7], v[128:131], v[164:167], v[4:7]
    ds_read_b128 v[176:179], v237 offset:20480
    ds_read_b128 v[180:183], v237 offset:21504
    s_add_u32 m0, s75, 81920
    v_mfma_f32_16x16x32_bf16 v[8:11], v[128:131], v[168:171], v[8:11]
    buffer_load_dwordx4 v240, s[20:23], s52 offen lds
    v_mfma_f32_16x16x32_bf16 v[12:15], v[128:131], v[172:175], v[12:15]
    s_waitcnt lgkmcnt(4)
    v_cmp_eq_u32 vcc, 0, v68
    v_accvgpr_write_b32 a72, 0
    v_mfma_f32_16x16x32_bf16 v[16:19], v[132:135], v[160:163], v[16:19]
    ds_read_b64_tr_b16 v[140:141], v247 offset:32768
    ds_read_b64_tr_b16 v[142:143], v247 offset:34816
    v_mfma_f32_16x16x32_bf16 v[20:23], v[132:135], v[164:167], v[20:23]
    v_accvgpr_write_b32 a73, 0
    v_cndmask_b32 v70, 0, v69, vcc
    v_mfma_f32_16x16x32_bf16 v[24:27], v[132:135], v[168:171], v[24:27]
    buffer_load_dwordx4 v241, s[20:23], s52 offen offset:1024 lds
    v_mfma_f32_16x16x32_bf16 v[28:31], v[132:135], v[172:175], v[28:31]
    s_waitcnt vmcnt(14) lgkmcnt(4)
    v_cndmask_b32 v71, v69, 0, vcc
    v_accvgpr_write_b32 a76, 0
    v_mfma_f32_16x16x32_bf16 v[32:35], v[136:139], v[160:163], v[32:35]
    ds_read_b64_tr_b16 v[144:145], v244 offset:49152
    ds_read_b64_tr_b16 v[146:147], v244 offset:51200
    v_mfma_f32_16x16x32_bf16 v[36:39], v[136:139], v[164:167], v[36:39]
    ds_read_b128 v[184:187], v237 offset:22528
    ds_read_b128 v[188:191], v237 offset:23552
    v_mfma_f32_16x16x32_bf16 v[40:43], v[136:139], v[168:171], v[40:43]
    buffer_load_dwordx4 v242, s[20:23], s52 offen offset:2048 lds
    v_mfma_f32_16x16x32_bf16 v[44:47], v[136:139], v[172:175], v[44:47]
    s_waitcnt lgkmcnt(4)
    v_accvgpr_write_b32 a77, 0
    v_accvgpr_write_b32 a74, v70
    v_mfma_f32_16x16x32_bf16 v[48:51], v[140:143], v[160:163], v[48:51]
    ds_read_b64_tr_b16 v[148:149], v245 offset:49152
    ds_read_b64_tr_b16 v[150:151], v245 offset:51200
    v_mfma_f32_16x16x32_bf16 v[52:55], v[140:143], v[164:167], v[52:55]
    v_accvgpr_write_b32 a75, v71
    v_mfma_f32_16x16x32_bf16 v[56:59], v[140:143], v[168:171], v[56:59]
    buffer_load_dwordx4 v243, s[20:23], s52 offen offset:3072 lds
    v_mfma_f32_16x16x32_bf16 v[60:63], v[140:143], v[172:175], v[60:63]
    s_waitcnt lgkmcnt(2)
    s_add_u32 s52, s52, 32768
    s_and_b32 s52, s52, 524287
    v_mfma_f32_16x16x32_bf16 v[0:3], v[144:147], v[176:179], v[0:3]
    ds_read_b64_tr_b16 v[152:153], v246 offset:49152
    ds_read_b64_tr_b16 v[154:155], v246 offset:51200
    v_mfma_f32_16x16x32_bf16 v[4:7], v[144:147], v[180:183], v[4:7]
    ds_read_b128 v[160:163], v237 offset:24576
    ds_read_b128 v[164:167], v237 offset:25600
    s_add_u32 m0, s75, 98304
    v_mfma_f32_16x16x32_bf16 v[8:11], v[144:147], v[184:187], v[8:11]
    buffer_load_dwordx4 v240, s[20:23], s52 offen lds
    v_mfma_f32_16x16x32_bf16 v[12:15], v[144:147], v[188:191], v[12:15]
    s_waitcnt lgkmcnt(4)
    v_mfma_f32_16x16x32_bf16 v[16:19], v[148:151], v[176:179], v[16:19]
    ds_read_b64_tr_b16 v[156:157], v247 offset:49152
    ds_read_b64_tr_b16 v[158:159], v247 offset:51200
    v_mfma_f32_16x16x32_bf16 v[20:23], v[148:151], v[180:183], v[20:23]
    v_mfma_f32_16x16x32_bf16 v[24:27], v[148:151], v[184:187], v[24:27]
    buffer_load_dwordx4 v241, s[20:23], s52 offen offset:1024 lds
    v_mfma_f32_16x16x32_bf16 v[28:31], v[148:151], v[188:191], v[28:31]
    s_waitcnt vmcnt(14) lgkmcnt(4)
    v_mfma_f32_16x16x32_bf16 v[32:35], v[152:155], v[176:179], v[32:35]
    ds_read_b64_tr_b16 v[128:129], v248 offset:0
    ds_read_b64_tr_b16 v[130:131], v248 offset:2048
    v_mfma_f32_16x16x32_bf16 v[36:39], v[152:155], v[180:183], v[36:39]
    ds_read_b128 v[168:171], v237 offset:26624
    ds_read_b128 v[172:175], v237 offset:27648
    v_mfma_f32_16x16x32_bf16 v[40:43], v[152:155], v[184:187], v[40:43]
    buffer_load_dwordx4 v242, s[20:23], s52 offen offset:2048 lds
    v_mfma_f32_16x16x32_bf16 v[44:47], v[152:155], v[188:191], v[44:47]
    s_waitcnt lgkmcnt(4)
    v_mfma_f32_16x16x32_bf16 v[48:51], v[156:159], v[176:179], v[48:51]
    ds_read_b64_tr_b16 v[132:133], v249 offset:0
    ds_read_b64_tr_b16 v[134:135], v249 offset:2048
    v_mfma_f32_16x16x32_bf16 v[52:55], v[156:159], v[180:183], v[52:55]
    v_mfma_f32_16x16x32_bf16 v[56:59], v[156:159], v[184:187], v[56:59]
    buffer_load_dwordx4 v243, s[20:23], s52 offen offset:3072 lds
    v_mfma_f32_16x16x32_bf16 v[60:63], v[156:159], v[188:191], v[60:63]
    s_waitcnt lgkmcnt(2)
    s_add_u32 s52, s52, 32768
    s_and_b32 s52, s52, 524287
    v_mfma_f32_16x16x32_bf16 v[0:3], v[128:131], v[160:163], v[0:3]
    ds_read_b64_tr_b16 v[136:137], v250 offset:0
    ds_read_b64_tr_b16 v[138:139], v250 offset:2048
    v_mfma_f32_16x16x32_bf16 v[4:7], v[128:131], v[164:167], v[4:7]
    ds_read_b128 v[176:179], v237 offset:28672
    ds_read_b128 v[180:183], v237 offset:29696
    s_add_u32 m0, s75, 114688
    v_mfma_f32_16x16x32_bf16 v[8:11], v[128:131], v[168:171], v[8:11]
    buffer_load_dwordx4 v240, s[20:23], s52 offen lds
    v_mfma_f32_16x16x32_bf16 v[12:15], v[128:131], v[172:175], v[12:15]
    s_waitcnt lgkmcnt(4)
    v_mfma_f32_16x16x32_bf16 v[16:19], v[132:135], v[160:163], v[16:19]
    ds_read_b64_tr_b16 v[140:141], v251 offset:0
    ds_read_b64_tr_b16 v[142:143], v251 offset:2048
    v_mfma_f32_16x16x32_bf16 v[20:23], v[132:135], v[164:167], v[20:23]
    v_mfma_f32_16x16x32_bf16 v[24:27], v[132:135], v[168:171], v[24:27]
    buffer_load_dwordx4 v241, s[20:23], s52 offen offset:1024 lds
    v_mfma_f32_16x16x32_bf16 v[28:31], v[132:135], v[172:175], v[28:31]
    s_waitcnt vmcnt(14) lgkmcnt(4)
    v_mfma_f32_16x16x32_bf16 v[32:35], v[136:139], v[160:163], v[32:35]
    ds_read_b64_tr_b16 v[144:145], v244 offset:0
    ds_read_b64_tr_b16 v[146:147], v244 offset:2048
    v_mfma_f32_16x16x32_bf16 v[36:39], v[136:139], v[164:167], v[36:39]
    ds_read_b128 v[184:187], v237 offset:30720
    ds_read_b128 v[188:191], v237 offset:31744
    v_mfma_f32_16x16x32_bf16 v[40:43], v[136:139], v[168:171], v[40:43]
    buffer_load_dwordx4 v242, s[20:23], s52 offen offset:2048 lds
    v_mfma_f32_16x16x32_bf16 v[44:47], v[136:139], v[172:175], v[44:47]
    s_waitcnt lgkmcnt(4)
    v_mfma_f32_16x16x32_bf16 v[48:51], v[140:143], v[160:163], v[48:51]
    ds_read_b64_tr_b16 v[148:149], v245 offset:0
    ds_read_b64_tr_b16 v[150:151], v245 offset:2048
    v_mfma_f32_16x16x32_bf16 v[52:55], v[140:143], v[164:167], v[52:55]
    v_mfma_f32_16x16x32_bf16 v[56:59], v[140:143], v[168:171], v[56:59]
    buffer_load_dwordx4 v243, s[20:23], s52 offen offset:3072 lds
    v_mfma_f32_16x16x32_bf16 v[60:63], v[140:143], v[172:175], v[60:63]
    s_waitcnt lgkmcnt(2)
    s_add_u32 s52, s52, 32768
    s_and_b32 s52, s52, 524287
    v_mfma_f32_16x16x32_bf16 v[0:3], v[144:147], v[176:179], v[0:3]
    ds_read_b64_tr_b16 v[152:153], v246 offset:0
    ds_read_b64_tr_b16 v[154:155], v246 offset:2048
    v_mfma_f32_16x16x32_bf16 v[4:7], v[144:147], v[180:183], v[4:7]
    ds_read_b128 v[160:163], v237 offset:32768
    ds_read_b128 v[164:167], v237 offset:33792
    s_add_u32 m0, s75, 131072
    v_mfma_f32_16x16x32_bf16 v[8:11], v[144:147], v[184:187], v[8:11]
    buffer_load_dwordx4 v240, s[20:23], s52 offen lds
    v_mfma_f32_16x16x32_bf16 v[12:15], v[144:147], v[188:191], v[12:15]
    s_waitcnt lgkmcnt(4)
    v_mfma_f32_16x16x32_bf16 v[16:19], v[148:151], v[176:179], v[16:19]
    ds_read_b64_tr_b16 v[156:157], v247 offset:0
    ds_read_b64_tr_b16 v[158:159], v247 offset:2048
    v_mfma_f32_16x16x32_bf16 v[20:23], v[148:151], v[180:183], v[20:23]
    v_mfma_f32_16x16x32_bf16 v[24:27], v[148:151], v[184:187], v[24:27]
    buffer_load_dwordx4 v241, s[20:23], s52 offen offset:1024 lds
    v_mfma_f32_16x16x32_bf16 v[28:31], v[148:151], v[188:191], v[28:31]
    s_waitcnt vmcnt(14) lgkmcnt(4)
    v_mfma_f32_16x16x32_bf16 v[32:35], v[152:155], v[176:179], v[32:35]
    ds_read_b64_tr_b16 v[128:129], v248 offset:16384
    ds_read_b64_tr_b16 v[130:131], v248 offset:18432
    v_mfma_f32_16x16x32_bf16 v[36:39], v[152:155], v[180:183], v[36:39]
    ds_read_b128 v[168:171], v237 offset:34816
    ds_read_b128 v[172:175], v237 offset:35840
    v_mfma_f32_16x16x32_bf16 v[40:43], v[152:155], v[184:187], v[40:43]
    buffer_load_dwordx4 v242, s[20:23], s52 offen offset:2048 lds
    v_mfma_f32_16x16x32_bf16 v[44:47], v[152:155], v[188:191], v[44:47]
    s_waitcnt lgkmcnt(4)
    v_mfma_f32_16x16x32_bf16 v[48:51], v[156:159], v[176:179], v[48:51]
    ds_read_b64_tr_b16 v[132:133], v249 offset:16384
    ds_read_b64_tr_b16 v[134:135], v249 offset:18432
    v_mfma_f32_16x16x32_bf16 v[52:55], v[156:159], v[180:183], v[52:55]
    v_mfma_f32_16x16x32_bf16 v[56:59], v[156:159], v[184:187], v[56:59]
    buffer_load_dwordx4 v243, s[20:23], s52 offen offset:3072 lds
    v_mfma_f32_16x16x32_bf16 v[60:63], v[156:159], v[188:191], v[60:63]
    s_waitcnt lgkmcnt(2)
    s_add_u32 s52, s52, 32768
    s_and_b32 s52, s52, 524287
    v_mfma_f32_16x16x32_bf16 v[0:3], v[128:131], v[160:163], v[0:3]
    ds_read_b64_tr_b16 v[136:137], v250 offset:16384
    ds_read_b64_tr_b16 v[138:139], v250 offset:18432
    v_mfma_f32_16x16x32_bf16 v[4:7], v[128:131], v[164:167], v[4:7]
    ds_read_b128 v[176:179], v237 offset:36864
    ds_read_b128 v[180:183], v237 offset:37888
    s_add_u32 m0, s75, 65536
    v_mfma_f32_16x16x32_bf16 v[8:11], v[128:131], v[168:171], v[8:11]
    buffer_load_dwordx4 v240, s[20:23], s52 offen lds
    v_mfma_f32_16x16x32_bf16 v[12:15], v[128:131], v[172:175], v[12:15]
    s_waitcnt lgkmcnt(4)
    v_mfma_f32_16x16x32_bf16 v[16:19], v[132:135], v[160:163], v[16:19]
    ds_read_b64_tr_b16 v[140:141], v251 offset:16384
    ds_read_b64_tr_b16 v[142:143], v251 offset:18432
    v_mfma_f32_16x16x32_bf16 v[20:23], v[132:135], v[164:167], v[20:23]
    v_mfma_f32_16x16x32_bf16 v[24:27], v[132:135], v[168:171], v[24:27]
    buffer_load_dwordx4 v241, s[20:23], s52 offen offset:1024 lds
    v_mfma_f32_16x16x32_bf16 v[28:31], v[132:135], v[172:175], v[28:31]
    s_waitcnt vmcnt(14) lgkmcnt(4)
    v_mfma_f32_16x16x32_bf16 v[32:35], v[136:139], v[160:163], v[32:35]
    ds_read_b64_tr_b16 v[144:145], v244 offset:16384
    ds_read_b64_tr_b16 v[146:147], v244 offset:18432
    v_mfma_f32_16x16x32_bf16 v[36:39], v[136:139], v[164:167], v[36:39]
    ds_read_b128 v[184:187], v237 offset:38912
    ds_read_b128 v[188:191], v237 offset:39936
    v_mfma_f32_16x16x32_bf16 v[40:43], v[136:139], v[168:171], v[40:43]
    buffer_load_dwordx4 v242, s[20:23], s52 offen offset:2048 lds
    v_mfma_f32_16x16x32_bf16 v[44:47], v[136:139], v[172:175], v[44:47]
    s_waitcnt lgkmcnt(4)
    v_mfma_f32_16x16x32_bf16 v[48:51], v[140:143], v[160:163], v[48:51]
    ds_read_b64_tr_b16 v[148:149], v245 offset:16384
    ds_read_b64_tr_b16 v[150:151], v245 offset:18432
    v_mfma_f32_16x16x32_bf16 v[52:55], v[140:143], v[164:167], v[52:55]
    v_mfma_f32_16x16x32_bf16 v[56:59], v[140:143], v[168:171], v[56:59]
    buffer_load_dwordx4 v243, s[20:23], s52 offen offset:3072 lds
    v_mfma_f32_16x16x32_bf16 v[60:63], v[140:143], v[172:175], v[60:63]
    s_waitcnt lgkmcnt(2)
    s_add_u32 s52, s52, 32768
    s_and_b32 s52, s52, 524287
    v_mfma_f32_16x16x32_bf16 v[0:3], v[144:147], v[176:179], v[0:3]
    ds_read_b64_tr_b16 v[152:153], v246 offset:16384
    ds_read_b64_tr_b16 v[154:155], v246 offset:18432
    v_mfma_f32_16x16x32_bf16 v[4:7], v[144:147], v[180:183], v[4:7]
    ds_read_b128 v[160:163], v237 offset:40960
    ds_read_b128 v[164:167], v237 offset:41984
    s_add_u32 m0, s75, 147456
    v_mfma_f32_16x16x32_bf16 v[8:11], v[144:147], v[184:187], v[8:11]
    buffer_load_dwordx4 v240, s[20:23], s52 offen lds
    v_mfma_f32_16x16x32_bf16 v[12:15], v[144:147], v[188:191], v[12:15]
    s_waitcnt lgkmcnt(4)
    v_mfma_f32_16x16x32_bf16 v[16:19], v[148:151], v[176:179], v[16:19]
    ds_read_b64_tr_b16 v[156:157], v247 offset:16384
    ds_read_b64_tr_b16 v[158:159], v247 offset:18432
    v_mfma_f32_16x16x32_bf16 v[20:23], v[148:151], v[180:183], v[20:23]
    v_mfma_f32_16x16x32_bf16 v[24:27], v[148:151], v[184:187], v[24:27]
    buffer_load_dwordx4 v241, s[20:23], s52 offen offset:1024 lds
    v_mfma_f32_16x16x32_bf16 v[28:31], v[148:151], v[188:191], v[28:31]
    s_waitcnt vmcnt(14) lgkmcnt(4)
    v_mfma_f32_16x16x32_bf16 v[32:35], v[152:155], v[176:179], v[32:35]
    ds_read_b64_tr_b16 v[128:129], v244 offset:32768
    ds_read_b64_tr_b16 v[130:131], v244 offset:34816
    v_mfma_f32_16x16x32_bf16 v[36:39], v[152:155], v[180:183], v[36:39]
    ds_read_b128 v[168:171], v237 offset:43008
    ds_read_b128 v[172:175], v237 offset:44032
    v_mfma_f32_16x16x32_bf16 v[40:43], v[152:155], v[184:187], v[40:43]
    buffer_load_dwordx4 v242, s[20:23], s52 offen offset:2048 lds
    v_mfma_f32_16x16x32_bf16 v[44:47], v[152:155], v[188:191], v[44:47]
    s_waitcnt lgkmcnt(4)
    v_mfma_f32_16x16x32_bf16 v[48:51], v[156:159], v[176:179], v[48:51]
    ds_read_b64_tr_b16 v[132:133], v245 offset:32768
    ds_read_b64_tr_b16 v[134:135], v245 offset:34816
    v_mfma_f32_16x16x32_bf16 v[52:55], v[156:159], v[180:183], v[52:55]
    v_mfma_f32_16x16x32_bf16 v[56:59], v[156:159], v[184:187], v[56:59]
    buffer_load_dwordx4 v243, s[20:23], s52 offen offset:3072 lds
    v_mfma_f32_16x16x32_bf16 v[60:63], v[156:159], v[188:191], v[60:63]
    s_waitcnt lgkmcnt(2)
    s_add_u32 s52, s52, 32768
    s_and_b32 s52, s52, 524287
    v_mfma_f32_16x16x32_bf16 v[0:3], v[128:131], v[160:163], v[0:3]
    ds_read_b64_tr_b16 v[136:137], v246 offset:32768
    ds_read_b64_tr_b16 v[138:139], v246 offset:34816
    v_mfma_f32_16x16x32_bf16 v[4:7], v[128:131], v[164:167], v[4:7]
    ds_read_b128 v[176:179], v237 offset:45056
    ds_read_b128 v[180:183], v237 offset:46080
    s_add_u32 m0, s75, 81920
    v_mfma_f32_16x16x32_bf16 v[8:11], v[128:131], v[168:171], v[8:11]
    buffer_load_dwordx4 v240, s[20:23], s52 offen lds
    v_mfma_f32_16x16x32_bf16 v[12:15], v[128:131], v[172:175], v[12:15]
    s_waitcnt lgkmcnt(4)
    v_mfma_f32_16x16x32_bf16 v[16:19], v[132:135], v[160:163], v[16:19]
    ds_read_b64_tr_b16 v[140:141], v247 offset:32768
    ds_read_b64_tr_b16 v[142:143], v247 offset:34816
    v_mfma_f32_16x16x32_bf16 v[20:23], v[132:135], v[164:167], v[20:23]
    v_mfma_f32_16x16x32_bf16 v[24:27], v[132:135], v[168:171], v[24:27]
    buffer_load_dwordx4 v241, s[20:23], s52 offen offset:1024 lds
    v_mfma_f32_16x16x32_bf16 v[28:31], v[132:135], v[172:175], v[28:31]
    s_waitcnt vmcnt(14) lgkmcnt(4)
    v_mfma_f32_16x16x32_bf16 v[32:35], v[136:139], v[160:163], v[32:35]
    ds_read_b64_tr_b16 v[144:145], v244 offset:49152
    ds_read_b64_tr_b16 v[146:147], v244 offset:51200
    v_mfma_f32_16x16x32_bf16 v[36:39], v[136:139], v[164:167], v[36:39]
    ds_read_b128 v[184:187], v237 offset:47104
    ds_read_b128 v[188:191], v237 offset:48128
    v_mfma_f32_16x16x32_bf16 v[40:43], v[136:139], v[168:171], v[40:43]
    buffer_load_dwordx4 v242, s[20:23], s52 offen offset:2048 lds
    v_mfma_f32_16x16x32_bf16 v[44:47], v[136:139], v[172:175], v[44:47]
    s_waitcnt lgkmcnt(4)
    v_mfma_f32_16x16x32_bf16 v[48:51], v[140:143], v[160:163], v[48:51]
    ds_read_b64_tr_b16 v[148:149], v245 offset:49152
    ds_read_b64_tr_b16 v[150:151], v245 offset:51200
    v_mfma_f32_16x16x32_bf16 v[52:55], v[140:143], v[164:167], v[52:55]
    v_mfma_f32_16x16x32_bf16 v[56:59], v[140:143], v[168:171], v[56:59]
    buffer_load_dwordx4 v243, s[20:23], s52 offen offset:3072 lds
    v_mfma_f32_16x16x32_bf16 v[60:63], v[140:143], v[172:175], v[60:63]
    s_waitcnt lgkmcnt(2)
    s_add_u32 s52, s52, 32768
    s_and_b32 s52, s52, 524287
    v_mfma_f32_16x16x32_bf16 v[0:3], v[144:147], v[176:179], v[0:3]
    ds_read_b64_tr_b16 v[152:153], v246 offset:49152
    ds_read_b64_tr_b16 v[154:155], v246 offset:51200
    v_mfma_f32_16x16x32_bf16 v[4:7], v[144:147], v[180:183], v[4:7]
    ds_read_b128 v[160:163], v237 offset:49152
    ds_read_b128 v[164:167], v237 offset:50176
    s_xor_b32 s52, s52, 128
    s_add_u32 m0, s75, 98304
    v_mfma_f32_16x16x32_bf16 v[8:11], v[144:147], v[184:187], v[8:11]
    buffer_load_dwordx4 v240, s[20:23], s52 offen lds
    v_mfma_f32_16x16x32_bf16 v[12:15], v[144:147], v[188:191], v[12:15]
    s_waitcnt lgkmcnt(4)
    v_mfma_f32_16x16x32_bf16 v[16:19], v[148:151], v[176:179], v[16:19]
    ds_read_b64_tr_b16 v[156:157], v247 offset:49152
    ds_read_b64_tr_b16 v[158:159], v247 offset:51200
    v_mfma_f32_16x16x32_bf16 v[20:23], v[148:151], v[180:183], v[20:23]
    v_mfma_f32_16x16x32_bf16 v[24:27], v[148:151], v[184:187], v[24:27]
    buffer_load_dwordx4 v241, s[20:23], s52 offen offset:1024 lds
    v_mfma_f32_16x16x32_bf16 v[28:31], v[148:151], v[188:191], v[28:31]
    s_waitcnt vmcnt(14) lgkmcnt(4)
    v_mfma_f32_16x16x32_bf16 v[32:35], v[152:155], v[176:179], v[32:35]
    ds_read_b64_tr_b16 v[128:129], v248 offset:0
    ds_read_b64_tr_b16 v[130:131], v248 offset:2048
    v_mfma_f32_16x16x32_bf16 v[36:39], v[152:155], v[180:183], v[36:39]
    ds_read_b128 v[168:171], v237 offset:51200
    ds_read_b128 v[172:175], v237 offset:52224
    v_mfma_f32_16x16x32_bf16 v[40:43], v[152:155], v[184:187], v[40:43]
    buffer_load_dwordx4 v242, s[20:23], s52 offen offset:2048 lds
    v_mfma_f32_16x16x32_bf16 v[44:47], v[152:155], v[188:191], v[44:47]
    s_waitcnt lgkmcnt(4)
    v_mfma_f32_16x16x32_bf16 v[48:51], v[156:159], v[176:179], v[48:51]
    ds_read_b64_tr_b16 v[132:133], v249 offset:0
    ds_read_b64_tr_b16 v[134:135], v249 offset:2048
    v_mfma_f32_16x16x32_bf16 v[52:55], v[156:159], v[180:183], v[52:55]
    v_mfma_f32_16x16x32_bf16 v[56:59], v[156:159], v[184:187], v[56:59]
    buffer_load_dwordx4 v243, s[20:23], s52 offen offset:3072 lds
    v_mfma_f32_16x16x32_bf16 v[60:63], v[156:159], v[188:191], v[60:63]
    s_waitcnt lgkmcnt(2)
    s_add_u32 s52, s52, 32768
    s_and_b32 s52, s52, 524287
    v_mfma_f32_16x16x32_bf16 v[0:3], v[128:131], v[160:163], v[0:3]
    ds_read_b64_tr_b16 v[136:137], v250 offset:0
    ds_read_b64_tr_b16 v[138:139], v250 offset:2048
    v_mfma_f32_16x16x32_bf16 v[4:7], v[128:131], v[164:167], v[4:7]
    ds_read_b128 v[176:179], v237 offset:53248
    ds_read_b128 v[180:183], v237 offset:54272
    s_add_u32 m0, s75, 114688
    v_mfma_f32_16x16x32_bf16 v[8:11], v[128:131], v[168:171], v[8:11]
    buffer_load_dwordx4 v240, s[20:23], s52 offen lds
    v_mfma_f32_16x16x32_bf16 v[12:15], v[128:131], v[172:175], v[12:15]
    s_waitcnt lgkmcnt(4)
    v_mfma_f32_16x16x32_bf16 v[16:19], v[132:135], v[160:163], v[16:19]
    ds_read_b64_tr_b16 v[140:141], v251 offset:0
    ds_read_b64_tr_b16 v[142:143], v251 offset:2048
    v_mfma_f32_16x16x32_bf16 v[20:23], v[132:135], v[164:167], v[20:23]
    v_mfma_f32_16x16x32_bf16 v[24:27], v[132:135], v[168:171], v[24:27]
    buffer_load_dwordx4 v241, s[20:23], s52 offen offset:1024 lds
    v_mfma_f32_16x16x32_bf16 v[28:31], v[132:135], v[172:175], v[28:31]
    s_waitcnt vmcnt(14) lgkmcnt(4)
    v_mfma_f32_16x16x32_bf16 v[32:35], v[136:139], v[160:163], v[32:35]
    ds_read_b64_tr_b16 v[144:145], v244 offset:0
    ds_read_b64_tr_b16 v[146:147], v244 offset:2048
    v_mfma_f32_16x16x32_bf16 v[36:39], v[136:139], v[164:167], v[36:39]
    ds_read_b128 v[184:187], v237 offset:55296
    ds_read_b128 v[188:191], v237 offset:56320
    v_mfma_f32_16x16x32_bf16 v[40:43], v[136:139], v[168:171], v[40:43]
    buffer_load_dwordx4 v242, s[20:23], s52 offen offset:2048 lds
    v_mfma_f32_16x16x32_bf16 v[44:47], v[136:139], v[172:175], v[44:47]
    s_waitcnt lgkmcnt(4)
    v_mfma_f32_16x16x32_bf16 v[48:51], v[140:143], v[160:163], v[48:51]
    ds_read_b64_tr_b16 v[148:149], v245 offset:0
    ds_read_b64_tr_b16 v[150:151], v245 offset:2048
    v_mfma_f32_16x16x32_bf16 v[52:55], v[140:143], v[164:167], v[52:55]
    v_mfma_f32_16x16x32_bf16 v[56:59], v[140:143], v[168:171], v[56:59]
    buffer_load_dwordx4 v243, s[20:23], s52 offen offset:3072 lds
    v_mfma_f32_16x16x32_bf16 v[60:63], v[140:143], v[172:175], v[60:63]
    s_waitcnt lgkmcnt(2)
    s_add_u32 s52, s52, 32768
    s_and_b32 s52, s52, 524287
    v_mfma_f32_16x16x32_bf16 v[0:3], v[144:147], v[176:179], v[0:3]
    ds_read_b64_tr_b16 v[152:153], v246 offset:0
    ds_read_b64_tr_b16 v[154:155], v246 offset:2048
    v_mfma_f32_16x16x32_bf16 v[4:7], v[144:147], v[180:183], v[4:7]
    ds_read_b128 v[160:163], v237 offset:57344
    ds_read_b128 v[164:167], v237 offset:58368
    s_add_u32 m0, s75, 131072
    v_mfma_f32_16x16x32_bf16 v[8:11], v[144:147], v[184:187], v[8:11]
    buffer_load_dwordx4 v240, s[20:23], s52 offen lds
    v_mfma_f32_16x16x32_bf16 v[12:15], v[144:147], v[188:191], v[12:15]
    s_waitcnt lgkmcnt(4)
    v_mfma_f32_16x16x32_bf16 v[16:19], v[148:151], v[176:179], v[16:19]
    ds_read_b64_tr_b16 v[156:157], v247 offset:0
    ds_read_b64_tr_b16 v[158:159], v247 offset:2048
    v_mfma_f32_16x16x32_bf16 v[20:23], v[148:151], v[180:183], v[20:23]
    v_mfma_f32_16x16x32_bf16 v[24:27], v[148:151], v[184:187], v[24:27]
    buffer_load_dwordx4 v241, s[20:23], s52 offen offset:1024 lds
    v_mfma_f32_16x16x32_bf16 v[28:31], v[148:151], v[188:191], v[28:31]
    s_waitcnt vmcnt(14) lgkmcnt(4)
    v_mfma_f32_16x16x32_bf16 v[32:35], v[152:155], v[176:179], v[32:35]
    ds_read_b64_tr_b16 v[128:129], v248 offset:16384
    ds_read_b64_tr_b16 v[130:131], v248 offset:18432
    v_mfma_f32_16x16x32_bf16 v[36:39], v[152:155], v[180:183], v[36:39]
    ds_read_b128 v[168:171], v237 offset:59392
    ds_read_b128 v[172:175], v237 offset:60416
    v_mfma_f32_16x16x32_bf16 v[40:43], v[152:155], v[184:187], v[40:43]
    buffer_load_dwordx4 v242, s[20:23], s52 offen offset:2048 lds
    v_mfma_f32_16x16x32_bf16 v[44:47], v[152:155], v[188:191], v[44:47]
    s_waitcnt lgkmcnt(4)
    v_mfma_f32_16x16x32_bf16 v[48:51], v[156:159], v[176:179], v[48:51]
    ds_read_b64_tr_b16 v[132:133], v249 offset:16384
    ds_read_b64_tr_b16 v[134:135], v249 offset:18432
    v_mfma_f32_16x16x32_bf16 v[52:55], v[156:159], v[180:183], v[52:55]
    v_mfma_f32_16x16x32_bf16 v[56:59], v[156:159], v[184:187], v[56:59]
    buffer_load_dwordx4 v243, s[20:23], s52 offen offset:3072 lds
    v_mfma_f32_16x16x32_bf16 v[60:63], v[156:159], v[188:191], v[60:63]
    s_waitcnt lgkmcnt(2)
    s_add_u32 s52, s52, 32768
    s_and_b32 s52, s52, 524287
    v_mfma_f32_16x16x32_bf16 v[0:3], v[128:131], v[160:163], v[0:3]
    ds_read_b64_tr_b16 v[136:137], v250 offset:16384
    ds_read_b64_tr_b16 v[138:139], v250 offset:18432
    v_mfma_f32_16x16x32_bf16 v[4:7], v[128:131], v[164:167], v[4:7]
    ds_read_b128 v[176:179], v237 offset:61440
    ds_read_b128 v[180:183], v237 offset:62464
    s_add_u32 m0, s75, 65536
    v_mfma_f32_16x16x32_bf16 v[8:11], v[128:131], v[168:171], v[8:11]
    buffer_load_dwordx4 v240, s[20:23], s52 offen lds
    v_mfma_f32_16x16x32_bf16 v[12:15], v[128:131], v[172:175], v[12:15]
    s_waitcnt lgkmcnt(4)
    v_mfma_f32_16x16x32_bf16 v[16:19], v[132:135], v[160:163], v[16:19]
    ds_read_b64_tr_b16 v[140:141], v251 offset:16384
    ds_read_b64_tr_b16 v[142:143], v251 offset:18432
    v_mfma_f32_16x16x32_bf16 v[20:23], v[132:135], v[164:167], v[20:23]
    v_mfma_f32_16x16x32_bf16 v[24:27], v[132:135], v[168:171], v[24:27]
    buffer_load_dwordx4 v241, s[20:23], s52 offen offset:1024 lds
    v_mfma_f32_16x16x32_bf16 v[28:31], v[132:135], v[172:175], v[28:31]
    s_waitcnt vmcnt(14) lgkmcnt(4)
    v_mfma_f32_16x16x32_bf16 v[32:35], v[136:139], v[160:163], v[32:35]
    ds_read_b64_tr_b16 v[144:145], v244 offset:16384
    ds_read_b64_tr_b16 v[146:147], v244 offset:18432
    v_mfma_f32_16x16x32_bf16 v[36:39], v[136:139], v[164:167], v[36:39]
    ds_read_b128 v[184:187], v237 offset:63488
    ds_read_b128 v[188:191], v237 offset:64512
    v_mfma_f32_16x16x32_bf16 v[40:43], v[136:139], v[168:171], v[40:43]
    buffer_load_dwordx4 v242, s[20:23], s52 offen offset:2048 lds
    v_mfma_f32_16x16x32_bf16 v[44:47], v[136:139], v[172:175], v[44:47]
    s_waitcnt lgkmcnt(4)
    v_mfma_f32_16x16x32_bf16 v[48:51], v[140:143], v[160:163], v[48:51]
    ds_read_b64_tr_b16 v[148:149], v245 offset:16384
    ds_read_b64_tr_b16 v[150:151], v245 offset:18432
    v_mfma_f32_16x16x32_bf16 v[52:55], v[140:143], v[164:167], v[52:55]
    v_mfma_f32_16x16x32_bf16 v[56:59], v[140:143], v[168:171], v[56:59]
    buffer_load_dwordx4 v243, s[20:23], s52 offen offset:3072 lds
    v_mfma_f32_16x16x32_bf16 v[60:63], v[140:143], v[172:175], v[60:63]
    s_waitcnt lgkmcnt(2)
    s_add_u32 s52, s52, 32768
    s_and_b32 s52, s52, 524287
    v_mfma_f32_16x16x32_bf16 v[0:3], v[144:147], v[176:179], v[0:3]
    ds_read_b64_tr_b16 v[152:153], v246 offset:16384
    ds_read_b64_tr_b16 v[154:155], v246 offset:18432
    v_mfma_f32_16x16x32_bf16 v[4:7], v[144:147], v[180:183], v[4:7]
    ds_read_b128 v[160:163], v237 offset:0
    ds_read_b128 v[164:167], v237 offset:1024
    s_add_u32 m0, s75, 147456
    v_mfma_f32_16x16x32_bf16 v[8:11], v[144:147], v[184:187], v[8:11]
    buffer_load_dwordx4 v240, s[20:23], s52 offen lds
    v_mfma_f32_16x16x32_bf16 v[12:15], v[144:147], v[188:191], v[12:15]
    s_waitcnt lgkmcnt(4)
    v_mfma_f32_16x16x32_bf16 v[16:19], v[148:151], v[176:179], v[16:19]
    ds_read_b64_tr_b16 v[156:157], v247 offset:16384
    ds_read_b64_tr_b16 v[158:159], v247 offset:18432
    v_mfma_f32_16x16x32_bf16 v[20:23], v[148:151], v[180:183], v[20:23]
    v_mfma_f32_16x16x32_bf16 v[24:27], v[148:151], v[184:187], v[24:27]
    buffer_load_dwordx4 v241, s[20:23], s52 offen offset:1024 lds
    v_mfma_f32_16x16x32_bf16 v[28:31], v[148:151], v[188:191], v[28:31]
    s_waitcnt vmcnt(14) lgkmcnt(4)
    v_mfma_f32_16x16x32_bf16 v[32:35], v[152:155], v[176:179], v[32:35]
    ds_read_b64_tr_b16 v[128:129], v244 offset:32768
    ds_read_b64_tr_b16 v[130:131], v244 offset:34816
    v_mfma_f32_16x16x32_bf16 v[36:39], v[152:155], v[180:183], v[36:39]
    ds_read_b128 v[168:171], v237 offset:2048
    ds_read_b128 v[172:175], v237 offset:3072
    v_mfma_f32_16x16x32_bf16 v[40:43], v[152:155], v[184:187], v[40:43]
    buffer_load_dwordx4 v242, s[20:23], s52 offen offset:2048 lds
    v_mfma_f32_16x16x32_bf16 v[44:47], v[152:155], v[188:191], v[44:47]
    s_waitcnt lgkmcnt(4)
    v_mfma_f32_16x16x32_bf16 v[48:51], v[156:159], v[176:179], v[48:51]
    ds_read_b64_tr_b16 v[132:133], v245 offset:32768
    ds_read_b64_tr_b16 v[134:135], v245 offset:34816
    v_mfma_f32_16x16x32_bf16 v[52:55], v[156:159], v[180:183], v[52:55]
    v_mfma_f32_16x16x32_bf16 v[56:59], v[156:159], v[184:187], v[56:59]
    buffer_load_dwordx4 v243, s[20:23], s52 offen offset:3072 lds
    v_mfma_f32_16x16x32_bf16 v[60:63], v[156:159], v[188:191], v[60:63]
    s_waitcnt lgkmcnt(2)
    s_add_u32 s52, s52, 32768
    s_and_b32 s52, s52, 524287
    v_mfma_f32_16x16x32_bf16 v[64:67], v[128:131], v[160:163], 0
    ds_read_b64_tr_b16 v[136:137], v246 offset:32768
    ds_read_b64_tr_b16 v[138:139], v246 offset:34816
    v_mfma_f32_16x16x32_bf16 v[68:71], v[128:131], v[164:167], 0
    ds_read_b128 v[176:179], v237 offset:4096
    ds_read_b128 v[180:183], v237 offset:5120
    s_add_u32 m0, s75, 81920
    v_mfma_f32_16x16x32_bf16 v[72:75], v[128:131], v[168:171], 0
    buffer_load_dwordx4 v240, s[20:23], s52 offen lds
    v_mfma_f32_16x16x32_bf16 v[76:79], v[128:131], v[172:175], 0
    s_waitcnt lgkmcnt(4)
    v_cvt_pk_bf16_f32 v0, v0, v1
    v_cvt_pk_bf16_f32 v1, v2, v3
    v_cvt_pk_bf16_f32 v2, v16, v17
    v_cvt_pk_bf16_f32 v3, v18, v19
    v_mfma_f32_16x16x32_bf16 v[80:83], v[132:135], v[160:163], 0
    ds_read_b64_tr_b16 v[140:141], v247 offset:32768
    ds_read_b64_tr_b16 v[142:143], v247 offset:34816
    v_mfma_f32_16x16x32_bf16 v[84:87], v[132:135], v[164:167], 0
    buffer_store_dwordx4 v[0:3], v237, s[40:43], s59 offen sc1
    v_mfma_f32_16x16x32_bf16 v[88:91], v[132:135], v[168:171], 0
    buffer_load_dwordx4 v241, s[20:23], s52 offen offset:1024 lds
    v_mfma_f32_16x16x32_bf16 v[92:95], v[132:135], v[172:175], 0
    s_waitcnt vmcnt(15) lgkmcnt(4)
    v_cvt_pk_bf16_f32 v32, v32, v33
    v_cvt_pk_bf16_f32 v33, v34, v35
    v_mfma_f32_16x16x32_bf16 v[96:99], v[136:139], v[160:163], 0
    ds_read_b64_tr_b16 v[144:145], v244 offset:49152
    ds_read_b64_tr_b16 v[146:147], v244 offset:51200
    v_mfma_f32_16x16x32_bf16 v[100:103], v[136:139], v[164:167], 0
    ds_read_b128 v[184:187], v237 offset:6144
    ds_read_b128 v[188:191], v237 offset:7168
    v_mfma_f32_16x16x32_bf16 v[104:107], v[136:139], v[168:171], 0
    buffer_load_dwordx4 v242, s[20:23], s52 offen offset:2048 lds
    v_mfma_f32_16x16x32_bf16 v[108:111], v[136:139], v[172:175], 0
    s_waitcnt lgkmcnt(4)
    v_cvt_pk_bf16_f32 v34, v48, v49
    v_cvt_pk_bf16_f32 v35, v50, v51
    v_mfma_f32_16x16x32_bf16 v[112:115], v[140:143], v[160:163], 0
    ds_read_b64_tr_b16 v[148:149], v245 offset:49152
    ds_read_b64_tr_b16 v[150:151], v245 offset:51200
    v_mfma_f32_16x16x32_bf16 v[116:119], v[140:143], v[164:167], 0
    v_cvt_pk_bf16_f32 v4, v4, v5
    v_cvt_pk_bf16_f32 v5, v6, v7
    v_mfma_f32_16x16x32_bf16 v[120:123], v[140:143], v[168:171], 0
    buffer_load_dwordx4 v243, s[20:23], s52 offen offset:3072 lds
    v_mfma_f32_16x16x32_bf16 v[124:127], v[140:143], v[172:175], 0
    s_waitcnt lgkmcnt(2)
    s_add_u32 s52, s52, 32768
    s_and_b32 s52, s52, 524287
    v_mfma_f32_16x16x32_bf16 v[64:67], v[144:147], v[176:179], v[64:67]
    ds_read_b64_tr_b16 v[152:153], v246 offset:49152
    ds_read_b64_tr_b16 v[154:155], v246 offset:51200
    v_mfma_f32_16x16x32_bf16 v[68:71], v[144:147], v[180:183], v[68:71]
    ds_read_b128 v[160:163], v237 offset:8192
    ds_read_b128 v[164:167], v237 offset:9216
    s_add_u32 m0, s75, 98304
    v_mfma_f32_16x16x32_bf16 v[72:75], v[144:147], v[184:187], v[72:75]
    buffer_load_dwordx4 v240, s[20:23], s52 offen lds
    v_mfma_f32_16x16x32_bf16 v[76:79], v[144:147], v[188:191], v[76:79]
    s_waitcnt lgkmcnt(4)
    v_cvt_pk_bf16_f32 v6, v20, v21
    v_cvt_pk_bf16_f32 v7, v22, v23
    v_mfma_f32_16x16x32_bf16 v[80:83], v[148:151], v[176:179], v[80:83]
    ds_read_b64_tr_b16 v[156:157], v247 offset:49152
    ds_read_b64_tr_b16 v[158:159], v247 offset:51200
    v_mfma_f32_16x16x32_bf16 v[84:87], v[148:151], v[180:183], v[84:87]
    v_cvt_pk_bf16_f32 v36, v36, v37
    v_cvt_pk_bf16_f32 v37, v38, v39
    v_mfma_f32_16x16x32_bf16 v[88:91], v[148:151], v[184:187], v[88:91]
    buffer_load_dwordx4 v241, s[20:23], s52 offen offset:1024 lds
    v_mfma_f32_16x16x32_bf16 v[92:95], v[148:151], v[188:191], v[92:95]
    s_waitcnt vmcnt(15) lgkmcnt(4)
    v_cvt_pk_bf16_f32 v38, v52, v53
    v_cvt_pk_bf16_f32 v39, v54, v55
    v_mfma_f32_16x16x32_bf16 v[96:99], v[152:155], v[176:179], v[96:99]
    ds_read_b64_tr_b16 v[128:129], v248 offset:0
    ds_read_b64_tr_b16 v[130:131], v248 offset:2048
    v_mfma_f32_16x16x32_bf16 v[100:103], v[152:155], v[180:183], v[100:103]
    ds_read_b128 v[168:171], v237 offset:10240
    ds_read_b128 v[172:175], v237 offset:11264
    v_mfma_f32_16x16x32_bf16 v[104:107], v[152:155], v[184:187], v[104:107]
    buffer_load_dwordx4 v242, s[20:23], s52 offen offset:2048 lds
    v_mfma_f32_16x16x32_bf16 v[108:111], v[152:155], v[188:191], v[108:111]
    s_waitcnt lgkmcnt(4)
    v_cvt_pk_bf16_f32 v8, v8, v9
    v_cvt_pk_bf16_f32 v9, v10, v11
    v_mfma_f32_16x16x32_bf16 v[112:115], v[156:159], v[176:179], v[112:115]
    ds_read_b64_tr_b16 v[132:133], v249 offset:0
    ds_read_b64_tr_b16 v[134:135], v249 offset:2048
    v_mfma_f32_16x16x32_bf16 v[116:119], v[156:159], v[180:183], v[116:119]
    buffer_store_dwordx4 v[32:35], v237, s[40:43], s59 offen offset:1024 sc1
    v_mfma_f32_16x16x32_bf16 v[120:123], v[156:159], v[184:187], v[120:123]
    buffer_load_dwordx4 v243, s[20:23], s52 offen offset:3072 lds
    v_mfma_f32_16x16x32_bf16 v[124:127], v[156:159], v[188:191], v[124:127]
    s_waitcnt lgkmcnt(2)
    s_add_u32 s52, s52, 32768
    s_and_b32 s52, s52, 524287
    v_mfma_f32_16x16x32_bf16 v[64:67], v[128:131], v[160:163], v[64:67]
    ds_read_b64_tr_b16 v[136:137], v250 offset:0
    ds_read_b64_tr_b16 v[138:139], v250 offset:2048
    v_mfma_f32_16x16x32_bf16 v[68:71], v[128:131], v[164:167], v[68:71]
    ds_read_b128 v[176:179], v237 offset:12288
    ds_read_b128 v[180:183], v237 offset:13312
    s_add_u32 m0, s75, 114688
    v_mfma_f32_16x16x32_bf16 v[72:75], v[128:131], v[168:171], v[72:75]
    buffer_load_dwordx4 v240, s[20:23], s52 offen lds
    v_mfma_f32_16x16x32_bf16 v[76:79], v[128:131], v[172:175], v[76:79]
    s_waitcnt lgkmcnt(4)
    v_cvt_pk_bf16_f32 v10, v24, v25
    v_cvt_pk_bf16_f32 v11, v26, v27
    v_mfma_f32_16x16x32_bf16 v[80:83], v[132:135], v[160:163], v[80:83]
    ds_read_b64_tr_b16 v[140:141], v251 offset:0
    ds_read_b64_tr_b16 v[142:143], v251 offset:2048
    v_mfma_f32_16x16x32_bf16 v[84:87], v[132:135], v[164:167], v[84:87]
    v_cvt_pk_bf16_f32 v40, v40, v41
    v_cvt_pk_bf16_f32 v41, v42, v43
    v_mfma_f32_16x16x32_bf16 v[88:91], v[132:135], v[168:171], v[88:91]
    buffer_load_dwordx4 v241, s[20:23], s52 offen offset:1024 lds
    v_mfma_f32_16x16x32_bf16 v[92:95], v[132:135], v[172:175], v[92:95]
    s_waitcnt vmcnt(16) lgkmcnt(4)
    v_cvt_pk_bf16_f32 v42, v56, v57
    v_cvt_pk_bf16_f32 v43, v58, v59
    v_mfma_f32_16x16x32_bf16 v[96:99], v[136:139], v[160:163], v[96:99]
    ds_read_b64_tr_b16 v[144:145], v244 offset:0
    ds_read_b64_tr_b16 v[146:147], v244 offset:2048
    v_mfma_f32_16x16x32_bf16 v[100:103], v[136:139], v[164:167], v[100:103]
    ds_read_b128 v[184:187], v237 offset:14336
    ds_read_b128 v[188:191], v237 offset:15360
    v_mfma_f32_16x16x32_bf16 v[104:107], v[136:139], v[168:171], v[104:107]
    buffer_load_dwordx4 v242, s[20:23], s52 offen offset:2048 lds
    v_mfma_f32_16x16x32_bf16 v[108:111], v[136:139], v[172:175], v[108:111]
    s_waitcnt lgkmcnt(4)
    v_cvt_pk_bf16_f32 v12, v12, v13
    v_cvt_pk_bf16_f32 v13, v14, v15
    v_mfma_f32_16x16x32_bf16 v[112:115], v[140:143], v[160:163], v[112:115]
    ds_read_b64_tr_b16 v[148:149], v245 offset:0
    ds_read_b64_tr_b16 v[150:151], v245 offset:2048
    v_mfma_f32_16x16x32_bf16 v[116:119], v[140:143], v[164:167], v[116:119]
    v_cvt_pk_bf16_f32 v14, v28, v29
    v_cvt_pk_bf16_f32 v15, v30, v31
    v_mfma_f32_16x16x32_bf16 v[120:123], v[140:143], v[168:171], v[120:123]
    buffer_load_dwordx4 v243, s[20:23], s52 offen offset:3072 lds
    v_mfma_f32_16x16x32_bf16 v[124:127], v[140:143], v[172:175], v[124:127]
    s_waitcnt lgkmcnt(2)
    s_add_u32 s52, s52, 32768
    s_and_b32 s52, s52, 524287
    v_mfma_f32_16x16x32_bf16 v[64:67], v[144:147], v[176:179], v[64:67]
    ds_read_b64_tr_b16 v[152:153], v246 offset:0
    ds_read_b64_tr_b16 v[154:155], v246 offset:2048
    v_mfma_f32_16x16x32_bf16 v[68:71], v[144:147], v[180:183], v[68:71]
    ds_read_b128 v[160:163], v237 offset:16384
    ds_read_b128 v[164:167], v237 offset:17408
    s_add_u32 m0, s75, 131072
    v_mfma_f32_16x16x32_bf16 v[72:75], v[144:147], v[184:187], v[72:75]
    buffer_load_dwordx4 v240, s[20:23], s52 offen lds
    v_mfma_f32_16x16x32_bf16 v[76:79], v[144:147], v[188:191], v[76:79]
    s_waitcnt lgkmcnt(4)
    v_cvt_pk_bf16_f32 v44, v44, v45
    v_cvt_pk_bf16_f32 v45, v46, v47
    v_mfma_f32_16x16x32_bf16 v[80:83], v[148:151], v[176:179], v[80:83]
    ds_read_b64_tr_b16 v[156:157], v247 offset:0
    ds_read_b64_tr_b16 v[158:159], v247 offset:2048
    v_mfma_f32_16x16x32_bf16 v[84:87], v[148:151], v[180:183], v[84:87]
    buffer_store_dwordx4 v[4:7], v237, s[40:43], s59 offen offset:2048 sc1
    v_mfma_f32_16x16x32_bf16 v[88:91], v[148:151], v[184:187], v[88:91]
    buffer_load_dwordx4 v241, s[20:23], s52 offen offset:1024 lds
    v_mfma_f32_16x16x32_bf16 v[92:95], v[148:151], v[188:191], v[92:95]
    s_waitcnt vmcnt(17) lgkmcnt(4)
    v_cvt_pk_bf16_f32 v46, v60, v61
    v_cvt_pk_bf16_f32 v47, v62, v63
    v_mfma_f32_16x16x32_bf16 v[96:99], v[152:155], v[176:179], v[96:99]
    ds_read_b64_tr_b16 v[128:129], v248 offset:16384
    ds_read_b64_tr_b16 v[130:131], v248 offset:18432
    v_mfma_f32_16x16x32_bf16 v[100:103], v[152:155], v[180:183], v[100:103]
    ds_read_b128 v[168:171], v237 offset:18432
    ds_read_b128 v[172:175], v237 offset:19456
    v_mfma_f32_16x16x32_bf16 v[104:107], v[152:155], v[184:187], v[104:107]
    buffer_load_dwordx4 v242, s[20:23], s52 offen offset:2048 lds
    v_mfma_f32_16x16x32_bf16 v[108:111], v[152:155], v[188:191], v[108:111]
    s_waitcnt lgkmcnt(4)
    v_mfma_f32_16x16x32_bf16 v[112:115], v[156:159], v[176:179], v[112:115]
    ds_read_b64_tr_b16 v[132:133], v249 offset:16384
    ds_read_b64_tr_b16 v[134:135], v249 offset:18432
    v_mfma_f32_16x16x32_bf16 v[116:119], v[156:159], v[180:183], v[116:119]
    v_mfma_f32_16x16x32_bf16 v[120:123], v[156:159], v[184:187], v[120:123]
    buffer_load_dwordx4 v243, s[20:23], s52 offen offset:3072 lds
    v_mfma_f32_16x16x32_bf16 v[124:127], v[156:159], v[188:191], v[124:127]
    s_waitcnt lgkmcnt(2)
    s_add_u32 s52, s52, 32768
    s_and_b32 s52, s52, 524287
    v_mfma_f32_16x16x32_bf16 v[64:67], v[128:131], v[160:163], v[64:67]
    ds_read_b64_tr_b16 v[136:137], v250 offset:16384
    ds_read_b64_tr_b16 v[138:139], v250 offset:18432
    v_mfma_f32_16x16x32_bf16 v[68:71], v[128:131], v[164:167], v[68:71]
    ds_read_b128 v[176:179], v237 offset:20480
    ds_read_b128 v[180:183], v237 offset:21504
    s_add_u32 m0, s75, 65536
    v_mfma_f32_16x16x32_bf16 v[72:75], v[128:131], v[168:171], v[72:75]
    buffer_load_dwordx4 v240, s[20:23], s52 offen lds
    v_mfma_f32_16x16x32_bf16 v[76:79], v[128:131], v[172:175], v[76:79]
    s_waitcnt lgkmcnt(4)
    v_mfma_f32_16x16x32_bf16 v[80:83], v[132:135], v[160:163], v[80:83]
    ds_read_b64_tr_b16 v[140:141], v251 offset:16384
    ds_read_b64_tr_b16 v[142:143], v251 offset:18432
    v_mfma_f32_16x16x32_bf16 v[84:87], v[132:135], v[164:167], v[84:87]
    v_mfma_f32_16x16x32_bf16 v[88:91], v[132:135], v[168:171], v[88:91]
    buffer_load_dwordx4 v241, s[20:23], s52 offen offset:1024 lds
    v_mfma_f32_16x16x32_bf16 v[92:95], v[132:135], v[172:175], v[92:95]
    s_waitcnt vmcnt(16) lgkmcnt(4)
    v_mfma_f32_16x16x32_bf16 v[96:99], v[136:139], v[160:163], v[96:99]
    ds_read_b64_tr_b16 v[144:145], v244 offset:16384
    ds_read_b64_tr_b16 v[146:147], v244 offset:18432
    v_mfma_f32_16x16x32_bf16 v[100:103], v[136:139], v[164:167], v[100:103]
    ds_read_b128 v[184:187], v237 offset:22528
    ds_read_b128 v[188:191], v237 offset:23552
    v_mfma_f32_16x16x32_bf16 v[104:107], v[136:139], v[168:171], v[104:107]
    buffer_load_dwordx4 v242, s[20:23], s52 offen offset:2048 lds
    v_mfma_f32_16x16x32_bf16 v[108:111], v[136:139], v[172:175], v[108:111]
    s_waitcnt lgkmcnt(4)
    v_mfma_f32_16x16x32_bf16 v[112:115], v[140:143], v[160:163], v[112:115]
    ds_read_b64_tr_b16 v[148:149], v245 offset:16384
    ds_read_b64_tr_b16 v[150:151], v245 offset:18432
    v_mfma_f32_16x16x32_bf16 v[116:119], v[140:143], v[164:167], v[116:119]
    buffer_store_dwordx4 v[36:39], v237, s[40:43], s59 offen offset:3072 sc1
    v_mfma_f32_16x16x32_bf16 v[120:123], v[140:143], v[168:171], v[120:123]
    buffer_load_dwordx4 v243, s[20:23], s52 offen offset:3072 lds
    v_mfma_f32_16x16x32_bf16 v[124:127], v[140:143], v[172:175], v[124:127]
    s_waitcnt lgkmcnt(2)
    s_add_u32 s52, s52, 32768
    s_and_b32 s52, s52, 524287
    v_mfma_f32_16x16x32_bf16 v[64:67], v[144:147], v[176:179], v[64:67]
    ds_read_b64_tr_b16 v[152:153], v246 offset:16384
    ds_read_b64_tr_b16 v[154:155], v246 offset:18432
    v_mfma_f32_16x16x32_bf16 v[68:71], v[144:147], v[180:183], v[68:71]
    ds_read_b128 v[160:163], v237 offset:24576
    ds_read_b128 v[164:167], v237 offset:25600
    s_add_u32 m0, s75, 147456
    v_mfma_f32_16x16x32_bf16 v[72:75], v[144:147], v[184:187], v[72:75]
    buffer_load_dwordx4 v240, s[20:23], s52 offen lds
    v_mfma_f32_16x16x32_bf16 v[76:79], v[144:147], v[188:191], v[76:79]
    s_waitcnt lgkmcnt(4)
    v_mfma_f32_16x16x32_bf16 v[80:83], v[148:151], v[176:179], v[80:83]
    ds_read_b64_tr_b16 v[156:157], v247 offset:16384
    ds_read_b64_tr_b16 v[158:159], v247 offset:18432
    v_mfma_f32_16x16x32_bf16 v[84:87], v[148:151], v[180:183], v[84:87]
    v_mfma_f32_16x16x32_bf16 v[88:91], v[148:151], v[184:187], v[88:91]
    buffer_load_dwordx4 v241, s[20:23], s52 offen offset:1024 lds
    v_mfma_f32_16x16x32_bf16 v[92:95], v[148:151], v[188:191], v[92:95]
    s_waitcnt vmcnt(16) lgkmcnt(4)
    v_mfma_f32_16x16x32_bf16 v[96:99], v[152:155], v[176:179], v[96:99]
    ds_read_b64_tr_b16 v[128:129], v244 offset:32768
    ds_read_b64_tr_b16 v[130:131], v244 offset:34816
    v_mfma_f32_16x16x32_bf16 v[100:103], v[152:155], v[180:183], v[100:103]
    ds_read_b128 v[168:171], v237 offset:26624
    ds_read_b128 v[172:175], v237 offset:27648
    v_mfma_f32_16x16x32_bf16 v[104:107], v[152:155], v[184:187], v[104:107]
    buffer_load_dwordx4 v242, s[20:23], s52 offen offset:2048 lds
    v_mfma_f32_16x16x32_bf16 v[108:111], v[152:155], v[188:191], v[108:111]
    s_waitcnt lgkmcnt(4)
    v_mfma_f32_16x16x32_bf16 v[112:115], v[156:159], v[176:179], v[112:115]
    ds_read_b64_tr_b16 v[132:133], v245 offset:32768
    ds_read_b64_tr_b16 v[134:135], v245 offset:34816
    v_mfma_f32_16x16x32_bf16 v[116:119], v[156:159], v[180:183], v[116:119]
    v_mfma_f32_16x16x32_bf16 v[120:123], v[156:159], v[184:187], v[120:123]
    buffer_load_dwordx4 v243, s[20:23], s52 offen offset:3072 lds
    v_mfma_f32_16x16x32_bf16 v[124:127], v[156:159], v[188:191], v[124:127]
    s_waitcnt lgkmcnt(2)
    s_add_u32 s52, s52, 32768
    s_and_b32 s52, s52, 524287
    v_mfma_f32_16x16x32_bf16 v[64:67], v[128:131], v[160:163], v[64:67]
    ds_read_b64_tr_b16 v[136:137], v246 offset:32768
    ds_read_b64_tr_b16 v[138:139], v246 offset:34816
    v_mfma_f32_16x16x32_bf16 v[68:71], v[128:131], v[164:167], v[68:71]
    ds_read_b128 v[176:179], v237 offset:28672
    ds_read_b128 v[180:183], v237 offset:29696
    s_add_u32 m0, s75, 81920
    v_mfma_f32_16x16x32_bf16 v[72:75], v[128:131], v[168:171], v[72:75]
    buffer_load_dwordx4 v240, s[20:23], s52 offen lds
    v_mfma_f32_16x16x32_bf16 v[76:79], v[128:131], v[172:175], v[76:79]
    s_waitcnt lgkmcnt(4)
    s_add_u32 s59, s59, 4096
    v_mfma_f32_16x16x32_bf16 v[80:83], v[132:135], v[160:163], v[80:83]
    ds_read_b64_tr_b16 v[140:141], v247 offset:32768
    ds_read_b64_tr_b16 v[142:143], v247 offset:34816
    v_mfma_f32_16x16x32_bf16 v[84:87], v[132:135], v[164:167], v[84:87]
    buffer_store_dwordx4 v[8:11], v237, s[40:43], s59 offen sc1
    v_mfma_f32_16x16x32_bf16 v[88:91], v[132:135], v[168:171], v[88:91]
    buffer_load_dwordx4 v241, s[20:23], s52 offen offset:1024 lds
    v_mfma_f32_16x16x32_bf16 v[92:95], v[132:135], v[172:175], v[92:95]
    s_waitcnt vmcnt(17) lgkmcnt(4)
    v_mfma_f32_16x16x32_bf16 v[96:99], v[136:139], v[160:163], v[96:99]
    ds_read_b64_tr_b16 v[144:145], v244 offset:49152
    ds_read_b64_tr_b16 v[146:147], v244 offset:51200
    v_mfma_f32_16x16x32_bf16 v[100:103], v[136:139], v[164:167], v[100:103]
    ds_read_b128 v[184:187], v237 offset:30720
    ds_read_b128 v[188:191], v237 offset:31744
    v_mfma_f32_16x16x32_bf16 v[104:107], v[136:139], v[168:171], v[104:107]
    buffer_load_dwordx4 v242, s[20:23], s52 offen offset:2048 lds
    v_mfma_f32_16x16x32_bf16 v[108:111], v[136:139], v[172:175], v[108:111]
    s_waitcnt lgkmcnt(4)
    v_mfma_f32_16x16x32_bf16 v[112:115], v[140:143], v[160:163], v[112:115]
    ds_read_b64_tr_b16 v[148:149], v245 offset:49152
    ds_read_b64_tr_b16 v[150:151], v245 offset:51200
    v_mfma_f32_16x16x32_bf16 v[116:119], v[140:143], v[164:167], v[116:119]
    v_mfma_f32_16x16x32_bf16 v[120:123], v[140:143], v[168:171], v[120:123]
    buffer_load_dwordx4 v243, s[20:23], s52 offen offset:3072 lds
    v_mfma_f32_16x16x32_bf16 v[124:127], v[140:143], v[172:175], v[124:127]
    s_waitcnt lgkmcnt(2)
    s_add_u32 s52, s52, 32768
    s_and_b32 s52, s52, 524287
    v_mfma_f32_16x16x32_bf16 v[64:67], v[144:147], v[176:179], v[64:67]
    ds_read_b64_tr_b16 v[152:153], v246 offset:49152
    ds_read_b64_tr_b16 v[154:155], v246 offset:51200
    v_mfma_f32_16x16x32_bf16 v[68:71], v[144:147], v[180:183], v[68:71]
    ds_read_b128 v[160:163], v237 offset:32768
    ds_read_b128 v[164:167], v237 offset:33792
    s_add_u32 m0, s75, 98304
    v_mfma_f32_16x16x32_bf16 v[72:75], v[144:147], v[184:187], v[72:75]
    buffer_load_dwordx4 v240, s[20:23], s52 offen lds
    v_mfma_f32_16x16x32_bf16 v[76:79], v[144:147], v[188:191], v[76:79]
    s_waitcnt lgkmcnt(4)
    v_mfma_f32_16x16x32_bf16 v[80:83], v[148:151], v[176:179], v[80:83]
    ds_read_b64_tr_b16 v[156:157], v247 offset:49152
    ds_read_b64_tr_b16 v[158:159], v247 offset:51200
    v_mfma_f32_16x16x32_bf16 v[84:87], v[148:151], v[180:183], v[84:87]
    v_mfma_f32_16x16x32_bf16 v[88:91], v[148:151], v[184:187], v[88:91]
    buffer_load_dwordx4 v241, s[20:23], s52 offen offset:1024 lds
    v_mfma_f32_16x16x32_bf16 v[92:95], v[148:151], v[188:191], v[92:95]
    s_waitcnt vmcnt(16) lgkmcnt(4)
    v_mfma_f32_16x16x32_bf16 v[96:99], v[152:155], v[176:179], v[96:99]
    ds_read_b64_tr_b16 v[128:129], v248 offset:0
    ds_read_b64_tr_b16 v[130:131], v248 offset:2048
    v_mfma_f32_16x16x32_bf16 v[100:103], v[152:155], v[180:183], v[100:103]
    ds_read_b128 v[168:171], v237 offset:34816
    ds_read_b128 v[172:175], v237 offset:35840
    v_mfma_f32_16x16x32_bf16 v[104:107], v[152:155], v[184:187], v[104:107]
    buffer_load_dwordx4 v242, s[20:23], s52 offen offset:2048 lds
    v_mfma_f32_16x16x32_bf16 v[108:111], v[152:155], v[188:191], v[108:111]
    s_waitcnt lgkmcnt(4)
    v_mfma_f32_16x16x32_bf16 v[112:115], v[156:159], v[176:179], v[112:115]
    ds_read_b64_tr_b16 v[132:133], v249 offset:0
    ds_read_b64_tr_b16 v[134:135], v249 offset:2048
    v_mfma_f32_16x16x32_bf16 v[116:119], v[156:159], v[180:183], v[116:119]
    buffer_store_dwordx4 v[40:43], v237, s[40:43], s59 offen offset:1024 sc1
    v_mfma_f32_16x16x32_bf16 v[120:123], v[156:159], v[184:187], v[120:123]
    buffer_load_dwordx4 v243, s[20:23], s52 offen offset:3072 lds
    v_mfma_f32_16x16x32_bf16 v[124:127], v[156:159], v[188:191], v[124:127]
    s_waitcnt lgkmcnt(2)
    s_add_u32 s52, s52, 32768
    s_and_b32 s52, s52, 524287
    v_mfma_f32_16x16x32_bf16 v[64:67], v[128:131], v[160:163], v[64:67]
    ds_read_b64_tr_b16 v[136:137], v250 offset:0
    ds_read_b64_tr_b16 v[138:139], v250 offset:2048
    v_mfma_f32_16x16x32_bf16 v[68:71], v[128:131], v[164:167], v[68:71]
    ds_read_b128 v[176:179], v237 offset:36864
    ds_read_b128 v[180:183], v237 offset:37888
    s_add_u32 m0, s75, 114688
    v_mfma_f32_16x16x32_bf16 v[72:75], v[128:131], v[168:171], v[72:75]
    buffer_load_dwordx4 v240, s[20:23], s52 offen lds
    v_mfma_f32_16x16x32_bf16 v[76:79], v[128:131], v[172:175], v[76:79]
    s_waitcnt lgkmcnt(4)
    v_mfma_f32_16x16x32_bf16 v[80:83], v[132:135], v[160:163], v[80:83]
    ds_read_b64_tr_b16 v[140:141], v251 offset:0
    ds_read_b64_tr_b16 v[142:143], v251 offset:2048
    v_mfma_f32_16x16x32_bf16 v[84:87], v[132:135], v[164:167], v[84:87]
    v_mfma_f32_16x16x32_bf16 v[88:91], v[132:135], v[168:171], v[88:91]
    buffer_load_dwordx4 v241, s[20:23], s52 offen offset:1024 lds
    v_mfma_f32_16x16x32_bf16 v[92:95], v[132:135], v[172:175], v[92:95]
    s_waitcnt vmcnt(16) lgkmcnt(4)
    v_mfma_f32_16x16x32_bf16 v[96:99], v[136:139], v[160:163], v[96:99]
    ds_read_b64_tr_b16 v[144:145], v244 offset:0
    ds_read_b64_tr_b16 v[146:147], v244 offset:2048
    v_mfma_f32_16x16x32_bf16 v[100:103], v[136:139], v[164:167], v[100:103]
    ds_read_b128 v[184:187], v237 offset:38912
    ds_read_b128 v[188:191], v237 offset:39936
    v_mfma_f32_16x16x32_bf16 v[104:107], v[136:139], v[168:171], v[104:107]
    buffer_load_dwordx4 v242, s[20:23], s52 offen offset:2048 lds
    v_mfma_f32_16x16x32_bf16 v[108:111], v[136:139], v[172:175], v[108:111]
    s_waitcnt lgkmcnt(4)
    v_mfma_f32_16x16x32_bf16 v[112:115], v[140:143], v[160:163], v[112:115]
    ds_read_b64_tr_b16 v[148:149], v245 offset:0
    ds_read_b64_tr_b16 v[150:151], v245 offset:2048
    v_mfma_f32_16x16x32_bf16 v[116:119], v[140:143], v[164:167], v[116:119]
    v_mfma_f32_16x16x32_bf16 v[120:123], v[140:143], v[168:171], v[120:123]
    buffer_load_dwordx4 v243, s[20:23], s52 offen offset:3072 lds
    v_mfma_f32_16x16x32_bf16 v[124:127], v[140:143], v[172:175], v[124:127]
    s_waitcnt lgkmcnt(2)
    s_add_u32 s52, s52, 32768
    s_and_b32 s52, s52, 524287
    v_mfma_f32_16x16x32_bf16 v[64:67], v[144:147], v[176:179], v[64:67]
    ds_read_b64_tr_b16 v[152:153], v246 offset:0
    ds_read_b64_tr_b16 v[154:155], v246 offset:2048
    v_mfma_f32_16x16x32_bf16 v[68:71], v[144:147], v[180:183], v[68:71]
    ds_read_b128 v[160:163], v237 offset:40960
    ds_read_b128 v[164:167], v237 offset:41984
    s_add_u32 m0, s75, 131072
    v_mfma_f32_16x16x32_bf16 v[72:75], v[144:147], v[184:187], v[72:75]
    buffer_load_dwordx4 v240, s[20:23], s52 offen lds
    v_mfma_f32_16x16x32_bf16 v[76:79], v[144:147], v[188:191], v[76:79]
    s_waitcnt lgkmcnt(4)
    v_mfma_f32_16x16x32_bf16 v[80:83], v[148:151], v[176:179], v[80:83]
    ds_read_b64_tr_b16 v[156:157], v247 offset:0
    ds_read_b64_tr_b16 v[158:159], v247 offset:2048
    v_mfma_f32_16x16x32_bf16 v[84:87], v[148:151], v[180:183], v[84:87]
    buffer_store_dwordx4 v[12:15], v237, s[40:43], s59 offen offset:2048 sc1
    v_mfma_f32_16x16x32_bf16 v[88:91], v[148:151], v[184:187], v[88:91]
    buffer_load_dwordx4 v241, s[20:23], s52 offen offset:1024 lds
    v_mfma_f32_16x16x32_bf16 v[92:95], v[148:151], v[188:191], v[92:95]
    s_waitcnt vmcnt(17) lgkmcnt(4)
    v_mfma_f32_16x16x32_bf16 v[96:99], v[152:155], v[176:179], v[96:99]
    ds_read_b64_tr_b16 v[128:129], v248 offset:16384
    ds_read_b64_tr_b16 v[130:131], v248 offset:18432
    v_mfma_f32_16x16x32_bf16 v[100:103], v[152:155], v[180:183], v[100:103]
    ds_read_b128 v[168:171], v237 offset:43008
    ds_read_b128 v[172:175], v237 offset:44032
    v_mfma_f32_16x16x32_bf16 v[104:107], v[152:155], v[184:187], v[104:107]
    buffer_load_dwordx4 v242, s[20:23], s52 offen offset:2048 lds
    v_mfma_f32_16x16x32_bf16 v[108:111], v[152:155], v[188:191], v[108:111]
    s_waitcnt lgkmcnt(4)
    v_mfma_f32_16x16x32_bf16 v[112:115], v[156:159], v[176:179], v[112:115]
    ds_read_b64_tr_b16 v[132:133], v249 offset:16384
    ds_read_b64_tr_b16 v[134:135], v249 offset:18432
    v_mfma_f32_16x16x32_bf16 v[116:119], v[156:159], v[180:183], v[116:119]
    v_mfma_f32_16x16x32_bf16 v[120:123], v[156:159], v[184:187], v[120:123]
    buffer_load_dwordx4 v243, s[20:23], s52 offen offset:3072 lds
    v_mfma_f32_16x16x32_bf16 v[124:127], v[156:159], v[188:191], v[124:127]
    s_waitcnt lgkmcnt(2)
    s_add_u32 s52, s52, 32768
    s_and_b32 s52, s52, 524287
    v_mfma_f32_16x16x32_bf16 v[64:67], v[128:131], v[160:163], v[64:67]
    ds_read_b64_tr_b16 v[136:137], v250 offset:16384
    ds_read_b64_tr_b16 v[138:139], v250 offset:18432
    v_mfma_f32_16x16x32_bf16 v[68:71], v[128:131], v[164:167], v[68:71]
    ds_read_b128 v[176:179], v237 offset:45056
    ds_read_b128 v[180:183], v237 offset:46080
    s_add_u32 m0, s75, 65536
    v_mfma_f32_16x16x32_bf16 v[72:75], v[128:131], v[168:171], v[72:75]
    buffer_load_dwordx4 v240, s[20:23], s52 offen lds
    v_mfma_f32_16x16x32_bf16 v[76:79], v[128:131], v[172:175], v[76:79]
    s_waitcnt lgkmcnt(4)
    v_mfma_f32_16x16x32_bf16 v[80:83], v[132:135], v[160:163], v[80:83]
    ds_read_b64_tr_b16 v[140:141], v251 offset:16384
    ds_read_b64_tr_b16 v[142:143], v251 offset:18432
    v_mfma_f32_16x16x32_bf16 v[84:87], v[132:135], v[164:167], v[84:87]
    v_mfma_f32_16x16x32_bf16 v[88:91], v[132:135], v[168:171], v[88:91]
    buffer_load_dwordx4 v241, s[20:23], s52 offen offset:1024 lds
    v_mfma_f32_16x16x32_bf16 v[92:95], v[132:135], v[172:175], v[92:95]
    s_waitcnt vmcnt(16) lgkmcnt(4)
    v_mfma_f32_16x16x32_bf16 v[96:99], v[136:139], v[160:163], v[96:99]
    ds_read_b64_tr_b16 v[144:145], v244 offset:16384
    ds_read_b64_tr_b16 v[146:147], v244 offset:18432
    v_mfma_f32_16x16x32_bf16 v[100:103], v[136:139], v[164:167], v[100:103]
    ds_read_b128 v[184:187], v237 offset:47104
    ds_read_b128 v[188:191], v237 offset:48128
    v_mfma_f32_16x16x32_bf16 v[104:107], v[136:139], v[168:171], v[104:107]
    buffer_load_dwordx4 v242, s[20:23], s52 offen offset:2048 lds
    v_mfma_f32_16x16x32_bf16 v[108:111], v[136:139], v[172:175], v[108:111]
    s_waitcnt lgkmcnt(4)
    v_mfma_f32_16x16x32_bf16 v[112:115], v[140:143], v[160:163], v[112:115]
    ds_read_b64_tr_b16 v[148:149], v245 offset:16384
    ds_read_b64_tr_b16 v[150:151], v245 offset:18432
    v_mfma_f32_16x16x32_bf16 v[116:119], v[140:143], v[164:167], v[116:119]
    buffer_store_dwordx4 v[44:47], v237, s[40:43], s59 offen offset:3072 sc1
    v_mfma_f32_16x16x32_bf16 v[120:123], v[140:143], v[168:171], v[120:123]
    buffer_load_dwordx4 v243, s[20:23], s52 offen offset:3072 lds
    v_mfma_f32_16x16x32_bf16 v[124:127], v[140:143], v[172:175], v[124:127]
    s_waitcnt lgkmcnt(2)
    s_add_u32 m0, s75, 147456
    v_mfma_f32_16x16x32_bf16 v[64:67], v[144:147], v[176:179], v[64:67]
    ds_read_b64_tr_b16 v[152:153], v246 offset:16384
    ds_read_b64_tr_b16 v[154:155], v246 offset:18432
    v_mfma_f32_16x16x32_bf16 v[68:71], v[144:147], v[180:183], v[68:71]
    ds_read_b128 v[160:163], v237 offset:49152
    ds_read_b128 v[164:167], v237 offset:50176
    v_mfma_f32_16x16x32_bf16 v[72:75], v[144:147], v[184:187], v[72:75]
    buffer_load_dwordx4 v240, s[32:35], s53 offen lds
    v_mfma_f32_16x16x32_bf16 v[76:79], v[144:147], v[188:191], v[76:79]
    s_waitcnt lgkmcnt(4)
    v_mfma_f32_16x16x32_bf16 v[80:83], v[148:151], v[176:179], v[80:83]
    ds_read_b64_tr_b16 v[156:157], v247 offset:16384
    ds_read_b64_tr_b16 v[158:159], v247 offset:18432
    v_mfma_f32_16x16x32_bf16 v[84:87], v[148:151], v[180:183], v[84:87]
    v_mfma_f32_16x16x32_bf16 v[88:91], v[148:151], v[184:187], v[88:91]
    buffer_load_dwordx4 v241, s[32:35], s53 offen offset:1024 lds
    v_mfma_f32_16x16x32_bf16 v[92:95], v[148:151], v[188:191], v[92:95]
    s_waitcnt vmcnt(16) lgkmcnt(4)
    v_mfma_f32_16x16x32_bf16 v[96:99], v[152:155], v[176:179], v[96:99]
    ds_read_b64_tr_b16 v[128:129], v244 offset:32768
    ds_read_b64_tr_b16 v[130:131], v244 offset:34816
    v_mfma_f32_16x16x32_bf16 v[100:103], v[152:155], v[180:183], v[100:103]
    ds_read_b128 v[168:171], v237 offset:51200
    ds_read_b128 v[172:175], v237 offset:52224
    v_mfma_f32_16x16x32_bf16 v[104:107], v[152:155], v[184:187], v[104:107]
    buffer_load_dwordx4 v242, s[32:35], s53 offen offset:2048 lds
    v_mfma_f32_16x16x32_bf16 v[108:111], v[152:155], v[188:191], v[108:111]
    s_waitcnt lgkmcnt(4)
    v_mfma_f32_16x16x32_bf16 v[112:115], v[156:159], v[176:179], v[112:115]
    ds_read_b64_tr_b16 v[132:133], v245 offset:32768
    ds_read_b64_tr_b16 v[134:135], v245 offset:34816
    v_mfma_f32_16x16x32_bf16 v[116:119], v[156:159], v[180:183], v[116:119]
    v_mfma_f32_16x16x32_bf16 v[120:123], v[156:159], v[184:187], v[120:123]
    buffer_load_dwordx4 v243, s[32:35], s53 offen offset:3072 lds
    v_mfma_f32_16x16x32_bf16 v[124:127], v[156:159], v[188:191], v[124:127]
    s_waitcnt lgkmcnt(2)
    s_add_u32 s53, s53, 32768
    s_cmp_lt_u32 s53, s55
    v_mfma_f32_16x16x32_bf16 v[64:67], v[128:131], v[160:163], v[64:67]
    ds_read_b64_tr_b16 v[136:137], v246 offset:32768
    ds_read_b64_tr_b16 v[138:139], v246 offset:34816
    v_mfma_f32_16x16x32_bf16 v[68:71], v[128:131], v[164:167], v[68:71]
    ds_read_b128 v[176:179], v237 offset:53248
    ds_read_b128 v[180:183], v237 offset:54272
    s_cselect_b32 s53, s53, s54
    s_add_u32 m0, s75, 81920
    v_mfma_f32_16x16x32_bf16 v[72:75], v[128:131], v[168:171], v[72:75]
    buffer_load_dwordx4 v240, s[32:35], s53 offen lds
    v_mfma_f32_16x16x32_bf16 v[76:79], v[128:131], v[172:175], v[76:79]
    s_waitcnt lgkmcnt(4)
    v_mfma_f32_16x16x32_bf16 v[80:83], v[132:135], v[160:163], v[80:83]
    ds_read_b64_tr_b16 v[140:141], v247 offset:32768
    ds_read_b64_tr_b16 v[142:143], v247 offset:34816
    v_mfma_f32_16x16x32_bf16 v[84:87], v[132:135], v[164:167], v[84:87]
    v_mfma_f32_16x16x32_bf16 v[88:91], v[132:135], v[168:171], v[88:91]
    buffer_load_dwordx4 v241, s[32:35], s53 offen offset:1024 lds
    v_mfma_f32_16x16x32_bf16 v[92:95], v[132:135], v[172:175], v[92:95]
    s_waitcnt vmcnt(16) lgkmcnt(4)
    v_mfma_f32_16x16x32_bf16 v[96:99], v[136:139], v[160:163], v[96:99]
    ds_read_b64_tr_b16 v[144:145], v244 offset:49152
    ds_read_b64_tr_b16 v[146:147], v244 offset:51200
    v_mfma_f32_16x16x32_bf16 v[100:103], v[136:139], v[164:167], v[100:103]
    ds_read_b128 v[184:187], v237 offset:55296
    ds_read_b128 v[188:191], v237 offset:56320
    v_mfma_f32_16x16x32_bf16 v[104:107], v[136:139], v[168:171], v[104:107]
    buffer_load_dwordx4 v242, s[32:35], s53 offen offset:2048 lds
    v_mfma_f32_16x16x32_bf16 v[108:111], v[136:139], v[172:175], v[108:111]
    s_waitcnt lgkmcnt(4)
    v_mfma_f32_16x16x32_bf16 v[112:115], v[140:143], v[160:163], v[112:115]
    ds_read_b64_tr_b16 v[148:149], v245 offset:49152
    ds_read_b64_tr_b16 v[150:151], v245 offset:51200
    v_mfma_f32_16x16x32_bf16 v[116:119], v[140:143], v[164:167], v[116:119]
    v_mfma_f32_16x16x32_bf16 v[120:123], v[140:143], v[168:171], v[120:123]
    buffer_load_dwordx4 v243, s[32:35], s53 offen offset:3072 lds
    v_mfma_f32_16x16x32_bf16 v[124:127], v[140:143], v[172:175], v[124:127]
    s_waitcnt lgkmcnt(2)
    s_add_u32 s53, s53, 32768
    s_cmp_lt_u32 s53, s55
    v_mfma_f32_16x16x32_bf16 v[64:67], v[144:147], v[176:179], v[64:67]
    ds_read_b64_tr_b16 v[152:153], v246 offset:49152
    ds_read_b64_tr_b16 v[154:155], v246 offset:51200
    v_mfma_f32_16x16x32_bf16 v[68:71], v[144:147], v[180:183], v[68:71]
    ds_read_b128 v[160:163], v237 offset:57344
    ds_read_b128 v[164:167], v237 offset:58368
    s_cselect_b32 s53, s53, s54
    s_add_u32 m0, s75, 98304
    v_mfma_f32_16x16x32_bf16 v[72:75], v[144:147], v[184:187], v[72:75]
    buffer_load_dwordx4 v240, s[32:35], s53 offen lds
    v_mfma_f32_16x16x32_bf16 v[76:79], v[144:147], v[188:191], v[76:79]
    s_waitcnt lgkmcnt(4)
    v_mfma_f32_16x16x32_bf16 v[80:83], v[148:151], v[176:179], v[80:83]
    ds_read_b64_tr_b16 v[156:157], v247 offset:49152
    ds_read_b64_tr_b16 v[158:159], v247 offset:51200
    v_mfma_f32_16x16x32_bf16 v[84:87], v[148:151], v[180:183], v[84:87]
    v_mfma_f32_16x16x32_bf16 v[88:91], v[148:151], v[184:187], v[88:91]
    buffer_load_dwordx4 v241, s[32:35], s53 offen offset:1024 lds
    v_mfma_f32_16x16x32_bf16 v[92:95], v[148:151], v[188:191], v[92:95]
    s_waitcnt vmcnt(15) lgkmcnt(4)
    v_mfma_f32_16x16x32_bf16 v[96:99], v[152:155], v[176:179], v[96:99]
    ds_read_b64_tr_b16 v[128:129], v248 offset:0
    ds_read_b64_tr_b16 v[130:131], v248 offset:2048
    v_mfma_f32_16x16x32_bf16 v[100:103], v[152:155], v[180:183], v[100:103]
    ds_read_b128 v[168:171], v237 offset:59392
    ds_read_b128 v[172:175], v237 offset:60416
    v_mfma_f32_16x16x32_bf16 v[104:107], v[152:155], v[184:187], v[104:107]
    buffer_load_dwordx4 v242, s[32:35], s53 offen offset:2048 lds
    v_mfma_f32_16x16x32_bf16 v[108:111], v[152:155], v[188:191], v[108:111]
    s_waitcnt lgkmcnt(4)
    v_mfma_f32_16x16x32_bf16 v[112:115], v[156:159], v[176:179], v[112:115]
    ds_read_b64_tr_b16 v[132:133], v249 offset:0
    ds_read_b64_tr_b16 v[134:135], v249 offset:2048
    v_mfma_f32_16x16x32_bf16 v[116:119], v[156:159], v[180:183], v[116:119]
    v_mfma_f32_16x16x32_bf16 v[120:123], v[156:159], v[184:187], v[120:123]
    buffer_load_dwordx4 v243, s[32:35], s53 offen offset:3072 lds
    v_mfma_f32_16x16x32_bf16 v[124:127], v[156:159], v[188:191], v[124:127]
    s_waitcnt lgkmcnt(2)
    s_add_u32 s53, s53, 32768
    s_cmp_lt_u32 s53, s55
    v_mfma_f32_16x16x32_bf16 v[64:67], v[128:131], v[160:163], v[64:67]
    ds_read_b64_tr_b16 v[136:137], v250 offset:0
    ds_read_b64_tr_b16 v[138:139], v250 offset:2048
    v_mfma_f32_16x16x32_bf16 v[68:71], v[128:131], v[164:167], v[68:71]
    ds_read_b128 v[176:179], v237 offset:61440
    ds_read_b128 v[180:183], v237 offset:62464
    s_cselect_b32 s53, s53, s54
    s_add_u32 m0, s75, 114688
    v_mfma_f32_16x16x32_bf16 v[72:75], v[128:131], v[168:171], v[72:75]
    buffer_load_dwordx4 v240, s[32:35], s53 offen lds
    v_mfma_f32_16x16x32_bf16 v[76:79], v[128:131], v[172:175], v[76:79]
    s_waitcnt lgkmcnt(4)
    v_mfma_f32_16x16x32_bf16 v[80:83], v[132:135], v[160:163], v[80:83]
    ds_read_b64_tr_b16 v[140:141], v251 offset:0
    ds_read_b64_tr_b16 v[142:143], v251 offset:2048
    v_mfma_f32_16x16x32_bf16 v[84:87], v[132:135], v[164:167], v[84:87]
    v_mfma_f32_16x16x32_bf16 v[88:91], v[132:135], v[168:171], v[88:91]
    buffer_load_dwordx4 v241, s[32:35], s53 offen offset:1024 lds
    v_mfma_f32_16x16x32_bf16 v[92:95], v[132:135], v[172:175], v[92:95]
    s_waitcnt vmcnt(14) lgkmcnt(4)
    v_mfma_f32_16x16x32_bf16 v[96:99], v[136:139], v[160:163], v[96:99]
    ds_read_b64_tr_b16 v[144:145], v244 offset:0
    ds_read_b64_tr_b16 v[146:147], v244 offset:2048
    v_mfma_f32_16x16x32_bf16 v[100:103], v[136:139], v[164:167], v[100:103]
    ds_read_b128 v[184:187], v237 offset:63488
    ds_read_b128 v[188:191], v237 offset:64512
    v_mfma_f32_16x16x32_bf16 v[104:107], v[136:139], v[168:171], v[104:107]
    buffer_load_dwordx4 v242, s[32:35], s53 offen offset:2048 lds
    v_mfma_f32_16x16x32_bf16 v[108:111], v[136:139], v[172:175], v[108:111]
    s_waitcnt lgkmcnt(4)
    v_mfma_f32_16x16x32_bf16 v[112:115], v[140:143], v[160:163], v[112:115]
    ds_read_b64_tr_b16 v[148:149], v245 offset:0
    ds_read_b64_tr_b16 v[150:151], v245 offset:2048
    v_mfma_f32_16x16x32_bf16 v[116:119], v[140:143], v[164:167], v[116:119]
    v_mfma_f32_16x16x32_bf16 v[120:123], v[140:143], v[168:171], v[120:123]
    buffer_load_dwordx4 v243, s[32:35], s53 offen offset:3072 lds
    v_mfma_f32_16x16x32_bf16 v[124:127], v[140:143], v[172:175], v[124:127]
    s_waitcnt lgkmcnt(2)
    s_add_u32 s53, s53, 32768
    s_cmp_lt_u32 s53, s55
    v_mfma_f32_16x16x32_bf16 v[64:67], v[144:147], v[176:179], v[64:67]
    ds_read_b64_tr_b16 v[152:153], v246 offset:0
    ds_read_b64_tr_b16 v[154:155], v246 offset:2048
    v_mfma_f32_16x16x32_bf16 v[68:71], v[144:147], v[180:183], v[68:71]
    s_cselect_b32 s53, s53, s54
    s_add_u32 m0, s75, 131072
    v_mfma_f32_16x16x32_bf16 v[72:75], v[144:147], v[184:187], v[72:75]
    buffer_load_dwordx4 v240, s[32:35], s53 offen lds
    v_mfma_f32_16x16x32_bf16 v[76:79], v[144:147], v[188:191], v[76:79]
    s_waitcnt lgkmcnt(2)
    v_mfma_f32_16x16x32_bf16 v[80:83], v[148:151], v[176:179], v[80:83]
    ds_read_b64_tr_b16 v[156:157], v247 offset:0
    ds_read_b64_tr_b16 v[158:159], v247 offset:2048
    v_mfma_f32_16x16x32_bf16 v[84:87], v[148:151], v[180:183], v[84:87]
    v_mfma_f32_16x16x32_bf16 v[88:91], v[148:151], v[184:187], v[88:91]
    buffer_load_dwordx4 v241, s[32:35], s53 offen offset:1024 lds
    v_mfma_f32_16x16x32_bf16 v[92:95], v[148:151], v[188:191], v[92:95]
    s_waitcnt vmcnt(14) lgkmcnt(2)
    v_mfma_f32_16x16x32_bf16 v[96:99], v[152:155], v[176:179], v[96:99]
    ds_read_b64_tr_b16 v[128:129], v248 offset:16384
    ds_read_b64_tr_b16 v[130:131], v248 offset:18432
    v_mfma_f32_16x16x32_bf16 v[100:103], v[152:155], v[180:183], v[100:103]
    v_mfma_f32_16x16x32_bf16 v[104:107], v[152:155], v[184:187], v[104:107]
    buffer_load_dwordx4 v242, s[32:35], s53 offen offset:2048 lds
    v_mfma_f32_16x16x32_bf16 v[108:111], v[152:155], v[188:191], v[108:111]
    s_waitcnt lgkmcnt(2)
    v_mfma_f32_16x16x32_bf16 v[112:115], v[156:159], v[176:179], v[112:115]
    ds_read_b64_tr_b16 v[132:133], v249 offset:16384
    ds_read_b64_tr_b16 v[134:135], v249 offset:18432
    v_mfma_f32_16x16x32_bf16 v[116:119], v[156:159], v[180:183], v[116:119]
    v_mfma_f32_16x16x32_bf16 v[120:123], v[156:159], v[184:187], v[120:123]
    buffer_load_dwordx4 v243, s[32:35], s53 offen offset:3072 lds
    v_mfma_f32_16x16x32_bf16 v[124:127], v[156:159], v[188:191], v[124:127]
    s_waitcnt lgkmcnt(2)
    s_add_u32 s53, s53, 32768
    s_cmp_lt_u32 s53, s55
    v_mfma_f32_16x16x32_bf16 v[160:163], v[128:131], a[128:131], 0
    ds_read_b64_tr_b16 v[136:137], v250 offset:16384
    ds_read_b64_tr_b16 v[138:139], v250 offset:18432
    v_mfma_f32_16x16x32_bf16 v[176:179], v[128:131], a[132:135], 0
    s_cselect_b32 s53, s53, s54
    s_add_u32 m0, s75, 65536
    v_mfma_f32_16x16x32_bf16 v[192:195], v[128:131], a[136:139], 0
    buffer_load_dwordx4 v240, s[32:35], s53 offen lds
    v_mfma_f32_16x16x32_bf16 v[208:211], v[128:131], a[140:143], 0
    s_waitcnt lgkmcnt(2)
    s_sub_u32 s59, s59, 4096
    s_xor_b32 s59, s59, 65536
    v_cvt_pk_bf16_f32 v64, v64, v65
    v_cvt_pk_bf16_f32 v65, v66, v67
    v_cvt_pk_bf16_f32 v66, v80, v81
    v_cvt_pk_bf16_f32 v67, v82, v83
    v_mfma_f32_16x16x32_bf16 v[164:167], v[132:135], a[128:131], 0
    ds_read_b64_tr_b16 v[140:141], v251 offset:16384
    ds_read_b64_tr_b16 v[142:143], v251 offset:18432
    v_mfma_f32_16x16x32_bf16 v[180:183], v[132:135], a[132:135], 0
    buffer_store_dwordx4 v[64:67], v237, s[40:43], s59 offen sc1
    v_mfma_f32_16x16x32_bf16 v[196:199], v[132:135], a[136:139], 0
    buffer_load_dwordx4 v241, s[32:35], s53 offen offset:1024 lds
    v_mfma_f32_16x16x32_bf16 v[212:215], v[132:135], a[140:143], 0
    s_waitcnt vmcnt(15) lgkmcnt(2)
    v_cvt_pk_bf16_f32 v96, v96, v97
    v_cvt_pk_bf16_f32 v97, v98, v99
    v_cvt_pk_bf16_f32 v98, v112, v113
    v_cvt_pk_bf16_f32 v99, v114, v115
    v_mfma_f32_16x16x32_bf16 v[168:171], v[136:139], a[128:131], 0
    ds_read_b64_tr_b16 v[144:145], v244 offset:16384
    ds_read_b64_tr_b16 v[146:147], v244 offset:18432
    v_mfma_f32_16x16x32_bf16 v[184:187], v[136:139], a[132:135], 0
    buffer_store_dwordx4 v[96:99], v237, s[40:43], s59 offen offset:1024 sc1
    v_mfma_f32_16x16x32_bf16 v[200:203], v[136:139], a[136:139], 0
    buffer_load_dwordx4 v242, s[32:35], s53 offen offset:2048 lds
    v_mfma_f32_16x16x32_bf16 v[216:219], v[136:139], a[140:143], 0
    s_waitcnt lgkmcnt(2)
    v_cvt_pk_bf16_f32 v68, v68, v69
    v_cvt_pk_bf16_f32 v69, v70, v71
    v_cvt_pk_bf16_f32 v70, v84, v85
    v_cvt_pk_bf16_f32 v71, v86, v87
    v_mfma_f32_16x16x32_bf16 v[172:175], v[140:143], a[128:131], 0
    ds_read_b64_tr_b16 v[148:149], v245 offset:16384
    ds_read_b64_tr_b16 v[150:151], v245 offset:18432
    v_mfma_f32_16x16x32_bf16 v[188:191], v[140:143], a[132:135], 0
    buffer_store_dwordx4 v[68:71], v237, s[40:43], s59 offen offset:2048 sc1
    v_mfma_f32_16x16x32_bf16 v[204:207], v[140:143], a[136:139], 0
    buffer_load_dwordx4 v243, s[32:35], s53 offen offset:3072 lds
    v_mfma_f32_16x16x32_bf16 v[220:223], v[140:143], a[140:143], 0
    s_waitcnt lgkmcnt(2)
    s_add_u32 s53, s53, 32768
    s_cmp_lt_u32 s53, s55
    v_cvt_pk_bf16_f32 v100, v100, v101
    v_cvt_pk_bf16_f32 v101, v102, v103
    v_cvt_pk_bf16_f32 v102, v116, v117
    v_cvt_pk_bf16_f32 v103, v118, v119
    v_mfma_f32_16x16x32_bf16 v[160:163], v[144:147], a[144:147], v[160:163]
    ds_read_b64_tr_b16 v[152:153], v246 offset:16384
    ds_read_b64_tr_b16 v[154:155], v246 offset:18432
    v_mfma_f32_16x16x32_bf16 v[176:179], v[144:147], a[148:151], v[176:179]
    s_cselect_b32 s53, s53, s54
    s_add_u32 m0, s75, 147456
    buffer_store_dwordx4 v[100:103], v237, s[40:43], s59 offen offset:3072 sc1
    v_mfma_f32_16x16x32_bf16 v[192:195], v[144:147], a[152:155], v[192:195]
    buffer_load_dwordx4 v240, s[32:35], s53 offen lds
    v_mfma_f32_16x16x32_bf16 v[208:211], v[144:147], a[156:159], v[208:211]
    s_waitcnt lgkmcnt(2)
    s_add_u32 s59, s59, 4096
    v_cvt_pk_bf16_f32 v72, v72, v73
    v_cvt_pk_bf16_f32 v73, v74, v75
    v_cvt_pk_bf16_f32 v74, v88, v89
    v_cvt_pk_bf16_f32 v75, v90, v91
    v_mfma_f32_16x16x32_bf16 v[164:167], v[148:151], a[144:147], v[164:167]
    ds_read_b64_tr_b16 v[156:157], v247 offset:16384
    ds_read_b64_tr_b16 v[158:159], v247 offset:18432
    v_mfma_f32_16x16x32_bf16 v[180:183], v[148:151], a[148:151], v[180:183]
    buffer_store_dwordx4 v[72:75], v237, s[40:43], s59 offen sc1
    v_mfma_f32_16x16x32_bf16 v[196:199], v[148:151], a[152:155], v[196:199]
    buffer_load_dwordx4 v241, s[32:35], s53 offen offset:1024 lds
    v_mfma_f32_16x16x32_bf16 v[212:215], v[148:151], a[156:159], v[212:215]
    s_waitcnt vmcnt(19) lgkmcnt(2)
    v_cvt_pk_bf16_f32 v104, v104, v105
    v_cvt_pk_bf16_f32 v105, v106, v107
    v_cvt_pk_bf16_f32 v106, v120, v121
    v_cvt_pk_bf16_f32 v107, v122, v123
    v_mfma_f32_16x16x32_bf16 v[168:171], v[152:155], a[144:147], v[168:171]
    ds_read_b64_tr_b16 v[128:129], v244 offset:32768
    ds_read_b64_tr_b16 v[130:131], v244 offset:34816
    v_mfma_f32_16x16x32_bf16 v[184:187], v[152:155], a[148:151], v[184:187]
    buffer_store_dwordx4 v[104:107], v237, s[40:43], s59 offen offset:1024 sc1
    v_mfma_f32_16x16x32_bf16 v[200:203], v[152:155], a[152:155], v[200:203]
    buffer_load_dwordx4 v242, s[32:35], s53 offen offset:2048 lds
    v_mfma_f32_16x16x32_bf16 v[216:219], v[152:155], a[156:159], v[216:219]
    s_waitcnt lgkmcnt(2)
    v_cvt_pk_bf16_f32 v76, v76, v77
    v_cvt_pk_bf16_f32 v77, v78, v79
    v_cvt_pk_bf16_f32 v78, v92, v93
    v_cvt_pk_bf16_f32 v79, v94, v95
    v_mfma_f32_16x16x32_bf16 v[172:175], v[156:159], a[144:147], v[172:175]
    ds_read_b64_tr_b16 v[132:133], v245 offset:32768
    ds_read_b64_tr_b16 v[134:135], v245 offset:34816
    v_mfma_f32_16x16x32_bf16 v[188:191], v[156:159], a[148:151], v[188:191]
    buffer_store_dwordx4 v[76:79], v237, s[40:43], s59 offen offset:2048 sc1
    v_mfma_f32_16x16x32_bf16 v[204:207], v[156:159], a[152:155], v[204:207]
    buffer_load_dwordx4 v243, s[32:35], s53 offen offset:3072 lds
    v_mfma_f32_16x16x32_bf16 v[220:223], v[156:159], a[156:159], v[220:223]
    s_waitcnt lgkmcnt(2)
    s_add_u32 s53, s53, 32768
    s_cmp_lt_u32 s53, s55
    v_cvt_pk_bf16_f32 v108, v108, v109
    v_cvt_pk_bf16_f32 v109, v110, v111
    v_cvt_pk_bf16_f32 v110, v124, v125
    v_cvt_pk_bf16_f32 v111, v126, v127
    v_mfma_f32_16x16x32_bf16 v[160:163], v[128:131], a[160:163], v[160:163]
    ds_read_b64_tr_b16 v[136:137], v246 offset:32768
    ds_read_b64_tr_b16 v[138:139], v246 offset:34816
    v_mfma_f32_16x16x32_bf16 v[176:179], v[128:131], a[164:167], v[176:179]
    s_cselect_b32 s53, s53, s54
    s_add_u32 m0, s75, 81920
    buffer_store_dwordx4 v[108:111], v237, s[40:43], s59 offen offset:3072 sc1
    v_mfma_f32_16x16x32_bf16 v[192:195], v[128:131], a[168:171], v[192:195]
    buffer_load_dwordx4 v240, s[32:35], s53 offen lds
    v_mfma_f32_16x16x32_bf16 v[208:211], v[128:131], a[172:175], v[208:211]
    s_waitcnt lgkmcnt(2)
    v_mfma_f32_16x16x32_bf16 v[164:167], v[132:135], a[160:163], v[164:167]
    ds_read_b64_tr_b16 v[140:141], v247 offset:32768
    ds_read_b64_tr_b16 v[142:143], v247 offset:34816
    v_mfma_f32_16x16x32_bf16 v[180:183], v[132:135], a[164:167], v[180:183]
    v_mfma_f32_16x16x32_bf16 v[196:199], v[132:135], a[168:171], v[196:199]
    buffer_load_dwordx4 v241, s[32:35], s53 offen offset:1024 lds
    v_mfma_f32_16x16x32_bf16 v[212:215], v[132:135], a[172:175], v[212:215]
    s_waitcnt vmcnt(22) lgkmcnt(2)
    v_mfma_f32_16x16x32_bf16 v[168:171], v[136:139], a[160:163], v[168:171]
    ds_read_b64_tr_b16 v[144:145], v244 offset:49152
    ds_read_b64_tr_b16 v[146:147], v244 offset:51200
    v_mfma_f32_16x16x32_bf16 v[184:187], v[136:139], a[164:167], v[184:187]
    v_mfma_f32_16x16x32_bf16 v[200:203], v[136:139], a[168:171], v[200:203]
    buffer_load_dwordx4 v242, s[32:35], s53 offen offset:2048 lds
    v_mfma_f32_16x16x32_bf16 v[216:219], v[136:139], a[172:175], v[216:219]
    s_waitcnt lgkmcnt(2)
    v_mfma_f32_16x16x32_bf16 v[172:175], v[140:143], a[160:163], v[172:175]
    ds_read_b64_tr_b16 v[148:149], v245 offset:49152
    ds_read_b64_tr_b16 v[150:151], v245 offset:51200
    v_mfma_f32_16x16x32_bf16 v[188:191], v[140:143], a[164:167], v[188:191]
    v_mfma_f32_16x16x32_bf16 v[204:207], v[140:143], a[168:171], v[204:207]
    buffer_load_dwordx4 v243, s[32:35], s53 offen offset:3072 lds
    v_mfma_f32_16x16x32_bf16 v[220:223], v[140:143], a[172:175], v[220:223]
    s_waitcnt lgkmcnt(2)
    s_add_u32 s53, s53, 32768
    s_cmp_lt_u32 s53, s55
    v_mfma_f32_16x16x32_bf16 v[160:163], v[144:147], a[176:179], v[160:163]
    ds_read_b64_tr_b16 v[152:153], v246 offset:49152
    ds_read_b64_tr_b16 v[154:155], v246 offset:51200
    v_mfma_f32_16x16x32_bf16 v[176:179], v[144:147], a[180:183], v[176:179]
    s_cselect_b32 s53, s53, s54
    s_add_u32 m0, s75, 98304
    v_mfma_f32_16x16x32_bf16 v[192:195], v[144:147], a[184:187], v[192:195]
    buffer_load_dwordx4 v240, s[32:35], s53 offen lds
    v_mfma_f32_16x16x32_bf16 v[208:211], v[144:147], a[188:191], v[208:211]
    s_waitcnt lgkmcnt(2)
    v_mfma_f32_16x16x32_bf16 v[164:167], v[148:151], a[176:179], v[164:167]
    ds_read_b64_tr_b16 v[156:157], v247 offset:49152
    ds_read_b64_tr_b16 v[158:159], v247 offset:51200
    v_mfma_f32_16x16x32_bf16 v[180:183], v[148:151], a[180:183], v[180:183]
    v_mfma_f32_16x16x32_bf16 v[196:199], v[148:151], a[184:187], v[196:199]
    buffer_load_dwordx4 v241, s[32:35], s53 offen offset:1024 lds
    v_mfma_f32_16x16x32_bf16 v[212:215], v[148:151], a[188:191], v[212:215]
    s_waitcnt vmcnt(22) lgkmcnt(2)
    v_mfma_f32_16x16x32_bf16 v[168:171], v[152:155], a[176:179], v[168:171]
    ds_read_b64_tr_b16 v[128:129], v248 offset:0
    ds_read_b64_tr_b16 v[130:131], v248 offset:2048
    v_mfma_f32_16x16x32_bf16 v[184:187], v[152:155], a[180:183], v[184:187]
    v_mfma_f32_16x16x32_bf16 v[200:203], v[152:155], a[184:187], v[200:203]
    buffer_load_dwordx4 v242, s[32:35], s53 offen offset:2048 lds
    v_mfma_f32_16x16x32_bf16 v[216:219], v[152:155], a[188:191], v[216:219]
    s_waitcnt lgkmcnt(2)
    v_mfma_f32_16x16x32_bf16 v[172:175], v[156:159], a[176:179], v[172:175]
    ds_read_b64_tr_b16 v[132:133], v249 offset:0
    ds_read_b64_tr_b16 v[134:135], v249 offset:2048
    v_mfma_f32_16x16x32_bf16 v[188:191], v[156:159], a[180:183], v[188:191]
    v_mfma_f32_16x16x32_bf16 v[204:207], v[156:159], a[184:187], v[204:207]
    buffer_load_dwordx4 v243, s[32:35], s53 offen offset:3072 lds
    v_mfma_f32_16x16x32_bf16 v[220:223], v[156:159], a[188:191], v[220:223]
    s_waitcnt lgkmcnt(2)
    s_add_u32 s53, s53, 32768
    s_cmp_lt_u32 s53, s55
    v_mfma_f32_16x16x32_bf16 v[160:163], v[128:131], a[96:99], v[160:163]
    ds_read_b64_tr_b16 v[136:137], v250 offset:0
    ds_read_b64_tr_b16 v[138:139], v250 offset:2048
    v_mfma_f32_16x16x32_bf16 v[176:179], v[128:131], a[100:103], v[176:179]
    s_cselect_b32 s53, s53, s54
    s_add_u32 m0, s75, 114688
    v_mfma_f32_16x16x32_bf16 v[192:195], v[128:131], a[104:107], v[192:195]
    buffer_load_dwordx4 v240, s[32:35], s53 offen lds
    v_mfma_f32_16x16x32_bf16 v[208:211], v[128:131], a[108:111], v[208:211]
    s_waitcnt lgkmcnt(2)
    v_mfma_f32_16x16x32_bf16 v[164:167], v[132:135], a[96:99], v[164:167]
    ds_read_b64_tr_b16 v[140:141], v251 offset:0
    ds_read_b64_tr_b16 v[142:143], v251 offset:2048
    v_mfma_f32_16x16x32_bf16 v[180:183], v[132:135], a[100:103], v[180:183]
    v_mfma_f32_16x16x32_bf16 v[196:199], v[132:135], a[104:107], v[196:199]
    buffer_load_dwordx4 v241, s[32:35], s53 offen offset:1024 lds
    v_mfma_f32_16x16x32_bf16 v[212:215], v[132:135], a[108:111], v[212:215]
    s_waitcnt vmcnt(19) lgkmcnt(2)
    v_mfma_f32_16x16x32_bf16 v[168:171], v[136:139], a[96:99], v[168:171]
    ds_read_b64_tr_b16 v[144:145], v244 offset:0
    ds_read_b64_tr_b16 v[146:147], v244 offset:2048
    v_mfma_f32_16x16x32_bf16 v[184:187], v[136:139], a[100:103], v[184:187]
    v_mfma_f32_16x16x32_bf16 v[200:203], v[136:139], a[104:107], v[200:203]
    buffer_load_dwordx4 v242, s[32:35], s53 offen offset:2048 lds
    v_mfma_f32_16x16x32_bf16 v[216:219], v[136:139], a[108:111], v[216:219]
    s_waitcnt lgkmcnt(2)
    v_mfma_f32_16x16x32_bf16 v[172:175], v[140:143], a[96:99], v[172:175]
    ds_read_b64_tr_b16 v[148:149], v245 offset:0
    ds_read_b64_tr_b16 v[150:151], v245 offset:2048
    v_mfma_f32_16x16x32_bf16 v[188:191], v[140:143], a[100:103], v[188:191]
    v_mfma_f32_16x16x32_bf16 v[204:207], v[140:143], a[104:107], v[204:207]
    buffer_load_dwordx4 v243, s[32:35], s53 offen offset:3072 lds
    v_mfma_f32_16x16x32_bf16 v[220:223], v[140:143], a[108:111], v[220:223]
    s_waitcnt lgkmcnt(2)
    s_add_u32 s53, s53, 32768
    s_cmp_lt_u32 s53, s55
    v_mfma_f32_16x16x32_bf16 v[160:163], v[144:147], a[112:115], v[160:163]
    ds_read_b64_tr_b16 v[152:153], v246 offset:0
    ds_read_b64_tr_b16 v[154:155], v246 offset:2048
    v_mfma_f32_16x16x32_bf16 v[176:179], v[144:147], a[116:119], v[176:179]
    s_cselect_b32 s53, s53, s54
    s_add_u32 m0, s75, 131072
    v_mfma_f32_16x16x32_bf16 v[192:195], v[144:147], a[120:123], v[192:195]
    buffer_load_dwordx4 v240, s[32:35], s53 offen lds
    v_mfma_f32_16x16x32_bf16 v[208:211], v[144:147], a[124:127], v[208:211]
    s_waitcnt lgkmcnt(2)
    v_mfma_f32_16x16x32_bf16 v[164:167], v[148:151], a[112:115], v[164:167]
    ds_read_b64_tr_b16 v[156:157], v247 offset:0
    ds_read_b64_tr_b16 v[158:159], v247 offset:2048
    v_mfma_f32_16x16x32_bf16 v[180:183], v[148:151], a[116:119], v[180:183]
    v_mfma_f32_16x16x32_bf16 v[196:199], v[148:151], a[120:123], v[196:199]
    buffer_load_dwordx4 v241, s[32:35], s53 offen offset:1024 lds
    v_mfma_f32_16x16x32_bf16 v[212:215], v[148:151], a[124:127], v[212:215]
    s_waitcnt vmcnt(15) lgkmcnt(2)
    v_mfma_f32_16x16x32_bf16 v[168:171], v[152:155], a[112:115], v[168:171]
    ds_read_b64_tr_b16 v[128:129], v248 offset:16384
    ds_read_b64_tr_b16 v[130:131], v248 offset:18432
    v_mfma_f32_16x16x32_bf16 v[184:187], v[152:155], a[116:119], v[184:187]
    s_waitcnt vmcnt(14)
    v_mov_b32 v252, 1
    s_mov_b64 exec, 1
    buffer_store_dword v252, off, s[40:43], s83 sc1
    s_mov_b64 exec, -1
    v_mfma_f32_16x16x32_bf16 v[200:203], v[152:155], a[120:123], v[200:203]
    buffer_load_dwordx4 v242, s[32:35], s53 offen offset:2048 lds
    v_mfma_f32_16x16x32_bf16 v[216:219], v[152:155], a[124:127], v[216:219]
    s_waitcnt lgkmcnt(2)
    v_mfma_f32_16x16x32_bf16 v[172:175], v[156:159], a[112:115], v[172:175]
    ds_read_b64_tr_b16 v[132:133], v249 offset:16384
    ds_read_b64_tr_b16 v[134:135], v249 offset:18432
    v_mfma_f32_16x16x32_bf16 v[188:191], v[156:159], a[116:119], v[188:191]
    v_mfma_f32_16x16x32_bf16 v[204:207], v[156:159], a[120:123], v[204:207]
    buffer_load_dwordx4 v243, s[32:35], s53 offen offset:3072 lds
    v_mfma_f32_16x16x32_bf16 v[220:223], v[156:159], a[124:127], v[220:223]
    s_waitcnt lgkmcnt(2)
    s_add_u32 s53, s53, 32768
    s_cmp_lt_u32 s53, s55
    s_barrier
    v_mfma_f32_16x16x32_bf16 v[160:163], v[128:131], a[192:195], v[160:163]
    ds_read_b64_tr_b16 v[136:137], v250 offset:16384
    ds_read_b64_tr_b16 v[138:139], v250 offset:18432
    v_mfma_f32_16x16x32_bf16 v[176:179], v[128:131], a[196:199], v[176:179]
    s_cselect_b32 s53, s53, s54
    s_add_u32 m0, s75, 65536
    v_lshlrev_b32 v112, 16, v224
    v_mfma_f32_16x16x32_bf16 v[192:195], v[128:131], a[200:203], v[192:195]
    buffer_load_dwordx4 v240, s[32:35], s53 offen lds
    v_mfma_f32_16x16x32_bf16 v[208:211], v[128:131], a[204:207], v[208:211]
    s_waitcnt lgkmcnt(2)
    v_and_b32 v113, 0xffff0000, v224
    v_lshlrev_b32 v114, 16, v225
    v_mfma_f32_16x16x32_bf16 v[164:167], v[132:135], a[192:195], v[164:167]
    ds_read_b64_tr_b16 v[140:141], v251 offset:16384
    ds_read_b64_tr_b16 v[142:143], v251 offset:18432
    v_mfma_f32_16x16x32_bf16 v[180:183], v[132:135], a[196:199], v[180:183]
    v_and_b32 v115, 0xffff0000, v225
    v_lshlrev_b32 v116, 16, v226
    v_mfma_f32_16x16x32_bf16 v[196:199], v[132:135], a[200:203], v[196:199]
    buffer_load_dwordx4 v241, s[32:35], s53 offen offset:1024 lds
    v_mfma_f32_16x16x32_bf16 v[212:215], v[132:135], a[204:207], v[212:215]
    s_waitcnt vmcnt(15) lgkmcnt(2)
    v_and_b32 v117, 0xffff0000, v226
    v_lshlrev_b32 v118, 16, v227
    v_mfma_f32_16x16x32_bf16 v[168:171], v[136:139], a[192:195], v[168:171]
    ds_read_b64_tr_b16 v[144:145], v244 offset:16384
    ds_read_b64_tr_b16 v[146:147], v244 offset:18432
    v_mfma_f32_16x16x32_bf16 v[184:187], v[136:139], a[196:199], v[184:187]
    v_and_b32 v119, 0xffff0000, v227
    v_lshlrev_b32 v120, 16, v228
    v_mfma_f32_16x16x32_bf16 v[200:203], v[136:139], a[200:203], v[200:203]
    buffer_load_dwordx4 v242, s[32:35], s53 offen offset:2048 lds
    v_mfma_f32_16x16x32_bf16 v[216:219], v[136:139], a[204:207], v[216:219]
    s_waitcnt lgkmcnt(2)
    v_and_b32 v121, 0xffff0000, v228
    v_lshlrev_b32 v122, 16, v229
    v_mfma_f32_16x16x32_bf16 v[172:175], v[140:143], a[192:195], v[172:175]
    ds_read_b64_tr_b16 v[148:149], v245 offset:16384
    ds_read_b64_tr_b16 v[150:151], v245 offset:18432
    v_mfma_f32_16x16x32_bf16 v[188:191], v[140:143], a[196:199], v[188:191]
    v_and_b32 v123, 0xffff0000, v229
    v_lshlrev_b32 v124, 16, v230
    v_mfma_f32_16x16x32_bf16 v[204:207], v[140:143], a[200:203], v[204:207]
    buffer_load_dwordx4 v243, s[32:35], s53 offen offset:3072 lds
    v_mfma_f32_16x16x32_bf16 v[220:223], v[140:143], a[204:207], v[220:223]
    s_waitcnt lgkmcnt(2)
    s_add_u32 s53, s53, 32768
    s_cmp_lt_u32 s53, s55
    v_mfma_f32_16x16x32_bf16 v[160:163], v[144:147], a[208:211], v[160:163]
    ds_read_b64_tr_b16 v[152:153], v246 offset:16384
    ds_read_b64_tr_b16 v[154:155], v246 offset:18432
    v_mfma_f32_16x16x32_bf16 v[176:179], v[144:147], a[212:215], v[176:179]
    s_cselect_b32 s53, s53, s54
    s_add_u32 m0, s75, 147456
    v_and_b32 v125, 0xffff0000, v230
    v_mfma_f32_16x16x32_bf16 v[192:195], v[144:147], a[216:219], v[192:195]
    buffer_load_dwordx4 v240, s[32:35], s53 offen lds
    v_mfma_f32_16x16x32_bf16 v[208:211], v[144:147], a[220:223], v[208:211]
    s_waitcnt lgkmcnt(2)
    v_lshlrev_b32 v126, 16, v231
    v_and_b32 v127, 0xffff0000, v231
    v_mfma_f32_16x16x32_bf16 v[164:167], v[148:151], a[208:211], v[164:167]
    ds_read_b64_tr_b16 v[156:157], v247 offset:16384
    ds_read_b64_tr_b16 v[158:159], v247 offset:18432
    v_mfma_f32_16x16x32_bf16 v[180:183], v[148:151], a[212:215], v[180:183]
    v_mfma_f32_16x16x32_bf16 v[196:199], v[148:151], a[216:219], v[196:199]
    buffer_load_dwordx4 v241, s[32:35], s53 offen offset:1024 lds
    v_mfma_f32_16x16x32_bf16 v[212:215], v[148:151], a[220:223], v[212:215]
    s_waitcnt vmcnt(15) lgkmcnt(2)
    v_mfma_f32_16x16x32_bf16 v[168:171], v[152:155], a[208:211], v[168:171]
    ds_read_b64_tr_b16 v[128:129], v244 offset:32768
    ds_read_b64_tr_b16 v[130:131], v244 offset:34816
    v_mfma_f32_16x16x32_bf16 v[184:187], v[152:155], a[212:215], v[184:187]
    v_mfma_f32_16x16x32_bf16 v[200:203], v[152:155], a[216:219], v[200:203]
    buffer_load_dwordx4 v242, s[32:35], s53 offen offset:2048 lds
    v_mfma_f32_16x16x32_bf16 v[216:219], v[152:155], a[220:223], v[216:219]
    s_waitcnt lgkmcnt(2)
    v_mfma_f32_16x16x32_bf16 v[172:175], v[156:159], a[208:211], v[172:175]
    ds_read_b64_tr_b16 v[132:133], v245 offset:32768
    ds_read_b64_tr_b16 v[134:135], v245 offset:34816
    v_mfma_f32_16x16x32_bf16 v[188:191], v[156:159], a[212:215], v[188:191]
    v_mfma_f32_16x16x32_bf16 v[204:207], v[156:159], a[216:219], v[204:207]
    buffer_load_dwordx4 v243, s[32:35], s53 offen offset:3072 lds
    v_mfma_f32_16x16x32_bf16 v[220:223], v[156:159], a[220:223], v[220:223]
    s_waitcnt lgkmcnt(2)
    s_add_u32 s53, s53, 32768
    s_cmp_lt_u32 s53, s55
    v_mfma_f32_16x16x32_bf16 v[160:163], v[128:131], a[224:227], v[160:163]
    ds_read_b64_tr_b16 v[136:137], v246 offset:32768
    ds_read_b64_tr_b16 v[138:139], v246 offset:34816
    v_mfma_f32_16x16x32_bf16 v[176:179], v[128:131], a[228:231], v[176:179]
    s_cselect_b32 s53, s53, s54
    s_add_u32 m0, s75, 81920
    v_mfma_f32_16x16x32_bf16 v[192:195], v[128:131], a[232:235], v[192:195]
    buffer_load_dwordx4 v240, s[32:35], s53 offen lds
    v_mfma_f32_16x16x32_bf16 v[208:211], v[128:131], a[236:239], v[208:211]
    s_waitcnt lgkmcnt(2)
    v_mfma_f32_16x16x32_bf16 v[164:167], v[132:135], a[224:227], v[164:167]
    ds_read_b64_tr_b16 v[140:141], v247 offset:32768
    ds_read_b64_tr_b16 v[142:143], v247 offset:34816
    v_mfma_f32_16x16x32_bf16 v[180:183], v[132:135], a[228:231], v[180:183]
    v_mfma_f32_16x16x32_bf16 v[196:199], v[132:135], a[232:235], v[196:199]
    buffer_load_dwordx4 v241, s[32:35], s53 offen offset:1024 lds
    v_mfma_f32_16x16x32_bf16 v[212:215], v[132:135], a[236:239], v[212:215]
    s_waitcnt vmcnt(15) lgkmcnt(2)
    v_mfma_f32_16x16x32_bf16 v[168:171], v[136:139], a[224:227], v[168:171]
    ds_read_b64_tr_b16 v[144:145], v244 offset:49152
    ds_read_b64_tr_b16 v[146:147], v244 offset:51200
    v_mfma_f32_16x16x32_bf16 v[184:187], v[136:139], a[228:231], v[184:187]
    v_mfma_f32_16x16x32_bf16 v[200:203], v[136:139], a[232:235], v[200:203]
    buffer_load_dwordx4 v242, s[32:35], s53 offen offset:2048 lds
    v_mfma_f32_16x16x32_bf16 v[216:219], v[136:139], a[236:239], v[216:219]
    s_waitcnt lgkmcnt(2)
    v_mfma_f32_16x16x32_bf16 v[172:175], v[140:143], a[224:227], v[172:175]
    ds_read_b64_tr_b16 v[148:149], v245 offset:49152
    ds_read_b64_tr_b16 v[150:151], v245 offset:51200
    v_mfma_f32_16x16x32_bf16 v[188:191], v[140:143], a[228:231], v[188:191]
    v_mfma_f32_16x16x32_bf16 v[204:207], v[140:143], a[232:235], v[204:207]
    buffer_load_dwordx4 v243, s[32:35], s53 offen offset:3072 lds
    v_mfma_f32_16x16x32_bf16 v[220:223], v[140:143], a[236:239], v[220:223]
    s_waitcnt lgkmcnt(2)
    v_mfma_f32_16x16x32_bf16 v[160:163], v[144:147], a[240:243], v[160:163]
    ds_read_b64_tr_b16 v[152:153], v246 offset:49152
    ds_read_b64_tr_b16 v[154:155], v246 offset:51200
    v_mfma_f32_16x16x32_bf16 v[176:179], v[144:147], a[244:247], v[176:179]
    v_mfma_f32_16x16x32_bf16 v[192:195], v[144:147], a[248:251], v[192:195]
    buffer_load_dword v252, v232, s[40:43], s48 offen sc1
    v_mfma_f32_16x16x32_bf16 v[208:211], v[144:147], a[252:255], v[208:211]
    s_waitcnt lgkmcnt(2)
    v_mfma_f32_16x16x32_bf16 v[164:167], v[148:151], a[240:243], v[164:167]
    ds_read_b64_tr_b16 v[156:157], v247 offset:49152
    ds_read_b64_tr_b16 v[158:159], v247 offset:51200
    v_mfma_f32_16x16x32_bf16 v[180:183], v[148:151], a[244:247], v[180:183]
    v_mfma_f32_16x16x32_bf16 v[196:199], v[148:151], a[248:251], v[196:199]
    v_mfma_f32_16x16x32_bf16 v[212:215], v[148:151], a[252:255], v[212:215]
    s_waitcnt vmcnt(13) lgkmcnt(2)
    v_mfma_f32_16x16x32_bf16 v[168:171], v[152:155], a[240:243], v[168:171]
    ds_read_b64_tr_b16 v[128:129], v248 offset:0
    ds_read_b64_tr_b16 v[130:131], v248 offset:2048
    v_mfma_f32_16x16x32_bf16 v[184:187], v[152:155], a[244:247], v[184:187]
    v_mfma_f32_16x16x32_bf16 v[200:203], v[152:155], a[248:251], v[200:203]
    v_mfma_f32_16x16x32_bf16 v[216:219], v[152:155], a[252:255], v[216:219]
    s_waitcnt lgkmcnt(2)
    v_mfma_f32_16x16x32_bf16 v[172:175], v[156:159], a[240:243], v[172:175]
    ds_read_b64_tr_b16 v[132:133], v249 offset:0
    ds_read_b64_tr_b16 v[134:135], v249 offset:2048
    v_mfma_f32_16x16x32_bf16 v[188:191], v[156:159], a[244:247], v[188:191]
    v_mfma_f32_16x16x32_bf16 v[204:207], v[156:159], a[248:251], v[204:207]
    v_mfma_f32_16x16x32_bf16 v[220:223], v[156:159], a[252:255], v[220:223]
    s_waitcnt lgkmcnt(2)
    v_mfma_f32_16x16x32_bf16 v[160:163], v[128:131], a[0:3], v[160:163]
    ds_read_b64_tr_b16 v[136:137], v250 offset:0
    ds_read_b64_tr_b16 v[138:139], v250 offset:2048
    v_mfma_f32_16x16x32_bf16 v[176:179], v[128:131], a[4:7], v[176:179]
    v_mfma_f32_16x16x32_bf16 v[192:195], v[128:131], a[8:11], v[192:195]
    v_mfma_f32_16x16x32_bf16 v[208:211], v[128:131], a[12:15], v[208:211]
    s_waitcnt lgkmcnt(2)
    v_mfma_f32_16x16x32_bf16 v[164:167], v[132:135], a[0:3], v[164:167]
    ds_read_b64_tr_b16 v[140:141], v251 offset:0
    ds_read_b64_tr_b16 v[142:143], v251 offset:2048
    v_mfma_f32_16x16x32_bf16 v[180:183], v[132:135], a[4:7], v[180:183]
    v_mfma_f32_16x16x32_bf16 v[196:199], v[132:135], a[8:11], v[196:199]
    v_mfma_f32_16x16x32_bf16 v[212:215], v[132:135], a[12:15], v[212:215]
    s_waitcnt vmcnt(9) lgkmcnt(2)
    v_mfma_f32_16x16x32_bf16 v[168:171], v[136:139], a[0:3], v[168:171]
    ds_read_b64_tr_b16 v[144:145], v244 offset:0
    ds_read_b64_tr_b16 v[146:147], v244 offset:2048
    v_mfma_f32_16x16x32_bf16 v[184:187], v[136:139], a[4:7], v[184:187]
    v_mfma_f32_16x16x32_bf16 v[200:203], v[136:139], a[8:11], v[200:203]
    v_mfma_f32_16x16x32_bf16 v[216:219], v[136:139], a[12:15], v[216:219]
    s_waitcnt lgkmcnt(2)
    v_mfma_f32_16x16x32_bf16 v[172:175], v[140:143], a[0:3], v[172:175]
    ds_read_b64_tr_b16 v[148:149], v245 offset:0
    ds_read_b64_tr_b16 v[150:151], v245 offset:2048
    v_mfma_f32_16x16x32_bf16 v[188:191], v[140:143], a[4:7], v[188:191]
    v_mfma_f32_16x16x32_bf16 v[204:207], v[140:143], a[8:11], v[204:207]
    v_mfma_f32_16x16x32_bf16 v[220:223], v[140:143], a[12:15], v[220:223]
    s_waitcnt lgkmcnt(2)
    v_mfma_f32_16x16x32_bf16 v[160:163], v[144:147], a[16:19], v[160:163]
    ds_read_b64_tr_b16 v[152:153], v246 offset:0
    ds_read_b64_tr_b16 v[154:155], v246 offset:2048
    v_mfma_f32_16x16x32_bf16 v[176:179], v[144:147], a[20:23], v[176:179]
    v_mfma_f32_16x16x32_bf16 v[192:195], v[144:147], a[24:27], v[192:195]
    v_mfma_f32_16x16x32_bf16 v[208:211], v[144:147], a[28:31], v[208:211]
    s_waitcnt lgkmcnt(2)
    v_mfma_f32_16x16x32_bf16 v[164:167], v[148:151], a[16:19], v[164:167]
    ds_read_b64_tr_b16 v[156:157], v247 offset:0
    ds_read_b64_tr_b16 v[158:159], v247 offset:2048
    v_mfma_f32_16x16x32_bf16 v[180:183], v[148:151], a[20:23], v[180:183]
    v_mfma_f32_16x16x32_bf16 v[196:199], v[148:151], a[24:27], v[196:199]
    s_waitcnt vmcnt(0)
    v_cmp_eq_u32 vcc, 1, v252
    s_lshl_b32 s52, 1, s73
    s_mov_b32 s57, 268435456
    s_or_b32 s52, s52, vcc_lo
    s_and_b32 s52, s52, 255
    v_mfma_f32_16x16x32_bf16 v[212:215], v[148:151], a[28:31], v[212:215]
    s_waitcnt lgkmcnt(2)
    s_bitcmp1_b32 s52, 0
    s_cselect_b32 s77, s49, s57
    v_mfma_f32_16x16x32_bf16 v[168:171], v[152:155], a[16:19], v[168:171]
    ds_read_b64_tr_b16 v[128:129], v248 offset:16384
    ds_read_b64_tr_b16 v[130:131], v248 offset:18432
    v_mfma_f32_16x16x32_bf16 v[184:187], v[152:155], a[20:23], v[184:187]
    s_add_u32 s49, s49, 8192
    v_mfma_f32_16x16x32_bf16 v[200:203], v[152:155], a[24:27], v[200:203]
    buffer_load_dwordx4 v[0:3], v237, s[40:43], s77 offen sc1
    v_mfma_f32_16x16x32_bf16 v[216:219], v[152:155], a[28:31], v[216:219]
    s_waitcnt lgkmcnt(2)
    v_mfma_f32_16x16x32_bf16 v[172:175], v[156:159], a[16:19], v[172:175]
    ds_read_b64_tr_b16 v[132:133], v249 offset:16384
    ds_read_b64_tr_b16 v[134:135], v249 offset:18432
    v_mfma_f32_16x16x32_bf16 v[188:191], v[156:159], a[20:23], v[188:191]
    v_mfma_f32_16x16x32_bf16 v[204:207], v[156:159], a[24:27], v[204:207]
    buffer_load_dwordx4 v[4:7], v237, s[40:43], s77 offen offset:1024 sc1
    v_mfma_f32_16x16x32_bf16 v[220:223], v[156:159], a[28:31], v[220:223]
    s_waitcnt lgkmcnt(2)
    s_bitcmp1_b32 s52, 1
    s_cselect_b32 s77, s49, s57
    v_mfma_f32_16x16x32_bf16 v[160:163], v[128:131], a[32:35], v[160:163]
    ds_read_b64_tr_b16 v[136:137], v250 offset:16384
    ds_read_b64_tr_b16 v[138:139], v250 offset:18432
    v_mfma_f32_16x16x32_bf16 v[176:179], v[128:131], a[36:39], v[176:179]
    s_add_u32 s49, s49, 8192
    v_mfma_f32_16x16x32_bf16 v[192:195], v[128:131], a[40:43], v[192:195]
    buffer_load_dwordx4 v[8:11], v237, s[40:43], s77 offen sc1
    v_mfma_f32_16x16x32_bf16 v[208:211], v[128:131], a[44:47], v[208:211]
    s_waitcnt lgkmcnt(2)
    v_mfma_f32_16x16x32_bf16 v[164:167], v[132:135], a[32:35], v[164:167]
    ds_read_b64_tr_b16 v[140:141], v251 offset:16384
    ds_read_b64_tr_b16 v[142:143], v251 offset:18432
    v_mfma_f32_16x16x32_bf16 v[180:183], v[132:135], a[36:39], v[180:183]
    v_mfma_f32_16x16x32_bf16 v[196:199], v[132:135], a[40:43], v[196:199]
    buffer_load_dwordx4 v[12:15], v237, s[40:43], s77 offen offset:1024 sc1
    v_mfma_f32_16x16x32_bf16 v[212:215], v[132:135], a[44:47], v[212:215]
    s_waitcnt lgkmcnt(2)
    s_bitcmp1_b32 s52, 2
    s_cselect_b32 s77, s49, s57
    v_mfma_f32_16x16x32_bf16 v[168:171], v[136:139], a[32:35], v[168:171]
    ds_read_b64_tr_b16 v[144:145], v244 offset:16384
    ds_read_b64_tr_b16 v[146:147], v244 offset:18432
    v_mfma_f32_16x16x32_bf16 v[184:187], v[136:139], a[36:39], v[184:187]
    s_add_u32 s49, s49, 8192
    v_mfma_f32_16x16x32_bf16 v[200:203], v[136:139], a[40:43], v[200:203]
    buffer_load_dwordx4 v[16:19], v237, s[40:43], s77 offen sc1
    v_mfma_f32_16x16x32_bf16 v[216:219], v[136:139], a[44:47], v[216:219]
    s_waitcnt lgkmcnt(2)
    v_mfma_f32_16x16x32_bf16 v[172:175], v[140:143], a[32:35], v[172:175]
    ds_read_b64_tr_b16 v[148:149], v245 offset:16384
    ds_read_b64_tr_b16 v[150:151], v245 offset:18432
    v_mfma_f32_16x16x32_bf16 v[188:191], v[140:143], a[36:39], v[188:191]
    v_mfma_f32_16x16x32_bf16 v[204:207], v[140:143], a[40:43], v[204:207]
    buffer_load_dwordx4 v[20:23], v237, s[40:43], s77 offen offset:1024 sc1
    v_mfma_f32_16x16x32_bf16 v[220:223], v[140:143], a[44:47], v[220:223]
    s_waitcnt lgkmcnt(2)
    s_bitcmp1_b32 s52, 3
    s_cselect_b32 s77, s49, s57
    v_mfma_f32_16x16x32_bf16 v[160:163], v[144:147], a[48:51], v[160:163]
    ds_read_b64_tr_b16 v[152:153], v246 offset:16384
    ds_read_b64_tr_b16 v[154:155], v246 offset:18432
    v_mfma_f32_16x16x32_bf16 v[176:179], v[144:147], a[52:55], v[176:179]
    s_add_u32 s49, s49, 8192
    v_mfma_f32_16x16x32_bf16 v[192:195], v[144:147], a[56:59], v[192:195]
    buffer_load_dwordx4 v[24:27], v237, s[40:43], s77 offen sc1
    v_mfma_f32_16x16x32_bf16 v[208:211], v[144:147], a[60:63], v[208:211]
    s_waitcnt lgkmcnt(2)
    v_mfma_f32_16x16x32_bf16 v[164:167], v[148:151], a[48:51], v[164:167]
    ds_read_b64_tr_b16 v[156:157], v247 offset:16384
    ds_read_b64_tr_b16 v[158:159], v247 offset:18432
    v_mfma_f32_16x16x32_bf16 v[180:183], v[148:151], a[52:55], v[180:183]
    v_mfma_f32_16x16x32_bf16 v[196:199], v[148:151], a[56:59], v[196:199]
    buffer_load_dwordx4 v[28:31], v237, s[40:43], s77 offen offset:1024 sc1
    v_mfma_f32_16x16x32_bf16 v[212:215], v[148:151], a[60:63], v[212:215]
    s_waitcnt lgkmcnt(2)
    s_bitcmp1_b32 s52, 4
    s_cselect_b32 s77, s49, s57
    v_mfma_f32_16x16x32_bf16 v[168:171], v[152:155], a[48:51], v[168:171]
    s_add_u32 s49, s49, 8192
    ds_write_b128 v233, v[176:179] offset:4096
    v_mfma_f32_16x16x32_bf16 v[184:187], v[152:155], a[52:55], v[184:187]
    ds_write_b128 v234, v[192:195] offset:8192
    v_mfma_f32_16x16x32_bf16 v[200:203], v[152:155], a[56:59], v[200:203]
    buffer_load_dwordx4 v[32:35], v237, s[40:43], s77 offen sc1
    v_mfma_f32_16x16x32_bf16 v[216:219], v[152:155], a[60:63], v[216:219]
    s_waitcnt lgkmcnt(2)
    ds_write_b128 v235, v[208:211] offset:12288
    v_mfma_f32_16x16x32_bf16 v[172:175], v[156:159], a[48:51], v[172:175]
    ds_write_b128 v233, v[180:183] offset:5120
    v_mfma_f32_16x16x32_bf16 v[188:191], v[156:159], a[52:55], v[188:191]
    ds_write_b128 v234, v[196:199] offset:9216
    v_mfma_f32_16x16x32_bf16 v[204:207], v[156:159], a[56:59], v[204:207]
    buffer_load_dwordx4 v[36:39], v237, s[40:43], s77 offen offset:1024 sc1
    v_mfma_f32_16x16x32_bf16 v[220:223], v[156:159], a[60:63], v[220:223]
    ds_write_b128 v235, v[212:215] offset:13312
    s_nop 2
    ds_write_b128 v233, v[184:187] offset:6144
    ds_write_b128 v234, v[200:203] offset:10240
    ds_write_b128 v235, v[216:219] offset:14336
    ds_write_b128 v233, v[188:191] offset:7168
    ds_write_b128 v234, v[204:207] offset:11264
    ds_write_b128 v235, v[220:223] offset:15360
    v_lshl_add_u32 v233, s75, 2, v237
    s_waitcnt lgkmcnt(0)
    s_barrier
    ds_read_b128 v[176:179], v233 offset:4096
    ds_read_b128 v[180:183], v233 offset:5120
    ds_read_b128 v[184:187], v233 offset:6144
    ds_read_b128 v[188:191], v233 offset:7168
    ds_read_b128 v[192:195], v233 offset:8192
    ds_read_b128 v[196:199], v233 offset:9216
    ds_read_b128 v[200:203], v233 offset:10240
    ds_read_b128 v[204:207], v233 offset:11264
    ds_read_b128 v[208:211], v233 offset:12288
    ds_read_b128 v[212:215], v233 offset:13312
    ds_read_b128 v[216:219], v233 offset:14336
    ds_read_b128 v[220:223], v233 offset:15360
    s_bitcmp1_b32 s52, 5
    s_cselect_b32 s77, s49, s57
    s_add_u32 s49, s49, 8192
    buffer_load_dwordx4 v[40:43], v237, s[40:43], s77 offen sc1
    buffer_load_dwordx4 v[44:47], v237, s[40:43], s77 offen offset:1024 sc1
    s_bitcmp1_b32 s52, 6
    s_cselect_b32 s77, s49, s57
    s_add_u32 s49, s49, 8192
    buffer_load_dwordx4 v[48:51], v237, s[40:43], s77 offen sc1
    buffer_load_dwordx4 v[52:55], v237, s[40:43], s77 offen offset:1024 sc1
    s_bitcmp1_b32 s52, 7
    s_cselect_b32 s77, s49, s57
    s_add_u32 s49, s49, 8192
    buffer_load_dwordx4 v[56:59], v237, s[40:43], s77 offen sc1
    buffer_load_dwordx4 v[60:63], v237, s[40:43], s77 offen offset:1024 sc1
    buffer_load_dword v252, v232, s[40:43], s48 offen sc1
    s_waitcnt vmcnt(15)
    v_mfma_f32_16x16x32_bf16 v[96:99], a[74:77], v[0:3], 0
    v_mfma_f32_16x16x32_bf16 v[100:103], a[72:75], v[0:3], 0
    v_mfma_f32_16x16x32_bf16 v[104:107], a[74:77], v[4:7], 0
    v_mfma_f32_16x16x32_bf16 v[108:111], a[72:75], v[4:7], 0
    s_waitcnt vmcnt(13)
    v_mfma_f32_16x16x32_bf16 v[96:99], a[74:77], v[8:11], v[96:99]
    v_mfma_f32_16x16x32_bf16 v[100:103], a[72:75], v[8:11], v[100:103]
    v_mfma_f32_16x16x32_bf16 v[104:107], a[74:77], v[12:15], v[104:107]
    v_mfma_f32_16x16x32_bf16 v[108:111], a[72:75], v[12:15], v[108:111]
    s_mov_b32 s77, 0xc2b17218
    s_mov_b32 s76, 0x3c853526
    s_waitcnt lgkmcnt(8)
    v_pk_add_f32 v[160:161], v[160:161], v[176:177]
    v_pk_add_f32 v[162:163], v[162:163], v[178:179]
    v_pk_add_f32 v[164:165], v[164:165], v[180:181]
    v_pk_add_f32 v[166:167], v[166:167], v[182:183]
    v_pk_add_f32 v[168:169], v[168:169], v[184:185]
    v_pk_add_f32 v[170:171], v[170:171], v[186:187]
    v_pk_add_f32 v[172:173], v[172:173], v[188:189]
    v_pk_add_f32 v[174:175], v[174:175], v[190:191]
    s_waitcnt lgkmcnt(4)
    v_pk_add_f32 v[160:161], v[160:161], v[192:193]
    v_pk_add_f32 v[162:163], v[162:163], v[194:195]
    v_pk_add_f32 v[164:165], v[164:165], v[196:197]
    v_pk_add_f32 v[166:167], v[166:167], v[198:199]
    v_pk_add_f32 v[168:169], v[168:169], v[200:201]
    v_pk_add_f32 v[170:171], v[170:171], v[202:203]
    v_pk_add_f32 v[172:173], v[172:173], v[204:205]
    v_pk_add_f32 v[174:175], v[174:175], v[206:207]
    s_waitcnt lgkmcnt(0)
    v_pk_add_f32 v[160:161], v[160:161], v[208:209]
    v_pk_add_f32 v[162:163], v[162:163], v[210:211]
    v_pk_add_f32 v[164:165], v[164:165], v[212:213]
    v_pk_add_f32 v[166:167], v[166:167], v[214:215]
    v_pk_add_f32 v[168:169], v[168:169], v[216:217]
    v_pk_add_f32 v[170:171], v[170:171], v[218:219]
    v_pk_add_f32 v[172:173], v[172:173], v[220:221]
    v_pk_add_f32 v[174:175], v[174:175], v[222:223]
    s_waitcnt vmcnt(11)
    v_mfma_f32_16x16x32_bf16 v[96:99], a[74:77], v[16:19], v[96:99]
    v_mul_f32 v176, s77, v160
    v_mul_f32 v177, s77, v161
    v_mul_f32 v178, s77, v162
    v_mul_f32 v179, s77, v163
    v_mfma_f32_16x16x32_bf16 v[100:103], a[72:75], v[16:19], v[100:103]
    v_mul_f32 v180, s77, v164
    v_mul_f32 v181, s77, v165
    v_mul_f32 v182, s77, v166
    v_mul_f32 v183, s77, v167
    v_mfma_f32_16x16x32_bf16 v[104:107], a[74:77], v[20:23], v[104:107]
    v_mul_f32 v184, s77, v168
    v_mul_f32 v185, s77, v169
    v_mul_f32 v186, s77, v170
    v_mul_f32 v187, s77, v171
    v_mfma_f32_16x16x32_bf16 v[108:111], a[72:75], v[20:23], v[108:111]
    v_mul_f32 v188, s77, v172
    v_mul_f32 v189, s77, v173
    v_mul_f32 v190, s77, v174
    v_mul_f32 v191, s77, v175
    s_waitcnt vmcnt(9)
    v_mfma_f32_16x16x32_bf16 v[96:99], a[74:77], v[24:27], v[96:99]
    v_exp_f32 v176, v176
    v_exp_f32 v177, v177
    v_exp_f32 v178, v178
    v_exp_f32 v179, v179
    v_mfma_f32_16x16x32_bf16 v[100:103], a[72:75], v[24:27], v[100:103]
    v_exp_f32 v180, v180
    v_exp_f32 v181, v181
    v_exp_f32 v182, v182
    v_exp_f32 v183, v183
    v_mfma_f32_16x16x32_bf16 v[104:107], a[74:77], v[28:31], v[104:107]
    v_exp_f32 v184, v184
    v_exp_f32 v185, v185
    v_exp_f32 v186, v186
    v_exp_f32 v187, v187
    v_mfma_f32_16x16x32_bf16 v[108:111], a[72:75], v[28:31], v[108:111]
    v_exp_f32 v188, v188
    v_exp_f32 v189, v189
    v_exp_f32 v190, v190
    v_exp_f32 v191, v191
    s_waitcnt vmcnt(7)
    v_mfma_f32_16x16x32_bf16 v[96:99], a[74:77], v[32:35], v[96:99]
    v_fma_f32 v176, v176, s76, s76
    v_fma_f32 v177, v177, s76, s76
    v_fma_f32 v178, v178, s76, s76
    v_mfma_f32_16x16x32_bf16 v[100:103], a[72:75], v[32:35], v[100:103]
    v_fma_f32 v179, v179, s76, s76
    v_fma_f32 v180, v180, s76, s76
    v_fma_f32 v181, v181, s76, s76
    v_mfma_f32_16x16x32_bf16 v[104:107], a[74:77], v[36:39], v[104:107]
    v_fma_f32 v182, v182, s76, s76
    v_fma_f32 v183, v183, s76, s76
    v_fma_f32 v184, v184, s76, s76
    v_mfma_f32_16x16x32_bf16 v[108:111], a[72:75], v[36:39], v[108:111]
    v_fma_f32 v185, v185, s76, s76
    v_fma_f32 v186, v186, s76, s76
    v_fma_f32 v187, v187, s76, s76
    s_waitcnt vmcnt(5)
    v_mfma_f32_16x16x32_bf16 v[96:99], a[74:77], v[40:43], v[96:99]
    v_fma_f32 v188, v188, s76, s76
    v_fma_f32 v189, v189, s76, s76
    v_fma_f32 v190, v190, s76, s76
    v_mfma_f32_16x16x32_bf16 v[100:103], a[72:75], v[40:43], v[100:103]
    v_fma_f32 v191, v191, s76, s76
    v_rcp_f32 v176, v176
    v_rcp_f32 v177, v177
    v_mfma_f32_16x16x32_bf16 v[104:107], a[74:77], v[44:47], v[104:107]
    v_rcp_f32 v178, v178
    v_rcp_f32 v179, v179
    v_rcp_f32 v180, v180
    v_mfma_f32_16x16x32_bf16 v[108:111], a[72:75], v[44:47], v[108:111]
    v_rcp_f32 v181, v181
    v_rcp_f32 v182, v182
    v_rcp_f32 v183, v183
    s_waitcnt vmcnt(3)
    v_mfma_f32_16x16x32_bf16 v[96:99], a[74:77], v[48:51], v[96:99]
    v_rcp_f32 v184, v184
    v_rcp_f32 v185, v185
    v_rcp_f32 v186, v186
    v_mfma_f32_16x16x32_bf16 v[100:103], a[72:75], v[48:51], v[100:103]
    v_rcp_f32 v187, v187
    v_rcp_f32 v188, v188
    v_rcp_f32 v189, v189
    v_mfma_f32_16x16x32_bf16 v[104:107], a[74:77], v[52:55], v[104:107]
    v_rcp_f32 v190, v190
    v_rcp_f32 v191, v191
    v_mul_f32 v160, v160, v176
    v_mfma_f32_16x16x32_bf16 v[108:111], a[72:75], v[52:55], v[108:111]
    v_mul_f32 v161, v161, v177
    v_mul_f32 v162, v162, v178
    v_mul_f32 v163, v163, v179
    s_waitcnt vmcnt(1)
    v_mfma_f32_16x16x32_bf16 v[96:99], a[74:77], v[56:59], v[96:99]
    v_mul_f32 v164, v164, v180
    v_mul_f32 v165, v165, v181
    v_mul_f32 v166, v166, v182
    v_mfma_f32_16x16x32_bf16 v[100:103], a[72:75], v[56:59], v[100:103]
    v_mul_f32 v167, v167, v183
    v_mul_f32 v168, v168, v184
    v_mul_f32 v169, v169, v185
    v_mfma_f32_16x16x32_bf16 v[104:107], a[74:77], v[60:63], v[104:107]
    v_mul_f32 v170, v170, v186
    v_mul_f32 v171, v171, v187
    v_mul_f32 v172, v172, v188
    v_mfma_f32_16x16x32_bf16 v[108:111], a[72:75], v[60:63], v[108:111]
    v_mul_f32 v173, v173, v189
    v_mul_f32 v174, v174, v190
    v_mul_f32 v175, v175, v191
    s_mov_b32 s91, 0
    s_cmp_lg_u32 s52, 255
    s_cbranch_scc1 L_spin_s0
L_s_ok:
    s_nop 1
    v_lshrrev_b32 v233, 4, v236
    v_lshl_add_u32 v233, v233, 3, v239
    v_pk_fma_f32 v[160:161], v[160:161], v[96:97], v[112:113]
    v_pk_fma_f32 v[162:163], v[162:163], v[98:99], v[114:115]
    v_cvt_pk_bf16_f32 v128, v160, v161
    v_cvt_pk_bf16_f32 v129, v162, v163
    v_pk_fma_f32 v[164:165], v[164:165], v[100:101], v[116:117]
    v_pk_fma_f32 v[166:167], v[166:167], v[102:103], v[118:119]
    v_cvt_pk_bf16_f32 v130, v164, v165
    v_cvt_pk_bf16_f32 v131, v166, v167
    v_pk_fma_f32 v[168:169], v[168:169], v[104:105], v[120:121]
    v_pk_fma_f32 v[170:171], v[170:171], v[106:107], v[122:123]
    v_cvt_pk_bf16_f32 v132, v168, v169
    v_cvt_pk_bf16_f32 v133, v170, v171
    v_pk_fma_f32 v[172:173], v[172:173], v[108:109], v[124:125]
    v_pk_fma_f32 v[174:175], v[174:175], v[110:111], v[126:127]
    v_cvt_pk_bf16_f32 v134, v172, v173
    v_cvt_pk_bf16_f32 v135, v174, v175
    s_nop 0
    v_permlane32_swap_b32 v128, v130
    v_permlane32_swap_b32 v129, v131
    v_permlane32_swap_b32 v132, v134
    v_permlane32_swap_b32 v133, v135
    v_permlane16_swap_b32 v128, v130
    v_permlane16_swap_b32 v129, v131
    v_permlane16_swap_b32 v132, v134
    v_permlane16_swap_b32 v133, v135
    buffer_store_dwordx4 v[128:131], v233, s[36:39], s82 offen offset:0 sc1
    buffer_store_dwordx4 v[132:135], v233, s[36:39], s82 offen offset:64 sc1
    s_endpgm
L_skipG:
    s_waitcnt lgkmcnt(0)
    s_barrier
    ds_read_b128 a[0:3], v237 offset:0
    ds_read_b128 a[4:7], v237 offset:1024
    ds_read_b128 a[8:11], v237 offset:2048
    ds_read_b128 a[12:15], v237 offset:3072
    ds_read_b128 a[16:19], v237 offset:4096
    ds_read_b128 a[20:23], v237 offset:5120
    ds_read_b128 a[24:27], v237 offset:6144
    ds_read_b128 a[28:31], v237 offset:7168
    s_waitcnt lgkmcnt(0)
    ds_read_b128 a[32:35], v237 offset:8192
    ds_read_b128 a[36:39], v237 offset:9216
    ds_read_b128 a[40:43], v237 offset:10240
    ds_read_b128 a[44:47], v237 offset:11264
    ds_read_b128 a[48:51], v237 offset:12288
    ds_read_b128 a[52:55], v237 offset:13312
    ds_read_b128 a[56:59], v237 offset:14336
    ds_read_b128 a[60:63], v237 offset:15360
    s_waitcnt lgkmcnt(0)
    ds_read_b128 a[64:67], v237 offset:16384
    ds_read_b128 a[68:71], v237 offset:17408
    ds_read_b128 a[72:75], v237 offset:18432
    ds_read_b128 a[76:79], v237 offset:19456
    ds_read_b128 a[80:83], v237 offset:20480
    ds_read_b128 a[84:87], v237 offset:21504
    ds_read_b128 a[88:91], v237 offset:22528
    ds_read_b128 a[92:95], v237 offset:23552
    s_waitcnt lgkmcnt(0)
    ds_read_b128 a[96:99], v237 offset:24576
    ds_read_b128 a[100:103], v237 offset:25600
    ds_read_b128 a[104:107], v237 offset:26624
    ds_read_b128 a[108:111], v237 offset:27648
    ds_read_b128 a[112:115], v237 offset:28672
    ds_read_b128 a[116:119], v237 offset:29696
    ds_read_b128 a[120:123], v237 offset:30720
    ds_read_b128 a[124:127], v237 offset:31744
    s_waitcnt lgkmcnt(0)
    ds_read_b128 a[128:131], v237 offset:32768
    ds_read_b128 a[132:135], v237 offset:33792
    ds_read_b128 a[136:139], v237 offset:34816
    ds_read_b128 a[140:143], v237 offset:35840
    ds_read_b128 a[144:147], v237 offset:36864
    ds_read_b128 a[148:151], v237 offset:37888
    ds_read_b128 a[152:155], v237 offset:38912
    ds_read_b128 a[156:159], v237 offset:39936
    s_waitcnt lgkmcnt(0)
    ds_read_b128 a[160:163], v237 offset:40960
    ds_read_b128 a[164:167], v237 offset:41984
    ds_read_b128 a[168:171], v237 offset:43008
    ds_read_b128 a[172:175], v237 offset:44032
    ds_read_b128 a[176:179], v237 offset:45056
    ds_read_b128 a[180:183], v237 offset:46080
    ds_read_b128 a[184:187], v237 offset:47104
    ds_read_b128 a[188:191], v237 offset:48128
    s_waitcnt lgkmcnt(0)
    ds_read_b128 a[192:195], v237 offset:49152
    ds_read_b128 a[196:199], v237 offset:50176
    ds_read_b128 a[200:203], v237 offset:51200
    ds_read_b128 a[204:207], v237 offset:52224
    ds_read_b128 a[208:211], v237 offset:53248
    ds_read_b128 a[212:215], v237 offset:54272
    ds_read_b128 a[216:219], v237 offset:55296
    ds_read_b128 a[220:223], v237 offset:56320
    s_waitcnt lgkmcnt(0)
    ds_read_b128 a[224:227], v237 offset:57344
    ds_read_b128 a[228:231], v237 offset:58368
    ds_read_b128 a[232:235], v237 offset:59392
    ds_read_b128 a[236:239], v237 offset:60416
    ds_read_b128 a[240:243], v237 offset:61440
    ds_read_b128 a[244:247], v237 offset:62464
    ds_read_b128 a[248:251], v237 offset:63488
    ds_read_b128 a[252:255], v237 offset:64512
    s_waitcnt lgkmcnt(0)
    s_add_u32 s51, s51, 262144
    s_and_b32 s51, s51, 4194303
    s_add_u32 m0, s75, 147456
    s_nop 0
    buffer_load_dwordx4 v172, s[16:19], s51 offen lds
    buffer_load_dwordx4 v173, s[16:19], s51 offen offset:1024 lds
    buffer_load_dwordx4 v174, s[16:19], s51 offen offset:2048 lds
    buffer_load_dwordx4 v175, s[16:19], s51 offen offset:3072 lds
    s_add_u32 s51, s51, 262144
    s_and_b32 s51, s51, 4194303
    s_add_u32 m0, s75, 65536
    s_nop 0
    buffer_load_dwordx4 v172, s[16:19], s51 offen lds
    buffer_load_dwordx4 v173, s[16:19], s51 offen offset:1024 lds
    buffer_load_dwordx4 v174, s[16:19], s51 offen offset:2048 lds
    buffer_load_dwordx4 v175, s[16:19], s51 offen offset:3072 lds
    s_cmp_lg_u32 s81, 0
    s_cbranch_scc1 L_nopf
    s_load_dwordx4 s[36:39], s[0:1], 8
    s_lshl_b32 s76, s74, 2
    s_add_u32 s76, s76, s72
    s_lshl_b32 s77, s76, 15
    buffer_load_dwordx4 v[0:3], v237, s[16:19], s77 offen
    s_add_u32 s77, s77, 1024
    buffer_load_dwordx4 v[4:7], v237, s[16:19], s77 offen
    s_add_u32 s77, s77, 1024
    buffer_load_dwordx4 v[8:11], v237, s[16:19], s77 offen
    s_add_u32 s77, s77, 1024
    buffer_load_dwordx4 v[12:15], v237, s[16:19], s77 offen
    s_add_u32 s77, s77, 1024
    buffer_load_dwordx4 v[16:19], v237, s[16:19], s77 offen
    s_add_u32 s77, s77, 1024
    buffer_load_dwordx4 v[20:23], v237, s[16:19], s77 offen
    s_add_u32 s77, s77, 1024
    buffer_load_dwordx4 v[24:27], v237, s[16:19], s77 offen
    s_add_u32 s77, s77, 1024
    buffer_load_dwordx4 v[28:31], v237, s[16:19], s77 offen
    s_add_u32 s77, s77, 1024
    buffer_load_dwordx4 v[32:35], v237, s[16:19], s77 offen
    s_add_u32 s77, s77, 1024
    buffer_load_dwordx4 v[36:39], v237, s[16:19], s77 offen
    s_add_u32 s77, s77, 1024
    buffer_load_dwordx4 v[40:43], v237, s[16:19], s77 offen
    s_add_u32 s77, s77, 1024
    buffer_load_dwordx4 v[44:47], v237, s[16:19], s77 offen
    s_add_u32 s77, s77, 1024
    buffer_load_dwordx4 v[48:51], v237, s[16:19], s77 offen
    s_add_u32 s77, s77, 1024
    buffer_load_dwordx4 v[52:55], v237, s[16:19], s77 offen
    s_add_u32 s77, s77, 1024
    buffer_load_dwordx4 v[56:59], v237, s[16:19], s77 offen
    s_add_u32 s77, s77, 1024
    buffer_load_dwordx4 v[60:63], v237, s[16:19], s77 offen
    s_add_u32 s77, s77, 1024
    buffer_load_dwordx4 v[0:3], v237, s[16:19], s77 offen
    s_add_u32 s77, s77, 1024
    buffer_load_dwordx4 v[4:7], v237, s[16:19], s77 offen
    s_add_u32 s77, s77, 1024
    buffer_load_dwordx4 v[8:11], v237, s[16:19], s77 offen
    s_add_u32 s77, s77, 1024
    buffer_load_dwordx4 v[12:15], v237, s[16:19], s77 offen
    s_add_u32 s77, s77, 1024
    buffer_load_dwordx4 v[16:19], v237, s[16:19], s77 offen
    s_add_u32 s77, s77, 1024
    buffer_load_dwordx4 v[20:23], v237, s[16:19], s77 offen
    s_add_u32 s77, s77, 1024
    buffer_load_dwordx4 v[24:27], v237, s[16:19], s77 offen
    s_add_u32 s77, s77, 1024
    buffer_load_dwordx4 v[28:31], v237, s[16:19], s77 offen
    s_add_u32 s77, s77, 1024
    buffer_load_dwordx4 v[32:35], v237, s[16:19], s77 offen
    s_add_u32 s77, s77, 1024
    buffer_load_dwordx4 v[36:39], v237, s[16:19], s77 offen
    s_add_u32 s77, s77, 1024
    buffer_load_dwordx4 v[40:43], v237, s[16:19], s77 offen
    s_add_u32 s77, s77, 1024
    buffer_load_dwordx4 v[44:47], v237, s[16:19], s77 offen
    s_add_u32 s77, s77, 1024
    buffer_load_dwordx4 v[48:51], v237, s[16:19], s77 offen
    s_add_u32 s77, s77, 1024
    buffer_load_dwordx4 v[52:55], v237, s[16:19], s77 offen
    s_add_u32 s77, s77, 1024
    buffer_load_dwordx4 v[56:59], v237, s[16:19], s77 offen
    s_add_u32 s77, s77, 1024
    buffer_load_dwordx4 v[60:63], v237, s[16:19], s77 offen
    s_add_u32 s77, s77, 1024
    s_lshr_b32 s77, s76, 4
    s_lshl_b32 s77, s77, 19
    s_and_b32 s76, s76, 15
    s_lshl_b32 s76, s76, 12
    s_add_u32 s77, s77, s76
    v_add_u32 v228, s77, v237
    s_waitcnt lgkmcnt(0)
    global_load_dwordx4 v[64:67], v228, s[36:37] offset:0
    global_load_dwordx4 v[68:71], v228, s[36:37] offset:1024
    global_load_dwordx4 v[72:75], v228, s[36:37] offset:2048
    global_load_dwordx4 v[76:79], v228, s[36:37] offset:3072
    global_load_dwordx4 v[80:83], v228, s[38:39] offset:0
    global_load_dwordx4 v[84:87], v228, s[38:39] offset:1024
    global_load_dwordx4 v[88:91], v228, s[38:39] offset:2048
    global_load_dwordx4 v[92:95], v228, s[38:39] offset:3072
    s_mov_b32 s36, s88
    s_mov_b32 s37, s89
    s_mov_b32 s38, 2097152
    s_mov_b32 s39, 0x20000
L_nopf:
    s_waitcnt vmcnt(0)
    ds_read_b64_tr_b16 v[128:129], v160 offset:32768
    ds_read_b64_tr_b16 v[130:131], v160 offset:33280
    ds_read_b64_tr_b16 v[132:133], v161 offset:32768
    ds_read_b64_tr_b16 v[134:135], v161 offset:33280
    s_waitcnt lgkmcnt(0)
    s_branch L_Q
L_signal:
    v_mov_b32 v252, 1
    s_mov_b64 exec, 1
    buffer_atomic_add v252, off, s[44:47], s96 offset:4 sc1
    s_mov_b64 exec, -1
    s_branch L_signalled
L_spin_h:
    s_mov_b32 s91, 0
L_spin_h1:
    buffer_load_dword v252, off, s[44:47], s96 offset:4 sc1
    s_add_u32 s91, s91, 1
    s_waitcnt vmcnt(0)
    v_readfirstlane_b32 s76, v252
    s_nop 0
    s_cmp_ge_u32 s76, 8
    s_cbranch_scc1 L_h_ok
    s_cmp_lt_u32 s91, 131072
    s_cbranch_scc1 L_spin_h1
    s_branch L_h_ok
L_spin_s:
    buffer_load_dword v252, v232, s[40:43], s48 offen sc1
L_spin_s0:
    s_add_u32 s91, s91, 1
    s_sub_u32 s77, s49, 65536
    s_waitcnt vmcnt(0)
    v_cmp_eq_u32 vcc, 1, v252
    s_cmp_lt_u32 s91, 131072
    s_cselect_b32 s55, vcc_lo, -1
    s_andn2_b32 s55, s55, s52
    s_and_b32 s55, s55, 255
    s_cbranch_scc0 L_spin_s
    s_bitcmp1_b32 s55, 0
    s_cbranch_scc0 L_nl0
    buffer_load_dwordx4 v[0:3], v237, s[40:43], s77 offen offset:0 sc1
    buffer_load_dwordx4 v[4:7], v237, s[40:43], s77 offen offset:1024 sc1
L_nl0:
    s_add_u32 s77, s77, 8192
    s_bitcmp1_b32 s55, 1
    s_cbranch_scc0 L_nl1
    buffer_load_dwordx4 v[8:11], v237, s[40:43], s77 offen offset:0 sc1
    buffer_load_dwordx4 v[12:15], v237, s[40:43], s77 offen offset:1024 sc1
L_nl1:
    s_add_u32 s77, s77, 8192
    s_bitcmp1_b32 s55, 2
    s_cbranch_scc0 L_nl2
    buffer_load_dwordx4 v[16:19], v237, s[40:43], s77 offen offset:0 sc1
    buffer_load_dwordx4 v[20:23], v237, s[40:43], s77 offen offset:1024 sc1
L_nl2:
    s_add_u32 s77, s77, 8192
    s_bitcmp1_b32 s55, 3
    s_cbranch_scc0 L_nl3
    buffer_load_dwordx4 v[24:27], v237, s[40:43], s77 offen offset:0 sc1
    buffer_load_dwordx4 v[28:31], v237, s[40:43], s77 offen offset:1024 sc1
L_nl3:
    s_add_u32 s77, s77, 8192
    s_bitcmp1_b32 s55, 4
    s_cbranch_scc0 L_nl4
    buffer_load_dwordx4 v[32:35], v237, s[40:43], s77 offen offset:0 sc1
    buffer_load_dwordx4 v[36:39], v237, s[40:43], s77 offen offset:1024 sc1
L_nl4:
    s_add_u32 s77, s77, 8192
    s_bitcmp1_b32 s55, 5
    s_cbranch_scc0 L_nl5
    buffer_load_dwordx4 v[40:43], v237, s[40:43], s77 offen offset:0 sc1
    buffer_load_dwordx4 v[44:47], v237, s[40:43], s77 offen offset:1024 sc1
L_nl5:
    s_add_u32 s77, s77, 8192
    s_bitcmp1_b32 s55, 6
    s_cbranch_scc0 L_nl6
    buffer_load_dwordx4 v[48:51], v237, s[40:43], s77 offen offset:0 sc1
    buffer_load_dwordx4 v[52:55], v237, s[40:43], s77 offen offset:1024 sc1
L_nl6:
    s_add_u32 s77, s77, 8192
    s_bitcmp1_b32 s55, 7
    s_cbranch_scc0 L_nl7
    buffer_load_dwordx4 v[56:59], v237, s[40:43], s77 offen offset:0 sc1
    buffer_load_dwordx4 v[60:63], v237, s[40:43], s77 offen offset:1024 sc1
L_nl7:
    s_add_u32 s77, s77, 8192
    s_or_b32 s52, s52, s55
    s_cmp_lg_u32 s52, 255
    s_cbranch_scc1 L_spin_s
    s_waitcnt vmcnt(0)
    v_mfma_f32_16x16x32_bf16 v[96:99], a[74:77], v[0:3], 0
    v_mfma_f32_16x16x32_bf16 v[100:103], a[72:75], v[0:3], 0
    v_mfma_f32_16x16x32_bf16 v[104:107], a[74:77], v[4:7], 0
    v_mfma_f32_16x16x32_bf16 v[108:111], a[72:75], v[4:7], 0
    v_mfma_f32_16x16x32_bf16 v[96:99], a[74:77], v[8:11], v[96:99]
    v_mfma_f32_16x16x32_bf16 v[100:103], a[72:75], v[8:11], v[100:103]
    v_mfma_f32_16x16x32_bf16 v[104:107], a[74:77], v[12:15], v[104:107]
    v_mfma_f32_16x16x32_bf16 v[108:111], a[72:75], v[12:15], v[108:111]
    v_mfma_f32_16x16x32_bf16 v[96:99], a[74:77], v[16:19], v[96:99]
    v_mfma_f32_16x16x32_bf16 v[100:103], a[72:75], v[16:19], v[100:103]
    v_mfma_f32_16x16x32_bf16 v[104:107], a[74:77], v[20:23], v[104:107]
    v_mfma_f32_16x16x32_bf16 v[108:111], a[72:75], v[20:23], v[108:111]
    v_mfma_f32_16x16x32_bf16 v[96:99], a[74:77], v[24:27], v[96:99]
    v_mfma_f32_16x16x32_bf16 v[100:103], a[72:75], v[24:27], v[100:103]
    v_mfma_f32_16x16x32_bf16 v[104:107], a[74:77], v[28:31], v[104:107]
    v_mfma_f32_16x16x32_bf16 v[108:111], a[72:75], v[28:31], v[108:111]
    v_mfma_f32_16x16x32_bf16 v[96:99], a[74:77], v[32:35], v[96:99]
    v_mfma_f32_16x16x32_bf16 v[100:103], a[72:75], v[32:35], v[100:103]
    v_mfma_f32_16x16x32_bf16 v[104:107], a[74:77], v[36:39], v[104:107]
    v_mfma_f32_16x16x32_bf16 v[108:111], a[72:75], v[36:39], v[108:111]
    v_mfma_f32_16x16x32_bf16 v[96:99], a[74:77], v[40:43], v[96:99]
    v_mfma_f32_16x16x32_bf16 v[100:103], a[72:75], v[40:43], v[100:103]
    v_mfma_f32_16x16x32_bf16 v[104:107], a[74:77], v[44:47], v[104:107]
    v_mfma_f32_16x16x32_bf16 v[108:111], a[72:75], v[44:47], v[108:111]
    v_mfma_f32_16x16x32_bf16 v[96:99], a[74:77], v[48:51], v[96:99]
    v_mfma_f32_16x16x32_bf16 v[100:103], a[72:75], v[48:51], v[100:103]
    v_mfma_f32_16x16x32_bf16 v[104:107], a[74:77], v[52:55], v[104:107]
    v_mfma_f32_16x16x32_bf16 v[108:111], a[72:75], v[52:55], v[108:111]
    v_mfma_f32_16x16x32_bf16 v[96:99], a[74:77], v[56:59], v[96:99]
    v_mfma_f32_16x16x32_bf16 v[100:103], a[72:75], v[56:59], v[100:103]
    v_mfma_f32_16x16x32_bf16 v[104:107], a[74:77], v[60:63], v[104:107]
    v_mfma_f32_16x16x32_bf16 v[108:111], a[72:75], v[60:63], v[108:111]
    s_nop 7
    s_branch L_s_ok
L_slow:
    s_mov_b32 s81, 1
    s_waitcnt vmcnt(0) lgkmcnt(0)
    s_barrier
    s_branch L_restart
L_maxpass:
    v_cvt_pk_bf16_f32 v96, v96, v97
    v_cvt_pk_bf16_f32 v97, v98, v99
    v_cvt_pk_bf16_f32 v112, v112, v113
    v_cvt_pk_bf16_f32 v113, v114, v115
    v_cvt_pk_bf16_f32 v100, v100, v101
    v_cvt_pk_bf16_f32 v101, v102, v103
    v_cvt_pk_bf16_f32 v116, v116, v117
    v_cvt_pk_bf16_f32 v117, v118, v119
    v_cvt_pk_bf16_f32 v104, v104, v105
    v_cvt_pk_bf16_f32 v105, v106, v107
    v_cvt_pk_bf16_f32 v120, v120, v121
    v_cvt_pk_bf16_f32 v121, v122, v123
    v_cvt_pk_bf16_f32 v108, v108, v109
    v_cvt_pk_bf16_f32 v109, v110, v111
    v_cvt_pk_bf16_f32 v124, v124, v125
    v_cvt_pk_bf16_f32 v125, v126, v127
    v_permlane32_swap_b32 v96, v112
    v_permlane32_swap_b32 v97, v113
    v_permlane32_swap_b32 v100, v116
    v_permlane32_swap_b32 v101, v117
    v_permlane32_swap_b32 v104, v120
    v_permlane32_swap_b32 v105, v121
    v_permlane32_swap_b32 v108, v124
    v_permlane32_swap_b32 v109, v125
    v_permlane16_swap_b32 v96, v112
    v_permlane16_swap_b32 v97, v113
    v_permlane16_swap_b32 v100, v116
    v_permlane16_swap_b32 v101, v117
    v_permlane16_swap_b32 v104, v120
    v_permlane16_swap_b32 v105, v121
    v_permlane16_swap_b32 v108, v124
    v_permlane16_swap_b32 v109, v125
    v_accvgpr_write_b32 a48, v96
    v_accvgpr_write_b32 a49, v97
    v_accvgpr_write_b32 a50, v112
    v_accvgpr_write_b32 a51, v113
    v_accvgpr_write_b32 a52, v100
    v_accvgpr_write_b32 a53, v101
    v_accvgpr_write_b32 a54, v116
    v_accvgpr_write_b32 a55, v117
    v_accvgpr_write_b32 a56, v104
    v_accvgpr_write_b32 a57, v105
    v_accvgpr_write_b32 a58, v120
    v_accvgpr_write_b32 a59, v121
    v_accvgpr_write_b32 a60, v108
    v_accvgpr_write_b32 a61, v109
    v_accvgpr_write_b32 a62, v124
    v_accvgpr_write_b32 a63, v125
    v_mov_b32 v228, 0xff800000
    v_mov_b32 v229, 0xff800000
    v_mov_b32 v230, 0xff800000
    v_mov_b32 v231, 0xff800000
    s_mov_b32 s78, 0
    s_waitcnt vmcnt(0) lgkmcnt(0)
L_max1:
    s_barrier
    s_add_u32 m0, s75, 114688
    s_nop 0
    buffer_load_dwordx4 v224, s[8:11], s78 offen lds
    buffer_load_dwordx4 v224, s[8:11], s78 offen offset:1024 lds
    buffer_load_dwordx4 v225, s[8:11], s78 offen offset:2048 lds
    buffer_load_dwordx4 v225, s[8:11], s78 offen offset:3072 lds
    s_waitcnt vmcnt(0)
    s_barrier
    ds_read_b128 a[64:67], v212 offset:16384
    ds_read_b128 a[68:71], v213 offset:16384
    ds_read_b128 a[72:75], v214 offset:16384
    ds_read_b128 a[76:79], v215 offset:16384
    ds_read_b128 a[80:83], v212 offset:17408
    ds_read_b128 a[84:87], v213 offset:17408
    ds_read_b128 a[88:91], v214 offset:17408
    ds_read_b128 a[92:95], v215 offset:17408
    s_waitcnt lgkmcnt(0)
    v_mfma_f32_16x16x32_bf16 v[128:131], a[64:67], a[0:3], 0
    v_mfma_f32_16x16x32_bf16 v[128:131], a[68:71], a[16:19], v[128:131]
    v_mfma_f32_16x16x32_bf16 v[128:131], a[72:75], a[32:35], v[128:131]
    v_mfma_f32_16x16x32_bf16 v[128:131], a[76:79], a[48:51], v[128:131]
    v_mfma_f32_16x16x32_bf16 v[136:139], a[64:67], a[4:7], 0
    v_mfma_f32_16x16x32_bf16 v[136:139], a[68:71], a[20:23], v[136:139]
    v_mfma_f32_16x16x32_bf16 v[136:139], a[72:75], a[36:39], v[136:139]
    v_mfma_f32_16x16x32_bf16 v[136:139], a[76:79], a[52:55], v[136:139]
    v_mfma_f32_16x16x32_bf16 v[144:147], a[64:67], a[8:11], 0
    v_mfma_f32_16x16x32_bf16 v[144:147], a[68:71], a[24:27], v[144:147]
    v_mfma_f32_16x16x32_bf16 v[144:147], a[72:75], a[40:43], v[144:147]
    v_mfma_f32_16x16x32_bf16 v[144:147], a[76:79], a[56:59], v[144:147]
    v_mfma_f32_16x16x32_bf16 v[152:155], a[64:67], a[12:15], 0
    v_mfma_f32_16x16x32_bf16 v[152:155], a[68:71], a[28:31], v[152:155]
    v_mfma_f32_16x16x32_bf16 v[152:155], a[72:75], a[44:47], v[152:155]
    v_mfma_f32_16x16x32_bf16 v[152:155], a[76:79], a[60:63], v[152:155]
    v_mfma_f32_16x16x32_bf16 v[132:135], a[80:83], a[0:3], 0
    v_mfma_f32_16x16x32_bf16 v[132:135], a[84:87], a[16:19], v[132:135]
    v_mfma_f32_16x16x32_bf16 v[132:135], a[88:91], a[32:35], v[132:135]
    v_mfma_f32_16x16x32_bf16 v[132:135], a[92:95], a[48:51], v[132:135]
    v_mfma_f32_16x16x32_bf16 v[140:143], a[80:83], a[4:7], 0
    v_mfma_f32_16x16x32_bf16 v[140:143], a[84:87], a[20:23], v[140:143]
    v_mfma_f32_16x16x32_bf16 v[140:143], a[88:91], a[36:39], v[140:143]
    v_mfma_f32_16x16x32_bf16 v[140:143], a[92:95], a[52:55], v[140:143]
    v_mfma_f32_16x16x32_bf16 v[148:151], a[80:83], a[8:11], 0
    v_mfma_f32_16x16x32_bf16 v[148:151], a[84:87], a[24:27], v[148:151]
    v_mfma_f32_16x16x32_bf16 v[148:151], a[88:91], a[40:43], v[148:151]
    v_mfma_f32_16x16x32_bf16 v[148:151], a[92:95], a[56:59], v[148:151]
    v_mfma_f32_16x16x32_bf16 v[156:159], a[80:83], a[12:15], 0
    v_mfma_f32_16x16x32_bf16 v[156:159], a[84:87], a[28:31], v[156:159]
    v_mfma_f32_16x16x32_bf16 v[156:159], a[88:91], a[44:47], v[156:159]
    v_mfma_f32_16x16x32_bf16 v[156:159], a[92:95], a[60:63], v[156:159]
    s_nop 7
    v_max3_f32 v228, v228, v128, v129
    v_max3_f32 v228, v228, v130, v131
    v_max3_f32 v228, v228, v132, v133
    v_max3_f32 v228, v228, v134, v135
    v_max3_f32 v229, v229, v136, v137
    v_max3_f32 v229, v229, v138, v139
    v_max3_f32 v229, v229, v140, v141
    v_max3_f32 v229, v229, v142, v143
    v_max3_f32 v230, v230, v144, v145
    v_max3_f32 v230, v230, v146, v147
    v_max3_f32 v230, v230, v148, v149
    v_max3_f32 v230, v230, v150, v151
    v_max3_f32 v231, v231, v152, v153
    v_max3_f32 v231, v231, v154, v155
    v_max3_f32 v231, v231, v156, v157
    v_max3_f32 v231, v231, v158, v159
    ds_read_b128 a[64:67], v212 offset:24576
    ds_read_b128 a[68:71], v213 offset:24576
    ds_read_b128 a[72:75], v214 offset:24576
    ds_read_b128 a[76:79], v215 offset:24576
    ds_read_b128 a[80:83], v212 offset:25600
    ds_read_b128 a[84:87], v213 offset:25600
    ds_read_b128 a[88:91], v214 offset:25600
    ds_read_b128 a[92:95], v215 offset:25600
    s_waitcnt lgkmcnt(0)
    v_mfma_f32_16x16x32_bf16 v[160:163], a[64:67], a[0:3], 0
    v_mfma_f32_16x16x32_bf16 v[160:163], a[68:71], a[16:19], v[160:163]
    v_mfma_f32_16x16x32_bf16 v[160:163], a[72:75], a[32:35], v[160:163]
    v_mfma_f32_16x16x32_bf16 v[160:163], a[76:79], a[48:51], v[160:163]
    v_mfma_f32_16x16x32_bf16 v[168:171], a[64:67], a[4:7], 0
    v_mfma_f32_16x16x32_bf16 v[168:171], a[68:71], a[20:23], v[168:171]
    v_mfma_f32_16x16x32_bf16 v[168:171], a[72:75], a[36:39], v[168:171]
    v_mfma_f32_16x16x32_bf16 v[168:171], a[76:79], a[52:55], v[168:171]
    v_mfma_f32_16x16x32_bf16 v[176:179], a[64:67], a[8:11], 0
    v_mfma_f32_16x16x32_bf16 v[176:179], a[68:71], a[24:27], v[176:179]
    v_mfma_f32_16x16x32_bf16 v[176:179], a[72:75], a[40:43], v[176:179]
    v_mfma_f32_16x16x32_bf16 v[176:179], a[76:79], a[56:59], v[176:179]
    v_mfma_f32_16x16x32_bf16 v[184:187], a[64:67], a[12:15], 0
    v_mfma_f32_16x16x32_bf16 v[184:187], a[68:71], a[28:31], v[184:187]
    v_mfma_f32_16x16x32_bf16 v[184:187], a[72:75], a[44:47], v[184:187]
    v_mfma_f32_16x16x32_bf16 v[184:187], a[76:79], a[60:63], v[184:187]
    v_mfma_f32_16x16x32_bf16 v[164:167], a[80:83], a[0:3], 0
    v_mfma_f32_16x16x32_bf16 v[164:167], a[84:87], a[16:19], v[164:167]
    v_mfma_f32_16x16x32_bf16 v[164:167], a[88:91], a[32:35], v[164:167]
    v_mfma_f32_16x16x32_bf16 v[164:167], a[92:95], a[48:51], v[164:167]
    v_mfma_f32_16x16x32_bf16 v[172:175], a[80:83], a[4:7], 0
    v_mfma_f32_16x16x32_bf16 v[172:175], a[84:87], a[20:23], v[172:175]
    v_mfma_f32_16x16x32_bf16 v[172:175], a[88:91], a[36:39], v[172:175]
    v_mfma_f32_16x16x32_bf16 v[172:175], a[92:95], a[52:55], v[172:175]
    v_mfma_f32_16x16x32_bf16 v[180:183], a[80:83], a[8:11], 0
    v_mfma_f32_16x16x32_bf16 v[180:183], a[84:87], a[24:27], v[180:183]
    v_mfma_f32_16x16x32_bf16 v[180:183], a[88:91], a[40:43], v[180:183]
    v_mfma_f32_16x16x32_bf16 v[180:183], a[92:95], a[56:59], v[180:183]
    v_mfma_f32_16x16x32_bf16 v[188:191], a[80:83], a[12:15], 0
    v_mfma_f32_16x16x32_bf16 v[188:191], a[84:87], a[28:31], v[188:191]
    v_mfma_f32_16x16x32_bf16 v[188:191], a[88:91], a[44:47], v[188:191]
    v_mfma_f32_16x16x32_bf16 v[188:191], a[92:95], a[60:63], v[188:191]
    s_nop 7
    v_max3_f32 v228, v228, v160, v161
    v_max3_f32 v228, v228, v162, v163
    v_max3_f32 v228, v228, v164, v165
    v_max3_f32 v228, v228, v166, v167
    v_max3_f32 v229, v229, v168, v169
    v_max3_f32 v229, v229, v170, v171
    v_max3_f32 v229, v229, v172, v173
    v_max3_f32 v229, v229, v174, v175
    v_max3_f32 v230, v230, v176, v177
    v_max3_f32 v230, v230, v178, v179
    v_max3_f32 v230, v230, v180, v181
    v_max3_f32 v230, v230, v182, v183
    v_max3_f32 v231, v231, v184, v185
    v_max3_f32 v231, v231, v186, v187
    v_max3_f32 v231, v231, v188, v189
    v_max3_f32 v231, v231, v190, v191
    s_add_u32 s78, s78, 16384
    s_cmp_lt_u32 s78, 524288
    s_cbranch_scc1 L_max1
    v_mov_b32 v232, v228
    v_mov_b32 v233, v229
    v_mov_b32 v234, v230
    v_mov_b32 v235, v231
    s_nop 0
    v_permlane32_swap_b32 v232, v228
    v_permlane32_swap_b32 v233, v229
    v_permlane32_swap_b32 v234, v230
    v_permlane32_swap_b32 v235, v231
    v_max_f32 v228, v232, v228
    v_max_f32 v229, v233, v229
    v_max_f32 v230, v234, v230
    v_max_f32 v231, v235, v231
    v_mov_b32 v232, v228
    v_mov_b32 v233, v229
    v_mov_b32 v234, v230
    v_mov_b32 v235, v231
    s_nop 0
    v_permlane16_swap_b32 v232, v228
    v_permlane16_swap_b32 v233, v229
    v_permlane16_swap_b32 v234, v230
    v_permlane16_swap_b32 v235, v231
    v_max_f32 v228, v232, v228
    v_max_f32 v229, v233, v229
    v_max_f32 v230, v234, v230
    v_max_f32 v231, v235, v231
    ds_read_b128 a[64:67], v212 offset:32768
    ds_read_b128 a[68:71], v213 offset:32768
    ds_read_b128 a[72:75], v214 offset:32768
    ds_read_b128 a[76:79], v215 offset:32768
    ds_read_b128 a[80:83], v212 offset:33792
    ds_read_b128 a[84:87], v213 offset:33792
    ds_read_b128 a[88:91], v214 offset:33792
    ds_read_b128 a[92:95], v215 offset:33792
    s_waitcnt lgkmcnt(0)
    v_mfma_f32_16x16x32_bf16 v[128:131], a[64:67], a[0:3], 0
    v_mfma_f32_16x16x32_bf16 v[128:131], a[68:71], a[16:19], v[128:131]
    v_mfma_f32_16x16x32_bf16 v[128:131], a[72:75], a[32:35], v[128:131]
    v_mfma_f32_16x16x32_bf16 v[128:131], a[76:79], a[48:51], v[128:131]
    v_mfma_f32_16x16x32_bf16 v[136:139], a[64:67], a[4:7], 0
    v_mfma_f32_16x16x32_bf16 v[136:139], a[68:71], a[20:23], v[136:139]
    v_mfma_f32_16x16x32_bf16 v[136:139], a[72:75], a[36:39], v[136:139]
    v_mfma_f32_16x16x32_bf16 v[136:139], a[76:79], a[52:55], v[136:139]
    v_mfma_f32_16x16x32_bf16 v[144:147], a[64:67], a[8:11], 0
    v_mfma_f32_16x16x32_bf16 v[144:147], a[68:71], a[24:27], v[144:147]
    v_mfma_f32_16x16x32_bf16 v[144:147], a[72:75], a[40:43], v[144:147]
    v_mfma_f32_16x16x32_bf16 v[144:147], a[76:79], a[56:59], v[144:147]
    v_mfma_f32_16x16x32_bf16 v[152:155], a[64:67], a[12:15], 0
    v_mfma_f32_16x16x32_bf16 v[152:155], a[68:71], a[28:31], v[152:155]
    v_mfma_f32_16x16x32_bf16 v[152:155], a[72:75], a[44:47], v[152:155]
    v_mfma_f32_16x16x32_bf16 v[152:155], a[76:79], a[60:63], v[152:155]
    v_mfma_f32_16x16x32_bf16 v[132:135], a[80:83], a[0:3], 0
    v_mfma_f32_16x16x32_bf16 v[132:135], a[84:87], a[16:19], v[132:135]
    v_mfma_f32_16x16x32_bf16 v[132:135], a[88:91], a[32:35], v[132:135]
    v_mfma_f32_16x16x32_bf16 v[132:135], a[92:95], a[48:51], v[132:135]
    v_mfma_f32_16x16x32_bf16 v[140:143], a[80:83], a[4:7], 0
    v_mfma_f32_16x16x32_bf16 v[140:143], a[84:87], a[20:23], v[140:143]
    v_mfma_f32_16x16x32_bf16 v[140:143], a[88:91], a[36:39], v[140:143]
    v_mfma_f32_16x16x32_bf16 v[140:143], a[92:95], a[52:55], v[140:143]
    v_mfma_f32_16x16x32_bf16 v[148:151], a[80:83], a[8:11], 0
    v_mfma_f32_16x16x32_bf16 v[148:151], a[84:87], a[24:27], v[148:151]
    v_mfma_f32_16x16x32_bf16 v[148:151], a[88:91], a[40:43], v[148:151]
    v_mfma_f32_16x16x32_bf16 v[148:151], a[92:95], a[56:59], v[148:151]
    v_mfma_f32_16x16x32_bf16 v[156:159], a[80:83], a[12:15], 0
    v_mfma_f32_16x16x32_bf16 v[156:159], a[84:87], a[28:31], v[156:159]
    v_mfma_f32_16x16x32_bf16 v[156:159], a[88:91], a[44:47], v[156:159]
    v_mfma_f32_16x16x32_bf16 v[156:159], a[92:95], a[60:63], v[156:159]
    s_nop 7
    ds_read_b128 a[64:67], v212 offset:40960
    ds_read_b128 a[68:71], v213 offset:40960
    ds_read_b128 a[72:75], v214 offset:40960
    ds_read_b128 a[76:79], v215 offset:40960
    ds_read_b128 a[80:83], v212 offset:41984
    s_waitcnt lgkmcnt(0)
    s_branch L_havemax
L_end:
    s_endpgm
.section .rodata,"a"
.p2align 6
.amdhsa_kernel recurrent_scan__gqa_block_cached__glu_gated_bilinear__prompt_kernel
  .amdhsa_next_free_vgpr 512
  .amdhsa_next_free_sgpr 102
  .amdhsa_accum_offset 256
  .amdhsa_group_segment_fixed_size 0
  .amdhsa_kernarg_size 96
  .amdhsa_user_sgpr_count 2
  .amdhsa_user_sgpr_kernarg_segment_ptr 1
  .amdhsa_system_sgpr_workgroup_id_x 1
.end_amdhsa_kernel
```
